```python
import torch

def _softmax(x, axis=-1):
    return torch.softmax(x, dim=axis)
def _gelu(x):
    return torch.nn.functional.gelu(x, approximate="tanh")
def _silu(x):
    return torch.nn.functional.silu(x)
def _sigmoid(x):
    return torch.sigmoid(x)
def _layernorm(x, axis=-1, eps=1e-5):
    m = x.mean(dim=axis, keepdim=True)
    v = x.var(dim=axis, keepdim=True, unbiased=False)
    return (x - m) / torch.sqrt(v + eps)
def _scatter_add(tgt, idx, src, axis=0):
    return tgt.clone().index_add_(axis, idx, src)
def _segment_sum(src, seg, n):
    out = torch.zeros((n,) + src.shape[1:], dtype=src.dtype)
    return out.index_add_(0, seg, src)
def _pad(x, pw):
    flat = tuple(v for pair in reversed(pw) for v in pair)
    return torch.nn.functional.pad(x, flat)

kernel_name = 'interleave_layers__linear_attn_block__dense_activation_relu__prompt'

def setup_inputs():

    _w = (lambda a: (lambda t: t.to(torch.bfloat16) if t.is_floating_point() else t)(torch.as_tensor(a)))
    def _A_setup():
        B, S, D = 1, 2048, 512
        return {
            "x": _w((lambda *s: torch.randn(*s, dtype=torch.bfloat16) * 0.05)(B, S, D)),
            "wqkv": _w((lambda *s: torch.randn(*s, dtype=torch.bfloat16) * 0.1)(D, 3 * D)),
            "wo": _w((lambda *s: torch.randn(*s, dtype=torch.bfloat16) * 0.05)(D, D)),
        }
    _A_in = _A_setup()

    def _B_setup():
        B, S, D, Dff = 1, 2048, 512, 1376
        return {
            "x": _w((lambda *s: torch.randn(*s, dtype=torch.bfloat16) * 0.05)(B, S, D)),
            "w1": _w((lambda *s: torch.randn(*s, dtype=torch.bfloat16) * 0.05)(D, Dff)),
            "w2": _w((lambda *s: torch.randn(*s, dtype=torch.bfloat16) * 0.05)(Dff, D)),
        }
    _B_in = _B_setup()

    return {
        "A_x": _A_in["x"],
        "A_wqkv": _A_in["wqkv"],
        "A_wo": _A_in["wo"],
        "B_x": _B_in["x"],
        "B_w1": _B_in["w1"],
        "B_w2": _B_in["w2"],
    }

def reference(A_x, A_wqkv, A_wo, B_x, B_w1, B_w2):
    def _A_ref(x, wqkv, wo):
        B, S, D = x.shape
        H = 32; Dh = D // H
        qkv = (lambda x, *d: x.permute(*d))((x @ wqkv).reshape(B, S, 3, H, Dh), 2, 0, 3, 1, 4)
        q, k, v = qkv[0], qkv[1], qkv[2]
        phi = lambda t: torch.where(t > 0, t + 1, torch.exp(t)) + 1e-6
        pq, pk = phi(q), phi(k)
        kv = torch.einsum("bhsd,bhse->bhde", pk, v)
        z = torch.einsum("bhsd->bhd", pk)
        num = torch.einsum("bhqd,bhde->bhqe", pq, kv)
        den = torch.einsum("bhqd,bhd->bhq", pq, z)[..., None] + 1e-6
        o = num / den
        return (lambda x, *d: x.permute(*d))(o, 0, 2, 1, 3).reshape(B, S, D) @ wo

    def _B_ref(x, w1, w2):
        h = torch.einsum("bsd,df->bsf", x, w1)
        zero = torch.zeros_like(h)
        h = torch.maximum(h, zero)
        return torch.einsum("bsf,fd->bsd", h, w2)

    x = A_x
    x = x + _A_ref(_layernorm(x, axis=-1), A_wqkv, A_wo)
    x = x + _B_ref(_layernorm(x, axis=-1), B_w1, B_w2)
    x = x + _A_ref(_layernorm(x, axis=-1), A_wqkv, A_wo)
    x = x + _B_ref(_layernorm(x, axis=-1), B_w1, B_w2)
    return x
```

```asm
; @launch grid=(256,1,1) block=(256,1,1) lds=163840
.amdgcn_target "amdgcn-amd-amdhsa--gfx950"
.text
.globl interleave_layers__linear_attn_block__dense_activation_relu__prompt_kernel
.p2align 8
.type interleave_layers__linear_attn_block__dense_activation_relu__prompt_kernel,@function
interleave_layers__linear_attn_block__dense_activation_relu__prompt_kernel:
 s_cmp_ge_u32 s2,256
 s_cbranch_scc1 L_end
 s_load_dwordx4 s[36:39],s[0:1],0
 s_load_dwordx2 s[40:41],s[0:1],16
 s_load_dwordx4 s[44:47],s[0:1],32
 s_load_dwordx2 s[48:49],s[0:1],48
 s_load_dwordx2 s[50:51],s[0:1],64
 v_mov_b32 v18,v0
 v_lshrrev_b32 v24,6,v0
 v_and_b32 v0,63,v0
 v_readfirstlane_b32 s4,v24
 s_and_b32 s5,s2,7
 s_lshl_b32 s5,s5,1
 s_lshr_b32 s52,s2,7
 s_add_u32 s5,s5,s52
 s_lshr_b32 s6,s2,3
 s_and_b32 s6,s6,15
 s_lshl_b32 s54,s4,10
 s_lshl_b32 s77,s5,17
 s_lshl_b32 s61,s6,6
 s_and_b32 s95,s5,1
 s_lshl_b32 s95,s95,1
 s_and_b32 s52,s6,1
 s_add_u32 s95,s95,s52
 s_lshl_b32 s95,s95,1
 s_lshr_b32 s52,s6,1
 s_add_u32 s95,s95,s52
 s_add_u32 s95,s95,s2
 v_lshlrev_b32 v1,4,v0
 v_lshrrev_b32 v27,3,v0
 v_and_b32 v28,7,v0
 v_lshrrev_b32 v29,1,v27
 v_xor_b32 v28,v28,v29
 v_lshlrev_b32 v28,4,v28
 s_lshl_b32 s52,s4,5
 v_add_u32 v27,s52,v27
 v_lshlrev_b32 v27,10,v27
 v_add_u32 v25,v27,v28
 v_xor_b32 v26,64,v25
 v_lshrrev_b32 v27,2,v0
 s_lshl_b32 s52,s4,4
 v_add_u32 v27,s52,v27
 v_and_b32 v28,3,v0
 v_lshlrev_b32 v28,4,v28
 v_mul_u32_u24 v7,3072,v27
 v_add_u32 v7,v7,v28
 v_mul_u32_u24 v8,2752,v27
 v_add_u32 v8,v8,v28
 s_waitcnt lgkmcnt(0)
 s_mov_b32 s8,s36
 s_mov_b32 s9,s37
 s_mov_b32 s10,2097152
 s_mov_b32 s11,0x00020000
 s_mov_b32 s32,s50
 s_mov_b32 s33,s51
 s_mov_b32 s34,67108864
 s_mov_b32 s35,0x00020000
 s_mov_b32 s12,s38
 s_mov_b32 s13,s39
 s_mov_b32 s14,1572864
 s_mov_b32 s15,0x00020000
 s_bitcmp1_b32 s6,0
 s_cbranch_scc1 Lo_1
 s_add_u32 s96,s95,0
 s_and_b32 s96,s96,7
 s_mul_i32 s96,s96,128
 s_add_u32 s96,s96,s77
 s_mov_b32 s99,s96
 s_add_u32 m0,s54,98304
 s_add_u32 s52,s99,0
 buffer_load_dwordx4 v25,s[8:11],s52 offen lds
 s_add_u32 m0,s54,102400
 s_add_u32 s52,s99,8192
 buffer_load_dwordx4 v26,s[8:11],s52 offen lds
 s_add_u32 m0,s54,106496
 s_add_u32 s52,s99,16384
 buffer_load_dwordx4 v25,s[8:11],s52 offen lds
 s_add_u32 m0,s54,110592
 s_add_u32 s52,s99,24576
 buffer_load_dwordx4 v26,s[8:11],s52 offen lds
 s_add_u32 s96,s95,0
 s_and_b32 s96,s96,7
 s_mul_i32 s96,s96,196608
 s_add_u32 s96,s96,s61
 s_mov_b32 s84,s96
 s_add_u32 m0,s54,0
 s_add_u32 s52,s84,1024
 buffer_load_dwordx4 v7,s[12:15],s52 offen lds
 s_add_u32 m0,s54,32768
 s_add_u32 s52,s84,2048
 buffer_load_dwordx4 v7,s[12:15],s52 offen lds
 s_branch Lo_2
Lo_1:
 s_add_u32 s96,s95,0
 s_and_b32 s96,s96,7
 s_mul_i32 s96,s96,196608
 s_add_u32 s96,s96,s61
 s_mov_b32 s84,s96
 s_add_u32 m0,s54,0
 s_add_u32 s52,s84,1024
 buffer_load_dwordx4 v7,s[12:15],s52 offen lds
 s_add_u32 m0,s54,32768
 s_add_u32 s52,s84,2048
 buffer_load_dwordx4 v7,s[12:15],s52 offen lds
 s_add_u32 s96,s95,0
 s_and_b32 s96,s96,7
 s_mul_i32 s96,s96,128
 s_add_u32 s96,s96,s77
 s_mov_b32 s99,s96
 s_add_u32 m0,s54,98304
 s_add_u32 s52,s99,0
 buffer_load_dwordx4 v25,s[8:11],s52 offen lds
 s_add_u32 m0,s54,102400
 s_add_u32 s52,s99,8192
 buffer_load_dwordx4 v26,s[8:11],s52 offen lds
 s_add_u32 m0,s54,106496
 s_add_u32 s52,s99,16384
 buffer_load_dwordx4 v25,s[8:11],s52 offen lds
 s_add_u32 m0,s54,110592
 s_add_u32 s52,s99,24576
 buffer_load_dwordx4 v26,s[8:11],s52 offen lds
Lo_2:
 buffer_load_dword v24,off,s[32:35],0 sc1
 s_add_u32 s96,s95,1
 s_and_b32 s96,s96,7
 s_mul_i32 s96,s96,128
 s_add_u32 s96,s96,s77
 s_mov_b32 s99,s96
 s_add_u32 m0,s54,114688
 s_add_u32 s52,s99,0
 buffer_load_dwordx4 v25,s[8:11],s52 offen lds
 s_add_u32 m0,s54,118784
 s_add_u32 s52,s99,8192
 buffer_load_dwordx4 v26,s[8:11],s52 offen lds
 s_add_u32 m0,s54,122880
 s_add_u32 s52,s99,16384
 buffer_load_dwordx4 v25,s[8:11],s52 offen lds
 s_getpc_b64 s[42:43]
L_pcx:
 s_lshr_b32 s52,s2,3
 s_lshl_b32 s52,s52,2
 s_add_u32 s52,s52,s4
 s_lshl_b32 s52,s52,10
 s_min_u32 s52,s52,L_slow-L_pcx-1024
 v_add_u32 v30,s52,v1
 global_load_dwordx4 a[96:99],v30,s[42:43]
 s_mov_b32 s16,s40
 s_mov_b32 s17,s41
 s_mov_b32 s18,524288
 s_mov_b32 s19,0x00020000
 s_mov_b32 s20,s44
 s_mov_b32 s21,s45
 s_mov_b32 s22,1409024
 s_mov_b32 s23,0x00020000
 s_mov_b32 s24,s46
 s_mov_b32 s25,s47
 s_mov_b32 s26,1409024
 s_mov_b32 s27,0x00020000
 s_mov_b32 s28,s48
 s_mov_b32 s29,s49
 s_mov_b32 s30,2097152
 s_mov_b32 s31,0x00020000
 s_mov_b32 s55,200000
 s_mul_i32 s57,s5,352256
 s_add_u32 s57,s57,6291456
 s_lshl_b32 s58,s5,13
 s_add_u32 s58,s58,1507328
 s_lshl_b32 s60,s5,7
 s_lshl_b32 s98,s5,8
 s_lshl_b32 s97,s6,2
 s_add_u32 s97,s97,s4
 s_lshl_b32 s97,s97,2
 s_add_u32 s97,s97,s98
 s_add_u32 s97,s97,4096
 s_mul_i32 s52,s6,3
 s_lshl_b32 s53,s6,1
 s_add_u32 s53,s53,11
 s_cmp_lt_u32 s6,11
 s_cselect_b32 s52,s52,s53
 s_cselect_b32 s53,128,64
 s_lshl_b32 s62,s52,6
 s_add_u32 s63,s62,s53
 s_lshl_b32 s64,s52,11
 s_add_u32 s64,s64,s57
 s_mul_i32 s52,s4,88064
 s_add_u32 s64,s64,s52
 s_and_b32 s66,s6,7
 s_lshl_b32 s66,s66,7
 s_lshr_b32 s52,s6,3
 s_lshl_b32 s53,s52,16
 s_add_u32 s53,s53,s77
 s_add_u32 s80,s53,s66
 s_add_u32 s71,s53,s54
 s_add_u32 s71,s71,4194304
 s_lshl_b32 s67,s66,5
 s_add_u32 s67,s67,s53
 s_add_u32 s67,s67,2097152
 s_mul_i32 s68,s52,176128
 s_add_u32 s68,s68,s57
 s_add_u32 s68,s68,s54
 s_lshl_b32 s69,s52,12
 s_add_u32 s69,s69,s58
 s_lshr_b32 s52,s4,1
 s_and_b32 s53,s4,1
 s_lshl_b32 s53,s53,8
 s_lshl_b32 s96,s52,15
 s_add_u32 s67,s67,s96
 s_add_u32 s67,s67,s53
 s_lshl_b32 s96,s52,11
 s_add_u32 s72,s69,s96
 s_add_u32 s72,s72,s53
 s_and_b32 s52,s6,4
 s_lshl_b32 s52,s52,7
 s_and_b32 s53,s6,3
 s_lshl_b32 s53,s53,2
 s_add_u32 s79,s52,s53
 s_add_u32 s79,s79,s72
 s_lshl_b32 s52,s4,15
 s_add_u32 s52,s52,s77
 s_add_u32 s56,s52,2097152
 s_lshl_b32 s94,s6,11
 s_add_u32 s94,s94,s52
 s_add_u32 s94,s94,4194304
 s_mov_b32 s92,-1
 s_mov_b32 s93,0
 s_cmp_ge_u32 s4,2
 s_cselect_b32 s70,20,21
 s_lshl_b32 s70,s70,12
 s_lshr_b32 s52,s6,3
 s_and_b32 s53,s5,1
 s_lshl_b32 s53,s53,1
 s_add_u32 s52,s52,s53
 s_and_b32 s53,s2,7
 s_lshl_b32 s59,s52,1
 s_add_u32 s59,s59,s53
 s_mul_i32 s78,s6,40960
 s_add_u32 s78,s78,65536
 s_mov_b32 s88,0x35c1a2a0
 s_mov_b32 s90,0x3f317218
 s_mov_b32 s89,s88
 s_mov_b32 s91,s90
 s_mov_b32 s73,0x3fb8aa3b
 s_mov_b32 s74,0x3b000000
 s_mov_b32 s75,0x3727c5ac
 s_mov_b32 s76,0x358637bd
 s_mov_b32 s85,0xffffff00
 v_lshrrev_b32 v17,5,v0
 v_lshrrev_b32 v27,4,v0
 v_lshlrev_b32 v27,9,v27
 v_and_b32 v28,15,v0
 v_lshl_add_u32 v3,v28,4,v27
 v_bfe_u32 v27,v0,2,2
 v_lshl_add_u32 v27,v17,2,v27
 v_bfe_u32 v28,v0,4,1
 v_lshlrev_b32 v28,5,v28
 v_and_b32 v29,3,v0
 v_lshl_add_u32 v28,v29,3,v28
 v_lshl_add_u32 v4,v27,6,v28
 v_lshl_add_u32 v4,v17,8,v4
 v_add_u32 v5,0x10000,v4
 v_add_u32 v6,0x20000,v4
 v_bfe_u32 v29,v0,3,1
 v_lshl_add_u32 v28,v29,6,v28
 v_lshl_add_u32 v10,v27,7,v28
 v_add_u32 v10,s54,v10
 v_xor_b32 v11,64,v10
 v_lshrrev_b32 v27,3,v0
 v_and_b32 v28,7,v0
 v_bfe_u32 v29,v0,4,1
 v_lshlrev_b32 v29,2,v29
 v_xor_b32 v28,v28,v29
 v_lshlrev_b32 v28,4,v28
 v_lshl_add_u32 v9,v27,10,v28
 s_lshl_b32 s52,s4,14
 v_add_u32 v9,s52,v9
 v_lshl_add_u32 v27,v17,9,v1
 s_lshl_b32 s52,s4,11
 v_add_u32 v13,s52,v27
 v_and_b32 v15,15,v0
 v_lshlrev_b32 v15,2,v15
 v_and_b32 v27,7,v0
 v_lshlrev_b32 v27,7,v27
 v_bfe_u32 v28,v0,3,2
 v_lshl_add_u32 v27,v28,12,v27
 s_add_u32 s52,s54,98304
 v_add_u32 v27,s52,v27
 v_bfe_u32 v28,v0,1,3
 v_xor_b32 v28,v28,v17
 v_xor_b32 v29,0,v28
 v_lshl_add_u32 v56,v29,4,v27
 v_xor_b32 v29,2,v28
 v_lshl_add_u32 v57,v29,4,v27
 v_xor_b32 v29,4,v28
 v_lshl_add_u32 v58,v29,4,v27
 v_xor_b32 v29,6,v28
 v_lshl_add_u32 v59,v29,4,v27
 v_add_u32 v60,s54,v4
 v_add_u32 v61,s54,v5
 v_add_u32 v62,s54,v6
 v_mov_b32 v64,0x3f803f80
 v_mov_b32 v65,0x3f803f80
 v_mov_b32 v66,0x3f803f80
 v_mov_b32 v67,0x3f803f80
 v_and_b32 v29,1,v0
 v_cmp_ne_u32 s[36:37],0,v29
 v_and_b32 v29,2,v0
 v_cmp_ne_u32 s[38:39],0,v29
 v_and_b32 v29,8,v0
 v_cmp_ne_u32 s[40:41],0,v29
 v_and_b32 v29,16,v0
 v_cmp_ne_u32 s[44:45],0,v29
 v_bfe_u32 v29,v0,2,1
 v_cmp_eq_u32 s[46:47],v29,v17
 s_lshr_b32 s52,s5,3
 s_cmp_eq_u32 s52,s4
 s_cselect_b32 s49,1,0
 s_lshl_b32 s50,s5,7
 s_mul_i32 s51,s52,544
 s_and_b32 s53,s5,7
 s_lshl_b32 s53,s53,6
 s_add_u32 s51,s51,s53
 s_mov_b32 s3,s90
 s_cmp_lg_u32 s4,2
 s_cbranch_scc1 Lz_3
 s_cmp_eq_u32 s5,s6
 s_cselect_b32 s49,1,0
 s_mov_b32 s50,2048
 s_mov_b32 s51,512
 s_mov_b32 s3,1.0
Lz_3:
 s_sub_u32 s65,s5,s6
 s_sub_u32 s65,s65,1
 s_and_b32 s65,s65,15
 s_cmp_eq_u32 s4,3
 s_cselect_b32 s65,s65,15
 s_mul_i32 s53,s6,1088
 s_add_u32 s51,s51,s53
 s_add_u32 s51,s51,1376256
 s_add_u32 s50,s50,s78
 s_and_b32 s53,s5,7
 s_lshl_b32 s53,s53,3
 s_mov_b64 s[100:101],0xff
 s_lshl_b64 s[100:101],s[100:101],s53
 s_not_b64 s[100:101],s[100:101]
 s_cmp_eq_u32 s52,0
 s_cselect_b64 s[0:1],-1,s[100:101]
 s_cselect_b64 s[100:101],s[100:101],-1
 s_add_u32 m0,s54,126976
 s_add_u32 s52,s99,24576
 buffer_load_dwordx4 v26,s[8:11],s52 offen lds
 s_add_u32 s96,s95,1
 s_and_b32 s96,s96,7
 s_mul_i32 s96,s96,196608
 s_add_u32 s96,s96,s61
 s_mov_b32 s84,s96
 s_add_u32 m0,s54,4096
 s_add_u32 s52,s84,1024
 buffer_load_dwordx4 v7,s[12:15],s52 offen lds
 s_add_u32 m0,s54,36864
 s_add_u32 s52,s84,2048
 buffer_load_dwordx4 v7,s[12:15],s52 offen lds
 s_waitcnt vmcnt(8)
 ds_read_b128 v[136:139],v56 offset:0
 ds_read_b128 v[140:143],v57 offset:0
 ds_read_b128 v[144:147],v58 offset:0
 ds_read_b128 v[148:151],v59 offset:0
 ds_read_b64_tr_b16 v[68:69],v60 offset:0
 ds_read_b64_tr_b16 v[70:71],v60 offset:256
 ds_read_b64_tr_b16 v[72:73],v60 offset:32768
 ds_read_b64_tr_b16 v[74:75],v60 offset:33024
 s_barrier
 ds_read_b64_tr_b16 v[40:41],v4 offset:0
 ds_read_b64_tr_b16 v[42:43],v4 offset:256
 ds_read_b64_tr_b16 v[44:45],v4 offset:32768
 ds_read_b64_tr_b16 v[46:47],v4 offset:33024
 ds_read_b64_tr_b16 v[48:49],v4 offset:1024
 ds_read_b64_tr_b16 v[50:51],v4 offset:1280
 ds_read_b64_tr_b16 v[52:53],v4 offset:33792
 ds_read_b64_tr_b16 v[54:55],v4 offset:34048
 s_waitcnt lgkmcnt(10)
 v_mfma_f32_32x32x16_bf16 a[32:47],v[64:67],v[68:71],0
 s_add_u32 s96,s95,2
 s_and_b32 s96,s96,7
 s_mul_i32 s96,s96,128
 s_add_u32 s96,s96,s77
 s_mov_b32 s99,s96
 s_add_u32 m0,s54,131072
 s_add_u32 s52,s99,0
 buffer_load_dwordx4 v25,s[8:11],s52 offen lds
 s_waitcnt lgkmcnt(8)
 v_mfma_f32_32x32x16_bf16 a[48:63],v[64:67],v[72:75],0
 v_mfma_f32_32x32x16_bf16 a[0:15],v[64:67],v[136:139],0
 s_add_u32 m0,s54,135168
 s_add_u32 s52,s99,8192
 buffer_load_dwordx4 v26,s[8:11],s52 offen lds
 v_mfma_f32_32x32x16_bf16 v[120:135],v[136:139],v[136:139],0
 v_mfma_f32_32x32x16_bf16 a[0:15],v[64:67],v[140:143],a[0:15]
 s_add_u32 m0,s54,139264
 s_add_u32 s52,s99,16384
 buffer_load_dwordx4 v25,s[8:11],s52 offen lds
 v_mfma_f32_32x32x16_bf16 v[120:135],v[140:143],v[140:143],v[120:135]
 v_mfma_f32_32x32x16_bf16 a[0:15],v[64:67],v[144:147],a[0:15]
 s_add_u32 m0,s54,143360
 s_add_u32 s52,s99,24576
 buffer_load_dwordx4 v26,s[8:11],s52 offen lds
 v_mfma_f32_32x32x16_bf16 v[120:135],v[144:147],v[144:147],v[120:135]
 v_mfma_f32_32x32x16_bf16 a[0:15],v[64:67],v[148:151],a[0:15]
 s_add_u32 s96,s95,2
 s_and_b32 s96,s96,7
 s_mul_i32 s96,s96,196608
 s_add_u32 s96,s96,s61
 s_mov_b32 s84,s96
 s_add_u32 m0,s54,8192
 s_add_u32 s52,s84,1024
 buffer_load_dwordx4 v7,s[12:15],s52 offen lds
 v_mfma_f32_32x32x16_bf16 v[120:135],v[148:151],v[148:151],v[120:135]
 s_waitcnt lgkmcnt(6)
 v_mfma_f32_32x32x16_bf16 v[88:103],v[136:139],v[40:43],0
 ds_read_b64_tr_b16 v[40:41],v4 offset:2048
 ds_read_b64_tr_b16 v[42:43],v4 offset:2304
 s_add_u32 m0,s54,40960
 s_add_u32 s52,s84,2048
 buffer_load_dwordx4 v7,s[12:15],s52 offen lds
 s_waitcnt lgkmcnt(6)
 v_mfma_f32_32x32x16_bf16 v[104:119],v[136:139],v[44:47],0
 ds_read_b64_tr_b16 v[44:45],v4 offset:34816
 ds_read_b64_tr_b16 v[46:47],v4 offset:35072
 s_waitcnt lgkmcnt(6)
 v_mfma_f32_32x32x16_bf16 v[88:103],v[140:143],v[48:51],v[88:103]
 ds_read_b64_tr_b16 v[48:49],v4 offset:3072
 ds_read_b64_tr_b16 v[50:51],v4 offset:3328
 s_waitcnt vmcnt(13)
 v_readfirstlane_b32 s7,v24
 s_nop 0
 s_add_u32 s7,s7,0x9e3779b1
 s_getreg_b32 s81,hwreg(HW_REG_XCC_ID)
 s_and_b32 s81,s81,15
 s_add_u32 s81,s81,s7
 s_add_u32 s81,s81,1
 s_cmp_lg_u32 s4,0
 s_cbranch_scc1 Lw_4
 s_mov_b64 s[82:83],exec
 s_mov_b64 exec,1
 v_mov_b32 v24,s81
 s_lshl_b32 s53,s6,2
 s_add_u32 s53,s53,s60
 s_add_u32 s53,s53,1024
 buffer_store_dword v24,off,s[32:35],s53 sc1
 s_mov_b64 exec,s[82:83]
Lw_4:
 s_waitcnt lgkmcnt(6)
 v_mfma_f32_32x32x16_bf16 v[104:119],v[140:143],v[52:55],v[104:119]
 ds_read_b64_tr_b16 v[52:53],v4 offset:35840
 ds_read_b64_tr_b16 v[54:55],v4 offset:36096
 s_waitcnt lgkmcnt(6)
 v_mfma_f32_32x32x16_bf16 v[88:103],v[144:147],v[40:43],v[88:103]
 s_waitcnt lgkmcnt(4)
 v_mfma_f32_32x32x16_bf16 v[104:119],v[144:147],v[44:47],v[104:119]
 s_waitcnt vmcnt(6)
 ds_read_b128 v[152:155],v56 offset:16384
 ds_read_b128 v[156:159],v57 offset:16384
 ds_read_b128 v[160:163],v58 offset:16384
 ds_read_b128 v[164:167],v59 offset:16384
 ds_read_b64_tr_b16 v[68:69],v60 offset:4096
 ds_read_b64_tr_b16 v[70:71],v60 offset:4352
 ds_read_b64_tr_b16 v[72:73],v60 offset:36864
 ds_read_b64_tr_b16 v[74:75],v60 offset:37120
 s_waitcnt lgkmcnt(10)
 v_mfma_f32_32x32x16_bf16 v[88:103],v[148:151],v[48:51],v[88:103]
 s_waitcnt lgkmcnt(8)
 v_mfma_f32_32x32x16_bf16 v[104:119],v[148:151],v[52:55],v[104:119]
 s_barrier
 ds_read_b64_tr_b16 v[40:41],v4 offset:4096
 ds_read_b64_tr_b16 v[42:43],v4 offset:4352
 ds_read_b64_tr_b16 v[44:45],v4 offset:36864
 ds_read_b64_tr_b16 v[46:47],v4 offset:37120
 ds_read_b64_tr_b16 v[48:49],v4 offset:5120
 ds_read_b64_tr_b16 v[50:51],v4 offset:5376
 ds_read_b64_tr_b16 v[52:53],v4 offset:37888
 ds_read_b64_tr_b16 v[54:55],v4 offset:38144
 s_waitcnt lgkmcnt(10)
 v_mfma_f32_32x32x16_bf16 a[32:47],v[64:67],v[68:71],a[32:47]
 s_add_u32 s96,s95,3
 s_and_b32 s96,s96,7
 s_mul_i32 s96,s96,128
 s_add_u32 s96,s96,s77
 s_mov_b32 s99,s96
 s_add_u32 m0,s54,98304
 s_add_u32 s52,s99,0
 buffer_load_dwordx4 v25,s[8:11],s52 offen lds
 s_waitcnt lgkmcnt(8)
 v_mfma_f32_32x32x16_bf16 a[48:63],v[64:67],v[72:75],a[48:63]
 v_mfma_f32_32x32x16_bf16 a[0:15],v[64:67],v[152:155],a[0:15]
 s_add_u32 m0,s54,102400
 s_add_u32 s52,s99,8192
 buffer_load_dwordx4 v26,s[8:11],s52 offen lds
 v_mfma_f32_32x32x16_bf16 v[120:135],v[152:155],v[152:155],v[120:135]
 v_mfma_f32_32x32x16_bf16 a[0:15],v[64:67],v[156:159],a[0:15]
 s_add_u32 m0,s54,106496
 s_add_u32 s52,s99,16384
 buffer_load_dwordx4 v25,s[8:11],s52 offen lds
 v_mfma_f32_32x32x16_bf16 v[120:135],v[156:159],v[156:159],v[120:135]
 v_mfma_f32_32x32x16_bf16 a[0:15],v[64:67],v[160:163],a[0:15]
 s_add_u32 m0,s54,110592
 s_add_u32 s52,s99,24576
 buffer_load_dwordx4 v26,s[8:11],s52 offen lds
 v_mfma_f32_32x32x16_bf16 v[120:135],v[160:163],v[160:163],v[120:135]
 v_mfma_f32_32x32x16_bf16 a[0:15],v[64:67],v[164:167],a[0:15]
 s_add_u32 s96,s95,3
 s_and_b32 s96,s96,7
 s_mul_i32 s96,s96,196608
 s_add_u32 s96,s96,s61
 s_mov_b32 s84,s96
 s_add_u32 m0,s54,12288
 s_add_u32 s52,s84,1024
 buffer_load_dwordx4 v7,s[12:15],s52 offen lds
 v_mfma_f32_32x32x16_bf16 v[120:135],v[164:167],v[164:167],v[120:135]
 s_waitcnt lgkmcnt(6)
 v_mfma_f32_32x32x16_bf16 v[88:103],v[152:155],v[40:43],v[88:103]
 ds_read_b64_tr_b16 v[40:41],v4 offset:6144
 ds_read_b64_tr_b16 v[42:43],v4 offset:6400
 s_add_u32 m0,s54,45056
 s_add_u32 s52,s84,2048
 buffer_load_dwordx4 v7,s[12:15],s52 offen lds
 s_waitcnt lgkmcnt(6)
 v_mfma_f32_32x32x16_bf16 v[104:119],v[152:155],v[44:47],v[104:119]
 ds_read_b64_tr_b16 v[44:45],v4 offset:38912
 ds_read_b64_tr_b16 v[46:47],v4 offset:39168
 s_waitcnt lgkmcnt(6)
 v_mfma_f32_32x32x16_bf16 v[88:103],v[156:159],v[48:51],v[88:103]
 ds_read_b64_tr_b16 v[48:49],v4 offset:7168
 ds_read_b64_tr_b16 v[50:51],v4 offset:7424
 s_cmp_eq_u32 s49,0
 s_cbranch_scc1 Lrs_5
 v_and_b32 v80,7,v0
 v_lshlrev_b32 v80,3,v80
 v_lshl_add_u32 v80,v17,2,v80
 s_cmp_eq_u32 s4,2
 s_cselect_b32 s53,128,0
 v_and_b32 v84,4,v0
 v_mad_u32_u24 v80,v84,s53,v80
 v_mov_b32 v84,-1
 s_mov_b32 exec_lo,0xff
 s_mov_b32 exec_hi,0xff
 s_add_u32 s52,s51,0
 buffer_store_dword v84,v80,s[32:35],s52 offen sc1
 s_add_u32 s52,s51,32768
 buffer_store_dword v84,v80,s[32:35],s52 offen sc1
 s_mov_b64 exec,-1
Lrs_5:
 s_cmp_ge_u32 s65,3
 s_cbranch_scc1 Lrc_6
 v_lshlrev_b32 v80,2,v0
 v_mov_b32 v84,-1
 s_mul_i32 s53,s6,384
 s_lshl_b32 s96,s65,7
 s_add_u32 s53,s53,s96
 s_mov_b32 exec_hi,0
 s_add_u32 s52,s53,1441792
 buffer_store_dword v84,v80,s[32:35],s52 offen sc1
 s_mov_b64 exec,-1
Lrc_6:
 s_cmp_eq_u32 s4,3
 s_cbranch_scc1 Lw_7
 v_lshlrev_b32 v80,4,v18
 s_not_b32 s53,s7
 v_mov_b32 v84,s53
 v_mov_b32 v85,s53
 v_mov_b32 v86,s53
 v_mov_b32 v87,s53
 v_cmp_gt_u32 vcc,136,v18
 s_nop 0
 s_and_saveexec_b64 s[82:83],vcc
 s_mul_i32 s53,s5,2560
 s_add_u32 s53,s53,s78
 s_add_u32 s52,s53,0
 buffer_store_dwordx4 v[84:87],v80,s[32:35],s52 offen sc1
 s_add_u32 s52,s53,655360
 buffer_store_dwordx4 v[84:87],v80,s[32:35],s52 offen sc1
 s_mov_b64 exec,s[82:83]
Lw_7:
 s_waitcnt lgkmcnt(6)
 v_mfma_f32_32x32x16_bf16 v[104:119],v[156:159],v[52:55],v[104:119]
 ds_read_b64_tr_b16 v[52:53],v4 offset:39936
 ds_read_b64_tr_b16 v[54:55],v4 offset:40192
 s_waitcnt lgkmcnt(6)
 v_mfma_f32_32x32x16_bf16 v[88:103],v[160:163],v[40:43],v[88:103]
 s_lshl_b32 s53,s4,6
 s_add_u32 s53,s53,s62
 s_cmp_lt_u32 s4,2
 s_cselect_b32 s53,s53,s63
 s_lshl_b32 s96,s5,1
 s_sub_u32 s96,s96,s4
 s_mul_i32 s96,s96,44032
 v_add_u32 v28,s96,v8
 s_cmp_eq_u32 s4,3
 s_cselect_b32 s53,0x10000000,s53
 s_add_u32 m0,s54,90112
 s_add_u32 s52,s53,0
 buffer_load_dwordx4 v28,s[20:23],s52 offen lds
 s_add_u32 m0,s54,94208
 s_add_u32 s52,s53,44032
 buffer_load_dwordx4 v28,s[20:23],s52 offen lds
 s_waitcnt lgkmcnt(4)
 v_mfma_f32_32x32x16_bf16 v[104:119],v[160:163],v[44:47],v[104:119]
 s_waitcnt vmcnt(8)
 ds_read_b128 v[168:171],v56 offset:32768
 ds_read_b128 v[172:175],v57 offset:32768
 ds_read_b128 v[176:179],v58 offset:32768
 ds_read_b128 v[180:183],v59 offset:32768
 ds_read_b64_tr_b16 v[68:69],v60 offset:8192
 ds_read_b64_tr_b16 v[70:71],v60 offset:8448
 ds_read_b64_tr_b16 v[72:73],v60 offset:40960
 ds_read_b64_tr_b16 v[74:75],v60 offset:41216
 s_waitcnt lgkmcnt(10)
 v_mfma_f32_32x32x16_bf16 v[88:103],v[164:167],v[48:51],v[88:103]
 s_waitcnt lgkmcnt(8)
 v_mfma_f32_32x32x16_bf16 v[104:119],v[164:167],v[52:55],v[104:119]
 s_barrier
 ds_read_b64_tr_b16 v[40:41],v4 offset:8192
 ds_read_b64_tr_b16 v[42:43],v4 offset:8448
 ds_read_b64_tr_b16 v[44:45],v4 offset:40960
 ds_read_b64_tr_b16 v[46:47],v4 offset:41216
 ds_read_b64_tr_b16 v[48:49],v4 offset:9216
 ds_read_b64_tr_b16 v[50:51],v4 offset:9472
 ds_read_b64_tr_b16 v[52:53],v4 offset:41984
 ds_read_b64_tr_b16 v[54:55],v4 offset:42240
 s_waitcnt lgkmcnt(10)
 v_mfma_f32_32x32x16_bf16 a[32:47],v[64:67],v[68:71],a[32:47]
 s_add_u32 s96,s95,4
 s_and_b32 s96,s96,7
 s_mul_i32 s96,s96,128
 s_add_u32 s96,s96,s77
 s_mov_b32 s99,s96
 s_add_u32 m0,s54,114688
 s_add_u32 s52,s99,0
 buffer_load_dwordx4 v25,s[8:11],s52 offen lds
 s_waitcnt lgkmcnt(8)
 v_mfma_f32_32x32x16_bf16 a[48:63],v[64:67],v[72:75],a[48:63]
 v_mfma_f32_32x32x16_bf16 a[0:15],v[64:67],v[168:171],a[0:15]
 s_add_u32 m0,s54,118784
 s_add_u32 s52,s99,8192
 buffer_load_dwordx4 v26,s[8:11],s52 offen lds
 v_mfma_f32_32x32x16_bf16 v[120:135],v[168:171],v[168:171],v[120:135]
 v_mfma_f32_32x32x16_bf16 a[0:15],v[64:67],v[172:175],a[0:15]
 s_add_u32 m0,s54,122880
 s_add_u32 s52,s99,16384
 buffer_load_dwordx4 v25,s[8:11],s52 offen lds
 v_mfma_f32_32x32x16_bf16 v[120:135],v[172:175],v[172:175],v[120:135]
 v_mfma_f32_32x32x16_bf16 a[0:15],v[64:67],v[176:179],a[0:15]
 s_add_u32 m0,s54,126976
 s_add_u32 s52,s99,24576
 buffer_load_dwordx4 v26,s[8:11],s52 offen lds
 v_mfma_f32_32x32x16_bf16 v[120:135],v[176:179],v[176:179],v[120:135]
 v_mfma_f32_32x32x16_bf16 a[0:15],v[64:67],v[180:183],a[0:15]
 s_add_u32 s96,s95,4
 s_and_b32 s96,s96,7
 s_mul_i32 s96,s96,196608
 s_add_u32 s96,s96,s61
 s_mov_b32 s84,s96
 s_add_u32 m0,s54,16384
 s_add_u32 s52,s84,1024
 buffer_load_dwordx4 v7,s[12:15],s52 offen lds
 v_mfma_f32_32x32x16_bf16 v[120:135],v[180:183],v[180:183],v[120:135]
 s_waitcnt lgkmcnt(6)
 v_mfma_f32_32x32x16_bf16 v[88:103],v[168:171],v[40:43],v[88:103]
 ds_read_b64_tr_b16 v[40:41],v4 offset:10240
 ds_read_b64_tr_b16 v[42:43],v4 offset:10496
 s_add_u32 m0,s54,49152
 s_add_u32 s52,s84,2048
 buffer_load_dwordx4 v7,s[12:15],s52 offen lds
 s_waitcnt lgkmcnt(6)
 v_mfma_f32_32x32x16_bf16 v[104:119],v[168:171],v[44:47],v[104:119]
 ds_read_b64_tr_b16 v[44:45],v4 offset:43008
 ds_read_b64_tr_b16 v[46:47],v4 offset:43264
 s_waitcnt lgkmcnt(6)
 v_mfma_f32_32x32x16_bf16 v[88:103],v[172:175],v[48:51],v[88:103]
 ds_read_b64_tr_b16 v[48:49],v4 offset:11264
 ds_read_b64_tr_b16 v[50:51],v4 offset:11520
 v_lshlrev_b32 v27,7,v0
 s_mov_b64 s[82:83],exec
 s_mov_b64 exec,0xffff
 buffer_load_dword v80,v27,s[32:35],s94 offen sc1
 v_lshlrev_b32 v27,12,v0
 s_mov_b64 exec,0x11
 buffer_load_dword v81,v27,s[32:35],s97 offen sc1
 s_mov_b64 exec,s[82:83]
 s_waitcnt lgkmcnt(6)
 v_mfma_f32_32x32x16_bf16 v[104:119],v[172:175],v[52:55],v[104:119]
 ds_read_b64_tr_b16 v[52:53],v4 offset:44032
 ds_read_b64_tr_b16 v[54:55],v4 offset:44288
 s_waitcnt lgkmcnt(6)
 v_mfma_f32_32x32x16_bf16 v[88:103],v[176:179],v[40:43],v[88:103]
 s_waitcnt lgkmcnt(4)
 v_mfma_f32_32x32x16_bf16 v[104:119],v[176:179],v[44:47],v[104:119]
 s_waitcnt vmcnt(10)
 ds_read_b128 v[184:187],v56 offset:0
 ds_read_b128 v[188:191],v57 offset:0
 ds_read_b128 v[192:195],v58 offset:0
 ds_read_b128 v[196:199],v59 offset:0
 ds_read_b64_tr_b16 v[68:69],v60 offset:12288
 ds_read_b64_tr_b16 v[70:71],v60 offset:12544
 ds_read_b64_tr_b16 v[72:73],v60 offset:45056
 ds_read_b64_tr_b16 v[74:75],v60 offset:45312
 s_waitcnt lgkmcnt(10)
 v_mfma_f32_32x32x16_bf16 v[88:103],v[180:183],v[48:51],v[88:103]
 s_waitcnt lgkmcnt(8)
 v_mfma_f32_32x32x16_bf16 v[104:119],v[180:183],v[52:55],v[104:119]
 s_barrier
 ds_read_b64_tr_b16 v[40:41],v4 offset:12288
 ds_read_b64_tr_b16 v[42:43],v4 offset:12544
 ds_read_b64_tr_b16 v[44:45],v4 offset:45056
 ds_read_b64_tr_b16 v[46:47],v4 offset:45312
 ds_read_b64_tr_b16 v[48:49],v4 offset:13312
 ds_read_b64_tr_b16 v[50:51],v4 offset:13568
 ds_read_b64_tr_b16 v[52:53],v4 offset:46080
 ds_read_b64_tr_b16 v[54:55],v4 offset:46336
 s_waitcnt lgkmcnt(10)
 v_mfma_f32_32x32x16_bf16 a[32:47],v[64:67],v[68:71],a[32:47]
 s_add_u32 s96,s95,5
 s_and_b32 s96,s96,7
 s_mul_i32 s96,s96,128
 s_add_u32 s96,s96,s77
 s_mov_b32 s99,s96
 s_add_u32 m0,s54,131072
 s_add_u32 s52,s99,0
 buffer_load_dwordx4 v25,s[8:11],s52 offen lds
 s_waitcnt lgkmcnt(8)
 v_mfma_f32_32x32x16_bf16 a[48:63],v[64:67],v[72:75],a[48:63]
 v_mfma_f32_32x32x16_bf16 a[0:15],v[64:67],v[184:187],a[0:15]
 s_add_u32 m0,s54,135168
 s_add_u32 s52,s99,8192
 buffer_load_dwordx4 v26,s[8:11],s52 offen lds
 v_mfma_f32_32x32x16_bf16 v[120:135],v[184:187],v[184:187],v[120:135]
 v_mfma_f32_32x32x16_bf16 a[0:15],v[64:67],v[188:191],a[0:15]
 s_add_u32 m0,s54,139264
 s_add_u32 s52,s99,16384
 buffer_load_dwordx4 v25,s[8:11],s52 offen lds
 v_mfma_f32_32x32x16_bf16 v[120:135],v[188:191],v[188:191],v[120:135]
 v_mfma_f32_32x32x16_bf16 a[0:15],v[64:67],v[192:195],a[0:15]
 s_add_u32 m0,s54,143360
 s_add_u32 s52,s99,24576
 buffer_load_dwordx4 v26,s[8:11],s52 offen lds
 v_mfma_f32_32x32x16_bf16 v[120:135],v[192:195],v[192:195],v[120:135]
 v_mfma_f32_32x32x16_bf16 a[0:15],v[64:67],v[196:199],a[0:15]
 s_add_u32 s96,s95,5
 s_and_b32 s96,s96,7
 s_mul_i32 s96,s96,196608
 s_add_u32 s96,s96,s61
 s_mov_b32 s84,s96
 s_add_u32 m0,s54,20480
 s_add_u32 s52,s84,1024
 buffer_load_dwordx4 v7,s[12:15],s52 offen lds
 v_mfma_f32_32x32x16_bf16 v[120:135],v[196:199],v[196:199],v[120:135]
 s_waitcnt lgkmcnt(6)
 v_mfma_f32_32x32x16_bf16 v[88:103],v[184:187],v[40:43],v[88:103]
 ds_read_b64_tr_b16 v[40:41],v4 offset:14336
 ds_read_b64_tr_b16 v[42:43],v4 offset:14592
 s_add_u32 m0,s54,53248
 s_add_u32 s52,s84,2048
 buffer_load_dwordx4 v7,s[12:15],s52 offen lds
 s_waitcnt lgkmcnt(6)
 v_mfma_f32_32x32x16_bf16 v[104:119],v[184:187],v[44:47],v[104:119]
 ds_read_b64_tr_b16 v[44:45],v4 offset:47104
 ds_read_b64_tr_b16 v[46:47],v4 offset:47360
 s_waitcnt lgkmcnt(6)
 v_mfma_f32_32x32x16_bf16 v[88:103],v[188:191],v[48:51],v[88:103]
 ds_read_b64_tr_b16 v[48:49],v4 offset:15360
 ds_read_b64_tr_b16 v[50:51],v4 offset:15616
 s_waitcnt lgkmcnt(6)
 v_mfma_f32_32x32x16_bf16 v[104:119],v[188:191],v[52:55],v[104:119]
 ds_read_b64_tr_b16 v[52:53],v4 offset:48128
 ds_read_b64_tr_b16 v[54:55],v4 offset:48384
 s_waitcnt lgkmcnt(6)
 v_mfma_f32_32x32x16_bf16 v[88:103],v[192:195],v[40:43],v[88:103]
 s_waitcnt lgkmcnt(4)
 v_mfma_f32_32x32x16_bf16 v[104:119],v[192:195],v[44:47],v[104:119]
 s_waitcnt vmcnt(8)
 ds_read_b128 v[200:203],v56 offset:16384
 ds_read_b128 v[204:207],v57 offset:16384
 ds_read_b128 v[208:211],v58 offset:16384
 ds_read_b128 v[212:215],v59 offset:16384
 ds_read_b64_tr_b16 v[68:69],v60 offset:16384
 ds_read_b64_tr_b16 v[70:71],v60 offset:16640
 ds_read_b64_tr_b16 v[72:73],v60 offset:49152
 ds_read_b64_tr_b16 v[74:75],v60 offset:49408
 s_waitcnt lgkmcnt(10)
 v_mfma_f32_32x32x16_bf16 v[88:103],v[196:199],v[48:51],v[88:103]
 s_waitcnt lgkmcnt(8)
 v_mfma_f32_32x32x16_bf16 v[104:119],v[196:199],v[52:55],v[104:119]
 s_barrier
 ds_read_b64_tr_b16 v[40:41],v4 offset:16384
 ds_read_b64_tr_b16 v[42:43],v4 offset:16640
 ds_read_b64_tr_b16 v[44:45],v4 offset:49152
 ds_read_b64_tr_b16 v[46:47],v4 offset:49408
 ds_read_b64_tr_b16 v[48:49],v4 offset:17408
 ds_read_b64_tr_b16 v[50:51],v4 offset:17664
 ds_read_b64_tr_b16 v[52:53],v4 offset:50176
 ds_read_b64_tr_b16 v[54:55],v4 offset:50432
 s_waitcnt lgkmcnt(10)
 v_mfma_f32_32x32x16_bf16 a[32:47],v[64:67],v[68:71],a[32:47]
 s_add_u32 s96,s95,6
 s_and_b32 s96,s96,7
 s_mul_i32 s96,s96,128
 s_add_u32 s96,s96,s77
 s_mov_b32 s99,s96
 s_add_u32 m0,s54,98304
 s_add_u32 s52,s99,0
 buffer_load_dwordx4 v25,s[8:11],s52 offen lds
 s_waitcnt lgkmcnt(8)
 v_mfma_f32_32x32x16_bf16 a[48:63],v[64:67],v[72:75],a[48:63]
 v_mfma_f32_32x32x16_bf16 a[0:15],v[64:67],v[200:203],a[0:15]
 s_add_u32 m0,s54,102400
 s_add_u32 s52,s99,8192
 buffer_load_dwordx4 v26,s[8:11],s52 offen lds
 v_mfma_f32_32x32x16_bf16 v[120:135],v[200:203],v[200:203],v[120:135]
 v_mfma_f32_32x32x16_bf16 a[0:15],v[64:67],v[204:207],a[0:15]
 s_add_u32 m0,s54,106496
 s_add_u32 s52,s99,16384
 buffer_load_dwordx4 v25,s[8:11],s52 offen lds
 v_mfma_f32_32x32x16_bf16 v[120:135],v[204:207],v[204:207],v[120:135]
 v_mfma_f32_32x32x16_bf16 a[0:15],v[64:67],v[208:211],a[0:15]
 s_add_u32 m0,s54,110592
 s_add_u32 s52,s99,24576
 buffer_load_dwordx4 v26,s[8:11],s52 offen lds
 v_mfma_f32_32x32x16_bf16 v[120:135],v[208:211],v[208:211],v[120:135]
 v_mfma_f32_32x32x16_bf16 a[0:15],v[64:67],v[212:215],a[0:15]
 s_add_u32 s96,s95,6
 s_and_b32 s96,s96,7
 s_mul_i32 s96,s96,196608
 s_add_u32 s96,s96,s61
 s_mov_b32 s84,s96
 s_add_u32 m0,s54,24576
 s_add_u32 s52,s84,1024
 buffer_load_dwordx4 v7,s[12:15],s52 offen lds
 v_mfma_f32_32x32x16_bf16 v[120:135],v[212:215],v[212:215],v[120:135]
 s_waitcnt lgkmcnt(6)
 v_mfma_f32_32x32x16_bf16 v[88:103],v[200:203],v[40:43],v[88:103]
 ds_read_b64_tr_b16 v[40:41],v4 offset:18432
 ds_read_b64_tr_b16 v[42:43],v4 offset:18688
 s_add_u32 m0,s54,57344
 s_add_u32 s52,s84,2048
 buffer_load_dwordx4 v7,s[12:15],s52 offen lds
 s_waitcnt lgkmcnt(6)
 v_mfma_f32_32x32x16_bf16 v[104:119],v[200:203],v[44:47],v[104:119]
 ds_read_b64_tr_b16 v[44:45],v4 offset:51200
 ds_read_b64_tr_b16 v[46:47],v4 offset:51456
 s_waitcnt lgkmcnt(6)
 v_mfma_f32_32x32x16_bf16 v[88:103],v[204:207],v[48:51],v[88:103]
 ds_read_b64_tr_b16 v[48:49],v4 offset:19456
 ds_read_b64_tr_b16 v[50:51],v4 offset:19712
 v_lshlrev_b32 v27,7,v0
 s_lshl_b32 s53,s2,2
 s_add_u32 s53,s53,s4
 s_mul_i32 s53,s53,1408
 s_mov_b64 s[82:83],exec
 s_mov_b64 exec,0x7ff
 buffer_load_dword v76,v27,s[20:23],s53 offen
 buffer_load_dword v77,v27,s[24:27],s53 offen
 s_lshl_b32 s53,s2,2
 s_add_u32 s53,s53,s4
 s_lshl_b32 s53,s53,9
 s_mov_b64 exec,15
 buffer_load_dword v78,v27,s[16:19],s53 offen
 s_mov_b64 exec,s[82:83]
 s_waitcnt lgkmcnt(6)
 v_mfma_f32_32x32x16_bf16 v[104:119],v[204:207],v[52:55],v[104:119]
 ds_read_b64_tr_b16 v[52:53],v4 offset:52224
 ds_read_b64_tr_b16 v[54:55],v4 offset:52480
 s_waitcnt lgkmcnt(6)
 v_mfma_f32_32x32x16_bf16 v[88:103],v[208:211],v[40:43],v[88:103]
 s_waitcnt lgkmcnt(4)
 v_mfma_f32_32x32x16_bf16 v[104:119],v[208:211],v[44:47],v[104:119]
 s_waitcnt vmcnt(9)
 ds_read_b128 v[216:219],v56 offset:32768
 ds_read_b128 v[220:223],v57 offset:32768
 ds_read_b128 v[224:227],v58 offset:32768
 ds_read_b128 v[228:231],v59 offset:32768
 ds_read_b64_tr_b16 v[68:69],v60 offset:20480
 ds_read_b64_tr_b16 v[70:71],v60 offset:20736
 ds_read_b64_tr_b16 v[72:73],v60 offset:53248
 ds_read_b64_tr_b16 v[74:75],v60 offset:53504
 s_waitcnt lgkmcnt(10)
 v_mfma_f32_32x32x16_bf16 v[88:103],v[212:215],v[48:51],v[88:103]
 s_waitcnt lgkmcnt(8)
 v_mfma_f32_32x32x16_bf16 v[104:119],v[212:215],v[52:55],v[104:119]
 s_barrier
 ds_read_b64_tr_b16 v[40:41],v4 offset:20480
 ds_read_b64_tr_b16 v[42:43],v4 offset:20736
 ds_read_b64_tr_b16 v[44:45],v4 offset:53248
 ds_read_b64_tr_b16 v[46:47],v4 offset:53504
 ds_read_b64_tr_b16 v[48:49],v4 offset:21504
 ds_read_b64_tr_b16 v[50:51],v4 offset:21760
 ds_read_b64_tr_b16 v[52:53],v4 offset:54272
 ds_read_b64_tr_b16 v[54:55],v4 offset:54528
 s_waitcnt lgkmcnt(10)
 v_mfma_f32_32x32x16_bf16 a[32:47],v[64:67],v[68:71],a[32:47]
 s_add_u32 s96,s95,7
 s_and_b32 s96,s96,7
 s_mul_i32 s96,s96,128
 s_add_u32 s96,s96,s77
 s_mov_b32 s99,s96
 s_add_u32 m0,s54,114688
 s_add_u32 s52,s99,0
 buffer_load_dwordx4 v25,s[8:11],s52 offen lds
 s_waitcnt lgkmcnt(8)
 v_mfma_f32_32x32x16_bf16 a[48:63],v[64:67],v[72:75],a[48:63]
 v_mfma_f32_32x32x16_bf16 a[0:15],v[64:67],v[216:219],a[0:15]
 s_add_u32 m0,s54,118784
 s_add_u32 s52,s99,8192
 buffer_load_dwordx4 v26,s[8:11],s52 offen lds
 v_mfma_f32_32x32x16_bf16 v[120:135],v[216:219],v[216:219],v[120:135]
 v_mfma_f32_32x32x16_bf16 a[0:15],v[64:67],v[220:223],a[0:15]
 s_add_u32 m0,s54,122880
 s_add_u32 s52,s99,16384
 buffer_load_dwordx4 v25,s[8:11],s52 offen lds
 v_mfma_f32_32x32x16_bf16 v[120:135],v[220:223],v[220:223],v[120:135]
 v_mfma_f32_32x32x16_bf16 a[0:15],v[64:67],v[224:227],a[0:15]
 s_add_u32 m0,s54,126976
 s_add_u32 s52,s99,24576
 buffer_load_dwordx4 v26,s[8:11],s52 offen lds
 v_mfma_f32_32x32x16_bf16 v[120:135],v[224:227],v[224:227],v[120:135]
 v_mfma_f32_32x32x16_bf16 a[0:15],v[64:67],v[228:231],a[0:15]
 s_add_u32 s96,s95,7
 s_and_b32 s96,s96,7
 s_mul_i32 s96,s96,196608
 s_add_u32 s96,s96,s61
 s_mov_b32 s84,s96
 s_add_u32 m0,s54,28672
 s_add_u32 s52,s84,1024
 buffer_load_dwordx4 v7,s[12:15],s52 offen lds
 v_mfma_f32_32x32x16_bf16 v[120:135],v[228:231],v[228:231],v[120:135]
 s_waitcnt lgkmcnt(6)
 v_mfma_f32_32x32x16_bf16 v[88:103],v[216:219],v[40:43],v[88:103]
 ds_read_b64_tr_b16 v[40:41],v4 offset:22528
 ds_read_b64_tr_b16 v[42:43],v4 offset:22784
 s_add_u32 m0,s54,61440
 s_add_u32 s52,s84,2048
 buffer_load_dwordx4 v7,s[12:15],s52 offen lds
 s_waitcnt lgkmcnt(6)
 v_mfma_f32_32x32x16_bf16 v[104:119],v[216:219],v[44:47],v[104:119]
 ds_read_b64_tr_b16 v[44:45],v4 offset:55296
 ds_read_b64_tr_b16 v[46:47],v4 offset:55552
 s_waitcnt lgkmcnt(6)
 v_mfma_f32_32x32x16_bf16 v[88:103],v[220:223],v[48:51],v[88:103]
 ds_read_b64_tr_b16 v[48:49],v4 offset:23552
 ds_read_b64_tr_b16 v[50:51],v4 offset:23808
 s_waitcnt lgkmcnt(6)
 v_mfma_f32_32x32x16_bf16 v[104:119],v[220:223],v[52:55],v[104:119]
 ds_read_b64_tr_b16 v[52:53],v4 offset:56320
 ds_read_b64_tr_b16 v[54:55],v4 offset:56576
 s_waitcnt lgkmcnt(6)
 v_mfma_f32_32x32x16_bf16 v[88:103],v[224:227],v[40:43],v[88:103]
 ds_read_b64_tr_b16 v[80:81],v61 offset:24576
 s_waitcnt lgkmcnt(5)
 v_mfma_f32_32x32x16_bf16 v[104:119],v[224:227],v[44:47],v[104:119]
 s_waitcnt vmcnt(9)
 ds_read_b128 v[232:235],v56 offset:0
 ds_read_b128 v[236:239],v57 offset:0
 ds_read_b128 v[240:243],v58 offset:0
 ds_read_b128 v[244:247],v59 offset:0
 ds_read_b64_tr_b16 v[68:69],v60 offset:24576
 ds_read_b64_tr_b16 v[70:71],v60 offset:24832
 ds_read_b64_tr_b16 v[72:73],v60 offset:57344
 ds_read_b64_tr_b16 v[74:75],v60 offset:57600
 s_waitcnt lgkmcnt(11)
 v_mfma_f32_32x32x16_bf16 v[88:103],v[228:231],v[48:51],v[88:103]
 ds_read_b64_tr_b16 v[82:83],v61 offset:24832
 s_waitcnt lgkmcnt(10)
 v_mfma_f32_32x32x16_bf16 v[104:119],v[228:231],v[52:55],v[104:119]
 ds_read_b64_tr_b16 v[84:85],v61 offset:28672
 ds_read_b64_tr_b16 v[86:87],v61 offset:28928
 s_waitcnt lgkmcnt(2)
 v_mfma_f32_32x32x16_bf16 a[80:95],v[64:67],v[80:83],0
 s_waitcnt lgkmcnt(0)
 v_mfma_f32_32x32x16_bf16 a[80:95],v[64:67],v[84:87],a[80:95]
 s_add_u32 s53,s60,1024
 buffer_load_dword v63,v15,s[32:35],s53 offen sc1
 s_barrier
 ds_read_b64_tr_b16 v[40:41],v4 offset:24576
 ds_read_b64_tr_b16 v[42:43],v4 offset:24832
 ds_read_b64_tr_b16 v[44:45],v4 offset:57344
 ds_read_b64_tr_b16 v[46:47],v4 offset:57600
 ds_read_b64_tr_b16 v[48:49],v4 offset:25600
 ds_read_b64_tr_b16 v[50:51],v4 offset:25856
 ds_read_b64_tr_b16 v[52:53],v4 offset:58368
 ds_read_b64_tr_b16 v[54:55],v4 offset:58624
 v_mfma_f32_32x32x16_bf16 a[32:47],v[64:67],v[68:71],a[32:47]
 v_accvgpr_read_b32 v80,a80
 s_and_b32 s53,s7,0xff
 v_mov_b32 v81,s53
 v_and_or_b32 v80,v80,s85,v81
 v_lshlrev_b32 v81,2,v0
 s_min_u32 s96,s4,2
 s_lshl_b32 s96,s96,7
 s_mul_i32 s53,s5,2560
 s_add_u32 s53,s53,s78
 s_add_u32 s53,s53,s96
 s_cmp_eq_u32 s4,3
 s_cbranch_scc1 Lw_8
 s_mov_b32 exec_hi,0
 s_add_u32 s52,s53,2176
 buffer_store_dword v80,v81,s[32:35],s52 offen sc1
 s_mov_b64 exec,-1
Lw_8:
 v_mfma_f32_32x32x16_bf16 a[48:63],v[64:67],v[72:75],a[48:63]
 v_mfma_f32_32x32x16_bf16 a[0:15],v[64:67],v[232:235],a[0:15]
 s_add_u32 s96,s95,0
 s_and_b32 s96,s96,7
 s_mul_i32 s96,s96,196608
 s_add_u32 s96,s96,s61
 s_add_u32 m0,s54,65536
 s_add_u32 s52,s96,0
 buffer_load_dwordx4 v7,s[12:15],s52 offen lds
 v_mfma_f32_32x32x16_bf16 v[120:135],v[232:235],v[232:235],v[120:135]
 v_mfma_f32_32x32x16_bf16 a[0:15],v[64:67],v[236:239],a[0:15]
 s_add_u32 s96,s95,1
 s_and_b32 s96,s96,7
 s_mul_i32 s96,s96,196608
 s_add_u32 s96,s96,s61
 s_add_u32 m0,s54,69632
 s_add_u32 s52,s96,0
 buffer_load_dwordx4 v7,s[12:15],s52 offen lds
 v_mfma_f32_32x32x16_bf16 v[120:135],v[236:239],v[236:239],v[120:135]
 v_mfma_f32_32x32x16_bf16 a[0:15],v[64:67],v[240:243],a[0:15]
 s_add_u32 s96,s95,2
 s_and_b32 s96,s96,7
 s_mul_i32 s96,s96,196608
 s_add_u32 s96,s96,s61
 s_add_u32 m0,s54,73728
 s_add_u32 s52,s96,0
 buffer_load_dwordx4 v7,s[12:15],s52 offen lds
 v_mfma_f32_32x32x16_bf16 v[120:135],v[240:243],v[240:243],v[120:135]
 v_mfma_f32_32x32x16_bf16 a[0:15],v[64:67],v[244:247],a[0:15]
 s_add_u32 s96,s95,3
 s_and_b32 s96,s96,7
 s_mul_i32 s96,s96,196608
 s_add_u32 s96,s96,s61
 s_add_u32 m0,s54,77824
 s_add_u32 s52,s96,0
 buffer_load_dwordx4 v7,s[12:15],s52 offen lds
 v_mfma_f32_32x32x16_bf16 v[120:135],v[244:247],v[244:247],v[120:135]
 s_waitcnt lgkmcnt(6)
 v_mfma_f32_32x32x16_bf16 v[88:103],v[232:235],v[40:43],v[88:103]
 ds_read_b64_tr_b16 v[40:41],v4 offset:26624
 ds_read_b64_tr_b16 v[42:43],v4 offset:26880
 s_waitcnt lgkmcnt(6)
 v_mfma_f32_32x32x16_bf16 v[104:119],v[232:235],v[44:47],v[104:119]
 ds_read_b64_tr_b16 v[44:45],v4 offset:59392
 ds_read_b64_tr_b16 v[46:47],v4 offset:59648
 s_waitcnt lgkmcnt(6)
 v_mfma_f32_32x32x16_bf16 v[88:103],v[236:239],v[48:51],v[88:103]
 ds_read_b64_tr_b16 v[48:49],v4 offset:27648
 ds_read_b64_tr_b16 v[50:51],v4 offset:27904
 s_waitcnt lgkmcnt(6)
 v_mfma_f32_32x32x16_bf16 v[104:119],v[236:239],v[52:55],v[104:119]
 ds_read_b64_tr_b16 v[52:53],v4 offset:60416
 ds_read_b64_tr_b16 v[54:55],v4 offset:60672
 s_waitcnt lgkmcnt(6)
 v_mfma_f32_32x32x16_bf16 v[88:103],v[240:243],v[40:43],v[88:103]
 s_waitcnt lgkmcnt(4)
 v_mfma_f32_32x32x16_bf16 v[104:119],v[240:243],v[44:47],v[104:119]
 s_waitcnt vmcnt(5)
 ds_read_b128 v[248:251],v56 offset:16384
 ds_read_b128 v[252:255],v57 offset:16384
 ds_read_b128 a[248:251],v58 offset:16384
 ds_read_b128 a[252:255],v59 offset:16384
 ds_read_b64_tr_b16 v[68:69],v60 offset:28672
 ds_read_b64_tr_b16 v[70:71],v60 offset:28928
 ds_read_b64_tr_b16 v[72:73],v60 offset:61440
 ds_read_b64_tr_b16 v[74:75],v60 offset:61696
 s_waitcnt lgkmcnt(10)
 v_mfma_f32_32x32x16_bf16 v[88:103],v[244:247],v[48:51],v[88:103]
 s_waitcnt lgkmcnt(8)
 v_mfma_f32_32x32x16_bf16 v[104:119],v[244:247],v[52:55],v[104:119]
 s_barrier
 ds_read_b64_tr_b16 v[40:41],v4 offset:28672
 ds_read_b64_tr_b16 v[42:43],v4 offset:28928
 ds_read_b64_tr_b16 v[44:45],v4 offset:61440
 ds_read_b64_tr_b16 v[46:47],v4 offset:61696
 ds_read_b64_tr_b16 v[48:49],v4 offset:29696
 ds_read_b64_tr_b16 v[50:51],v4 offset:29952
 ds_read_b64_tr_b16 v[52:53],v4 offset:62464
 ds_read_b64_tr_b16 v[54:55],v4 offset:62720
 s_waitcnt lgkmcnt(10)
 v_mfma_f32_32x32x16_bf16 a[32:47],v[64:67],v[68:71],a[32:47]
 s_waitcnt lgkmcnt(8)
 v_mfma_f32_32x32x16_bf16 a[48:63],v[64:67],v[72:75],a[48:63]
 v_mfma_f32_32x32x16_bf16 a[0:15],v[64:67],v[248:251],a[0:15]
 v_mfma_f32_32x32x16_bf16 v[120:135],v[248:251],v[248:251],v[120:135]
 v_mfma_f32_32x32x16_bf16 a[0:15],v[64:67],v[252:255],a[0:15]
 v_mfma_f32_32x32x16_bf16 v[120:135],v[252:255],v[252:255],v[120:135]
 v_mfma_f32_32x32x16_bf16 a[0:15],v[64:67],a[248:251],a[0:15]
 v_mfma_f32_32x32x16_bf16 v[120:135],a[248:251],a[248:251],v[120:135]
 v_mfma_f32_32x32x16_bf16 a[0:15],v[64:67],a[252:255],a[0:15]
 v_mfma_f32_32x32x16_bf16 v[120:135],a[252:255],a[252:255],v[120:135]
 s_waitcnt lgkmcnt(6)
 v_mfma_f32_32x32x16_bf16 v[88:103],v[248:251],v[40:43],v[88:103]
 ds_read_b64_tr_b16 v[40:41],v4 offset:30720
 ds_read_b64_tr_b16 v[42:43],v4 offset:30976
 v_accvgpr_read_b32 v76,a32
 v_accvgpr_read_b32 v77,a48
 v_and_b32 v78,31,v0
 v_lshlrev_b32 v78,4,v78
 v_add_u32 v78,0x20000,v78
 s_lshl_b32 s53,s4,2
 v_add_u32 v79,s53,v78
 s_waitcnt lgkmcnt(6)
 v_mfma_f32_32x32x16_bf16 v[104:119],v[248:251],v[44:47],v[104:119]
 ds_read_b64_tr_b16 v[44:45],v4 offset:63488
 ds_read_b64_tr_b16 v[46:47],v4 offset:63744
 ds_write_b32 v79,v76 offset:0
 ds_write_b32 v79,v77 offset:512
 s_waitcnt lgkmcnt(0)
 s_barrier
 ds_read_b128 v[80:83],v78 offset:0
 ds_read_b128 v[84:87],v78 offset:512
 s_waitcnt lgkmcnt(1)
 v_add_f32 v80,v80,v81
 v_add_f32 v82,v82,v83
 v_mfma_f32_32x32x16_bf16 v[88:103],v[252:255],v[48:51],v[88:103]
 ds_read_b64_tr_b16 v[48:49],v4 offset:31744
 ds_read_b64_tr_b16 v[50:51],v4 offset:32000
 v_add_f32 v80,v80,v82
 v_cvt_pk_bf16_f32 v81,v80,v80
 v_lshlrev_b32 v81,16,v81
 v_sub_f32 v81,v80,v81
 v_cvt_pk_bf16_f32 v20,v80,v81
 s_waitcnt lgkmcnt(2)
 v_add_f32 v84,v84,v85
 v_add_f32 v86,v86,v87
 v_mfma_f32_32x32x16_bf16 v[104:119],v[252:255],v[52:55],v[104:119]
 ds_read_b64_tr_b16 v[52:53],v4 offset:64512
 ds_read_b64_tr_b16 v[54:55],v4 offset:64768
 v_add_f32 v84,v84,v86
 v_cvt_pk_bf16_f32 v85,v84,v84
 v_lshlrev_b32 v85,16,v85
 v_sub_f32 v85,v84,v85
 v_cvt_pk_bf16_f32 v21,v84,v85
 v_accvgpr_read_b32 v76,a0
 v_cndmask_b32 v120,v120,v121,s[36:37]
 v_mfma_f32_32x32x16_bf16 v[88:103],a[248:251],v[40:43],v[88:103]
 v_cndmask_b32 v121,v122,v123,s[36:37]
 v_cndmask_b32 v122,v124,v125,s[36:37]
 v_cndmask_b32 v123,v126,v127,s[36:37]
 v_cndmask_b32 v124,v128,v129,s[36:37]
 v_cndmask_b32 v125,v130,v131,s[36:37]
 v_cndmask_b32 v126,v132,v133,s[36:37]
 v_cndmask_b32 v127,v134,v135,s[36:37]
 v_mfma_f32_32x32x16_bf16 v[104:119],a[248:251],v[44:47],v[104:119]
 v_cndmask_b32 v120,v120,v121,s[38:39]
 v_cndmask_b32 v121,v122,v123,s[38:39]
 v_cndmask_b32 v122,v124,v125,s[38:39]
 v_cndmask_b32 v123,v126,v127,s[38:39]
 v_cndmask_b32 v120,v120,v121,s[40:41]
 v_cndmask_b32 v121,v122,v123,s[40:41]
 v_cndmask_b32 v120,v120,v121,s[44:45]
 s_waitcnt lgkmcnt(2)
 v_mfma_f32_32x32x16_bf16 v[88:103],a[252:255],v[48:51],v[88:103]
 v_cndmask_b32 v120,0,v120,s[46:47]
 v_mov_b32 v78,v120
 s_nop 1
 v_permlane32_swap_b32 v120,v78
 v_add_f32 v120,v120,v78
 v_mov_b32 v26,0
 v_mov_b32 v27,0
 v_mov_b32 v30,0
 s_waitcnt lgkmcnt(0)
 v_mfma_f32_32x32x16_bf16 v[104:119],a[252:255],v[52:55],v[104:119]
 v_mov_b32 v31,0
 v_mov_b32 v32,0x3f803f80
 v_mov_b32 v33,0x3f803f80
 v_mul_f32 v76,s74,v76
 v_mul_f32 v120,s74,v120
 v_fma_f32 v120,-v76,v76,v120
 v_max_f32 v120,0,v120
 v_add_f32 v120,s75,v120
 v_rsq_f32 v120,v120
 s_nop 0
 v_mul_f32 v16,s73,v120
 v_cndmask_b32_e64 v76,0,-v76,s[92:93]
 v_cvt_pk_bf16_f32 v24,v76,v76
 v_lshlrev_b32 v78,16,v24
 v_sub_f32 v76,v76,v78
 v_cvt_pk_bf16_f32 v25,v76,v76
 v_cndmask_b32 v120,0,v16,s[92:93]
 v_cvt_pk_bf16_f32 v78,v120,v120
 v_lshlrev_b32 v78,16,v78
 v_sub_f32 v78,v120,v78
 v_cvt_pk_bf16_f32 v26,v120,v78
 s_add_u32 s96,s95,4
 s_and_b32 s96,s96,7
 s_mul_i32 s96,s96,196608
 s_add_u32 s96,s96,s61
 s_add_u32 m0,s54,81920
 s_add_u32 s52,s96,0
 buffer_load_dwordx4 v7,s[12:15],s52 offen lds
 s_add_u32 s96,s95,5
 s_and_b32 s96,s96,7
 s_mul_i32 s96,s96,196608
 s_add_u32 s96,s96,s61
 s_add_u32 m0,s54,86016
 s_add_u32 s52,s96,0
 buffer_load_dwordx4 v7,s[12:15],s52 offen lds
 s_add_u32 s96,s95,6
 s_and_b32 s96,s96,7
 s_mul_i32 s96,s96,196608
 s_add_u32 s96,s96,s61
 s_add_u32 m0,s54,90112
 s_add_u32 s52,s96,0
 buffer_load_dwordx4 v7,s[12:15],s52 offen lds
 s_add_u32 s96,s95,7
 s_and_b32 s96,s96,7
 s_mul_i32 s96,s96,196608
 s_add_u32 s96,s96,s61
 s_add_u32 m0,s54,94208
 s_add_u32 s52,s96,0
 buffer_load_dwordx4 v7,s[12:15],s52 offen lds
 v_mov_b32 v28,v20
 v_mov_b32 v29,v20
 s_nop 1
 v_mfma_f32_32x32x16_bf16 v[88:103],v[24:27],v[28:31],v[88:103]
 v_mov_b32 v28,v21
 v_mov_b32 v29,v21
 s_nop 1
 v_mfma_f32_32x32x16_bf16 v[104:119],v[24:27],v[28:31],v[104:119]
 s_waitcnt vmcnt(8)
Lhp_9:
 v_subrev_u32 v35,s7,v63
 v_add_u32 v35,-1,v35
 v_cmp_le_u32 vcc,16,v35
 s_cbranch_vccz Lhd_10
 s_add_u32 s53,s60,1024
 buffer_load_dword v63,v15,s[32:35],s53 offen sc1
 s_waitcnt vmcnt(0)
 s_sub_u32 s55,s55,1
 s_cbranch_scc0 Lhp_9
 s_mov_b32 s55,0
Lhd_10:
 v_cmp_ne_u32 vcc,s81,v63
 v_mov_b32 v35,v60
 v_mov_b32 v36,v61
 v_mov_b32 v37,v62
 v_mfma_f32_32x32x16_bf16 v[56:71],v[24:27],v[30:33],0
 s_cbranch_vccz L_fast
L_slow_tramp:
 s_getpc_b64 s[86:87]
L_pc0:
 s_add_u32 s86,s86,L_slow-L_pc0
 s_addc_u32 s87,s87,0
 s_setpc_b64 s[86:87]
L_end:
 s_endpgm
L_fast:
 s_nop 5
 v_pk_fma_f32 v[88:89],v[88:89],v[56:57],s[88:89]
 v_pk_fma_f32 v[90:91],v[90:91],v[58:59],s[88:89]
 v_pk_fma_f32 v[92:93],v[92:93],v[60:61],s[88:89]
 v_pk_fma_f32 v[94:95],v[94:95],v[62:63],s[88:89]
 v_exp_f32_e64 v72,v88 clamp
 v_exp_f32_e64 v73,v89 clamp
 v_exp_f32_e64 v74,v90 clamp
 v_exp_f32_e64 v75,v91 clamp
 v_exp_f32_e64 v76,v92 clamp
 v_exp_f32_e64 v77,v93 clamp
 v_exp_f32_e64 v78,v94 clamp
 v_exp_f32_e64 v79,v95 clamp
 v_max_f32 v88,s88,v88
 v_max_f32 v89,s88,v89
 v_max_f32 v90,s88,v90
 v_max_f32 v91,s88,v91
 v_max_f32 v92,s88,v92
 v_max_f32 v93,s88,v93
 v_max_f32 v94,s88,v94
 v_max_f32 v95,s88,v95
 v_pk_fma_f32 v[88:89],v[88:89],s[90:91],v[72:73]
 v_pk_fma_f32 v[90:91],v[90:91],s[90:91],v[74:75]
 v_pk_fma_f32 v[92:93],v[92:93],s[90:91],v[76:77]
 v_pk_fma_f32 v[94:95],v[94:95],s[90:91],v[78:79]
 v_cvt_pk_bf16_f32 v88,v88,v89
 v_cvt_pk_bf16_f32 v89,v90,v91
 v_cvt_pk_bf16_f32 v90,v92,v93
 v_cvt_pk_bf16_f32 v91,v94,v95
 v_pk_fma_f32 v[96:97],v[96:97],v[64:65],s[88:89]
 v_pk_fma_f32 v[98:99],v[98:99],v[66:67],s[88:89]
 v_pk_fma_f32 v[100:101],v[100:101],v[68:69],s[88:89]
 v_pk_fma_f32 v[102:103],v[102:103],v[70:71],s[88:89]
 v_exp_f32_e64 v72,v96 clamp
 v_exp_f32_e64 v73,v97 clamp
 v_exp_f32_e64 v74,v98 clamp
 v_exp_f32_e64 v75,v99 clamp
 v_exp_f32_e64 v76,v100 clamp
 v_exp_f32_e64 v77,v101 clamp
 v_exp_f32_e64 v78,v102 clamp
 v_exp_f32_e64 v79,v103 clamp
 v_max_f32 v96,s88,v96
 v_max_f32 v97,s88,v97
 v_max_f32 v98,s88,v98
 v_max_f32 v99,s88,v99
 v_max_f32 v100,s88,v100
 v_max_f32 v101,s88,v101
 v_max_f32 v102,s88,v102
 v_max_f32 v103,s88,v103
 v_pk_fma_f32 v[96:97],v[96:97],s[90:91],v[72:73]
 v_pk_fma_f32 v[98:99],v[98:99],s[90:91],v[74:75]
 v_pk_fma_f32 v[100:101],v[100:101],s[90:91],v[76:77]
 v_pk_fma_f32 v[102:103],v[102:103],s[90:91],v[78:79]
 v_cvt_pk_bf16_f32 v92,v96,v97
 v_cvt_pk_bf16_f32 v93,v98,v99
 v_cvt_pk_bf16_f32 v94,v100,v101
 v_cvt_pk_bf16_f32 v95,v102,v103
 v_mov_b32 v48,v32
 v_mov_b32 v49,v32
 v_mov_b32 v50,v32
 v_mov_b32 v51,v32
 v_pk_mul_f32 v[104:105],v[104:105],v[56:57]
 s_waitcnt vmcnt(0)
 v_pk_mul_f32 v[106:107],v[106:107],v[58:59]
 ds_read_b64_tr_b16 v[40:41],v36 offset:0
 v_pk_mul_f32 v[108:109],v[108:109],v[60:61]
 ds_read_b64_tr_b16 v[42:43],v36 offset:256
 v_pk_mul_f32 v[110:111],v[110:111],v[62:63]
 ds_read_b64_tr_b16 v[44:45],v36 offset:4096
 v_cvt_pk_bf16_f32 v104,v104,v105
 ds_read_b64_tr_b16 v[46:47],v36 offset:4352
 v_cvt_pk_bf16_f32 v105,v106,v107
 s_waitcnt lgkmcnt(2)
 v_mfma_f32_32x32x16_bf16 v[120:135],v[48:51],v[40:43],0
 v_cvt_pk_bf16_f32 v106,v108,v109
 ds_read_b64_tr_b16 v[40:41],v36 offset:8192
 v_cvt_pk_bf16_f32 v107,v110,v111
 ds_read_b64_tr_b16 v[42:43],v36 offset:8448
 v_mov_b32 v96,v32
 s_waitcnt lgkmcnt(2)
 v_mfma_f32_32x32x16_bf16 v[120:135],v[48:51],v[44:47],v[120:135]
 v_mov_b32 v97,v32
 ds_read_b64_tr_b16 v[44:45],v36 offset:12288
 v_mov_b32 v98,v32
 ds_read_b64_tr_b16 v[46:47],v36 offset:12544
 v_mov_b32 v99,v32
 s_waitcnt lgkmcnt(2)
 v_mfma_f32_32x32x16_bf16 v[120:135],v[48:51],v[40:43],v[120:135]
 v_mov_b32 v100,v32
 ds_read_b64_tr_b16 v[40:41],v36 offset:16384
 v_mov_b32 v101,v32
 ds_read_b64_tr_b16 v[42:43],v36 offset:16640
 v_mov_b32 v102,v32
 s_waitcnt lgkmcnt(2)
 v_mfma_f32_32x32x16_bf16 v[120:135],v[48:51],v[44:47],v[120:135]
 v_mov_b32 v103,v32
 ds_read_b64_tr_b16 v[44:45],v36 offset:20480
 v_permlane16_swap_b32 v104,v96
 ds_read_b64_tr_b16 v[46:47],v36 offset:20736
 v_permlane16_swap_b32 v105,v97
 s_waitcnt lgkmcnt(2)
 v_mfma_f32_32x32x16_bf16 v[120:135],v[48:51],v[40:43],v[120:135]
 v_permlane16_swap_b32 v106,v98
 ds_read_b64_tr_b16 v[40:41],v36 offset:24576
 v_permlane16_swap_b32 v107,v99
 ds_read_b64_tr_b16 v[42:43],v36 offset:24832
 v_pk_mul_f32 v[112:113],v[112:113],v[64:65]
 s_waitcnt lgkmcnt(2)
 v_mfma_f32_32x32x16_bf16 v[120:135],v[48:51],v[44:47],v[120:135]
 v_pk_mul_f32 v[114:115],v[114:115],v[66:67]
 ds_read_b64_tr_b16 v[44:45],v36 offset:28672
 v_pk_mul_f32 v[116:117],v[116:117],v[68:69]
 ds_read_b64_tr_b16 v[46:47],v36 offset:28928
 v_pk_mul_f32 v[118:119],v[118:119],v[70:71]
 s_waitcnt lgkmcnt(2)
 v_mfma_f32_32x32x16_bf16 v[120:135],v[48:51],v[40:43],v[120:135]
 v_cvt_pk_bf16_f32 v108,v112,v113
 s_waitcnt lgkmcnt(0)
 v_mfma_f32_32x32x16_bf16 v[120:135],v[48:51],v[44:47],v[120:135]
 v_cvt_pk_bf16_f32 v109,v114,v115
 v_cvt_pk_bf16_f32 v110,v116,v117
 v_cvt_pk_bf16_f32 v111,v118,v119
 v_mfma_f32_32x32x16_bf16 v[72:87],v[88:91],v[96:99],0
 v_permlane16_swap_b32 v108,v100
 v_permlane16_swap_b32 v109,v101
 v_permlane16_swap_b32 v110,v102
 v_permlane16_swap_b32 v111,v103
 v_mfma_f32_32x32x16_bf16 v[56:71],v[88:91],v[104:107],0
 s_nop 0
 v_mfma_f32_32x32x16_bf16 v[72:87],v[92:95],v[100:103],v[72:87]
 v_mfma_f32_32x32x16_bf16 v[56:71],v[92:95],v[108:111],v[56:71]
 s_lshl_b32 s53,s4,12
 s_add_u32 s53,s53,147456
 v_add_u32 v112,s53,v1
 v_bfe_u32 v118,v0,1,4
 v_lshl_add_u32 v118,v17,5,v118
 v_lshlrev_b32 v118,4,v118
 s_lshl_b32 s53,s4,11
 v_add_u32 v118,s53,v118
 v_bfe_u32 v119,v0,1,2
 v_lshlrev_b32 v119,9,v119
 v_bfe_u32 v117,v0,2,1
 v_lshl_add_u32 v119,v117,10,v119
 v_add_u32 v119,256,v119
 s_cmp_eq_u32 s4,2
 s_cselect_b64 vcc,-1,0
 v_cndmask_b32 v113,v118,v119,vcc
 v_and_b32 v118,1,v0
 v_lshl_add_u32 v113,v118,10,v113
 v_add_u32 v113,0x24000,v113
 v_add_u32 v115,s54,v1
 s_and_b32 s53,s7,0xff
 v_mov_b32 v116,s53
 v_lshrrev_b32 v118,3,v0
 v_mul_u32_u24 v118,2560,v118
 v_and_b32 v119,7,v0
 v_lshl_add_u32 v114,v119,4,v118
 v_and_b32 v117,7,v0
 v_lshlrev_b32 v117,3,v117
 v_lshl_add_u32 v117,v17,2,v117
 s_cmp_eq_u32 s4,2
 s_cselect_b32 s53,128,0
 v_and_b32 v118,4,v0
 v_mad_u32_u24 v117,v118,s53,v117
 ds_write_b128 v112,v[80:83] offset:2048
 ds_write_b128 v112,v[84:87] offset:3072
 ds_write_b128 v112,v[56:59] offset:0
 ds_write_b128 v112,v[60:63] offset:1024
 v_and_b32 v104,31,v0
 v_lshlrev_b32 v104,4,v104
 v_add_u32 v104,0x21000,v104
 s_lshl_b32 s53,s4,2
 v_add_u32 v105,s53,v104
 ds_write_b32 v105,v120 offset:0
 s_waitcnt lgkmcnt(0)
 s_barrier
 s_cmp_eq_u32 s4,3
 s_cbranch_scc1 Lw_11
 ds_read_b128 v[56:59],v113 offset:0
 ds_read_b128 v[60:63],v113 offset:4096
 ds_read_b128 v[64:67],v113 offset:8192
 ds_read_b128 v[68:71],v113 offset:12288
 s_waitcnt lgkmcnt(2)
 v_pk_add_f32 v[56:57],v[56:57],v[60:61]
 v_pk_add_f32 v[58:59],v[58:59],v[62:63]
 s_waitcnt lgkmcnt(0)
 v_pk_add_f32 v[64:65],v[64:65],v[68:69]
 v_pk_add_f32 v[66:67],v[66:67],v[70:71]
 v_pk_add_f32 v[56:57],v[56:57],v[64:65]
 v_pk_add_f32 v[58:59],v[58:59],v[66:67]
 v_cmp_gt_u32 vcc,2176,v115
 v_and_or_b32 v56,v56,s85,v116
 v_and_or_b32 v57,v57,s85,v116
 v_and_or_b32 v58,v58,s85,v116
 v_and_or_b32 v59,v59,s85,v116
 s_mul_i32 s53,s5,2560
 s_add_u32 s53,s53,s78
 s_mov_b64 exec,vcc
 s_add_u32 s52,s53,0
 buffer_store_dwordx4 v[56:59],v115,s[32:35],s52 offen sc1
 s_mov_b64 exec,-1
Lw_11:
 s_xor_b32 s48,s49,1
 s_cmp_lg_u32 s48,0
 s_cbranch_scc1 Lp_12
 v_mov_b32 v60,v56
 v_mov_b32 v64,v56
 v_mov_b32 v61,v57
 v_mov_b32 v65,v57
 v_mov_b32 v62,v58
 v_mov_b32 v66,v58
 v_mov_b32 v63,v59
 v_mov_b32 v67,v59
 s_mov_b64 exec,s[100:101]
 s_add_u32 s52,s50,0
 buffer_load_dwordx4 v[60:63],v114,s[32:35],s52 offen sc1
 s_mov_b64 exec,s[0:1]
 s_add_u32 s52,s50,20480
 buffer_load_dwordx4 v[64:67],v114,s[32:35],s52 offen sc1
 s_mov_b64 exec,-1
Lp_12:
 ds_read_b64_tr_b16 v[40:41],v5 offset:0
 ds_read_b64_tr_b16 v[42:43],v5 offset:256
 ds_read_b64_tr_b16 v[44:45],v5 offset:1024
 ds_read_b64_tr_b16 v[46:47],v5 offset:1280
 ds_read_b64_tr_b16 v[48:49],v5 offset:2048
 ds_read_b64_tr_b16 v[50:51],v5 offset:2304
 ds_read_b64_tr_b16 v[52:53],v5 offset:3072
 ds_read_b64_tr_b16 v[54:55],v5 offset:3328
 s_waitcnt lgkmcnt(6)
 v_mfma_f32_32x32x16_bf16 v[120:135],v[40:43],v[136:139],0
 ds_read_b128 v[106:109],v104 offset:0
 s_waitcnt lgkmcnt(0)
 v_add_f32 v106,v106,v107
 ds_read_b64_tr_b16 v[40:41],v5 offset:4096
 ds_read_b64_tr_b16 v[42:43],v5 offset:4352
 v_mfma_f32_32x32x16_bf16 v[120:135],v[44:47],v[140:143],v[120:135]
 v_add_f32 v108,v108,v109
 v_add_f32 v106,v106,v108
 ds_read_b64_tr_b16 v[44:45],v5 offset:5120
 ds_read_b64_tr_b16 v[46:47],v5 offset:5376
 v_mfma_f32_32x32x16_bf16 v[120:135],v[48:51],v[144:147],v[120:135]
 v_cvt_pk_bf16_f32 v107,v106,v106
 v_lshlrev_b32 v107,16,v107
 ds_read_b64_tr_b16 v[48:49],v5 offset:6144
 ds_read_b64_tr_b16 v[50:51],v5 offset:6400
 v_mfma_f32_32x32x16_bf16 v[120:135],v[52:55],v[148:151],v[120:135]
 v_sub_f32 v107,v106,v107
 v_cvt_pk_bf16_f32 v19,v106,v107
 ds_read_b64_tr_b16 v[52:53],v5 offset:7168
 ds_read_b64_tr_b16 v[54:55],v5 offset:7424
 s_waitcnt lgkmcnt(6)
 v_mfma_f32_32x32x16_bf16 v[120:135],v[40:43],v[152:155],v[120:135]
 v_lshrrev_b32 v110,2,v0
 s_lshl_b32 s53,s4,4
 v_add_u32 v110,s53,v110
 v_lshlrev_b32 v110,10,v110
 v_and_b32 v111,3,v0
 v_lshl_add_u32 v110,v111,4,v110
 buffer_load_dwordx4 a[240:243],v110,s[8:11],s80 offen
 buffer_load_dwordx4 a[244:247],v110,s[8:11],s80 offen offset:64
 s_sub_u32 s60,s63,s62
 s_add_u32 s63,s62,64
 s_cmp_lt_u32 s6,11
 s_cselect_b32 s63,s63,0x10000000
 s_lshl_b32 s53,s4,13
 s_add_u32 s53,s53,131072
 v_add_u32 v18,s53,v1
 s_lshr_b32 s52,s4,1
 s_lshl_b32 s53,s52,12
 s_and_b32 s96,s4,1
 s_lshl_b32 s96,s96,8
 s_add_u32 s53,s53,s96
 s_add_u32 s53,s53,131072
 v_lshl_add_u32 v15,v17,10,v3
 v_add_u32 v15,s53,v15
 s_add_u32 s36,s95,0
 s_and_b32 s36,s36,7
 s_and_b32 s96,s36,1
 s_lshl_b32 s36,s36,1
 s_add_u32 s36,s36,s96
 s_lshl_b32 s36,s36,11
 s_xor_b32 s8,s36,2048
 s_add_u32 s37,s95,1
 s_and_b32 s37,s37,7
 s_and_b32 s96,s37,1
 s_lshl_b32 s37,s37,1
 s_add_u32 s37,s37,s96
 s_lshl_b32 s37,s37,11
 s_xor_b32 s9,s37,2048
 s_add_u32 s38,s95,2
 s_and_b32 s38,s38,7
 s_and_b32 s96,s38,1
 s_lshl_b32 s38,s38,1
 s_add_u32 s38,s38,s96
 s_lshl_b32 s38,s38,11
 s_xor_b32 s10,s38,2048
 s_add_u32 s39,s95,3
 s_and_b32 s39,s39,7
 s_and_b32 s96,s39,1
 s_lshl_b32 s39,s39,1
 s_add_u32 s39,s39,s96
 s_lshl_b32 s39,s39,11
 s_xor_b32 s11,s39,2048
 s_add_u32 s40,s95,4
 s_and_b32 s40,s40,7
 s_and_b32 s96,s40,1
 s_lshl_b32 s40,s40,1
 s_add_u32 s40,s40,s96
 s_lshl_b32 s40,s40,11
 s_xor_b32 s57,s40,2048
 s_add_u32 s41,s95,5
 s_and_b32 s41,s41,7
 s_and_b32 s96,s41,1
 s_lshl_b32 s41,s41,1
 s_add_u32 s41,s41,s96
 s_lshl_b32 s41,s41,11
 s_xor_b32 s77,s41,2048
 s_add_u32 s42,s95,6
 s_and_b32 s42,s42,7
 s_and_b32 s96,s42,1
 s_lshl_b32 s42,s42,1
 s_add_u32 s42,s42,s96
 s_lshl_b32 s42,s42,11
 s_xor_b32 s81,s42,2048
 s_add_u32 s43,s95,7
 s_and_b32 s43,s43,7
 s_and_b32 s96,s43,1
 s_lshl_b32 s43,s43,1
 s_add_u32 s43,s43,s96
 s_lshl_b32 s43,s43,11
 s_xor_b32 s99,s43,2048
 s_mov_b32 s44,0x1ec49860
 s_cmp_eq_u32 s52,0
 s_cselect_b32 s44,s44,0x20d51c81
 s_mov_b32 s45,0x20d51c81
 s_cmp_eq_u32 s52,0
 s_cselect_b32 s45,s45,0xa2a4e51
 s_mov_b32 s46,0xa2a4e51
 s_cmp_eq_u32 s52,0
 s_cselect_b32 s46,s46,0xc303968
 s_mov_b32 s47,0xab968
 s_cmp_eq_u32 s52,0
 s_cselect_b32 s47,s47,0xabd89
 ds_read_b64_tr_b16 v[40:41],v5 offset:8192
 ds_read_b64_tr_b16 v[42:43],v5 offset:8448
 s_waitcnt lgkmcnt(6)
 v_mfma_f32_32x32x16_bf16 v[120:135],v[44:47],v[156:159],v[120:135]
 s_add_u32 s96,s59,0
 s_and_b32 s96,s96,7
 s_lshl_b32 s96,s96,16
 s_add_u32 s96,s96,s66
 s_add_u32 m0,s54,98304
 s_add_u32 s52,s96,0
 buffer_load_dwordx4 v9,s[16:19],s52 offen lds
 s_add_u32 m0,s54,102400
 s_add_u32 s52,s96,8192
 buffer_load_dwordx4 v9,s[16:19],s52 offen lds
 ds_read_b64_tr_b16 v[44:45],v5 offset:9216
 ds_read_b64_tr_b16 v[46:47],v5 offset:9472
 s_waitcnt lgkmcnt(6)
 v_mfma_f32_32x32x16_bf16 v[120:135],v[48:51],v[160:163],v[120:135]
 ds_read_b64_tr_b16 v[48:49],v5 offset:10240
 ds_read_b64_tr_b16 v[50:51],v5 offset:10496
 s_waitcnt lgkmcnt(6)
 v_mfma_f32_32x32x16_bf16 v[120:135],v[52:55],v[164:167],v[120:135]
 s_add_u32 s96,s59,1
 s_and_b32 s96,s96,7
 s_lshl_b32 s96,s96,16
 s_add_u32 s96,s96,s66
 s_add_u32 m0,s54,106496
 s_add_u32 s52,s96,0
 buffer_load_dwordx4 v9,s[16:19],s52 offen lds
 s_add_u32 m0,s54,110592
 s_add_u32 s52,s96,8192
 buffer_load_dwordx4 v9,s[16:19],s52 offen lds
 ds_read_b64_tr_b16 v[52:53],v5 offset:11264
 ds_read_b64_tr_b16 v[54:55],v5 offset:11520
 s_waitcnt lgkmcnt(6)
 v_mfma_f32_32x32x16_bf16 v[120:135],v[40:43],v[168:171],v[120:135]
 ds_read_b64_tr_b16 v[40:41],v5 offset:12288
 ds_read_b64_tr_b16 v[42:43],v5 offset:12544
 s_waitcnt lgkmcnt(6)
 v_mfma_f32_32x32x16_bf16 v[120:135],v[44:47],v[172:175],v[120:135]
 s_add_u32 s96,s59,2
 s_and_b32 s96,s96,7
 s_lshl_b32 s96,s96,16
 s_add_u32 s96,s96,s66
 s_add_u32 m0,s54,114688
 s_add_u32 s52,s96,0
 buffer_load_dwordx4 v9,s[16:19],s52 offen lds
 s_add_u32 m0,s54,118784
 s_add_u32 s52,s96,8192
 buffer_load_dwordx4 v9,s[16:19],s52 offen lds
 ds_read_b64_tr_b16 v[44:45],v5 offset:13312
 ds_read_b64_tr_b16 v[46:47],v5 offset:13568
 s_waitcnt lgkmcnt(6)
 v_mfma_f32_32x32x16_bf16 v[120:135],v[48:51],v[176:179],v[120:135]
 ds_read_b64_tr_b16 v[48:49],v5 offset:14336
 ds_read_b64_tr_b16 v[50:51],v5 offset:14592
 s_waitcnt lgkmcnt(6)
 v_mfma_f32_32x32x16_bf16 v[120:135],v[52:55],v[180:183],v[120:135]
 s_add_u32 s96,s59,3
 s_and_b32 s96,s96,7
 s_lshl_b32 s96,s96,16
 s_add_u32 s96,s96,s66
 s_add_u32 m0,s54,122880
 s_add_u32 s52,s96,0
 buffer_load_dwordx4 v9,s[16:19],s52 offen lds
 s_add_u32 m0,s54,126976
 s_add_u32 s52,s96,8192
 buffer_load_dwordx4 v9,s[16:19],s52 offen lds
 ds_read_b64_tr_b16 v[52:53],v5 offset:15360
 ds_read_b64_tr_b16 v[54:55],v5 offset:15616
 s_waitcnt lgkmcnt(6)
 v_mfma_f32_32x32x16_bf16 v[120:135],v[40:43],v[184:187],v[120:135]
 ds_read_b64_tr_b16 v[40:41],v5 offset:16384
 ds_read_b64_tr_b16 v[42:43],v5 offset:16640
 s_waitcnt lgkmcnt(6)
 v_mfma_f32_32x32x16_bf16 v[120:135],v[44:47],v[188:191],v[120:135]
 s_add_u32 s96,s59,4
 s_and_b32 s96,s96,7
 s_lshl_b32 s96,s96,16
 s_add_u32 s96,s96,s66
 s_add_u32 m0,s54,139264
 s_add_u32 s52,s96,0
 buffer_load_dwordx4 v9,s[16:19],s52 offen lds
 s_add_u32 m0,s54,143360
 s_add_u32 s52,s96,8192
 buffer_load_dwordx4 v9,s[16:19],s52 offen lds
 ds_read_b64_tr_b16 v[44:45],v5 offset:17408
 ds_read_b64_tr_b16 v[46:47],v5 offset:17664
 s_waitcnt lgkmcnt(6)
 v_mfma_f32_32x32x16_bf16 v[120:135],v[48:51],v[192:195],v[120:135]
 ds_read_b64_tr_b16 v[48:49],v5 offset:18432
 ds_read_b64_tr_b16 v[50:51],v5 offset:18688
 s_waitcnt lgkmcnt(6)
 v_mfma_f32_32x32x16_bf16 v[120:135],v[52:55],v[196:199],v[120:135]
 ds_read_b64_tr_b16 v[52:53],v5 offset:19456
 ds_read_b64_tr_b16 v[54:55],v5 offset:19712
 s_waitcnt lgkmcnt(6)
 v_mfma_f32_32x32x16_bf16 v[120:135],v[40:43],v[200:203],v[120:135]
 ds_read_b64_tr_b16 v[40:41],v5 offset:20480
 ds_read_b64_tr_b16 v[42:43],v5 offset:20736
 s_waitcnt lgkmcnt(6)
 v_mfma_f32_32x32x16_bf16 v[120:135],v[44:47],v[204:207],v[120:135]
 ds_read_b64_tr_b16 v[44:45],v5 offset:21504
 ds_read_b64_tr_b16 v[46:47],v5 offset:21760
 s_waitcnt lgkmcnt(6)
 v_mfma_f32_32x32x16_bf16 v[120:135],v[48:51],v[208:211],v[120:135]
 ds_read_b64_tr_b16 v[48:49],v5 offset:22528
 ds_read_b64_tr_b16 v[50:51],v5 offset:22784
 s_waitcnt lgkmcnt(6)
 v_mfma_f32_32x32x16_bf16 v[120:135],v[52:55],v[212:215],v[120:135]
 ds_read_b64_tr_b16 v[52:53],v5 offset:23552
 ds_read_b64_tr_b16 v[54:55],v5 offset:23808
 s_waitcnt lgkmcnt(6)
 v_mfma_f32_32x32x16_bf16 v[120:135],v[40:43],v[216:219],v[120:135]
 ds_read_b64_tr_b16 v[40:41],v5 offset:24576
 ds_read_b64_tr_b16 v[42:43],v5 offset:24832
 s_waitcnt lgkmcnt(6)
 v_mfma_f32_32x32x16_bf16 v[120:135],v[44:47],v[220:223],v[120:135]
 ds_read_b64_tr_b16 v[44:45],v5 offset:25600
 ds_read_b64_tr_b16 v[46:47],v5 offset:25856
 s_waitcnt lgkmcnt(6)
 v_mfma_f32_32x32x16_bf16 v[120:135],v[48:51],v[224:227],v[120:135]
 ds_read_b64_tr_b16 v[48:49],v5 offset:26624
 ds_read_b64_tr_b16 v[50:51],v5 offset:26880
 s_waitcnt lgkmcnt(6)
 v_mfma_f32_32x32x16_bf16 v[120:135],v[52:55],v[228:231],v[120:135]
 ds_read_b64_tr_b16 v[52:53],v5 offset:27648
 ds_read_b64_tr_b16 v[54:55],v5 offset:27904
 s_waitcnt lgkmcnt(6)
 v_mfma_f32_32x32x16_bf16 v[120:135],v[40:43],v[232:235],v[120:135]
 s_cmp_lg_u32 s48,0
 s_cbranch_scc1 Lp_13
 s_waitcnt vmcnt(12)
 v_xor_b32 v118,v60,v116
 v_bitop3_b32 v118,v63,v116,v118 bitop3:0xbe
 v_bitop3_b32 v118,v64,v116,v118 bitop3:0xbe
 v_bitop3_b32 v118,v67,v116,v118 bitop3:0xbe
 v_and_b32 v118,0xff,v118
 v_cmp_ne_u32 vcc,0,v118
 s_cbranch_vccnz La_14
 v_pk_add_f32 v[60:61],v[60:61],v[64:65]
 v_pk_add_f32 v[62:63],v[62:63],v[66:67]
 s_nop 0
 v_add_f32_dpp v60,v60,v60 row_ror:8 row_mask:0xf bank_mask:0xf
 v_add_f32_dpp v61,v61,v61 row_ror:8 row_mask:0xf bank_mask:0xf
 v_add_f32_dpp v62,v62,v62 row_ror:8 row_mask:0xf bank_mask:0xf
 v_add_f32_dpp v63,v63,v63 row_ror:8 row_mask:0xf bank_mask:0xf
 v_permlane16_swap_b32 v60,v61
 s_nop 0
 v_permlane16_swap_b32 v62,v63
 v_add_f32 v60,v60,v61
 v_add_f32 v62,v62,v63
 s_nop 1
 v_permlane32_swap_b32 v60,v62
 v_add_f32 v60,v60,v62
 v_mul_f32 v60,s3,v60
 v_mov_b32 v61,v60
 s_nop 1
 v_permlane16_swap_b32 v60,v61
 v_cvt_pk_bf16_f32 v60,v60,v61
 s_mov_b32 exec_lo,0xff
 s_mov_b32 exec_hi,0xff
 s_add_u32 s52,s51,0
 buffer_store_dword v60,v117,s[32:35],s52 offen sc1
 s_mov_b64 exec,-1
 s_mov_b32 s48,1
 s_branch Lb_15
La_14:
 s_mov_b64 exec,s[100:101]
 s_add_u32 s52,s50,0
 buffer_load_dwordx4 v[60:63],v114,s[32:35],s52 offen sc1
 s_mov_b64 exec,s[0:1]
 s_add_u32 s52,s50,20480
 buffer_load_dwordx4 v[64:67],v114,s[32:35],s52 offen sc1
 s_mov_b64 exec,-1
Lb_15:
Lp_13:
 ds_read_b64_tr_b16 v[40:41],v5 offset:28672
 ds_read_b64_tr_b16 v[42:43],v5 offset:28928
 s_waitcnt lgkmcnt(6)
 v_mfma_f32_32x32x16_bf16 v[120:135],v[44:47],v[236:239],v[120:135]
 ds_read_b64_tr_b16 v[44:45],v5 offset:29696
 ds_read_b64_tr_b16 v[46:47],v5 offset:29952
 s_waitcnt lgkmcnt(6)
 v_mfma_f32_32x32x16_bf16 v[120:135],v[48:51],v[240:243],v[120:135]
 ds_read_b64_tr_b16 v[48:49],v5 offset:30720
 ds_read_b64_tr_b16 v[50:51],v5 offset:30976
 s_waitcnt lgkmcnt(6)
 v_mfma_f32_32x32x16_bf16 v[120:135],v[52:55],v[244:247],v[120:135]
 ds_read_b64_tr_b16 v[52:53],v5 offset:31744
 ds_read_b64_tr_b16 v[54:55],v5 offset:32000
 s_waitcnt lgkmcnt(6)
 v_mfma_f32_32x32x16_bf16 v[120:135],v[40:43],v[248:251],v[120:135]
 s_waitcnt lgkmcnt(4)
 v_mfma_f32_32x32x16_bf16 v[120:135],v[44:47],v[252:255],v[120:135]
 s_waitcnt lgkmcnt(2)
 v_mfma_f32_32x32x16_bf16 v[120:135],v[48:51],a[248:251],v[120:135]
 s_waitcnt lgkmcnt(0)
 v_mfma_f32_32x32x16_bf16 v[120:135],v[52:55],a[252:255],v[120:135]
 v_mov_b32 v28,v19
 v_mov_b32 v29,v19
 s_nop 1
 v_mfma_f32_32x32x16_bf16 v[120:135],v[28:31],v[24:27],v[120:135]
 v_lshlrev_b32 v35,8,v17
 v_sub_u32 v4,v4,v35
 v_sub_u32 v5,v5,v35
 v_sub_u32 v6,v6,v35
 s_barrier
 s_cmp_lg_u32 s48,0
 s_cbranch_scc1 Lp_16
 s_waitcnt vmcnt(0)
 v_xor_b32 v118,v60,v116
 v_bitop3_b32 v118,v63,v116,v118 bitop3:0xbe
 v_bitop3_b32 v118,v64,v116,v118 bitop3:0xbe
 v_bitop3_b32 v118,v67,v116,v118 bitop3:0xbe
 v_and_b32 v118,0xff,v118
 v_cmp_ne_u32 vcc,0,v118
 s_cbranch_vccnz La_17
 v_pk_add_f32 v[60:61],v[60:61],v[64:65]
 v_pk_add_f32 v[62:63],v[62:63],v[66:67]
 s_nop 0
 v_add_f32_dpp v60,v60,v60 row_ror:8 row_mask:0xf bank_mask:0xf
 v_add_f32_dpp v61,v61,v61 row_ror:8 row_mask:0xf bank_mask:0xf
 v_add_f32_dpp v62,v62,v62 row_ror:8 row_mask:0xf bank_mask:0xf
 v_add_f32_dpp v63,v63,v63 row_ror:8 row_mask:0xf bank_mask:0xf
 v_permlane16_swap_b32 v60,v61
 s_nop 0
 v_permlane16_swap_b32 v62,v63
 v_add_f32 v60,v60,v61
 v_add_f32 v62,v62,v63
 s_nop 1
 v_permlane32_swap_b32 v60,v62
 v_add_f32 v60,v60,v62
 v_mul_f32 v60,s3,v60
 v_mov_b32 v61,v60
 s_nop 1
 v_permlane16_swap_b32 v60,v61
 v_cvt_pk_bf16_f32 v60,v60,v61
 s_mov_b32 exec_lo,0xff
 s_mov_b32 exec_hi,0xff
 s_add_u32 s52,s51,0
 buffer_store_dword v60,v117,s[32:35],s52 offen sc1
 s_mov_b64 exec,-1
 s_mov_b32 s48,1
 s_branch Lb_18
La_17:
 s_mov_b64 exec,s[100:101]
 s_add_u32 s52,s50,0
 buffer_load_dwordx4 v[60:63],v114,s[32:35],s52 offen sc1
 s_mov_b64 exec,s[0:1]
 s_add_u32 s52,s50,20480
 buffer_load_dwordx4 v[64:67],v114,s[32:35],s52 offen sc1
 s_mov_b64 exec,-1
Lb_18:
Lp_16:
 s_add_u32 s96,s59,5
 s_and_b32 s96,s96,7
 s_lshl_b32 s96,s96,16
 s_add_u32 s96,s96,s66
 s_add_u32 m0,s54,131072
 s_add_u32 s52,s96,0
 buffer_load_dwordx4 v9,s[16:19],s52 offen lds
 s_add_u32 m0,s54,135168
 s_add_u32 s52,s96,8192
 buffer_load_dwordx4 v9,s[16:19],s52 offen lds
 s_add_u32 s96,s59,6
 s_and_b32 s96,s96,7
 s_lshl_b32 s96,s96,16
 s_add_u32 s96,s96,s66
 s_add_u32 m0,s54,147456
 s_add_u32 s52,s96,0
 buffer_load_dwordx4 v9,s[16:19],s52 offen lds
 s_add_u32 m0,s54,151552
 s_add_u32 s52,s96,8192
 buffer_load_dwordx4 v9,s[16:19],s52 offen lds
 s_add_u32 s96,s59,7
 s_and_b32 s96,s96,7
 s_lshl_b32 s96,s96,16
 s_add_u32 s96,s96,s66
 s_add_u32 m0,s54,155648
 s_add_u32 s52,s96,0
 buffer_load_dwordx4 v9,s[16:19],s52 offen lds
 s_add_u32 m0,s54,159744
 s_add_u32 s52,s96,8192
 buffer_load_dwordx4 v9,s[16:19],s52 offen lds
 v_fma_f32 v120,v120,v16,s88
 v_fma_f32 v121,v121,v16,s88
 v_fma_f32 v122,v122,v16,s88
 v_fma_f32 v123,v123,v16,s88
 v_fma_f32 v124,v124,v16,s88
 v_fma_f32 v125,v125,v16,s88
 v_fma_f32 v126,v126,v16,s88
 v_fma_f32 v127,v127,v16,s88
 v_exp_f32_e64 v72,v120 clamp
 v_exp_f32_e64 v73,v121 clamp
 v_exp_f32_e64 v74,v122 clamp
 v_exp_f32_e64 v75,v123 clamp
 v_exp_f32_e64 v76,v124 clamp
 v_exp_f32_e64 v77,v125 clamp
 v_exp_f32_e64 v78,v126 clamp
 v_exp_f32_e64 v79,v127 clamp
 v_max_f32 v120,s88,v120
 v_max_f32 v121,s88,v121
 v_max_f32 v122,s88,v122
 v_max_f32 v123,s88,v123
 v_max_f32 v124,s88,v124
 v_max_f32 v125,s88,v125
 v_max_f32 v126,s88,v126
 v_max_f32 v127,s88,v127
 v_pk_fma_f32 v[120:121],v[120:121],s[90:91],v[72:73]
 v_pk_fma_f32 v[122:123],v[122:123],s[90:91],v[74:75]
 v_pk_fma_f32 v[124:125],v[124:125],s[90:91],v[76:77]
 v_pk_fma_f32 v[126:127],v[126:127],s[90:91],v[78:79]
 v_cvt_pk_bf16_f32 v120,v120,v121
 v_cvt_pk_bf16_f32 v121,v122,v123
 v_cvt_pk_bf16_f32 v122,v124,v125
 v_cvt_pk_bf16_f32 v123,v126,v127
 v_fma_f32 v128,v128,v16,s88
 v_fma_f32 v129,v129,v16,s88
 v_fma_f32 v130,v130,v16,s88
 v_fma_f32 v131,v131,v16,s88
 v_fma_f32 v132,v132,v16,s88
 v_fma_f32 v133,v133,v16,s88
 v_fma_f32 v134,v134,v16,s88
 v_fma_f32 v135,v135,v16,s88
 v_exp_f32_e64 v72,v128 clamp
 v_exp_f32_e64 v73,v129 clamp
 v_exp_f32_e64 v74,v130 clamp
 v_exp_f32_e64 v75,v131 clamp
 v_exp_f32_e64 v76,v132 clamp
 v_exp_f32_e64 v77,v133 clamp
 v_exp_f32_e64 v78,v134 clamp
 v_exp_f32_e64 v79,v135 clamp
 v_max_f32 v128,s88,v128
 v_max_f32 v129,s88,v129
 v_max_f32 v130,s88,v130
 v_max_f32 v131,s88,v131
 v_max_f32 v132,s88,v132
 v_max_f32 v133,s88,v133
 v_max_f32 v134,s88,v134
 v_max_f32 v135,s88,v135
 v_pk_fma_f32 v[128:129],v[128:129],s[90:91],v[72:73]
 v_pk_fma_f32 v[130:131],v[130:131],s[90:91],v[74:75]
 v_pk_fma_f32 v[132:133],v[132:133],s[90:91],v[76:77]
 v_pk_fma_f32 v[134:135],v[134:135],s[90:91],v[78:79]
 v_cvt_pk_bf16_f32 v124,v128,v129
 v_cvt_pk_bf16_f32 v125,v130,v131
 v_cvt_pk_bf16_f32 v126,v132,v133
 v_cvt_pk_bf16_f32 v127,v134,v135
 s_add_u32 s52,s94,0
 buffer_store_dwordx4 v[120:123],v1,s[32:35],s52 offen
 s_add_u32 s52,s94,0
 buffer_store_dwordx4 v[124:127],v1,s[32:35],s52 offen offset:1024
 v_mov_b32 v96,0
 v_mov_b32 v97,0
 v_mov_b32 v98,0
 v_mov_b32 v99,0
 s_and_b32 s53,s4,1
 s_mul_i32 s53,s53,1792
 s_add_u32 s53,s53,s67
 s_add_u32 s52,s53,0
 buffer_store_dwordx4 v[96:99],v1,s[32:35],s52 offen
 s_add_u32 s52,s53,0
 buffer_store_dwordx4 v[96:99],v1,s[32:35],s52 offen offset:1024
 s_add_u32 s52,s64,0
 buffer_store_dwordx4 v[96:99],v1,s[32:35],s52 offen
 s_add_u32 s52,s64,0
 buffer_store_dwordx4 v[96:99],v1,s[32:35],s52 offen offset:1024
 s_add_u32 s52,s64,2048
 buffer_store_dwordx4 v[96:99],v1,s[32:35],s52 offen
 s_add_u32 s52,s64,2048
 buffer_store_dwordx4 v[96:99],v1,s[32:35],s52 offen offset:1024
 s_cmp_ge_u32 s6,11
 s_cbranch_scc1 Lr3_19
 s_add_u32 s52,s64,4096
 buffer_store_dwordx4 v[96:99],v1,s[32:35],s52 offen
 s_add_u32 s52,s64,4096
 buffer_store_dwordx4 v[96:99],v1,s[32:35],s52 offen offset:1024
Lr3_19:
 v_and_b32 v100,512,v3
 v_add_u32 v100,v100,v3
 s_mov_b32 exec_hi,0
 s_add_u32 s52,s79,0
 buffer_store_dword v96,v100,s[32:35],s52 offen
 s_add_u32 s52,s79,131072
 buffer_store_dword v96,v100,s[32:35],s52 offen
 s_add_u32 s52,s79,262144
 buffer_store_dword v96,v100,s[32:35],s52 offen
 s_mov_b64 exec,-1
 v_and_b32 v36,15,v0
 v_lshlrev_b32 v36,4,v36
 v_lshl_add_u32 v36,v17,8,v36
 v_lshlrev_b32 v37,4,v17
 v_add_u32 v37,512,v37
 v_and_b32 v38,16,v0
 v_cmp_ne_u32 vcc,0,v38
 s_nop 1
 v_cndmask_b32 v36,v36,v37,vcc
 s_mul_i32 s53,s4,544
 v_add_u32 v253,s53,v36
 s_cmp_lg_u32 s48,0
 s_cbranch_scc1 Lp_20
 s_waitcnt vmcnt(17)
Lg_21:
 v_xor_b32 v118,v60,v116
 v_bitop3_b32 v118,v63,v116,v118 bitop3:0xbe
 v_bitop3_b32 v118,v64,v116,v118 bitop3:0xbe
 v_bitop3_b32 v118,v67,v116,v118 bitop3:0xbe
 v_and_b32 v118,0xff,v118
 v_cmp_ne_u32 vcc,0,v118
 s_cbranch_vccz Lgd_22
 s_mov_b64 exec,s[100:101]
 s_add_u32 s52,s50,0
 buffer_load_dwordx4 v[60:63],v114,s[32:35],s52 offen sc1
 s_mov_b64 exec,s[0:1]
 s_add_u32 s52,s50,20480
 buffer_load_dwordx4 v[64:67],v114,s[32:35],s52 offen sc1
 s_mov_b64 exec,-1
 s_waitcnt vmcnt(0)
 s_sub_u32 s55,s55,1
 s_cbranch_scc0 Lg_21
 s_mov_b32 s55,0
Lgd_22:
 v_pk_add_f32 v[60:61],v[60:61],v[64:65]
 v_pk_add_f32 v[62:63],v[62:63],v[66:67]
 s_nop 0
 v_add_f32_dpp v60,v60,v60 row_ror:8 row_mask:0xf bank_mask:0xf
 v_add_f32_dpp v61,v61,v61 row_ror:8 row_mask:0xf bank_mask:0xf
 v_add_f32_dpp v62,v62,v62 row_ror:8 row_mask:0xf bank_mask:0xf
 v_add_f32_dpp v63,v63,v63 row_ror:8 row_mask:0xf bank_mask:0xf
 v_permlane16_swap_b32 v60,v61
 s_nop 0
 v_permlane16_swap_b32 v62,v63
 v_add_f32 v60,v60,v61
 v_add_f32 v62,v62,v63
 s_nop 1
 v_permlane32_swap_b32 v60,v62
 v_add_f32 v60,v60,v62
 v_mul_f32 v60,s3,v60
 v_mov_b32 v61,v60
 s_nop 1
 v_permlane16_swap_b32 v60,v61
 v_cvt_pk_bf16_f32 v60,v60,v61
 s_mov_b32 exec_lo,0xff
 s_mov_b32 exec_hi,0xff
 s_add_u32 s52,s51,0
 buffer_store_dword v60,v117,s[32:35],s52 offen sc1
 s_mov_b64 exec,-1
 s_mov_b32 s48,1
 s_waitcnt vmcnt(1)
 s_mov_b64 exec,1
 v_mov_b32 v118,s7
 s_add_u32 s53,s97,0
 buffer_store_dword v118,off,s[32:35],s53
 s_mov_b64 exec,-1
 s_mov_b32 s48,0
Lp_20:
 s_cmp_eq_u32 s48,0
 s_cbranch_scc1 Lsk_23
 v_mov_b32 v35,s7
 s_add_u32 s53,s97,0
 s_waitcnt vmcnt(0)
 s_mov_b64 s[82:83],exec
 s_mov_b64 exec,1
 buffer_store_dword v35,off,s[32:35],s53
 s_mov_b64 exec,s[82:83]
Lsk_23:
 s_cmp_ge_u32 s65,3
 s_cbranch_scc1 Lc_24
 s_lshl_b32 s96,s65,7
 s_add_u32 s96,s96,s78
Lc_25:
 s_add_u32 s52,s96,2176
 buffer_load_dwordx4 v[60:63],v114,s[32:35],s52 offen sc1
 s_add_u32 s52,s96,22656
 buffer_load_dwordx4 v[64:67],v114,s[32:35],s52 offen sc1
 s_waitcnt vmcnt(1)
 v_xor_b32 v118,v60,v116
 v_bitop3_b32 v118,v61,v116,v118 bitop3:0xbe
 v_bitop3_b32 v118,v62,v116,v118 bitop3:0xbe
 v_bitop3_b32 v118,v63,v116,v118 bitop3:0xbe
 s_waitcnt vmcnt(0)
 v_bitop3_b32 v118,v64,v116,v118 bitop3:0xbe
 v_bitop3_b32 v118,v65,v116,v118 bitop3:0xbe
 v_bitop3_b32 v118,v66,v116,v118 bitop3:0xbe
 v_bitop3_b32 v118,v67,v116,v118 bitop3:0xbe
 v_and_b32 v118,0xff,v118
 v_cmp_ne_u32 vcc,0,v118
 s_cbranch_vccz Lc_26
 s_sub_u32 s55,s55,1
 s_cbranch_scc0 Lc_25
 s_mov_b32 s55,0
Lc_26:
 v_pk_add_f32 v[60:61],v[60:61],v[64:65]
 v_pk_add_f32 v[62:63],v[62:63],v[66:67]
 s_nop 0
 v_add_f32_dpp v60,v60,v60 row_ror:8 row_mask:0xf bank_mask:0xf
 v_add_f32_dpp v61,v61,v61 row_ror:8 row_mask:0xf bank_mask:0xf
 v_add_f32_dpp v62,v62,v62 row_ror:8 row_mask:0xf bank_mask:0xf
 v_add_f32_dpp v63,v63,v63 row_ror:8 row_mask:0xf bank_mask:0xf
 v_permlane16_swap_b32 v60,v61
 s_nop 0
 v_permlane16_swap_b32 v62,v63
 v_add_f32 v60,v60,v61
 v_add_f32 v62,v62,v63
 s_nop 1
 v_permlane32_swap_b32 v60,v62
 v_add_f32 v60,v60,v62
 v_cvt_pk_bf16_f32 v61,v60,v60
 v_lshlrev_b32 v61,16,v61
 v_sub_f32 v61,v60,v61
 v_cvt_pk_bf16_f32 v60,v60,v61
 v_and_b32 v61,7,v0
 v_lshlrev_b32 v61,4,v61
 v_lshrrev_b32 v62,4,v0
 v_lshl_add_u32 v61,v62,2,v61
 s_mul_i32 s53,s6,384
 s_lshl_b32 s96,s65,7
 s_add_u32 s53,s53,s96
 s_mov_b32 exec_lo,0x00ff00ff
 s_mov_b32 exec_hi,0x00ff00ff
 s_add_u32 s52,s53,1441792
 buffer_store_dword v60,v61,s[32:35],s52 offen sc1
 s_mov_b64 exec,-1
Lc_24:
 s_waitcnt vmcnt(11)
 v_add_u32 v12,0x10000,v10
 v_add_u32 v14,0x10000,v11
 ds_read_b64_tr_b16 a[176:177],v12 offset:32768
 ds_read_b64_tr_b16 a[180:181],v14 offset:32768
 ds_read_b64_tr_b16 a[178:179],v12 offset:36864
 ds_read_b64_tr_b16 a[182:183],v14 offset:36864
 ds_read_b64_tr_b16 a[184:185],v12 offset:40960
 ds_read_b64_tr_b16 a[188:189],v14 offset:40960
 ds_read_b64_tr_b16 a[186:187],v12 offset:45056
 ds_read_b64_tr_b16 a[190:191],v14 offset:45056
 ds_read_b64_tr_b16 a[192:193],v12 offset:49152
 ds_read_b64_tr_b16 a[196:197],v14 offset:49152
 ds_read_b64_tr_b16 a[194:195],v12 offset:53248
 ds_read_b64_tr_b16 a[198:199],v14 offset:53248
 ds_read_b64_tr_b16 a[200:201],v12 offset:57344
 ds_read_b64_tr_b16 a[204:205],v14 offset:57344
 ds_read_b64_tr_b16 a[202:203],v12 offset:61440
 ds_read_b64_tr_b16 a[206:207],v14 offset:61440
 v_add_u32 v12,0x20000,v10
 v_add_u32 v14,0x20000,v11
 ds_read_b64_tr_b16 a[208:209],v12 offset:8192
 ds_read_b64_tr_b16 a[212:213],v14 offset:8192
 ds_read_b64_tr_b16 a[210:211],v12 offset:12288
 ds_read_b64_tr_b16 a[214:215],v14 offset:12288
 ds_read_b64_tr_b16 a[216:217],v12 offset:0
 ds_read_b64_tr_b16 a[220:221],v14 offset:0
 ds_read_b64_tr_b16 a[218:219],v12 offset:4096
 ds_read_b64_tr_b16 a[222:223],v14 offset:4096
 ds_read_b64_tr_b16 a[224:225],v12 offset:16384
 ds_read_b64_tr_b16 a[228:229],v14 offset:16384
 ds_read_b64_tr_b16 a[226:227],v12 offset:20480
 ds_read_b64_tr_b16 a[230:231],v14 offset:20480
 ds_read_b64_tr_b16 a[232:233],v12 offset:24576
 ds_read_b64_tr_b16 a[236:237],v14 offset:24576
 ds_read_b64_tr_b16 a[234:235],v12 offset:28672
 ds_read_b64_tr_b16 a[238:239],v14 offset:28672
 s_waitcnt lgkmcnt(0)
 s_add_u32 s53,s54,131072
 v_add_u32 v35,s53,v1
 v_and_b32 v36,15,v0
 v_lshlrev_b32 v36,6,v36
 v_lshl_add_u32 v36,v17,5,v36
 v_bfe_u32 v37,v0,4,1
 v_lshl_add_u32 v36,v37,3,v36
 v_add_u32 v36,s53,v36
 ds_write_b128 v35,a[240:243] offset:0
 ds_write_b128 v35,a[244:247] offset:4096
 s_waitcnt lgkmcnt(0)
 ds_read_b64 a[240:241],v36 offset:0
 ds_read_b64 a[242:243],v36 offset:16
 ds_read_b64 a[244:245],v36 offset:4096
 ds_read_b64 a[246:247],v36 offset:4112
 s_waitcnt lgkmcnt(0)
 s_bfe_u32 s96,s44,0x50000
 s_lshl_b32 s96,s96,16
 s_add_u32 s96,s96,s66
 s_add_u32 m0,s54,131072
 s_add_u32 s52,s96,0
 buffer_load_dwordx4 v9,s[24:27],s52 offen lds
 s_add_u32 m0,s54,135168
 s_add_u32 s52,s96,8192
 buffer_load_dwordx4 v9,s[24:27],s52 offen lds
 s_bfe_u32 s96,s44,0x50005
 s_lshl_b32 s96,s96,16
 s_add_u32 s96,s96,s66
 s_add_u32 m0,s54,139264
 s_add_u32 s52,s96,0
 buffer_load_dwordx4 v9,s[24:27],s52 offen lds
 s_add_u32 m0,s54,143360
 s_add_u32 s52,s96,8192
 buffer_load_dwordx4 v9,s[24:27],s52 offen lds
 s_bfe_u32 s96,s44,0x5000a
 s_lshl_b32 s96,s96,16
 s_add_u32 s96,s96,s66
 s_add_u32 m0,s54,147456
 s_add_u32 s52,s96,0
 buffer_load_dwordx4 v9,s[24:27],s52 offen lds
 s_add_u32 m0,s54,151552
 s_add_u32 s52,s96,8192
 buffer_load_dwordx4 v9,s[24:27],s52 offen lds
 s_bfe_u32 s96,s44,0x5000f
 s_lshl_b32 s96,s96,16
 s_add_u32 s96,s96,s66
 s_add_u32 m0,s54,155648
 s_add_u32 s52,s96,0
 buffer_load_dwordx4 v9,s[24:27],s52 offen lds
 s_add_u32 m0,s54,159744
 s_add_u32 s52,s96,8192
 buffer_load_dwordx4 v9,s[24:27],s52 offen lds
 s_add_u32 s96,s95,0
 s_and_b32 s96,s96,7
 s_mul_i32 s96,s96,176128
 s_add_u32 s96,s96,s62
 s_add_u32 m0,s54,65536
 s_add_u32 s52,s96,0
 buffer_load_dwordx4 v8,s[20:23],s52 offen lds
 s_add_u32 s96,s96,s60
 s_add_u32 m0,s54,81920
 s_add_u32 s52,s96,0
 buffer_load_dwordx4 v8,s[20:23],s52 offen lds
 s_add_u32 s53,s98,4096
 v_lshlrev_b32 v36,2,v0
Lpoll_27:
 buffer_load_dword v35,v36,s[32:35],s53 offen sc1
 s_waitcnt vmcnt(0)
 v_cmp_ne_u32 vcc,s7,v35
 s_cbranch_vccz Lpd_28
 s_sub_u32 s55,s55,1
 s_cbranch_scc0 Lpoll_27
 s_mov_b32 s55,0
Lpd_28:
 s_add_u32 s96,s59,0
 s_and_b32 s96,s96,7
 s_mul_i32 s96,s96,2176
 s_add_u32 s52,s96,1376256
 buffer_load_dwordx4 v[136:139],v253,s[32:35],s52 offen sc1
 s_add_u32 s96,s59,1
 s_and_b32 s96,s96,7
 s_mul_i32 s96,s96,2176
 s_add_u32 s52,s96,1376256
 buffer_load_dwordx4 v[140:143],v253,s[32:35],s52 offen sc1
 s_add_u32 s96,s59,2
 s_and_b32 s96,s96,7
 s_mul_i32 s96,s96,2176
 s_add_u32 s52,s96,1376256
 buffer_load_dwordx4 v[144:147],v253,s[32:35],s52 offen sc1
 s_add_u32 s96,s59,3
 s_and_b32 s96,s96,7
 s_mul_i32 s96,s96,2176
 s_add_u32 s52,s96,1376256
 buffer_load_dwordx4 v[148:151],v253,s[32:35],s52 offen sc1
 s_add_u32 s96,s59,4
 s_and_b32 s96,s96,7
 s_mul_i32 s96,s96,2176
 s_add_u32 s52,s96,1376256
 buffer_load_dwordx4 v[152:155],v253,s[32:35],s52 offen sc1
 s_add_u32 s96,s59,5
 s_and_b32 s96,s96,7
 s_mul_i32 s96,s96,2176
 s_add_u32 s52,s96,1376256
 buffer_load_dwordx4 v[156:159],v253,s[32:35],s52 offen sc1
 s_add_u32 s96,s59,6
 s_and_b32 s96,s96,7
 s_mul_i32 s96,s96,2176
 s_add_u32 s52,s96,1376256
 buffer_load_dwordx4 v[160:163],v253,s[32:35],s52 offen sc1
 s_add_u32 s96,s59,7
 s_and_b32 s96,s96,7
 s_mul_i32 s96,s96,2176
 s_add_u32 s52,s96,1376256
 buffer_load_dwordx4 v[164:167],v253,s[32:35],s52 offen sc1
 s_add_u32 s96,s59,0
 s_and_b32 s96,s96,7
 s_mul_i32 s96,s96,4096
 s_add_u32 s96,s96,s71
 s_add_u32 s52,s96,0
 buffer_load_dwordx4 v[168:171],v1,s[32:35],s52 offen sc1
 s_add_u32 s96,s59,1
 s_and_b32 s96,s96,7
 s_mul_i32 s96,s96,4096
 s_add_u32 s96,s96,s71
 s_add_u32 s52,s96,0
 buffer_load_dwordx4 v[172:175],v1,s[32:35],s52 offen sc1
 s_add_u32 s96,s59,2
 s_and_b32 s96,s96,7
 s_mul_i32 s96,s96,4096
 s_add_u32 s96,s96,s71
 s_add_u32 s52,s96,0
 buffer_load_dwordx4 v[176:179],v1,s[32:35],s52 offen sc1
 s_add_u32 s96,s59,3
 s_and_b32 s96,s96,7
 s_mul_i32 s96,s96,4096
 s_add_u32 s96,s96,s71
 s_add_u32 s52,s96,0
 buffer_load_dwordx4 v[180:183],v1,s[32:35],s52 offen sc1
 s_add_u32 s96,s59,4
 s_and_b32 s96,s96,7
 s_mul_i32 s96,s96,4096
 s_add_u32 s96,s96,s71
 s_add_u32 s52,s96,0
 buffer_load_dwordx4 v[184:187],v1,s[32:35],s52 offen sc1
 s_add_u32 s96,s59,5
 s_and_b32 s96,s96,7
 s_mul_i32 s96,s96,4096
 s_add_u32 s96,s96,s71
 s_add_u32 s52,s96,0
 buffer_load_dwordx4 v[188:191],v1,s[32:35],s52 offen sc1
 s_add_u32 s96,s59,6
 s_and_b32 s96,s96,7
 s_mul_i32 s96,s96,4096
 s_add_u32 s96,s96,s71
 s_add_u32 s52,s96,0
 buffer_load_dwordx4 v[192:195],v1,s[32:35],s52 offen sc1
 s_add_u32 s96,s59,7
 s_and_b32 s96,s96,7
 s_mul_i32 s96,s96,4096
 s_add_u32 s96,s96,s71
 s_add_u32 s52,s96,0
 buffer_load_dwordx4 v[196:199],v1,s[32:35],s52 offen sc1
 s_add_u32 s96,s59,0
 s_and_b32 s96,s96,7
 s_mul_i32 s96,s96,4096
 s_add_u32 s96,s96,s71
 s_add_u32 s52,s96,32768
 buffer_load_dwordx4 v[200:203],v1,s[32:35],s52 offen sc1
 s_add_u32 s96,s59,1
 s_and_b32 s96,s96,7
 s_mul_i32 s96,s96,4096
 s_add_u32 s96,s96,s71
 s_add_u32 s52,s96,32768
 buffer_load_dwordx4 v[204:207],v1,s[32:35],s52 offen sc1
 s_add_u32 s96,s59,2
 s_and_b32 s96,s96,7
 s_mul_i32 s96,s96,4096
 s_add_u32 s96,s96,s71
 s_add_u32 s52,s96,32768
 buffer_load_dwordx4 v[208:211],v1,s[32:35],s52 offen sc1
 s_add_u32 s96,s59,3
 s_and_b32 s96,s96,7
 s_mul_i32 s96,s96,4096
 s_add_u32 s96,s96,s71
 s_add_u32 s52,s96,32768
 buffer_load_dwordx4 v[212:215],v1,s[32:35],s52 offen sc1
 s_add_u32 s96,s59,4
 s_and_b32 s96,s96,7
 s_mul_i32 s96,s96,4096
 s_add_u32 s96,s96,s71
 s_add_u32 s52,s96,32768
 buffer_load_dwordx4 v[216:219],v1,s[32:35],s52 offen sc1
 s_add_u32 s96,s59,5
 s_and_b32 s96,s96,7
 s_mul_i32 s96,s96,4096
 s_add_u32 s96,s96,s71
 s_add_u32 s52,s96,32768
 buffer_load_dwordx4 v[220:223],v1,s[32:35],s52 offen sc1
 s_add_u32 s96,s59,6
 s_and_b32 s96,s96,7
 s_mul_i32 s96,s96,4096
 s_add_u32 s96,s96,s71
 s_add_u32 s52,s96,32768
 buffer_load_dwordx4 v[224:227],v1,s[32:35],s52 offen sc1
 s_add_u32 s96,s59,7
 s_and_b32 s96,s96,7
 s_mul_i32 s96,s96,4096
 s_add_u32 s96,s96,s71
 s_add_u32 s52,s96,32768
 buffer_load_dwordx4 v[228:231],v1,s[32:35],s52 offen sc1
 ds_read_b64_tr_b16 a[0:1],v12 offset:0
 ds_read_b64_tr_b16 a[4:5],v14 offset:0
 ds_read_b64_tr_b16 a[2:3],v12 offset:4096
 ds_read_b64_tr_b16 a[6:7],v14 offset:4096
 ds_read_b64_tr_b16 a[8:9],v12 offset:8192
 ds_read_b64_tr_b16 a[12:13],v14 offset:8192
 ds_read_b64_tr_b16 a[10:11],v12 offset:12288
 ds_read_b64_tr_b16 a[14:15],v14 offset:12288
 ds_read_b64_tr_b16 a[16:17],v12 offset:16384
 ds_read_b64_tr_b16 a[20:21],v14 offset:16384
 ds_read_b64_tr_b16 a[18:19],v12 offset:20480
 ds_read_b64_tr_b16 a[22:23],v14 offset:20480
 ds_read_b64_tr_b16 a[24:25],v12 offset:24576
 ds_read_b64_tr_b16 a[28:29],v14 offset:24576
 ds_read_b64_tr_b16 a[26:27],v12 offset:28672
 ds_read_b64_tr_b16 a[30:31],v14 offset:28672
Lk_29:
 s_waitcnt vmcnt(23)
 v_max_u32 v37,v136,v137
 v_max3_u32 v37,v138,v139,v37
 s_waitcnt vmcnt(22)
 v_max3_u32 v37,v140,v141,v37
 v_max3_u32 v37,v142,v143,v37
 s_waitcnt vmcnt(21)
 v_max3_u32 v37,v144,v145,v37
 v_max3_u32 v37,v146,v147,v37
 s_waitcnt vmcnt(20)
 v_max3_u32 v37,v148,v149,v37
 v_max3_u32 v37,v150,v151,v37
 s_waitcnt vmcnt(19)
 v_max3_u32 v37,v152,v153,v37
 v_max3_u32 v37,v154,v155,v37
 s_waitcnt vmcnt(18)
 v_max3_u32 v37,v156,v157,v37
 v_max3_u32 v37,v158,v159,v37
 s_waitcnt vmcnt(17)
 v_max3_u32 v37,v160,v161,v37
 v_max3_u32 v37,v162,v163,v37
 s_waitcnt vmcnt(16)
 v_max3_u32 v37,v164,v165,v37
 v_max3_u32 v37,v166,v167,v37
 v_cmp_eq_u32 vcc,-1,v37
 s_cbranch_vccz Lkd_30
 s_add_u32 s96,s59,0
 s_and_b32 s96,s96,7
 s_mul_i32 s96,s96,2176
 s_add_u32 s52,s96,1376256
 buffer_load_dwordx4 v[136:139],v253,s[32:35],s52 offen sc1
 s_add_u32 s96,s59,1
 s_and_b32 s96,s96,7
 s_mul_i32 s96,s96,2176
 s_add_u32 s52,s96,1376256
 buffer_load_dwordx4 v[140:143],v253,s[32:35],s52 offen sc1
 s_add_u32 s96,s59,2
 s_and_b32 s96,s96,7
 s_mul_i32 s96,s96,2176
 s_add_u32 s52,s96,1376256
 buffer_load_dwordx4 v[144:147],v253,s[32:35],s52 offen sc1
 s_add_u32 s96,s59,3
 s_and_b32 s96,s96,7
 s_mul_i32 s96,s96,2176
 s_add_u32 s52,s96,1376256
 buffer_load_dwordx4 v[148:151],v253,s[32:35],s52 offen sc1
 s_add_u32 s96,s59,4
 s_and_b32 s96,s96,7
 s_mul_i32 s96,s96,2176
 s_add_u32 s52,s96,1376256
 buffer_load_dwordx4 v[152:155],v253,s[32:35],s52 offen sc1
 s_add_u32 s96,s59,5
 s_and_b32 s96,s96,7
 s_mul_i32 s96,s96,2176
 s_add_u32 s52,s96,1376256
 buffer_load_dwordx4 v[156:159],v253,s[32:35],s52 offen sc1
 s_add_u32 s96,s59,6
 s_and_b32 s96,s96,7
 s_mul_i32 s96,s96,2176
 s_add_u32 s52,s96,1376256
 buffer_load_dwordx4 v[160:163],v253,s[32:35],s52 offen sc1
 s_add_u32 s96,s59,7
 s_and_b32 s96,s96,7
 s_mul_i32 s96,s96,2176
 s_add_u32 s52,s96,1376256
 buffer_load_dwordx4 v[164:167],v253,s[32:35],s52 offen sc1
 s_waitcnt vmcnt(0)
 s_sub_u32 s55,s55,1
 s_cbranch_scc0 Lk_29
 s_mov_b32 s55,0
Lkd_30:
 s_waitcnt vmcnt(15)
 v_mfma_f32_32x32x16_bf16 v[56:71],v[136:139],v[168:171],0
 s_waitcnt vmcnt(14)
 v_mfma_f32_32x32x16_bf16 v[72:87],v[140:143],v[172:175],0
 s_getpc_b64 s[82:83]
Lpc_32:
 s_lshr_b32 s52,s2,3
 s_lshl_b32 s52,s52,2
 s_add_u32 s52,s52,s4
 s_lshl_b32 s52,s52,10
 s_min_u32 s52,s52,L_slow-Lpc_32-1024
 v_add_u32 v252,s52,v1
 global_load_dwordx4 v[248:251],v252,s[82:83]
 v_and_b32 v255,31,v0
 v_lshlrev_b32 v255,2,v255
 s_mul_i32 s84,s6,384
 s_add_u32 s84,s84,1441792
 buffer_load_dword v22,v255,s[32:35],s84 offen sc1
 buffer_load_dword v23,v255,s[32:35],s84 offen offset:256 sc1
 buffer_load_dword v34,v255,s[32:35],s84 offen offset:128 sc1
 v_add_f32 v64,s76,v64
 v_rcp_f32 v64,v64
 s_nop 0
 v_mul_f32 v56,v56,v64
 v_mul_f32 v57,v57,v64
 v_mul_f32 v58,v58,v64
 v_mul_f32 v59,v59,v64
 v_mul_f32 v60,v60,v64
 v_mul_f32 v61,v61,v64
 v_mul_f32 v62,v62,v64
 v_mul_f32 v63,v63,v64
 v_cvt_pk_bf16_f32 v168,v56,v57
 v_cvt_pk_bf16_f32 v169,v58,v59
 v_cvt_pk_bf16_f32 v170,v60,v61
 v_cvt_pk_bf16_f32 v171,v62,v63
 s_waitcnt vmcnt(17)
 v_mfma_f32_32x32x16_bf16 v[40:55],v[144:147],v[176:179],0
 v_add_f32 v80,s76,v80
 v_rcp_f32 v80,v80
 s_waitcnt lgkmcnt(0)
 v_mul_f32 v72,v72,v80
 v_mul_f32 v73,v73,v80
 v_mul_f32 v74,v74,v80
 v_mul_f32 v75,v75,v80
 v_mul_f32 v76,v76,v80
 v_mul_f32 v77,v77,v80
 v_mfma_f32_32x32x16_bf16 v[88:103],a[176:179],v[168:171],0
 v_mul_f32 v78,v78,v80
 v_mul_f32 v79,v79,v80
 v_cvt_pk_bf16_f32 v172,v72,v73
 v_cvt_pk_bf16_f32 v173,v74,v75
 v_cvt_pk_bf16_f32 v174,v76,v77
 v_cvt_pk_bf16_f32 v175,v78,v79
 s_waitcnt vmcnt(16)
 v_mfma_f32_32x32x16_bf16 v[56:71],v[148:151],v[180:183],0
 v_add_f32 v48,s76,v48
 v_rcp_f32 v48,v48
 s_nop 0
 v_mul_f32 v40,v40,v48
 v_mul_f32 v41,v41,v48
 v_mul_f32 v42,v42,v48
 v_mul_f32 v43,v43,v48
 v_mul_f32 v44,v44,v48
 v_mul_f32 v45,v45,v48
 v_mfma_f32_32x32x16_bf16 v[88:103],a[184:187],v[172:175],v[88:103]
 v_mul_f32 v46,v46,v48
 v_mul_f32 v47,v47,v48
 v_cvt_pk_bf16_f32 v176,v40,v41
 v_cvt_pk_bf16_f32 v177,v42,v43
 v_cvt_pk_bf16_f32 v178,v44,v45
 v_cvt_pk_bf16_f32 v179,v46,v47
 s_waitcnt vmcnt(15)
 v_mfma_f32_32x32x16_bf16 v[72:87],v[152:155],v[184:187],0
 v_add_f32 v64,s76,v64
 v_rcp_f32 v64,v64
 s_bfe_u32 s96,s44,0x50014
 s_lshl_b32 s96,s96,16
 s_add_u32 s96,s96,s66
 s_add_u32 m0,s54,131072
 s_add_u32 s52,s96,0
 buffer_load_dwordx4 v9,s[24:27],s52 offen lds
 s_add_u32 m0,s54,135168
 s_add_u32 s52,s96,8192
 buffer_load_dwordx4 v9,s[24:27],s52 offen lds
 v_mul_f32 v56,v56,v64
 v_mul_f32 v57,v57,v64
 v_mul_f32 v58,v58,v64
 v_mul_f32 v59,v59,v64
 v_mul_f32 v60,v60,v64
 v_mul_f32 v61,v61,v64
 v_mfma_f32_32x32x16_bf16 v[88:103],a[192:195],v[176:179],v[88:103]
 v_mul_f32 v62,v62,v64
 v_mul_f32 v63,v63,v64
 v_cvt_pk_bf16_f32 v180,v56,v57
 v_cvt_pk_bf16_f32 v181,v58,v59
 v_cvt_pk_bf16_f32 v182,v60,v61
 v_cvt_pk_bf16_f32 v183,v62,v63
 s_waitcnt vmcnt(16)
 v_mfma_f32_32x32x16_bf16 v[40:55],v[156:159],v[188:191],0
 v_add_f32 v80,s76,v80
 v_rcp_f32 v80,v80
 s_nop 0
 v_mul_f32 v72,v72,v80
 v_mul_f32 v73,v73,v80
 v_mul_f32 v74,v74,v80
 v_mul_f32 v75,v75,v80
 v_mul_f32 v76,v76,v80
 v_mul_f32 v77,v77,v80
 v_mfma_f32_32x32x16_bf16 v[88:103],a[200:203],v[180:183],v[88:103]
 v_mul_f32 v78,v78,v80
 v_mul_f32 v79,v79,v80
 v_cvt_pk_bf16_f32 v184,v72,v73
 v_cvt_pk_bf16_f32 v185,v74,v75
 v_cvt_pk_bf16_f32 v186,v76,v77
 v_cvt_pk_bf16_f32 v187,v78,v79
 s_waitcnt vmcnt(15)
 v_mfma_f32_32x32x16_bf16 v[56:71],v[160:163],v[192:195],0
 v_add_f32 v48,s76,v48
 v_rcp_f32 v48,v48
 s_bfe_u32 s96,s44,0x50019
 s_lshl_b32 s96,s96,16
 s_add_u32 s96,s96,s66
 s_add_u32 m0,s54,139264
 s_add_u32 s52,s96,0
 buffer_load_dwordx4 v9,s[24:27],s52 offen lds
 s_add_u32 m0,s54,143360
 s_add_u32 s52,s96,8192
 buffer_load_dwordx4 v9,s[24:27],s52 offen lds
 v_mul_f32 v40,v40,v48
 v_mul_f32 v41,v41,v48
 v_mul_f32 v42,v42,v48
 v_mul_f32 v43,v43,v48
 v_mul_f32 v44,v44,v48
 v_mul_f32 v45,v45,v48
 v_mfma_f32_32x32x16_bf16 v[88:103],a[208:211],v[184:187],v[88:103]
 v_mul_f32 v46,v46,v48
 v_mul_f32 v47,v47,v48
 v_cvt_pk_bf16_f32 v188,v40,v41
 v_cvt_pk_bf16_f32 v189,v42,v43
 v_cvt_pk_bf16_f32 v190,v44,v45
 v_cvt_pk_bf16_f32 v191,v46,v47
 s_waitcnt vmcnt(16)
 v_mfma_f32_32x32x16_bf16 v[72:87],v[164:167],v[196:199],0
 v_add_f32 v64,s76,v64
 v_rcp_f32 v64,v64
 s_nop 0
 v_mul_f32 v56,v56,v64
 v_mul_f32 v57,v57,v64
 v_mul_f32 v58,v58,v64
 v_mul_f32 v59,v59,v64
 v_mul_f32 v60,v60,v64
 v_mul_f32 v61,v61,v64
 v_mfma_f32_32x32x16_bf16 v[88:103],a[216:219],v[188:191],v[88:103]
 v_mul_f32 v62,v62,v64
 v_mul_f32 v63,v63,v64
 v_cvt_pk_bf16_f32 v192,v56,v57
 v_cvt_pk_bf16_f32 v193,v58,v59
 v_cvt_pk_bf16_f32 v194,v60,v61
 v_cvt_pk_bf16_f32 v195,v62,v63
 s_waitcnt vmcnt(15)
 v_mfma_f32_32x32x16_bf16 v[40:55],v[136:139],v[200:203],0
 v_add_f32 v80,s76,v80
 v_rcp_f32 v80,v80
 s_bfe_u32 s96,s45,0x50000
 s_lshl_b32 s96,s96,16
 s_add_u32 s96,s96,s66
 s_add_u32 m0,s54,147456
 s_add_u32 s52,s96,0
 buffer_load_dwordx4 v9,s[24:27],s52 offen lds
 s_add_u32 m0,s54,151552
 s_add_u32 s52,s96,8192
 buffer_load_dwordx4 v9,s[24:27],s52 offen lds
 v_mul_f32 v72,v72,v80
 v_mul_f32 v73,v73,v80
 v_mul_f32 v74,v74,v80
 v_mul_f32 v75,v75,v80
 v_mul_f32 v76,v76,v80
 v_mul_f32 v77,v77,v80
 v_mfma_f32_32x32x16_bf16 v[88:103],a[224:227],v[192:195],v[88:103]
 v_mul_f32 v78,v78,v80
 v_mul_f32 v79,v79,v80
 v_cvt_pk_bf16_f32 v196,v72,v73
 v_cvt_pk_bf16_f32 v197,v74,v75
 v_cvt_pk_bf16_f32 v198,v76,v77
 v_cvt_pk_bf16_f32 v199,v78,v79
 s_waitcnt vmcnt(16)
 v_mfma_f32_32x32x16_bf16 v[56:71],v[140:143],v[204:207],0
 v_add_f32 v48,s76,v48
 v_rcp_f32 v48,v48
 s_nop 0
 v_mul_f32 v40,v40,v48
 v_mul_f32 v41,v41,v48
 v_mul_f32 v42,v42,v48
 v_mul_f32 v43,v43,v48
 v_mul_f32 v44,v44,v48
 v_mul_f32 v45,v45,v48
 v_mfma_f32_32x32x16_bf16 v[88:103],a[232:235],v[196:199],v[88:103]
 v_mul_f32 v46,v46,v48
 v_mul_f32 v47,v47,v48
 v_cvt_pk_bf16_f32 v200,v40,v41
 v_cvt_pk_bf16_f32 v201,v42,v43
 v_cvt_pk_bf16_f32 v202,v44,v45
 v_cvt_pk_bf16_f32 v203,v46,v47
 s_waitcnt vmcnt(15)
 v_mfma_f32_32x32x16_bf16 v[72:87],v[144:147],v[208:211],0
 v_add_f32 v64,s76,v64
 v_rcp_f32 v64,v64
 s_bfe_u32 s96,s45,0x50005
 s_lshl_b32 s96,s96,16
 s_add_u32 s96,s96,s66
 s_add_u32 m0,s54,155648
 s_add_u32 s52,s96,0
 buffer_load_dwordx4 v9,s[24:27],s52 offen lds
 s_add_u32 m0,s54,159744
 s_add_u32 s52,s96,8192
 buffer_load_dwordx4 v9,s[24:27],s52 offen lds
 v_mul_f32 v56,v56,v64
 v_mul_f32 v57,v57,v64
 v_mul_f32 v58,v58,v64
 v_mul_f32 v59,v59,v64
 v_mul_f32 v60,v60,v64
 v_mul_f32 v61,v61,v64
 v_mfma_f32_32x32x16_bf16 v[104:119],a[176:179],v[200:203],0
 v_mul_f32 v62,v62,v64
 v_mul_f32 v63,v63,v64
 v_cvt_pk_bf16_f32 v204,v56,v57
 v_cvt_pk_bf16_f32 v205,v58,v59
 v_cvt_pk_bf16_f32 v206,v60,v61
 v_cvt_pk_bf16_f32 v207,v62,v63
 s_waitcnt vmcnt(16)
 v_mfma_f32_32x32x16_bf16 v[40:55],v[148:151],v[212:215],0
 v_add_f32 v80,s76,v80
 v_rcp_f32 v80,v80
 s_nop 0
 v_mul_f32 v72,v72,v80
 v_mul_f32 v73,v73,v80
 v_mul_f32 v74,v74,v80
 v_mul_f32 v75,v75,v80
 v_mul_f32 v76,v76,v80
 v_mul_f32 v77,v77,v80
 v_mfma_f32_32x32x16_bf16 v[104:119],a[184:187],v[204:207],v[104:119]
 v_mul_f32 v78,v78,v80
 v_mul_f32 v79,v79,v80
 v_cvt_pk_bf16_f32 v208,v72,v73
 v_cvt_pk_bf16_f32 v209,v74,v75
 v_cvt_pk_bf16_f32 v210,v76,v77
 v_cvt_pk_bf16_f32 v211,v78,v79
 s_waitcnt vmcnt(15)
 v_mfma_f32_32x32x16_bf16 v[56:71],v[152:155],v[216:219],0
 v_add_f32 v48,s76,v48
 v_rcp_f32 v48,v48
 s_add_u32 s96,s95,1
 s_and_b32 s96,s96,7
 s_mul_i32 s96,s96,176128
 s_add_u32 s96,s96,s62
 s_add_u32 m0,s54,69632
 s_add_u32 s52,s96,0
 buffer_load_dwordx4 v8,s[20:23],s52 offen lds
 s_add_u32 s96,s96,s60
 s_add_u32 m0,s54,86016
 s_add_u32 s52,s96,0
 buffer_load_dwordx4 v8,s[20:23],s52 offen lds
 v_mul_f32 v40,v40,v48
 v_mul_f32 v41,v41,v48
 v_mul_f32 v42,v42,v48
 v_mul_f32 v43,v43,v48
 v_mul_f32 v44,v44,v48
 v_mul_f32 v45,v45,v48
 v_mfma_f32_32x32x16_bf16 v[104:119],a[192:195],v[208:211],v[104:119]
 v_mul_f32 v46,v46,v48
 v_mul_f32 v47,v47,v48
 v_cvt_pk_bf16_f32 v212,v40,v41
 v_cvt_pk_bf16_f32 v213,v42,v43
 v_cvt_pk_bf16_f32 v214,v44,v45
 v_cvt_pk_bf16_f32 v215,v46,v47
 s_waitcnt vmcnt(16)
 v_mfma_f32_32x32x16_bf16 v[72:87],v[156:159],v[220:223],0
 v_add_f32 v64,s76,v64
 v_rcp_f32 v64,v64
 s_nop 0
 v_mul_f32 v56,v56,v64
 v_mul_f32 v57,v57,v64
 v_mul_f32 v58,v58,v64
 v_mul_f32 v59,v59,v64
 v_mul_f32 v60,v60,v64
 v_mul_f32 v61,v61,v64
 v_mfma_f32_32x32x16_bf16 v[104:119],a[200:203],v[212:215],v[104:119]
 v_mul_f32 v62,v62,v64
 v_mul_f32 v63,v63,v64
 v_cvt_pk_bf16_f32 v216,v56,v57
 v_cvt_pk_bf16_f32 v217,v58,v59
 v_cvt_pk_bf16_f32 v218,v60,v61
 v_cvt_pk_bf16_f32 v219,v62,v63
 s_waitcnt vmcnt(15)
 v_mfma_f32_32x32x16_bf16 v[40:55],v[160:163],v[224:227],0
 v_add_f32 v80,s76,v80
 v_rcp_f32 v80,v80
 s_add_u32 s96,s95,2
 s_and_b32 s96,s96,7
 s_mul_i32 s96,s96,176128
 s_add_u32 s96,s96,s62
 s_add_u32 m0,s54,73728
 s_add_u32 s52,s96,0
 buffer_load_dwordx4 v8,s[20:23],s52 offen lds
 s_add_u32 s96,s96,s60
 s_add_u32 m0,s54,90112
 s_add_u32 s52,s96,0
 buffer_load_dwordx4 v8,s[20:23],s52 offen lds
 v_mul_f32 v72,v72,v80
 v_mul_f32 v73,v73,v80
 v_mul_f32 v74,v74,v80
 v_mul_f32 v75,v75,v80
 v_mul_f32 v76,v76,v80
 v_mul_f32 v77,v77,v80
 v_mfma_f32_32x32x16_bf16 v[104:119],a[208:211],v[216:219],v[104:119]
 v_mul_f32 v78,v78,v80
 v_mul_f32 v79,v79,v80
 v_cvt_pk_bf16_f32 v220,v72,v73
 v_cvt_pk_bf16_f32 v221,v74,v75
 v_cvt_pk_bf16_f32 v222,v76,v77
 v_cvt_pk_bf16_f32 v223,v78,v79
 s_waitcnt vmcnt(16)
 v_mfma_f32_32x32x16_bf16 v[56:71],v[164:167],v[228:231],0
 v_add_f32 v48,s76,v48
 v_rcp_f32 v48,v48
 s_nop 0
 v_mul_f32 v40,v40,v48
 v_mul_f32 v41,v41,v48
 v_mul_f32 v42,v42,v48
 v_mul_f32 v43,v43,v48
 v_mul_f32 v44,v44,v48
 v_mul_f32 v45,v45,v48
 v_mfma_f32_32x32x16_bf16 v[104:119],a[216:219],v[220:223],v[104:119]
 v_mul_f32 v46,v46,v48
 v_mul_f32 v47,v47,v48
 v_cvt_pk_bf16_f32 v224,v40,v41
 v_cvt_pk_bf16_f32 v225,v42,v43
 v_cvt_pk_bf16_f32 v226,v44,v45
 v_cvt_pk_bf16_f32 v227,v46,v47
 v_add_f32 v64,s76,v64
 v_rcp_f32 v64,v64
 s_add_u32 s96,s95,3
 s_and_b32 s96,s96,7
 s_mul_i32 s96,s96,176128
 s_add_u32 s96,s96,s62
 s_add_u32 m0,s54,77824
 s_add_u32 s52,s96,0
 buffer_load_dwordx4 v8,s[20:23],s52 offen lds
 s_add_u32 s96,s96,s60
 s_add_u32 m0,s54,94208
 s_add_u32 s52,s96,0
 buffer_load_dwordx4 v8,s[20:23],s52 offen lds
 v_mul_f32 v56,v56,v64
 v_mul_f32 v57,v57,v64
 v_mul_f32 v58,v58,v64
 v_mul_f32 v59,v59,v64
 v_mul_f32 v60,v60,v64
 v_mul_f32 v61,v61,v64
 v_mfma_f32_32x32x16_bf16 v[104:119],a[224:227],v[224:227],v[104:119]
 v_mul_f32 v62,v62,v64
 v_mul_f32 v63,v63,v64
 v_cvt_pk_bf16_f32 v228,v56,v57
 v_cvt_pk_bf16_f32 v229,v58,v59
 v_cvt_pk_bf16_f32 v230,v60,v61
 v_cvt_pk_bf16_f32 v231,v62,v63
 s_nop 1
 v_mfma_f32_32x32x16_bf16 v[104:119],a[232:235],v[228:231],v[104:119]
 s_add_u32 s96,s95,4
 s_and_b32 s96,s96,7
 s_mul_i32 s96,s96,176128
 s_add_u32 s96,s96,s62
 s_add_u32 m0,s54,98304
 s_add_u32 s52,s96,0
 buffer_load_dwordx4 v8,s[20:23],s52 offen lds
 s_add_u32 s96,s96,s60
 s_add_u32 m0,s54,114688
 s_add_u32 s52,s96,0
 buffer_load_dwordx4 v8,s[20:23],s52 offen lds
 s_add_u32 s96,s95,5
 s_and_b32 s96,s96,7
 s_mul_i32 s96,s96,176128
 s_add_u32 s96,s96,s62
 s_add_u32 m0,s54,102400
 s_add_u32 s52,s96,0
 buffer_load_dwordx4 v8,s[20:23],s52 offen lds
 s_add_u32 s96,s96,s60
 s_add_u32 m0,s54,118784
 s_add_u32 s52,s96,0
 buffer_load_dwordx4 v8,s[20:23],s52 offen lds
 s_waitcnt vmcnt(10)
 ds_read_b64_tr_b16 a[32:33],v12 offset:0
 ds_read_b64_tr_b16 a[36:37],v14 offset:0
 ds_read_b64_tr_b16 a[34:35],v12 offset:4096
 ds_read_b64_tr_b16 a[38:39],v14 offset:4096
 ds_read_b64_tr_b16 a[40:41],v12 offset:8192
 ds_read_b64_tr_b16 a[44:45],v14 offset:8192
 ds_read_b64_tr_b16 a[42:43],v12 offset:12288
 ds_read_b64_tr_b16 a[46:47],v14 offset:12288
 ds_read_b64_tr_b16 a[48:49],v12 offset:16384
 ds_read_b64_tr_b16 a[52:53],v14 offset:16384
 ds_read_b64_tr_b16 a[50:51],v12 offset:20480
 ds_read_b64_tr_b16 a[54:55],v14 offset:20480
 ds_read_b64_tr_b16 a[56:57],v12 offset:24576
 ds_read_b64_tr_b16 a[60:61],v14 offset:24576
 ds_read_b64_tr_b16 a[58:59],v12 offset:28672
 ds_read_b64_tr_b16 a[62:63],v14 offset:28672
 s_waitcnt lgkmcnt(0)
 s_barrier
 v_mfma_f32_32x32x16_bf16 v[120:135],a[180:183],v[168:171],0
 ds_write_b128 v18,v[88:91] offset:0
 v_accvgpr_read_b32 v41,a240
 v_accvgpr_read_b32 v43,a241
 v_accvgpr_read_b32 v45,a242
 v_mfma_f32_32x32x16_bf16 v[120:135],a[188:191],v[172:175],v[120:135]
 v_accvgpr_read_b32 v47,a243
 v_lshlrev_b32 v40,16,v41
 v_and_b32 v41,0xffff0000,v41
 v_mfma_f32_32x32x16_bf16 v[120:135],a[196:199],v[176:179],v[120:135]
 ds_write_b128 v18,v[92:95] offset:1024
 v_lshlrev_b32 v42,16,v43
 v_and_b32 v43,0xffff0000,v43
 v_lshlrev_b32 v44,16,v45
 v_mfma_f32_32x32x16_bf16 v[120:135],a[204:207],v[180:183],v[120:135]
 ds_write_b128 v18,v[96:99] offset:2048
 v_and_b32 v45,0xffff0000,v45
 v_lshlrev_b32 v46,16,v47
 v_and_b32 v47,0xffff0000,v47
 v_mfma_f32_32x32x16_bf16 v[120:135],a[212:215],v[184:187],v[120:135]
 v_accvgpr_read_b32 v49,a244
 v_accvgpr_read_b32 v51,a245
 v_accvgpr_read_b32 v53,a246
 s_add_u32 s96,s95,6
 s_and_b32 s96,s96,7
 s_mul_i32 s96,s96,176128
 s_add_u32 s96,s96,s62
 s_add_u32 m0,s54,106496
 s_add_u32 s52,s96,0
 buffer_load_dwordx4 v8,s[20:23],s52 offen lds
 s_add_u32 s96,s96,s60
 s_add_u32 m0,s54,122880
 s_add_u32 s52,s96,0
 buffer_load_dwordx4 v8,s[20:23],s52 offen lds
 v_mfma_f32_32x32x16_bf16 v[120:135],a[220:223],v[188:191],v[120:135]
 ds_write_b128 v18,v[100:103] offset:3072
 v_accvgpr_read_b32 v55,a247
 v_lshlrev_b32 v48,16,v49
 v_and_b32 v49,0xffff0000,v49
 v_mfma_f32_32x32x16_bf16 v[120:135],a[228:231],v[192:195],v[120:135]
 ds_write_b128 v18,v[104:107] offset:4096
 v_lshlrev_b32 v50,16,v51
 v_and_b32 v51,0xffff0000,v51
 v_lshlrev_b32 v52,16,v53
 v_mfma_f32_32x32x16_bf16 v[120:135],a[236:239],v[196:199],v[120:135]
 v_and_b32 v53,0xffff0000,v53
 v_lshlrev_b32 v54,16,v55
 v_and_b32 v55,0xffff0000,v55
 v_mfma_f32_32x32x16_bf16 v[232:247],a[180:183],v[200:203],0
 ds_write_b128 v18,v[108:111] offset:5120
 v_mfma_f32_32x32x16_bf16 v[232:247],a[188:191],v[204:207],v[232:247]
 s_add_u32 s96,s95,7
 s_and_b32 s96,s96,7
 s_mul_i32 s96,s96,176128
 s_add_u32 s96,s96,s62
 s_add_u32 m0,s54,110592
 s_add_u32 s52,s96,0
 buffer_load_dwordx4 v8,s[20:23],s52 offen lds
 s_add_u32 s96,s96,s60
 s_add_u32 m0,s54,126976
 s_add_u32 s52,s96,0
 buffer_load_dwordx4 v8,s[20:23],s52 offen lds
 v_mfma_f32_32x32x16_bf16 v[232:247],a[196:199],v[208:211],v[232:247]
 ds_write_b128 v18,v[112:115] offset:6144
 v_mfma_f32_32x32x16_bf16 v[232:247],a[204:207],v[212:215],v[232:247]
 ds_write_b128 v18,v[116:119] offset:7168
 v_mfma_f32_32x32x16_bf16 v[232:247],a[212:215],v[216:219],v[232:247]
 s_waitcnt lgkmcnt(0)
 s_barrier
 ds_read_b128 v[56:59],v15 offset:0
 ds_read_b128 v[60:63],v15 offset:1024
 v_mfma_f32_32x32x16_bf16 v[232:247],a[220:223],v[220:223],v[232:247]
 ds_read_b128 v[64:67],v15 offset:8192
 ds_read_b128 v[68:71],v15 offset:9216
 ds_read_b128 v[72:75],v15 offset:16384
 v_mfma_f32_32x32x16_bf16 v[232:247],a[228:231],v[224:227],v[232:247]
 ds_read_b128 v[76:79],v15 offset:17408
 ds_read_b128 v[80:83],v15 offset:24576
 ds_read_b128 v[84:87],v15 offset:25600
 v_mfma_f32_32x32x16_bf16 v[232:247],a[236:239],v[228:231],v[232:247]
 s_waitcnt lgkmcnt(7)
 v_pk_add_f32 v[56:57],v[56:57],v[40:41]
 v_pk_add_f32 v[58:59],v[58:59],v[42:43]
 s_waitcnt lgkmcnt(6)
 v_pk_add_f32 v[60:61],v[60:61],v[44:45]
 v_pk_add_f32 v[62:63],v[62:63],v[46:47]
 s_waitcnt lgkmcnt(5)
 v_pk_add_f32 v[56:57],v[56:57],v[64:65]
 v_pk_add_f32 v[58:59],v[58:59],v[66:67]
 s_waitcnt lgkmcnt(4)
 v_pk_add_f32 v[60:61],v[60:61],v[68:69]
 v_pk_add_f32 v[62:63],v[62:63],v[70:71]
 s_waitcnt lgkmcnt(1)
 v_pk_add_f32 v[72:73],v[72:73],v[80:81]
 v_pk_add_f32 v[74:75],v[74:75],v[82:83]
 s_waitcnt lgkmcnt(0)
 v_pk_add_f32 v[76:77],v[76:77],v[84:85]
 v_pk_add_f32 v[78:79],v[78:79],v[86:87]
 s_barrier
 ds_write_b128 v18,v[120:123] offset:0
 v_pk_add_f32 v[56:57],v[56:57],v[72:73]
 v_pk_add_f32 v[58:59],v[58:59],v[74:75]
 v_pk_add_f32 v[60:61],v[60:61],v[76:77]
 v_pk_add_f32 v[62:63],v[62:63],v[78:79]
 ds_write_b128 v18,v[124:127] offset:1024
 v_cvt_pk_bf16_f32 v64,v56,v57
 v_cvt_pk_bf16_f32 v65,v58,v59
 v_cvt_pk_bf16_f32 v66,v60,v61
 v_cvt_pk_bf16_f32 v67,v62,v63
 ds_write_b128 v18,v[128:131] offset:2048
 v_accvgpr_write_b32 a240,v64
 v_or_b32 v64,1,v64
 s_and_b32 s52,s6,1
 s_xor_b32 s52,s52,0
 s_lshl_b32 s52,s52,11
 s_add_u32 s52,s52,s67
 buffer_store_dwordx4 v[64:67],v3,s[32:35],s52 offen
 v_pk_add_f32 v[24:25],v[56:57],v[58:59]
 ds_write_b128 v18,v[132:135] offset:3072
 v_pk_mul_f32 v[26:27],v[56:57],v[56:57]
 v_pk_fma_f32 v[26:27],v[58:59],v[58:59],v[26:27]
 v_pk_add_f32 v[24:25],v[24:25],v[60:61]
 v_pk_fma_f32 v[26:27],v[60:61],v[60:61],v[26:27]
 ds_write_b128 v18,v[232:235] offset:4096
 v_pk_add_f32 v[24:25],v[24:25],v[62:63]
 v_pk_fma_f32 v[26:27],v[62:63],v[62:63],v[26:27]
 v_accvgpr_write_b32 a241,v65
 v_accvgpr_write_b32 a242,v66
 ds_write_b128 v18,v[236:239] offset:5120
 v_accvgpr_write_b32 a243,v67
 ds_write_b128 v18,v[240:243] offset:6144
 ds_write_b128 v18,v[244:247] offset:7168
 s_waitcnt lgkmcnt(0)
 s_barrier
 ds_read_b128 v[56:59],v15 offset:0
 ds_read_b128 v[60:63],v15 offset:1024
 ds_read_b128 v[64:67],v15 offset:8192
 ds_read_b128 v[68:71],v15 offset:9216
 ds_read_b128 v[72:75],v15 offset:16384
 ds_read_b128 v[76:79],v15 offset:17408
 ds_read_b128 v[80:83],v15 offset:24576
 ds_read_b128 v[84:87],v15 offset:25600
 s_add_u32 s52,s56,0
 v_add_u32 v2,s52,v1
 s_waitcnt lgkmcnt(7)
 v_pk_add_f32 v[56:57],v[56:57],v[48:49]
 v_pk_add_f32 v[58:59],v[58:59],v[50:51]
 s_waitcnt lgkmcnt(6)
 v_pk_add_f32 v[60:61],v[60:61],v[52:53]
 v_pk_add_f32 v[62:63],v[62:63],v[54:55]
 s_waitcnt lgkmcnt(5)
 v_pk_add_f32 v[56:57],v[56:57],v[64:65]
 v_pk_add_f32 v[58:59],v[58:59],v[66:67]
 s_waitcnt lgkmcnt(4)
 v_pk_add_f32 v[60:61],v[60:61],v[68:69]
 v_pk_add_f32 v[62:63],v[62:63],v[70:71]
 s_waitcnt lgkmcnt(1)
 v_pk_add_f32 v[72:73],v[72:73],v[80:81]
 v_pk_add_f32 v[74:75],v[74:75],v[82:83]
 s_waitcnt lgkmcnt(0)
 v_pk_add_f32 v[76:77],v[76:77],v[84:85]
 v_pk_add_f32 v[78:79],v[78:79],v[86:87]
 v_pk_add_f32 v[56:57],v[56:57],v[72:73]
 v_pk_add_f32 v[58:59],v[58:59],v[74:75]
 v_pk_add_f32 v[60:61],v[60:61],v[76:77]
 v_pk_add_f32 v[62:63],v[62:63],v[78:79]
 v_cvt_pk_bf16_f32 v64,v56,v57
 v_cvt_pk_bf16_f32 v65,v58,v59
 v_cvt_pk_bf16_f32 v66,v60,v61
 v_cvt_pk_bf16_f32 v67,v62,v63
 v_accvgpr_write_b32 a244,v64
 v_or_b32 v64,1,v64
 s_and_b32 s52,s6,1
 s_xor_b32 s52,s52,1
 s_lshl_b32 s52,s52,11
 s_add_u32 s52,s52,s67
 buffer_store_dwordx4 v[64:67],v3,s[32:35],s52 offen
 v_pk_add_f32 v[24:25],v[24:25],v[56:57]
 v_pk_fma_f32 v[26:27],v[56:57],v[56:57],v[26:27]
 v_pk_add_f32 v[24:25],v[24:25],v[58:59]
 buffer_load_dwordx4 v[136:139],v2,s[32:35],s36 offen sc1
 v_pk_fma_f32 v[26:27],v[58:59],v[58:59],v[26:27]
 v_pk_add_f32 v[24:25],v[24:25],v[60:61]
 v_pk_fma_f32 v[26:27],v[60:61],v[60:61],v[26:27]
 buffer_load_dwordx4 v[140:143],v2,s[32:35],s36 offen offset:1024 sc1
 v_pk_add_f32 v[24:25],v[24:25],v[62:63]
 v_pk_fma_f32 v[26:27],v[62:63],v[62:63],v[26:27]
 v_accvgpr_write_b32 a245,v65
 buffer_load_dwordx4 v[152:155],v2,s[32:35],s37 offen sc1
 v_accvgpr_write_b32 a246,v66
 v_accvgpr_write_b32 a247,v67
 v_add_f32 v24,v24,v25
 buffer_load_dwordx4 v[156:159],v2,s[32:35],s37 offen offset:1024 sc1
 v_add_f32 v26,v26,v27
 v_and_b32 v27,512,v3
 v_add_u32 v27,v27,v3
 buffer_load_dwordx4 v[168:171],v2,s[32:35],s38 offen sc1
 v_permlane16_swap_b32 v24,v26
 v_add_f32 v24,v24,v26
 v_mov_b32 v25,v24
 buffer_load_dwordx4 v[172:175],v2,s[32:35],s38 offen offset:1024 sc1
 s_nop 0
 v_permlane32_swap_b32 v24,v25
 v_add_f32 v24,v24,v25
 v_or_b32 v24,1,v24
 buffer_load_dwordx4 v[184:187],v2,s[32:35],s39 offen sc1
 s_mov_b32 exec_hi,0
 s_add_u32 s52,s79,0
 buffer_store_dword v24,v27,s[32:35],s52 offen
 s_mov_b64 exec,-1
 buffer_load_dwordx4 v[188:191],v2,s[32:35],s39 offen offset:1024 sc1
 buffer_load_dwordx4 v[200:203],v2,s[32:35],s40 offen sc1
 buffer_load_dwordx4 v[204:207],v2,s[32:35],s40 offen offset:1024 sc1
 buffer_load_dwordx4 v[216:219],v2,s[32:35],s41 offen sc1
 v_max_u32 v35,v22,v23
 v_max3_u32 v35,v34,v34,v35
 v_cmp_eq_u32 s[82:83],-1,v35
 s_nop 0
 s_cmp_lg_u64 s[82:83],0
 s_cbranch_scc1 Lfix_33
Lret_34:
 s_waitcnt vmcnt(14)
 s_barrier
 ds_read_b64_tr_b16 v[40:41],v5 offset:0
 ds_read_b64_tr_b16 v[42:43],v5 offset:512
 ds_read_b64_tr_b16 v[44:45],v5 offset:16384
 ds_read_b64_tr_b16 v[46:47],v5 offset:16896
 ds_read_b64_tr_b16 v[48:49],v5 offset:1024
 ds_read_b64_tr_b16 v[50:51],v5 offset:1536
 ds_read_b64_tr_b16 v[52:53],v5 offset:17408
 ds_read_b64_tr_b16 v[54:55],v5 offset:17920
 s_waitcnt vmcnt(10)
 v_bitop3_b32 v38,v136,v140,1 bitop3:0x80
 v_cmp_eq_u32 vcc,0,v38
 s_cbranch_vccnz Lfix_36
Lret_37:
 s_waitcnt lgkmcnt(4)
 v_mfma_f32_32x32x16_bf16 v[88:103],v[40:43],v[136:139],0
 ds_read_b64_tr_b16 v[40:41],v5 offset:4096
 ds_read_b64_tr_b16 v[42:43],v5 offset:4608
 buffer_load_dwordx4 v[220:223],v2,s[32:35],s41 offen offset:1024 sc1
 v_mov_b32 v26,0
 v_mfma_f32_32x32x16_bf16 v[104:119],v[44:47],v[136:139],0
 ds_read_b64_tr_b16 v[44:45],v5 offset:20480
 ds_read_b64_tr_b16 v[46:47],v5 offset:20992
 v_mov_b32 v27,0
 s_waitcnt vmcnt(9) lgkmcnt(4)
 v_mfma_f32_32x32x16_bf16 v[88:103],v[48:51],v[140:143],v[88:103]
 ds_read_b64_tr_b16 v[48:49],v5 offset:5120
 ds_read_b64_tr_b16 v[50:51],v5 offset:5632
 buffer_load_dwordx4 v[232:235],v2,s[32:35],s42 offen sc1
 v_bitop3_b32 v38,v152,v156,1 bitop3:0x80
 v_cmp_eq_u32 vcc,0,v38
 v_mfma_f32_32x32x16_bf16 v[104:119],v[52:55],v[140:143],v[104:119]
 ds_read_b64_tr_b16 v[52:53],v5 offset:21504
 ds_read_b64_tr_b16 v[54:55],v5 offset:22016
 v_mov_b32 v30,0
 s_cbranch_vccnz Lfix_39
Lret_40:
 s_waitcnt lgkmcnt(4)
 v_mfma_f32_32x32x16_bf16 v[88:103],v[40:43],v[152:155],v[88:103]
 ds_read_b64_tr_b16 v[40:41],v5 offset:8192
 ds_read_b64_tr_b16 v[42:43],v5 offset:8704
 buffer_load_dwordx4 v[236:239],v2,s[32:35],s42 offen offset:1024 sc1
 v_mov_b32 v31,0
 v_mfma_f32_32x32x16_bf16 v[104:119],v[44:47],v[152:155],v[104:119]
 ds_read_b64_tr_b16 v[44:45],v5 offset:24576
 ds_read_b64_tr_b16 v[46:47],v5 offset:25088
 v_mov_b32 v32,0x3f803f80
 s_waitcnt vmcnt(9) lgkmcnt(4)
 v_mfma_f32_32x32x16_bf16 v[88:103],v[48:51],v[156:159],v[88:103]
 ds_read_b64_tr_b16 v[48:49],v5 offset:9216
 ds_read_b64_tr_b16 v[50:51],v5 offset:9728
 buffer_load_dwordx4 v[248:251],v2,s[32:35],s43 offen sc1
 v_bitop3_b32 v38,v168,v172,1 bitop3:0x80
 v_cmp_eq_u32 vcc,0,v38
 v_mfma_f32_32x32x16_bf16 v[104:119],v[52:55],v[156:159],v[104:119]
 ds_read_b64_tr_b16 v[52:53],v5 offset:25600
 ds_read_b64_tr_b16 v[54:55],v5 offset:26112
 v_mov_b32 v33,0x3f803f80
 s_cbranch_vccnz Lfix_42
Lret_43:
 s_waitcnt lgkmcnt(4)
 v_mfma_f32_32x32x16_bf16 v[88:103],v[40:43],v[168:171],v[88:103]
 ds_read_b64_tr_b16 v[40:41],v5 offset:12288
 ds_read_b64_tr_b16 v[42:43],v5 offset:12800
 buffer_load_dwordx4 v[252:255],v2,s[32:35],s43 offen offset:1024 sc1
 v_mfma_f32_32x32x16_bf16 v[104:119],v[44:47],v[168:171],v[104:119]
 ds_read_b64_tr_b16 v[44:45],v5 offset:28672
 ds_read_b64_tr_b16 v[46:47],v5 offset:29184
 s_waitcnt vmcnt(8) lgkmcnt(4)
 v_mfma_f32_32x32x16_bf16 v[88:103],v[48:51],v[172:175],v[88:103]
 ds_read_b64_tr_b16 v[48:49],v5 offset:13312
 ds_read_b64_tr_b16 v[50:51],v5 offset:13824
 buffer_load_dwordx4 v[144:147],v2,s[32:35],s8 offen sc1
 v_bitop3_b32 v38,v184,v188,1 bitop3:0x80
 v_cmp_eq_u32 vcc,0,v38
 v_mfma_f32_32x32x16_bf16 v[104:119],v[52:55],v[172:175],v[104:119]
 ds_read_b64_tr_b16 v[52:53],v5 offset:29696
 ds_read_b64_tr_b16 v[54:55],v5 offset:30208
 s_cbranch_vccnz Lfix_45
Lret_46:
 s_waitcnt lgkmcnt(4)
 v_mfma_f32_32x32x16_bf16 v[88:103],v[40:43],v[184:187],v[88:103]
 ds_read_b64_tr_b16 v[40:41],v5 offset:32768
 ds_read_b64_tr_b16 v[42:43],v5 offset:33280
 buffer_load_dwordx4 v[148:151],v2,s[32:35],s8 offen offset:1024 sc1
 v_mfma_f32_32x32x16_bf16 v[104:119],v[44:47],v[184:187],v[104:119]
 ds_read_b64_tr_b16 v[44:45],v5 offset:49152
 ds_read_b64_tr_b16 v[46:47],v5 offset:49664
 s_waitcnt vmcnt(8) lgkmcnt(4)
 v_mfma_f32_32x32x16_bf16 v[88:103],v[48:51],v[188:191],v[88:103]
 ds_read_b64_tr_b16 v[48:49],v5 offset:33792
 ds_read_b64_tr_b16 v[50:51],v5 offset:34304
 buffer_load_dwordx4 v[160:163],v2,s[32:35],s9 offen sc1
 v_bitop3_b32 v38,v200,v204,1 bitop3:0x80
 v_cmp_eq_u32 vcc,0,v38
 v_mfma_f32_32x32x16_bf16 v[104:119],v[52:55],v[188:191],v[104:119]
 ds_read_b64_tr_b16 v[52:53],v5 offset:50176
 ds_read_b64_tr_b16 v[54:55],v5 offset:50688
 s_cbranch_vccnz Lfix_48
Lret_49:
 s_waitcnt lgkmcnt(4)
 v_mfma_f32_32x32x16_bf16 v[88:103],v[40:43],v[200:203],v[88:103]
 ds_read_b64_tr_b16 v[40:41],v5 offset:36864
 ds_read_b64_tr_b16 v[42:43],v5 offset:37376
 buffer_load_dwordx4 v[164:167],v2,s[32:35],s9 offen offset:1024 sc1
 v_mfma_f32_32x32x16_bf16 v[104:119],v[44:47],v[200:203],v[104:119]
 ds_read_b64_tr_b16 v[44:45],v5 offset:53248
 ds_read_b64_tr_b16 v[46:47],v5 offset:53760
 s_waitcnt vmcnt(8) lgkmcnt(4)
 v_mfma_f32_32x32x16_bf16 v[88:103],v[48:51],v[204:207],v[88:103]
 ds_read_b64_tr_b16 v[48:49],v5 offset:37888
 ds_read_b64_tr_b16 v[50:51],v5 offset:38400
 s_add_u32 s84,s58,0
 buffer_load_dwordx4 v[72:75],v13,s[32:35],s84 offen sc1
 buffer_load_dwordx4 v[76:79],v13,s[32:35],s84 offen offset:512 sc1
 buffer_load_dwordx4 v[176:179],v2,s[32:35],s10 offen sc1
 v_bitop3_b32 v38,v216,v220,1 bitop3:0x80
 v_cmp_eq_u32 vcc,0,v38
 v_mfma_f32_32x32x16_bf16 v[104:119],v[52:55],v[204:207],v[104:119]
 ds_read_b64_tr_b16 v[52:53],v5 offset:54272
 ds_read_b64_tr_b16 v[54:55],v5 offset:54784
 s_cbranch_vccnz Lfix_51
Lret_52:
 s_waitcnt lgkmcnt(4)
 v_mfma_f32_32x32x16_bf16 v[88:103],v[40:43],v[216:219],v[88:103]
 ds_read_b64_tr_b16 v[40:41],v5 offset:40960
 ds_read_b64_tr_b16 v[42:43],v5 offset:41472
 buffer_load_dwordx4 v[180:183],v2,s[32:35],s10 offen offset:1024 sc1
 v_mfma_f32_32x32x16_bf16 v[104:119],v[44:47],v[216:219],v[104:119]
 ds_read_b64_tr_b16 v[44:45],v5 offset:57344
 ds_read_b64_tr_b16 v[46:47],v5 offset:57856
 s_waitcnt vmcnt(10) lgkmcnt(4)
 v_mfma_f32_32x32x16_bf16 v[88:103],v[48:51],v[220:223],v[88:103]
 ds_read_b64_tr_b16 v[48:49],v5 offset:41984
 ds_read_b64_tr_b16 v[50:51],v5 offset:42496
 buffer_load_dwordx4 v[192:195],v2,s[32:35],s11 offen sc1
 v_bitop3_b32 v38,v232,v236,1 bitop3:0x80
 v_cmp_eq_u32 vcc,0,v38
 v_mfma_f32_32x32x16_bf16 v[104:119],v[52:55],v[220:223],v[104:119]
 ds_read_b64_tr_b16 v[52:53],v5 offset:58368
 ds_read_b64_tr_b16 v[54:55],v5 offset:58880
 s_cbranch_vccnz Lfix_54
Lret_55:
 s_waitcnt lgkmcnt(4)
 v_mfma_f32_32x32x16_bf16 v[88:103],v[40:43],v[232:235],v[88:103]
 ds_read_b64_tr_b16 v[40:41],v5 offset:45056
 ds_read_b64_tr_b16 v[42:43],v5 offset:45568
 buffer_load_dwordx4 v[196:199],v2,s[32:35],s11 offen offset:1024 sc1
 v_mfma_f32_32x32x16_bf16 v[104:119],v[44:47],v[232:235],v[104:119]
 ds_read_b64_tr_b16 v[44:45],v5 offset:61440
 ds_read_b64_tr_b16 v[46:47],v5 offset:61952
 s_waitcnt vmcnt(10) lgkmcnt(4)
 v_mfma_f32_32x32x16_bf16 v[88:103],v[48:51],v[236:239],v[88:103]
 ds_read_b64_tr_b16 v[48:49],v5 offset:46080
 ds_read_b64_tr_b16 v[50:51],v5 offset:46592
 buffer_load_dwordx4 v[208:211],v2,s[32:35],s57 offen sc1
 v_bitop3_b32 v38,v248,v252,1 bitop3:0x80
 v_cmp_eq_u32 vcc,0,v38
 v_mfma_f32_32x32x16_bf16 v[104:119],v[52:55],v[236:239],v[104:119]
 ds_read_b64_tr_b16 v[52:53],v5 offset:62464
 ds_read_b64_tr_b16 v[54:55],v5 offset:62976
 s_cbranch_vccnz Lfix_57
Lret_58:
 s_waitcnt lgkmcnt(4)
 v_mfma_f32_32x32x16_bf16 v[88:103],v[40:43],v[248:251],v[88:103]
 ds_read_b64_tr_b16 v[40:41],v5 offset:2048
 ds_read_b64_tr_b16 v[42:43],v5 offset:2560
 buffer_load_dwordx4 v[212:215],v2,s[32:35],s57 offen offset:1024 sc1
 v_mfma_f32_32x32x16_bf16 v[104:119],v[44:47],v[248:251],v[104:119]
 ds_read_b64_tr_b16 v[44:45],v5 offset:18432
 ds_read_b64_tr_b16 v[46:47],v5 offset:18944
 s_waitcnt vmcnt(10) lgkmcnt(4)
 v_mfma_f32_32x32x16_bf16 v[88:103],v[48:51],v[252:255],v[88:103]
 ds_read_b64_tr_b16 v[48:49],v5 offset:3072
 ds_read_b64_tr_b16 v[50:51],v5 offset:3584
 buffer_load_dwordx4 v[224:227],v2,s[32:35],s77 offen sc1
 v_bitop3_b32 v38,v144,v148,1 bitop3:0x80
 v_cmp_eq_u32 vcc,0,v38
 v_mfma_f32_32x32x16_bf16 v[104:119],v[52:55],v[252:255],v[104:119]
 ds_read_b64_tr_b16 v[52:53],v5 offset:19456
 ds_read_b64_tr_b16 v[54:55],v5 offset:19968
 s_cbranch_vccnz Lfix_60
Lret_61:
 s_waitcnt lgkmcnt(4)
 v_mfma_f32_32x32x16_bf16 v[88:103],v[40:43],v[144:147],v[88:103]
 ds_read_b64_tr_b16 v[40:41],v5 offset:6144
 ds_read_b64_tr_b16 v[42:43],v5 offset:6656
 buffer_load_dwordx4 v[228:231],v2,s[32:35],s77 offen offset:1024 sc1
 s_add_u32 s96,s95,0
 s_and_b32 s96,s96,7
 s_mul_i32 s96,s96,176128
 s_add_u32 s96,s96,s63
 s_add_u32 m0,s54,131072
 s_add_u32 s52,s96,0
 buffer_load_dwordx4 v8,s[20:23],s52 offen lds
 v_mfma_f32_32x32x16_bf16 v[104:119],v[44:47],v[144:147],v[104:119]
 ds_read_b64_tr_b16 v[44:45],v5 offset:22528
 ds_read_b64_tr_b16 v[46:47],v5 offset:23040
 s_waitcnt vmcnt(11) lgkmcnt(4)
 v_mfma_f32_32x32x16_bf16 v[88:103],v[48:51],v[148:151],v[88:103]
 ds_read_b64_tr_b16 v[48:49],v5 offset:7168
 ds_read_b64_tr_b16 v[50:51],v5 offset:7680
 buffer_load_dwordx4 v[240:243],v2,s[32:35],s81 offen sc1
 s_add_u32 s96,s95,1
 s_and_b32 s96,s96,7
 s_mul_i32 s96,s96,176128
 s_add_u32 s96,s96,s63
 s_add_u32 m0,s54,135168
 s_add_u32 s52,s96,0
 buffer_load_dwordx4 v8,s[20:23],s52 offen lds
 v_bitop3_b32 v38,v160,v164,1 bitop3:0x80
 v_cmp_eq_u32 vcc,0,v38
 v_mfma_f32_32x32x16_bf16 v[104:119],v[52:55],v[148:151],v[104:119]
 ds_read_b64_tr_b16 v[52:53],v5 offset:23552
 ds_read_b64_tr_b16 v[54:55],v5 offset:24064
 s_cbranch_vccnz Lfix_63
Lret_64:
 s_waitcnt lgkmcnt(4)
 v_mfma_f32_32x32x16_bf16 v[88:103],v[40:43],v[160:163],v[88:103]
 ds_read_b64_tr_b16 v[40:41],v5 offset:10240
 ds_read_b64_tr_b16 v[42:43],v5 offset:10752
 buffer_load_dwordx4 v[244:247],v2,s[32:35],s81 offen offset:1024 sc1
 s_add_u32 s96,s95,2
 s_and_b32 s96,s96,7
 s_mul_i32 s96,s96,176128
 s_add_u32 s96,s96,s63
 s_add_u32 m0,s54,139264
 s_add_u32 s52,s96,0
 buffer_load_dwordx4 v8,s[20:23],s52 offen lds
 v_mfma_f32_32x32x16_bf16 v[104:119],v[44:47],v[160:163],v[104:119]
 ds_read_b64_tr_b16 v[44:45],v5 offset:26624
 ds_read_b64_tr_b16 v[46:47],v5 offset:27136
 s_waitcnt vmcnt(11) lgkmcnt(4)
 v_mfma_f32_32x32x16_bf16 v[88:103],v[48:51],v[164:167],v[88:103]
 ds_read_b64_tr_b16 v[48:49],v5 offset:11264
 ds_read_b64_tr_b16 v[50:51],v5 offset:11776
 buffer_load_dwordx4 a[248:251],v2,s[32:35],s99 offen sc1
 s_add_u32 s96,s95,3
 s_and_b32 s96,s96,7
 s_mul_i32 s96,s96,176128
 s_add_u32 s96,s96,s63
 s_add_u32 m0,s54,143360
 s_add_u32 s52,s96,0
 buffer_load_dwordx4 v8,s[20:23],s52 offen lds
 v_bitop3_b32 v38,v176,v180,1 bitop3:0x80
 v_cmp_eq_u32 vcc,0,v38
 v_mfma_f32_32x32x16_bf16 v[104:119],v[52:55],v[164:167],v[104:119]
 ds_read_b64_tr_b16 v[52:53],v5 offset:27648
 ds_read_b64_tr_b16 v[54:55],v5 offset:28160
 v_and_b32 v38,v72,v73
 v_bitop3_b32 v38,v74,v75,v38 bitop3:0x80
 v_bitop3_b32 v38,v76,v77,v38 bitop3:0x80
 v_bitop3_b32 v38,v78,v79,v38 bitop3:0x80
 v_and_b32 v38,1,v38
 v_cmp_eq_u32 s[82:83],0,v38
 s_nop 0
 s_cmp_lg_u64 s[82:83],0
 s_cbranch_scc1 Lfix_69
Lret_70:
 v_add_f32 v72,v72,v73
 s_cbranch_vccnz Lfix_66
Lret_67:
 s_waitcnt lgkmcnt(4)
 v_mfma_f32_32x32x16_bf16 v[88:103],v[40:43],v[176:179],v[88:103]
 ds_read_b64_tr_b16 v[40:41],v5 offset:14336
 ds_read_b64_tr_b16 v[42:43],v5 offset:14848
 buffer_load_dwordx4 a[252:255],v2,s[32:35],s99 offen offset:1024 sc1
 s_add_u32 s96,s95,4
 s_and_b32 s96,s96,7
 s_mul_i32 s96,s96,176128
 s_add_u32 s96,s96,s63
 s_add_u32 m0,s54,147456
 s_add_u32 s52,s96,0
 buffer_load_dwordx4 v8,s[20:23],s52 offen lds
 v_add_f32 v74,v74,v75
 v_add_f32 v76,v76,v77
 v_mfma_f32_32x32x16_bf16 v[104:119],v[44:47],v[176:179],v[104:119]
 ds_read_b64_tr_b16 v[44:45],v5 offset:30720
 ds_read_b64_tr_b16 v[46:47],v5 offset:31232
 v_add_f32 v78,v78,v79
 v_add_f32 v72,v72,v74
 s_waitcnt vmcnt(13) lgkmcnt(4)
 v_mfma_f32_32x32x16_bf16 v[88:103],v[48:51],v[180:183],v[88:103]
 ds_read_b64_tr_b16 v[48:49],v5 offset:15360
 ds_read_b64_tr_b16 v[50:51],v5 offset:15872
 s_add_u32 s96,s95,5
 s_and_b32 s96,s96,7
 s_mul_i32 s96,s96,176128
 s_add_u32 s96,s96,s63
 s_add_u32 m0,s54,151552
 s_add_u32 s52,s96,0
 buffer_load_dwordx4 v8,s[20:23],s52 offen lds
 v_bitop3_b32 v38,v192,v196,1 bitop3:0x80
 v_cmp_eq_u32 vcc,0,v38
 v_mfma_f32_32x32x16_bf16 v[104:119],v[52:55],v[180:183],v[104:119]
 ds_read_b64_tr_b16 v[52:53],v5 offset:31744
 ds_read_b64_tr_b16 v[54:55],v5 offset:32256
 v_add_f32 v76,v76,v78
 v_add_f32 v72,v72,v76
 s_cbranch_vccnz Lfix_72
Lret_73:
 s_waitcnt lgkmcnt(4)
 v_mfma_f32_32x32x16_bf16 v[88:103],v[40:43],v[192:195],v[88:103]
 ds_read_b64_tr_b16 v[40:41],v5 offset:34816
 ds_read_b64_tr_b16 v[42:43],v5 offset:35328
 s_add_u32 s96,s95,6
 s_and_b32 s96,s96,7
 s_mul_i32 s96,s96,176128
 s_add_u32 s96,s96,s63
 s_add_u32 m0,s54,155648
 s_add_u32 s52,s96,0
 buffer_load_dwordx4 v8,s[20:23],s52 offen lds
 v_mov_b32 v73,v72
 s_nop 1
 v_permlane32_swap_b32 v72,v73
 v_mfma_f32_32x32x16_bf16 v[104:119],v[44:47],v[192:195],v[104:119]
 ds_read_b64_tr_b16 v[44:45],v5 offset:51200
 ds_read_b64_tr_b16 v[46:47],v5 offset:51712
 v_mul_f32 v72,s74,v72
 v_cndmask_b32_e64 v72,0,-v72,s[92:93]
 s_waitcnt vmcnt(13) lgkmcnt(4)
 v_mfma_f32_32x32x16_bf16 v[88:103],v[48:51],v[196:199],v[88:103]
 ds_read_b64_tr_b16 v[48:49],v5 offset:35840
 ds_read_b64_tr_b16 v[50:51],v5 offset:36352
 s_add_u32 s96,s95,7
 s_and_b32 s96,s96,7
 s_mul_i32 s96,s96,176128
 s_add_u32 s96,s96,s63
 s_add_u32 m0,s54,159744
 s_add_u32 s52,s96,0
 buffer_load_dwordx4 v8,s[20:23],s52 offen lds
 v_bitop3_b32 v38,v208,v212,1 bitop3:0x80
 v_cmp_eq_u32 vcc,0,v38
 v_mfma_f32_32x32x16_bf16 v[104:119],v[52:55],v[196:199],v[104:119]
 ds_read_b64_tr_b16 v[52:53],v5 offset:52224
 ds_read_b64_tr_b16 v[54:55],v5 offset:52736
 v_cvt_pk_bf16_f32 v24,v72,v72
 v_lshlrev_b32 v74,16,v24
 s_cbranch_vccnz Lfix_75
Lret_76:
 s_waitcnt lgkmcnt(4)
 v_mfma_f32_32x32x16_bf16 v[88:103],v[40:43],v[208:211],v[88:103]
 ds_read_b64_tr_b16 v[40:41],v5 offset:38912
 ds_read_b64_tr_b16 v[42:43],v5 offset:39424
 v_sub_f32 v72,v72,v74
 v_cvt_pk_bf16_f32 v25,v72,v72
 v_mfma_f32_32x32x16_bf16 v[104:119],v[44:47],v[208:211],v[104:119]
 ds_read_b64_tr_b16 v[44:45],v5 offset:55296
 ds_read_b64_tr_b16 v[46:47],v5 offset:55808
 s_waitcnt vmcnt(12) lgkmcnt(4)
 v_mfma_f32_32x32x16_bf16 v[88:103],v[48:51],v[212:215],v[88:103]
 ds_read_b64_tr_b16 v[48:49],v5 offset:39936
 ds_read_b64_tr_b16 v[50:51],v5 offset:40448
 v_bitop3_b32 v38,v224,v228,1 bitop3:0x80
 v_cmp_eq_u32 vcc,0,v38
 v_mfma_f32_32x32x16_bf16 v[104:119],v[52:55],v[212:215],v[104:119]
 ds_read_b64_tr_b16 v[52:53],v5 offset:56320
 ds_read_b64_tr_b16 v[54:55],v5 offset:56832
 s_cbranch_vccnz Lfix_78
Lret_79:
 s_waitcnt lgkmcnt(4)
 v_mfma_f32_32x32x16_bf16 v[88:103],v[40:43],v[224:227],v[88:103]
 ds_read_b64_tr_b16 v[40:41],v5 offset:43008
 ds_read_b64_tr_b16 v[42:43],v5 offset:43520
 s_waitcnt lgkmcnt(0)
 s_barrier
 s_bfe_u32 s96,s45,0x5000a
 s_lshl_b32 s96,s96,16
 s_add_u32 s96,s96,s66
 s_add_u32 m0,s54,65536
 s_add_u32 s52,s96,0
 buffer_load_dwordx4 v9,s[24:27],s52 offen lds
 s_add_u32 m0,s54,69632
 s_add_u32 s52,s96,8192
 buffer_load_dwordx4 v9,s[24:27],s52 offen lds
 v_mfma_f32_32x32x16_bf16 v[104:119],v[44:47],v[224:227],v[104:119]
 ds_read_b64_tr_b16 v[44:45],v5 offset:59392
 ds_read_b64_tr_b16 v[46:47],v5 offset:59904
 s_bfe_u32 s96,s45,0x5000f
 s_lshl_b32 s96,s96,16
 s_add_u32 s96,s96,s66
 s_add_u32 m0,s54,73728
 s_add_u32 s52,s96,0
 buffer_load_dwordx4 v9,s[24:27],s52 offen lds
 s_add_u32 m0,s54,77824
 s_add_u32 s52,s96,8192
 buffer_load_dwordx4 v9,s[24:27],s52 offen lds
 s_bfe_u32 s96,s45,0x50014
 s_lshl_b32 s96,s96,16
 s_add_u32 s96,s96,s66
 s_add_u32 m0,s54,81920
 s_add_u32 s52,s96,0
 buffer_load_dwordx4 v9,s[24:27],s52 offen lds
 s_add_u32 m0,s54,86016
 s_add_u32 s52,s96,8192
 buffer_load_dwordx4 v9,s[24:27],s52 offen lds
 s_waitcnt vmcnt(14)
 v_mfma_f32_32x32x16_bf16 v[88:103],v[48:51],v[228:231],v[88:103]
 ds_read_b64_tr_b16 v[48:49],v5 offset:44032
 ds_read_b64_tr_b16 v[50:51],v5 offset:44544
 v_bitop3_b32 v38,v240,v244,1 bitop3:0x80
 v_cmp_eq_u32 vcc,0,v38
 v_mfma_f32_32x32x16_bf16 v[104:119],v[52:55],v[228:231],v[104:119]
 ds_read_b64_tr_b16 v[52:53],v5 offset:60416
 ds_read_b64_tr_b16 v[54:55],v5 offset:60928
 s_bfe_u32 s96,s45,0x50019
 s_lshl_b32 s96,s96,16
 s_add_u32 s96,s96,s66
 s_add_u32 m0,s54,90112
 s_add_u32 s52,s96,0
 buffer_load_dwordx4 v9,s[24:27],s52 offen lds
 s_add_u32 m0,s54,94208
 s_add_u32 s52,s96,8192
 buffer_load_dwordx4 v9,s[24:27],s52 offen lds
 s_cbranch_vccnz Lfix_81
Lret_82:
 s_waitcnt lgkmcnt(4)
 v_mfma_f32_32x32x16_bf16 v[88:103],v[40:43],v[240:243],v[88:103]
 ds_read_b64_tr_b16 v[40:41],v5 offset:47104
 ds_read_b64_tr_b16 v[42:43],v5 offset:47616
 v_mfma_f32_32x32x16_bf16 v[104:119],v[44:47],v[240:243],v[104:119]
 ds_read_b64_tr_b16 v[44:45],v5 offset:63488
 ds_read_b64_tr_b16 v[46:47],v5 offset:64000
 s_waitcnt vmcnt(12) lgkmcnt(4)
 v_mfma_f32_32x32x16_bf16 v[88:103],v[48:51],v[244:247],v[88:103]
 ds_read_b64_tr_b16 v[48:49],v5 offset:48128
 ds_read_b64_tr_b16 v[50:51],v5 offset:48640
 v_accvgpr_read_b32 v38,a248
 v_lshlrev_b32 v38,31,v38
 v_cmp_eq_u32 s[82:83],0,v38
 v_accvgpr_read_b32 v38,a252
 v_lshlrev_b32 v38,31,v38
 v_cmp_eq_u32 vcc,0,v38
 s_nop 1
 s_or_b64 vcc,vcc,s[82:83]
 v_mfma_f32_32x32x16_bf16 v[104:119],v[52:55],v[244:247],v[104:119]
 ds_read_b64_tr_b16 v[52:53],v5 offset:64512
 ds_read_b64_tr_b16 v[54:55],v5 offset:65024
 s_cbranch_vccnz Lfix_84
Lret_85:
 s_waitcnt lgkmcnt(4)
 v_mfma_f32_32x32x16_bf16 v[88:103],v[40:43],a[248:251],v[88:103]
 v_mfma_f32_32x32x16_bf16 v[104:119],v[44:47],a[248:251],v[104:119]
 s_waitcnt lgkmcnt(0)
 v_mfma_f32_32x32x16_bf16 v[88:103],v[48:51],a[252:255],v[88:103]
 v_mfma_f32_32x32x16_bf16 v[104:119],v[52:55],a[252:255],v[104:119]
 v_mov_b32 v28,v22
 v_mov_b32 v29,v22
 s_nop 1
 v_mfma_f32_32x32x16_bf16 v[88:103],v[28:31],v[24:27],v[88:103]
 v_mov_b32 v28,v23
 v_mov_b32 v29,v23
 s_nop 1
 v_mfma_f32_32x32x16_bf16 v[104:119],v[28:31],v[24:27],v[104:119]
 s_waitcnt vmcnt(8)
 s_barrier
 ds_read_b64_tr_b16 v[40:41],v6 offset:0
 ds_read_b64_tr_b16 v[42:43],v6 offset:512
 ds_read_b64_tr_b16 v[44:45],v6 offset:1024
 ds_read_b64_tr_b16 v[46:47],v6 offset:1536
 ds_read_b64_tr_b16 v[48:49],v6 offset:2048
 ds_read_b64_tr_b16 v[50:51],v6 offset:2560
 ds_read_b64_tr_b16 v[52:53],v6 offset:3072
 ds_read_b64_tr_b16 v[54:55],v6 offset:3584
 s_waitcnt lgkmcnt(6)
 v_mfma_f32_32x32x16_bf16 v[120:135],v[40:43],v[136:139],0
 ds_read_b64_tr_b16 v[40:41],v6 offset:4096
 ds_read_b64_tr_b16 v[42:43],v6 offset:4608
 s_waitcnt lgkmcnt(6)
 v_mfma_f32_32x32x16_bf16 v[120:135],v[44:47],v[140:143],v[120:135]
 ds_read_b64_tr_b16 v[44:45],v6 offset:5120
 ds_read_b64_tr_b16 v[46:47],v6 offset:5632
 s_waitcnt lgkmcnt(6)
 v_mfma_f32_32x32x16_bf16 v[120:135],v[48:51],v[144:147],v[120:135]
 v_cvt_pk_bf16_f32 v88,v88,v89
 v_cvt_pk_bf16_f32 v89,v90,v91
 v_cvt_pk_bf16_f32 v90,v92,v93
 ds_read_b64_tr_b16 v[48:49],v6 offset:6144
 ds_read_b64_tr_b16 v[50:51],v6 offset:6656
 s_waitcnt lgkmcnt(6)
 v_mfma_f32_32x32x16_bf16 v[120:135],v[52:55],v[148:151],v[120:135]
 v_cvt_pk_bf16_f32 v91,v94,v95
 v_cvt_pk_bf16_f32 v92,v96,v97
 v_cvt_pk_bf16_f32 v93,v98,v99
 ds_read_b64_tr_b16 v[52:53],v6 offset:7168
 ds_read_b64_tr_b16 v[54:55],v6 offset:7680
 s_waitcnt lgkmcnt(6)
 v_mfma_f32_32x32x16_bf16 v[120:135],v[40:43],v[152:155],v[120:135]
 v_cvt_pk_bf16_f32 v94,v100,v101
 v_cvt_pk_bf16_f32 v95,v102,v103
 v_pk_max_i16 v88,v88,0
 ds_read_b64_tr_b16 v[40:41],v6 offset:8192
 ds_read_b64_tr_b16 v[42:43],v6 offset:8704
 s_waitcnt lgkmcnt(6)
 v_mfma_f32_32x32x16_bf16 v[120:135],v[44:47],v[156:159],v[120:135]
 v_pk_max_i16 v89,v89,0
 v_pk_max_i16 v90,v90,0
 v_pk_max_i16 v91,v91,0
 ds_read_b64_tr_b16 v[44:45],v6 offset:9216
 ds_read_b64_tr_b16 v[46:47],v6 offset:9728
 s_waitcnt lgkmcnt(6)
 v_mfma_f32_32x32x16_bf16 v[120:135],v[48:51],v[160:163],v[120:135]
 v_pk_max_i16 v92,v92,0
 v_pk_max_i16 v93,v93,0
 v_pk_max_i16 v94,v94,0
 ds_read_b64_tr_b16 v[48:49],v6 offset:10240
 ds_read_b64_tr_b16 v[50:51],v6 offset:10752
 s_waitcnt lgkmcnt(6)
 v_mfma_f32_32x32x16_bf16 v[120:135],v[52:55],v[164:167],v[120:135]
 v_pk_max_i16 v95,v95,0
 v_or_b32 v88,0x80000000,v88
 v_or_b32 v92,0x80000000,v92
 ds_read_b64_tr_b16 v[52:53],v6 offset:11264
 ds_read_b64_tr_b16 v[54:55],v6 offset:11776
 s_waitcnt lgkmcnt(6)
 v_mfma_f32_32x32x16_bf16 v[120:135],v[40:43],v[168:171],v[120:135]
 s_add_u32 s52,s64,0
 buffer_store_dwordx4 v[88:91],v1,s[32:35],s52 offen
 s_add_u32 s52,s64,0
 buffer_store_dwordx4 v[92:95],v1,s[32:35],s52 offen offset:1024
 v_cvt_pk_bf16_f32 v104,v104,v105
 v_cvt_pk_bf16_f32 v105,v106,v107
 ds_read_b64_tr_b16 v[40:41],v6 offset:12288
 ds_read_b64_tr_b16 v[42:43],v6 offset:12800
 s_waitcnt lgkmcnt(6)
 v_mfma_f32_32x32x16_bf16 v[120:135],v[44:47],v[172:175],v[120:135]
 v_cvt_pk_bf16_f32 v106,v108,v109
 v_cvt_pk_bf16_f32 v107,v110,v111
 v_cvt_pk_bf16_f32 v108,v112,v113
 ds_read_b64_tr_b16 v[44:45],v6 offset:13312
 ds_read_b64_tr_b16 v[46:47],v6 offset:13824
 s_waitcnt lgkmcnt(6)
 v_mfma_f32_32x32x16_bf16 v[120:135],v[48:51],v[176:179],v[120:135]
 v_cvt_pk_bf16_f32 v109,v114,v115
 v_cvt_pk_bf16_f32 v110,v116,v117
 v_cvt_pk_bf16_f32 v111,v118,v119
 ds_read_b64_tr_b16 v[48:49],v6 offset:14336
 ds_read_b64_tr_b16 v[50:51],v6 offset:14848
 s_waitcnt lgkmcnt(6)
 v_mfma_f32_32x32x16_bf16 v[120:135],v[52:55],v[180:183],v[120:135]
 v_pk_max_i16 v104,v104,0
 v_pk_max_i16 v105,v105,0
 v_pk_max_i16 v106,v106,0
 ds_read_b64_tr_b16 v[52:53],v6 offset:15360
 ds_read_b64_tr_b16 v[54:55],v6 offset:15872
 s_waitcnt lgkmcnt(6)
 v_mfma_f32_32x32x16_bf16 v[120:135],v[40:43],v[184:187],v[120:135]
 v_pk_max_i16 v107,v107,0
 v_pk_max_i16 v108,v108,0
 v_pk_max_i16 v109,v109,0
 ds_read_b64_tr_b16 v[40:41],v6 offset:16384
 ds_read_b64_tr_b16 v[42:43],v6 offset:16896
 s_waitcnt lgkmcnt(6)
 v_mfma_f32_32x32x16_bf16 v[120:135],v[44:47],v[188:191],v[120:135]
 v_pk_max_i16 v110,v110,0
 v_pk_max_i16 v111,v111,0
 v_or_b32 v104,0x80000000,v104
 ds_read_b64_tr_b16 v[44:45],v6 offset:17408
 ds_read_b64_tr_b16 v[46:47],v6 offset:17920
 s_waitcnt lgkmcnt(6)
 v_mfma_f32_32x32x16_bf16 v[120:135],v[48:51],v[192:195],v[120:135]
 v_or_b32 v108,0x80000000,v108
 s_lshl_b32 s53,s60,5
 s_add_u32 s53,s53,s64
 s_add_u32 s52,s53,0
 buffer_store_dwordx4 v[104:107],v1,s[32:35],s52 offen
 s_add_u32 s52,s53,0
 buffer_store_dwordx4 v[108:111],v1,s[32:35],s52 offen offset:1024
 v_add_u32 v32,s68,v1
 ds_read_b64_tr_b16 v[48:49],v6 offset:18432
 ds_read_b64_tr_b16 v[50:51],v6 offset:18944
 s_waitcnt lgkmcnt(6)
 v_mfma_f32_32x32x16_bf16 v[120:135],v[52:55],v[196:199],v[120:135]
 v_add_u32 v33,88064,v32
 s_bfe_u32 s96,s46,0x50000
 s_lshl_b32 s96,s96,16
 s_add_u32 s96,s96,s66
 s_add_u32 m0,s54,98304
 s_add_u32 s52,s96,0
 buffer_load_dwordx4 v9,s[24:27],s52 offen lds
 s_add_u32 m0,s54,102400
 s_add_u32 s52,s96,8192
 buffer_load_dwordx4 v9,s[24:27],s52 offen lds
 s_bfe_u32 s96,s46,0x50005
 s_lshl_b32 s96,s96,16
 s_add_u32 s96,s96,s66
 s_add_u32 m0,s54,106496
 s_add_u32 s52,s96,0
 buffer_load_dwordx4 v9,s[24:27],s52 offen lds
 s_add_u32 m0,s54,110592
 s_add_u32 s52,s96,8192
 buffer_load_dwordx4 v9,s[24:27],s52 offen lds
 ds_read_b64_tr_b16 v[52:53],v6 offset:19456
 ds_read_b64_tr_b16 v[54:55],v6 offset:19968
 s_waitcnt lgkmcnt(6)
 v_mfma_f32_32x32x16_bf16 v[120:135],v[40:43],v[200:203],v[120:135]
 s_bfe_u32 s96,s46,0x5000a
 s_lshl_b32 s96,s96,16
 s_add_u32 s96,s96,s66
 s_add_u32 m0,s54,114688
 s_add_u32 s52,s96,0
 buffer_load_dwordx4 v9,s[24:27],s52 offen lds
 s_add_u32 m0,s54,118784
 s_add_u32 s52,s96,8192
 buffer_load_dwordx4 v9,s[24:27],s52 offen lds
 s_bfe_u32 s96,s46,0x5000f
 s_lshl_b32 s96,s96,16
 s_add_u32 s96,s96,s66
 s_add_u32 m0,s54,122880
 s_add_u32 s52,s96,0
 buffer_load_dwordx4 v9,s[24:27],s52 offen lds
 s_add_u32 m0,s54,126976
 s_add_u32 s52,s96,8192
 buffer_load_dwordx4 v9,s[24:27],s52 offen lds
 s_waitcnt vmcnt(12)
 ds_read_b64_tr_b16 v[40:41],v6 offset:20480
 ds_read_b64_tr_b16 v[42:43],v6 offset:20992
 s_waitcnt lgkmcnt(6)
 v_mfma_f32_32x32x16_bf16 v[120:135],v[44:47],v[204:207],v[120:135]
 v_add_u32 v12,0x10000,v10
 v_add_u32 v14,0x10000,v11
 ds_read_b64_tr_b16 a[64:65],v12 offset:0
 ds_read_b64_tr_b16 a[68:69],v14 offset:0
 ds_read_b64_tr_b16 a[66:67],v12 offset:4096
 ds_read_b64_tr_b16 a[70:71],v14 offset:4096
 ds_read_b64_tr_b16 a[72:73],v12 offset:8192
 ds_read_b64_tr_b16 a[76:77],v14 offset:8192
 ds_read_b64_tr_b16 v[44:45],v6 offset:21504
 ds_read_b64_tr_b16 v[46:47],v6 offset:22016
 s_waitcnt lgkmcnt(12)
 v_mfma_f32_32x32x16_bf16 v[120:135],v[48:51],v[208:211],v[120:135]
 ds_read_b64_tr_b16 a[74:75],v12 offset:12288
 ds_read_b64_tr_b16 a[78:79],v14 offset:12288
 ds_read_b64_tr_b16 a[80:81],v12 offset:16384
 ds_read_b64_tr_b16 a[84:85],v14 offset:16384
 ds_read_b64_tr_b16 a[82:83],v12 offset:20480
 ds_read_b64_tr_b16 a[86:87],v14 offset:20480
 ds_read_b64_tr_b16 v[48:49],v6 offset:22528
 ds_read_b64_tr_b16 v[50:51],v6 offset:23040
 s_waitcnt lgkmcnt(15)
 v_mfma_f32_32x32x16_bf16 v[120:135],v[52:55],v[212:215],v[120:135]
 ds_read_b64_tr_b16 a[88:89],v12 offset:24576
 ds_read_b64_tr_b16 a[92:93],v14 offset:24576
 ds_read_b64_tr_b16 a[90:91],v12 offset:28672
 ds_read_b64_tr_b16 a[94:95],v14 offset:28672
 s_waitcnt lgkmcnt(0)
 ds_read_b64_tr_b16 v[52:53],v6 offset:23552
 ds_read_b64_tr_b16 v[54:55],v6 offset:24064
 v_mfma_f32_32x32x16_bf16 v[120:135],v[40:43],v[216:219],v[120:135]
 s_bfe_u32 s84,s44,0x50000
 s_lshl_b32 s84,s84,12
 buffer_load_dwordx4 v[136:139],v32,s[32:35],s84 offen sc1
 ds_read_b64_tr_b16 v[40:41],v6 offset:24576
 ds_read_b64_tr_b16 v[42:43],v6 offset:25088
 v_mfma_f32_32x32x16_bf16 v[120:135],v[44:47],v[220:223],v[120:135]
 s_bfe_u32 s84,s44,0x50000
 s_lshl_b32 s84,s84,12
 buffer_load_dwordx4 v[140:143],v33,s[32:35],s84 offen sc1
 ds_read_b64_tr_b16 v[44:45],v6 offset:25600
 ds_read_b64_tr_b16 v[46:47],v6 offset:26112
 v_mfma_f32_32x32x16_bf16 v[120:135],v[48:51],v[224:227],v[120:135]
 s_bfe_u32 s84,s44,0x50005
 s_lshl_b32 s84,s84,12
 buffer_load_dwordx4 v[144:147],v32,s[32:35],s84 offen sc1
 ds_read_b64_tr_b16 v[48:49],v6 offset:26624
 ds_read_b64_tr_b16 v[50:51],v6 offset:27136
 s_waitcnt lgkmcnt(6)
 v_mfma_f32_32x32x16_bf16 v[120:135],v[52:55],v[228:231],v[120:135]
 s_bfe_u32 s84,s44,0x50005
 s_lshl_b32 s84,s84,12
 buffer_load_dwordx4 v[148:151],v33,s[32:35],s84 offen sc1
 ds_read_b64_tr_b16 v[52:53],v6 offset:27648
 ds_read_b64_tr_b16 v[54:55],v6 offset:28160
 s_waitcnt lgkmcnt(6)
 v_mfma_f32_32x32x16_bf16 v[120:135],v[40:43],v[232:235],v[120:135]
 s_bfe_u32 s84,s44,0x5000a
 s_lshl_b32 s84,s84,12
 buffer_load_dwordx4 v[152:155],v32,s[32:35],s84 offen sc1
 ds_read_b64_tr_b16 v[40:41],v6 offset:28672
 ds_read_b64_tr_b16 v[42:43],v6 offset:29184
 s_waitcnt lgkmcnt(6)
 v_mfma_f32_32x32x16_bf16 v[120:135],v[44:47],v[236:239],v[120:135]
 s_bfe_u32 s84,s44,0x5000a
 s_lshl_b32 s84,s84,12
 buffer_load_dwordx4 v[156:159],v33,s[32:35],s84 offen sc1
 ds_read_b64_tr_b16 v[44:45],v6 offset:29696
 ds_read_b64_tr_b16 v[46:47],v6 offset:30208
 s_waitcnt lgkmcnt(6)
 v_mfma_f32_32x32x16_bf16 v[120:135],v[48:51],v[240:243],v[120:135]
 s_bfe_u32 s84,s44,0x5000f
 s_lshl_b32 s84,s84,12
 buffer_load_dwordx4 v[160:163],v32,s[32:35],s84 offen sc1
 ds_read_b64_tr_b16 v[48:49],v6 offset:30720
 ds_read_b64_tr_b16 v[50:51],v6 offset:31232
 s_waitcnt lgkmcnt(6)
 v_mfma_f32_32x32x16_bf16 v[120:135],v[52:55],v[244:247],v[120:135]
 s_bfe_u32 s84,s44,0x5000f
 s_lshl_b32 s84,s84,12
 buffer_load_dwordx4 v[164:167],v33,s[32:35],s84 offen sc1
 ds_read_b64_tr_b16 v[52:53],v6 offset:31744
 ds_read_b64_tr_b16 v[54:55],v6 offset:32256
 s_waitcnt lgkmcnt(6)
 v_mfma_f32_32x32x16_bf16 v[120:135],v[40:43],v[248:251],v[120:135]
 s_bfe_u32 s84,s44,0x50014
 s_lshl_b32 s84,s84,12
 buffer_load_dwordx4 v[168:171],v32,s[32:35],s84 offen sc1
 s_waitcnt lgkmcnt(4)
 v_mfma_f32_32x32x16_bf16 v[120:135],v[44:47],v[252:255],v[120:135]
 s_bfe_u32 s84,s44,0x50014
 s_lshl_b32 s84,s84,12
 buffer_load_dwordx4 v[172:175],v33,s[32:35],s84 offen sc1
 s_waitcnt lgkmcnt(2)
 v_mfma_f32_32x32x16_bf16 v[120:135],v[48:51],a[248:251],v[120:135]
 s_waitcnt lgkmcnt(0)
 v_mfma_f32_32x32x16_bf16 v[120:135],v[52:55],a[252:255],v[120:135]
 v_mov_b32 v28,v34
 v_mov_b32 v29,v34
 s_nop 1
 v_mfma_f32_32x32x16_bf16 v[120:135],v[28:31],v[24:27],v[120:135]
 s_barrier
 s_bfe_u32 s96,s46,0x50014
 s_lshl_b32 s96,s96,16
 s_add_u32 s96,s96,s66
 s_add_u32 m0,s54,131072
 s_add_u32 s52,s96,0
 buffer_load_dwordx4 v9,s[24:27],s52 offen lds
 s_add_u32 m0,s54,135168
 s_add_u32 s52,s96,8192
 buffer_load_dwordx4 v9,s[24:27],s52 offen lds
 s_bfe_u32 s96,s46,0x50019
 s_lshl_b32 s96,s96,16
 s_add_u32 s96,s96,s66
 s_add_u32 m0,s54,139264
 s_add_u32 s52,s96,0
 buffer_load_dwordx4 v9,s[24:27],s52 offen lds
 s_add_u32 m0,s54,143360
 s_add_u32 s52,s96,8192
 buffer_load_dwordx4 v9,s[24:27],s52 offen lds
 s_bfe_u32 s96,s47,0x50000
 s_lshl_b32 s96,s96,16
 s_add_u32 s96,s96,s66
 s_add_u32 m0,s54,147456
 s_add_u32 s52,s96,0
 buffer_load_dwordx4 v9,s[24:27],s52 offen lds
 s_add_u32 m0,s54,151552
 s_add_u32 s52,s96,8192
 buffer_load_dwordx4 v9,s[24:27],s52 offen lds
 s_bfe_u32 s96,s47,0x50005
 s_lshl_b32 s96,s96,16
 s_add_u32 s96,s96,s66
 s_add_u32 m0,s54,155648
 s_add_u32 s52,s96,0
 buffer_load_dwordx4 v9,s[24:27],s52 offen lds
 s_add_u32 m0,s54,159744
 s_add_u32 s52,s96,8192
 buffer_load_dwordx4 v9,s[24:27],s52 offen lds
 v_cvt_pk_bf16_f32 v120,v120,v121
 v_cvt_pk_bf16_f32 v121,v122,v123
 v_cvt_pk_bf16_f32 v122,v124,v125
 v_cvt_pk_bf16_f32 v123,v126,v127
 v_cvt_pk_bf16_f32 v124,v128,v129
 v_cvt_pk_bf16_f32 v125,v130,v131
 v_cvt_pk_bf16_f32 v126,v132,v133
 v_cvt_pk_bf16_f32 v127,v134,v135
 v_pk_max_i16 v120,v120,0
 v_pk_max_i16 v121,v121,0
 v_pk_max_i16 v122,v122,0
 v_pk_max_i16 v123,v123,0
 v_pk_max_i16 v124,v124,0
 v_pk_max_i16 v125,v125,0
 v_pk_max_i16 v126,v126,0
 v_pk_max_i16 v127,v127,0
 v_or_b32 v120,0x80000000,v120
 v_or_b32 v124,0x80000000,v124
 s_cmp_ge_u32 s6,11
 s_cbranch_scc1 Lh3_87
 s_add_u32 s52,s64,2048
 buffer_store_dwordx4 v[120:123],v1,s[32:35],s52 offen
 s_add_u32 s52,s64,2048
 buffer_store_dwordx4 v[124:127],v1,s[32:35],s52 offen offset:1024
Lh3_87:
 s_waitcnt vmcnt(18)
 ds_read_b64_tr_b16 a[96:97],v12 offset:32768
 ds_read_b64_tr_b16 a[100:101],v14 offset:32768
 ds_read_b64_tr_b16 a[98:99],v12 offset:36864
 ds_read_b64_tr_b16 a[102:103],v14 offset:36864
 ds_read_b64_tr_b16 a[104:105],v12 offset:40960
 ds_read_b64_tr_b16 a[108:109],v14 offset:40960
 ds_read_b64_tr_b16 a[106:107],v12 offset:45056
 ds_read_b64_tr_b16 a[110:111],v14 offset:45056
 ds_read_b64_tr_b16 a[112:113],v12 offset:49152
 ds_read_b64_tr_b16 a[116:117],v14 offset:49152
 ds_read_b64_tr_b16 a[114:115],v12 offset:53248
 ds_read_b64_tr_b16 a[118:119],v14 offset:53248
 ds_read_b64_tr_b16 a[120:121],v12 offset:57344
 ds_read_b64_tr_b16 a[124:125],v14 offset:57344
 ds_read_b64_tr_b16 a[122:123],v12 offset:61440
 ds_read_b64_tr_b16 a[126:127],v14 offset:61440
 s_waitcnt lgkmcnt(0)
 s_bfe_u32 s96,s47,0x5000a
 s_lshl_b32 s96,s96,16
 s_add_u32 s96,s96,s66
 s_add_u32 m0,s54,98304
 s_add_u32 s52,s96,0
 buffer_load_dwordx4 v9,s[24:27],s52 offen lds
 s_add_u32 m0,s54,102400
 s_add_u32 s52,s96,8192
 buffer_load_dwordx4 v9,s[24:27],s52 offen lds
 s_bfe_u32 s96,s47,0x5000f
 s_lshl_b32 s96,s96,16
 s_add_u32 s96,s96,s66
 s_add_u32 m0,s54,106496
 s_add_u32 s52,s96,0
 buffer_load_dwordx4 v9,s[24:27],s52 offen lds
 s_add_u32 m0,s54,110592
 s_add_u32 s52,s96,8192
 buffer_load_dwordx4 v9,s[24:27],s52 offen lds
 s_add_u32 s84,s72,0
 buffer_load_dwordx4 v[24:27],v3,s[32:35],s84 offen sc1
 s_getpc_b64 s[82:83]
Lpc_88:
 s_lshr_b32 s52,s2,3
 s_lshl_b32 s52,s52,2
 s_add_u32 s52,s52,s4
 s_lshl_b32 s52,s52,10
 s_min_u32 s52,s52,L_slow-Lpc_88-1024
 v_add_u32 v252,s52,v1
 global_load_dwordx4 v[248:251],v252,s[82:83]
 s_waitcnt vmcnt(23)
 v_xor_b32 v136,0x80000000,v136
 s_waitcnt vmcnt(22)
 v_xor_b32 v140,0x80000000,v140
 v_or_b32 v38,v136,v140
 v_cmp_gt_i32 vcc,0,v38
 s_cbranch_vccnz Lfix_89
Lret_90:
 v_mfma_f32_32x32x16_bf16 v[88:103],a[0:3],v[136:139],0
 s_bfe_u32 s84,s44,0x50019
 s_lshl_b32 s84,s84,12
 buffer_load_dwordx4 v[176:179],v32,s[32:35],s84 offen sc1
 v_mfma_f32_32x32x16_bf16 v[120:135],a[4:7],v[136:139],0
 v_mfma_f32_32x32x16_bf16 v[104:119],a[0:3],v[140:143],0
 s_bfe_u32 s84,s44,0x50019
 s_lshl_b32 s84,s84,12
 buffer_load_dwordx4 v[180:183],v33,s[32:35],s84 offen sc1
 s_waitcnt vmcnt(23)
 v_xor_b32 v144,0x80000000,v144
 s_waitcnt vmcnt(22)
 v_xor_b32 v148,0x80000000,v148
 v_or_b32 v38,v144,v148
 v_cmp_gt_i32 vcc,0,v38
 v_mfma_f32_32x32x16_bf16 v[232:247],a[4:7],v[140:143],0
 s_cbranch_vccnz Lfix_92
Lret_93:
 v_mfma_f32_32x32x16_bf16 v[88:103],a[8:11],v[144:147],v[88:103]
 s_bfe_u32 s84,s45,0x50000
 s_lshl_b32 s84,s84,12
 buffer_load_dwordx4 v[184:187],v32,s[32:35],s84 offen sc1
 v_mfma_f32_32x32x16_bf16 v[120:135],a[12:15],v[144:147],v[120:135]
 v_mfma_f32_32x32x16_bf16 v[104:119],a[8:11],v[148:151],v[104:119]
 s_bfe_u32 s84,s45,0x50000
 s_lshl_b32 s84,s84,12
 buffer_load_dwordx4 v[188:191],v33,s[32:35],s84 offen sc1
 s_waitcnt vmcnt(23)
 v_xor_b32 v152,0x80000000,v152
 s_waitcnt vmcnt(22)
 v_xor_b32 v156,0x80000000,v156
 v_or_b32 v38,v152,v156
 v_cmp_gt_i32 vcc,0,v38
 v_mfma_f32_32x32x16_bf16 v[232:247],a[12:15],v[148:151],v[232:247]
 s_cbranch_vccnz Lfix_95
Lret_96:
 v_mfma_f32_32x32x16_bf16 v[88:103],a[16:19],v[152:155],v[88:103]
 s_bfe_u32 s84,s45,0x50005
 s_lshl_b32 s84,s84,12
 buffer_load_dwordx4 v[192:195],v32,s[32:35],s84 offen sc1
 s_waitcnt vmcnt(7)
 v_mfma_f32_32x32x16_bf16 v[120:135],a[20:23],v[152:155],v[120:135]
 v_mfma_f32_32x32x16_bf16 v[104:119],a[16:19],v[156:159],v[104:119]
 s_bfe_u32 s84,s45,0x50005
 s_lshl_b32 s84,s84,12
 buffer_load_dwordx4 v[196:199],v33,s[32:35],s84 offen sc1
 v_xor_b32 v160,0x80000000,v160
 v_xor_b32 v164,0x80000000,v164
 v_or_b32 v38,v160,v164
 v_cmp_gt_i32 vcc,0,v38
 v_add_u32 v12,0x20000,v10
 v_add_u32 v14,0x20000,v11
 ds_read_b64_tr_b16 a[128:129],v12 offset:0
 ds_read_b64_tr_b16 a[132:133],v14 offset:0
 v_mfma_f32_32x32x16_bf16 v[232:247],a[20:23],v[156:159],v[232:247]
 s_cbranch_vccnz Lfix_98
Lret_99:
 v_mfma_f32_32x32x16_bf16 v[88:103],a[24:27],v[160:163],v[88:103]
 s_bfe_u32 s84,s45,0x5000a
 s_lshl_b32 s84,s84,12
 buffer_load_dwordx4 v[200:203],v32,s[32:35],s84 offen sc1
 ds_read_b64_tr_b16 a[130:131],v12 offset:4096
 ds_read_b64_tr_b16 a[134:135],v14 offset:4096
 v_mfma_f32_32x32x16_bf16 v[120:135],a[28:31],v[160:163],v[120:135]
 v_mfma_f32_32x32x16_bf16 v[104:119],a[24:27],v[164:167],v[104:119]
 s_bfe_u32 s84,s45,0x5000a
 s_lshl_b32 s84,s84,12
 buffer_load_dwordx4 v[204:207],v33,s[32:35],s84 offen sc1
 v_xor_b32 v168,0x80000000,v168
 v_xor_b32 v172,0x80000000,v172
 v_or_b32 v38,v168,v172
 v_cmp_gt_i32 vcc,0,v38
 ds_read_b64_tr_b16 a[136:137],v12 offset:8192
 ds_read_b64_tr_b16 a[140:141],v14 offset:8192
 v_mfma_f32_32x32x16_bf16 v[232:247],a[28:31],v[164:167],v[232:247]
 s_cbranch_vccnz Lfix_101
Lret_102:
 v_mfma_f32_32x32x16_bf16 v[88:103],a[32:35],v[168:171],v[88:103]
 s_bfe_u32 s84,s45,0x5000f
 s_lshl_b32 s84,s84,12
 buffer_load_dwordx4 v[208:211],v32,s[32:35],s84 offen sc1
 ds_read_b64_tr_b16 a[138:139],v12 offset:12288
 ds_read_b64_tr_b16 a[142:143],v14 offset:12288
 v_mfma_f32_32x32x16_bf16 v[120:135],a[36:39],v[168:171],v[120:135]
 v_mfma_f32_32x32x16_bf16 v[104:119],a[32:35],v[172:175],v[104:119]
 s_bfe_u32 s84,s45,0x5000f
 s_lshl_b32 s84,s84,12
 buffer_load_dwordx4 v[212:215],v33,s[32:35],s84 offen sc1
 s_waitcnt vmcnt(9)
 v_xor_b32 v176,0x80000000,v176
 s_waitcnt vmcnt(8)
 v_xor_b32 v180,0x80000000,v180
 v_or_b32 v38,v176,v180
 v_cmp_gt_i32 vcc,0,v38
 ds_read_b64_tr_b16 a[144:145],v12 offset:16384
 ds_read_b64_tr_b16 a[148:149],v14 offset:16384
 v_mfma_f32_32x32x16_bf16 v[232:247],a[36:39],v[172:175],v[232:247]
 s_cbranch_vccnz Lfix_104
Lret_105:
 v_mfma_f32_32x32x16_bf16 v[88:103],a[40:43],v[176:179],v[88:103]
 s_bfe_u32 s84,s45,0x50014
 s_lshl_b32 s84,s84,12
 buffer_load_dwordx4 v[216:219],v32,s[32:35],s84 offen sc1
 ds_read_b64_tr_b16 a[146:147],v12 offset:20480
 ds_read_b64_tr_b16 a[150:151],v14 offset:20480
 v_mfma_f32_32x32x16_bf16 v[120:135],a[44:47],v[176:179],v[120:135]
 v_mfma_f32_32x32x16_bf16 v[104:119],a[40:43],v[180:183],v[104:119]
 s_bfe_u32 s84,s45,0x50014
 s_lshl_b32 s84,s84,12
 buffer_load_dwordx4 v[220:223],v33,s[32:35],s84 offen sc1
 s_waitcnt vmcnt(9)
 v_xor_b32 v184,0x80000000,v184
 s_waitcnt vmcnt(8)
 v_xor_b32 v188,0x80000000,v188
 v_or_b32 v38,v184,v188
 v_cmp_gt_i32 vcc,0,v38
 ds_read_b64_tr_b16 a[152:153],v12 offset:24576
 ds_read_b64_tr_b16 a[156:157],v14 offset:24576
 v_mfma_f32_32x32x16_bf16 v[232:247],a[44:47],v[180:183],v[232:247]
 s_cbranch_vccnz Lfix_107
Lret_108:
 v_mfma_f32_32x32x16_bf16 v[88:103],a[48:51],v[184:187],v[88:103]
 s_bfe_u32 s84,s45,0x50019
 s_lshl_b32 s84,s84,12
 buffer_load_dwordx4 v[224:227],v32,s[32:35],s84 offen sc1
 ds_read_b64_tr_b16 a[154:155],v12 offset:28672
 ds_read_b64_tr_b16 a[158:159],v14 offset:28672
 v_mfma_f32_32x32x16_bf16 v[120:135],a[52:55],v[184:187],v[120:135]
 v_mfma_f32_32x32x16_bf16 v[104:119],a[48:51],v[188:191],v[104:119]
 s_bfe_u32 s84,s45,0x50019
 s_lshl_b32 s84,s84,12
 buffer_load_dwordx4 v[228:231],v33,s[32:35],s84 offen sc1
 s_waitcnt vmcnt(9)
 v_xor_b32 v192,0x80000000,v192
 s_waitcnt vmcnt(8)
 v_xor_b32 v196,0x80000000,v196
 v_or_b32 v38,v192,v196
 v_cmp_gt_i32 vcc,0,v38
 v_add_u32 v12,0x10000,v10
 v_add_u32 v14,0x10000,v11
 ds_read_b64_tr_b16 a[160:161],v12 offset:32768
 ds_read_b64_tr_b16 a[164:165],v14 offset:32768
 v_mfma_f32_32x32x16_bf16 v[232:247],a[52:55],v[188:191],v[232:247]
 s_cbranch_vccnz Lfix_110
Lret_111:
 v_mfma_f32_32x32x16_bf16 v[88:103],a[56:59],v[192:195],v[88:103]
 s_bfe_u32 s84,s46,0x50000
 s_lshl_b32 s84,s84,12
 buffer_load_dwordx4 v[136:139],v32,s[32:35],s84 offen sc1
 ds_read_b64_tr_b16 a[162:163],v12 offset:36864
 ds_read_b64_tr_b16 a[166:167],v14 offset:36864
 v_mfma_f32_32x32x16_bf16 v[120:135],a[60:63],v[192:195],v[120:135]
 v_mfma_f32_32x32x16_bf16 v[104:119],a[56:59],v[196:199],v[104:119]
 s_bfe_u32 s84,s46,0x50000
 s_lshl_b32 s84,s84,12
 buffer_load_dwordx4 v[140:143],v33,s[32:35],s84 offen sc1
 s_waitcnt vmcnt(9)
 v_xor_b32 v200,0x80000000,v200
 s_waitcnt vmcnt(8)
 v_xor_b32 v204,0x80000000,v204
 v_or_b32 v38,v200,v204
 v_cmp_gt_i32 vcc,0,v38
 ds_read_b64_tr_b16 a[168:169],v12 offset:40960
 ds_read_b64_tr_b16 a[172:173],v14 offset:40960
 v_mfma_f32_32x32x16_bf16 v[232:247],a[60:63],v[196:199],v[232:247]
 s_cbranch_vccnz Lfix_113
Lret_114:
 v_mfma_f32_32x32x16_bf16 v[88:103],a[64:67],v[200:203],v[88:103]
 s_bfe_u32 s84,s46,0x50005
 s_lshl_b32 s84,s84,12
 buffer_load_dwordx4 v[144:147],v32,s[32:35],s84 offen sc1
 ds_read_b64_tr_b16 a[170:171],v12 offset:45056
 ds_read_b64_tr_b16 a[174:175],v14 offset:45056
 v_mfma_f32_32x32x16_bf16 v[120:135],a[68:71],v[200:203],v[120:135]
 v_and_b32 v30,v24,v25
 v_bitop3_b32 v30,v26,v27,v30 bitop3:0x80
 v_and_b32 v30,1,v30
 v_cmp_eq_u32 s[82:83],0,v30
 s_nop 0
 s_cmp_lg_u64 s[82:83],0
 s_cbranch_scc1 Lfix_116
Lret_117:
 v_mfma_f32_32x32x16_bf16 v[104:119],a[64:67],v[204:207],v[104:119]
 s_bfe_u32 s84,s46,0x50005
 s_lshl_b32 s84,s84,12
 buffer_load_dwordx4 v[148:151],v33,s[32:35],s84 offen sc1
 s_waitcnt vmcnt(9)
 v_xor_b32 v208,0x80000000,v208
 s_waitcnt vmcnt(8)
 v_xor_b32 v212,0x80000000,v212
 v_or_b32 v38,v208,v212
 v_cmp_gt_i32 vcc,0,v38
 v_add_f32 v24,v24,v25
 v_mfma_f32_32x32x16_bf16 v[232:247],a[68:71],v[204:207],v[232:247]
 v_add_f32 v26,v26,v27
 v_add_f32 v24,v24,v26
 v_mov_b32 v25,v24
 s_nop 1
 v_permlane16_swap_b32 v24,v25
 v_add_f32 v24,v24,v25
 v_mov_b32 v25,v24
 s_cbranch_vccnz Lfix_119
Lret_120:
 v_mfma_f32_32x32x16_bf16 v[88:103],a[72:75],v[208:211],v[88:103]
 s_bfe_u32 s84,s46,0x5000a
 s_lshl_b32 s84,s84,12
 buffer_load_dwordx4 v[152:155],v32,s[32:35],s84 offen sc1
 v_permlane32_swap_b32 v24,v25
 v_mfma_f32_32x32x16_bf16 v[120:135],a[76:79],v[208:211],v[120:135]
 v_mul_f32 v24,s74,v24
 v_mul_f32 v25,s74,v25
 v_fma_f32 v25,-v24,v24,v25
 v_max_f32 v25,0,v25
 v_add_f32 v25,s75,v25
 v_rsq_f32 v28,v25
 v_mfma_f32_32x32x16_bf16 v[104:119],a[72:75],v[212:215],v[104:119]
 s_bfe_u32 s84,s46,0x5000a
 s_lshl_b32 s84,s84,12
 buffer_load_dwordx4 v[156:159],v33,s[32:35],s84 offen sc1
 s_waitcnt vmcnt(9)
 v_xor_b32 v216,0x80000000,v216
 s_waitcnt vmcnt(8)
 v_xor_b32 v220,0x80000000,v220
 v_or_b32 v38,v216,v220
 v_cmp_gt_i32 vcc,0,v38
 v_mfma_f32_32x32x16_bf16 v[232:247],a[76:79],v[212:215],v[232:247]
 s_waitcnt lgkmcnt(0)
 s_barrier
 s_cbranch_vccnz Lfix_122
Lret_123:
 v_mfma_f32_32x32x16_bf16 v[88:103],a[80:83],v[216:219],v[88:103]
 s_bfe_u32 s84,s46,0x5000f
 s_lshl_b32 s84,s84,12
 buffer_load_dwordx4 v[160:163],v32,s[32:35],s84 offen sc1
 v_mfma_f32_32x32x16_bf16 v[120:135],a[84:87],v[216:219],v[120:135]
 v_mfma_f32_32x32x16_bf16 v[104:119],a[80:83],v[220:223],v[104:119]
 s_bfe_u32 s84,s46,0x5000f
 s_lshl_b32 s84,s84,12
 buffer_load_dwordx4 v[164:167],v33,s[32:35],s84 offen sc1
 s_waitcnt vmcnt(9)
 v_xor_b32 v224,0x80000000,v224
 s_waitcnt vmcnt(8)
 v_xor_b32 v228,0x80000000,v228
 v_or_b32 v38,v224,v228
 v_cmp_gt_i32 vcc,0,v38
 v_mfma_f32_32x32x16_bf16 v[232:247],a[84:87],v[220:223],v[232:247]
 s_cbranch_vccnz Lfix_125
Lret_126:
 v_mfma_f32_32x32x16_bf16 v[88:103],a[88:91],v[224:227],v[88:103]
 s_bfe_u32 s84,s46,0x50014
 s_lshl_b32 s84,s84,12
 buffer_load_dwordx4 v[168:171],v32,s[32:35],s84 offen sc1
 v_mfma_f32_32x32x16_bf16 v[120:135],a[92:95],v[224:227],v[120:135]
 v_mfma_f32_32x32x16_bf16 v[104:119],a[88:91],v[228:231],v[104:119]
 s_bfe_u32 s84,s46,0x50014
 s_lshl_b32 s84,s84,12
 buffer_load_dwordx4 v[172:175],v33,s[32:35],s84 offen sc1
 s_waitcnt vmcnt(9)
 v_xor_b32 v136,0x80000000,v136
 s_waitcnt vmcnt(8)
 v_xor_b32 v140,0x80000000,v140
 v_or_b32 v38,v136,v140
 v_cmp_gt_i32 vcc,0,v38
 v_mfma_f32_32x32x16_bf16 v[232:247],a[92:95],v[228:231],v[232:247]
 s_cbranch_vccnz Lfix_128
Lret_129:
 v_mfma_f32_32x32x16_bf16 v[88:103],a[96:99],v[136:139],v[88:103]
 s_bfe_u32 s84,s46,0x50019
 s_lshl_b32 s84,s84,12
 buffer_load_dwordx4 v[176:179],v32,s[32:35],s84 offen sc1
 v_mfma_f32_32x32x16_bf16 v[120:135],a[100:103],v[136:139],v[120:135]
 v_mfma_f32_32x32x16_bf16 v[104:119],a[96:99],v[140:143],v[104:119]
 s_bfe_u32 s84,s46,0x50019
 s_lshl_b32 s84,s84,12
 buffer_load_dwordx4 v[180:183],v33,s[32:35],s84 offen sc1
 s_waitcnt vmcnt(9)
 v_xor_b32 v144,0x80000000,v144
 s_waitcnt vmcnt(8)
 v_xor_b32 v148,0x80000000,v148
 v_or_b32 v38,v144,v148
 v_cmp_gt_i32 vcc,0,v38
 v_mfma_f32_32x32x16_bf16 v[232:247],a[100:103],v[140:143],v[232:247]
 s_cbranch_vccnz Lfix_131
Lret_132:
 v_mfma_f32_32x32x16_bf16 v[88:103],a[104:107],v[144:147],v[88:103]
 s_bfe_u32 s84,s47,0x50000
 s_lshl_b32 s84,s84,12
 buffer_load_dwordx4 v[184:187],v32,s[32:35],s84 offen sc1
 v_mfma_f32_32x32x16_bf16 v[120:135],a[108:111],v[144:147],v[120:135]
 v_mfma_f32_32x32x16_bf16 v[104:119],a[104:107],v[148:151],v[104:119]
 s_bfe_u32 s84,s47,0x50000
 s_lshl_b32 s84,s84,12
 buffer_load_dwordx4 v[188:191],v33,s[32:35],s84 offen sc1
 s_waitcnt vmcnt(9)
 v_xor_b32 v152,0x80000000,v152
 s_waitcnt vmcnt(8)
 v_xor_b32 v156,0x80000000,v156
 v_or_b32 v38,v152,v156
 v_cmp_gt_i32 vcc,0,v38
 v_mfma_f32_32x32x16_bf16 v[232:247],a[108:111],v[148:151],v[232:247]
 s_cbranch_vccnz Lfix_134
Lret_135:
 v_mfma_f32_32x32x16_bf16 v[88:103],a[112:115],v[152:155],v[88:103]
 s_bfe_u32 s84,s47,0x50005
 s_lshl_b32 s84,s84,12
 buffer_load_dwordx4 v[192:195],v32,s[32:35],s84 offen sc1
 v_mfma_f32_32x32x16_bf16 v[104:119],a[112:115],v[156:159],v[104:119]
 s_bfe_u32 s84,s47,0x50005
 s_lshl_b32 s84,s84,12
 buffer_load_dwordx4 v[196:199],v33,s[32:35],s84 offen sc1
 s_waitcnt vmcnt(9)
 v_xor_b32 v160,0x80000000,v160
 s_waitcnt vmcnt(8)
 v_xor_b32 v164,0x80000000,v164
 v_or_b32 v38,v160,v164
 v_cmp_gt_i32 vcc,0,v38
 s_cbranch_vccnz Lfix_137
Lret_138:
 v_mfma_f32_32x32x16_bf16 v[88:103],a[120:123],v[160:163],v[88:103]
 s_bfe_u32 s84,s47,0x5000a
 s_lshl_b32 s84,s84,12
 buffer_load_dwordx4 v[200:203],v32,s[32:35],s84 offen sc1
 v_mfma_f32_32x32x16_bf16 v[104:119],a[120:123],v[164:167],v[104:119]
 s_bfe_u32 s84,s47,0x5000a
 s_lshl_b32 s84,s84,12
 buffer_load_dwordx4 v[204:207],v33,s[32:35],s84 offen sc1
 s_waitcnt vmcnt(9)
 v_xor_b32 v168,0x80000000,v168
 s_waitcnt vmcnt(8)
 v_xor_b32 v172,0x80000000,v172
 v_or_b32 v38,v168,v172
 v_cmp_gt_i32 vcc,0,v38
 s_cbranch_vccnz Lfix_140
Lret_141:
 v_mfma_f32_32x32x16_bf16 v[88:103],a[128:131],v[168:171],v[88:103]
 buffer_load_dwordx4 v[208:211],v32,s[32:35],s70 offen sc1
 v_mfma_f32_32x32x16_bf16 v[104:119],a[128:131],v[172:175],v[104:119]
 buffer_load_dwordx4 v[212:215],v33,s[32:35],s70 offen sc1
 s_waitcnt vmcnt(9)
 v_xor_b32 v176,0x80000000,v176
 s_waitcnt vmcnt(8)
 v_xor_b32 v180,0x80000000,v180
 v_or_b32 v38,v176,v180
 v_cmp_gt_i32 vcc,0,v38
 s_cbranch_vccnz Lfix_143
Lret_144:
 v_mfma_f32_32x32x16_bf16 v[88:103],a[136:139],v[176:179],v[88:103]
 v_mfma_f32_32x32x16_bf16 v[104:119],a[136:139],v[180:183],v[104:119]
 s_waitcnt vmcnt(7)
 v_xor_b32 v184,0x80000000,v184
 s_waitcnt vmcnt(6)
 v_xor_b32 v188,0x80000000,v188
 v_or_b32 v38,v184,v188
 v_cmp_gt_i32 vcc,0,v38
 s_cbranch_vccnz Lfix_146
Lret_147:
 v_mfma_f32_32x32x16_bf16 v[88:103],a[144:147],v[184:187],v[88:103]
 v_mfma_f32_32x32x16_bf16 v[104:119],a[144:147],v[188:191],v[104:119]
 s_waitcnt vmcnt(5)
 v_xor_b32 v192,0x80000000,v192
 s_waitcnt vmcnt(4)
 v_xor_b32 v196,0x80000000,v196
 v_or_b32 v38,v192,v196
 v_cmp_gt_i32 vcc,0,v38
 s_cbranch_vccnz Lfix_149
Lret_150:
 v_mfma_f32_32x32x16_bf16 v[88:103],a[152:155],v[192:195],v[88:103]
 v_mfma_f32_32x32x16_bf16 v[104:119],a[152:155],v[196:199],v[104:119]
 s_waitcnt vmcnt(3)
 v_xor_b32 v200,0x80000000,v200
 s_waitcnt vmcnt(2)
 v_xor_b32 v204,0x80000000,v204
 v_or_b32 v38,v200,v204
 v_cmp_gt_i32 vcc,0,v38
 s_cbranch_vccnz Lfix_152
Lret_153:
 v_mfma_f32_32x32x16_bf16 v[88:103],a[160:163],v[200:203],v[88:103]
 v_mfma_f32_32x32x16_bf16 v[104:119],a[160:163],v[204:207],v[104:119]
 s_waitcnt vmcnt(1)
 v_xor_b32 v208,0x80000000,v208
 s_waitcnt vmcnt(0)
 v_xor_b32 v212,0x80000000,v212
 v_or_b32 v38,v208,v212
 v_cmp_gt_i32 vcc,0,v38
 s_cbranch_vccnz Lfix_155
Lret_156:
 v_mfma_f32_32x32x16_bf16 v[88:103],a[168:171],v[208:211],v[88:103]
 v_mfma_f32_32x32x16_bf16 v[104:119],a[168:171],v[212:215],v[104:119]
 v_mfma_f32_32x32x16_bf16 v[120:135],a[116:119],v[152:155],v[120:135]
 s_nop 9
 ds_write_b128 v18,v[88:91] offset:0
 v_accvgpr_read_b32 v41,a240
 v_accvgpr_read_b32 v43,a241
 v_accvgpr_read_b32 v45,a242
 v_mfma_f32_32x32x16_bf16 v[232:247],a[116:119],v[156:159],v[232:247]
 v_accvgpr_read_b32 v47,a243
 v_lshlrev_b32 v40,16,v41
 v_and_b32 v41,0xffff0000,v41
 v_mfma_f32_32x32x16_bf16 v[120:135],a[124:127],v[160:163],v[120:135]
 ds_write_b128 v18,v[92:95] offset:1024
 v_lshlrev_b32 v42,16,v43
 v_and_b32 v43,0xffff0000,v43
 v_lshlrev_b32 v44,16,v45
 v_mfma_f32_32x32x16_bf16 v[232:247],a[124:127],v[164:167],v[232:247]
 ds_write_b128 v18,v[96:99] offset:2048
 v_and_b32 v45,0xffff0000,v45
 v_lshlrev_b32 v46,16,v47
 v_and_b32 v47,0xffff0000,v47
 v_mfma_f32_32x32x16_bf16 v[120:135],a[132:135],v[168:171],v[120:135]
 v_accvgpr_read_b32 v49,a244
 v_accvgpr_read_b32 v51,a245
 v_accvgpr_read_b32 v53,a246
 s_add_u32 s96,s95,4
 s_and_b32 s96,s96,7
 s_mul_i32 s96,s96,176128
 s_add_u32 s96,s96,s62
 s_add_u32 m0,s54,98304
 s_add_u32 s52,s96,0
 buffer_load_dwordx4 v8,s[20:23],s52 offen lds
 s_add_u32 s96,s96,s60
 s_add_u32 m0,s54,114688
 s_add_u32 s52,s96,0
 buffer_load_dwordx4 v8,s[20:23],s52 offen lds
 v_mfma_f32_32x32x16_bf16 v[232:247],a[132:135],v[172:175],v[232:247]
 ds_write_b128 v18,v[100:103] offset:3072
 v_accvgpr_read_b32 v55,a247
 v_lshlrev_b32 v48,16,v49
 v_and_b32 v49,0xffff0000,v49
 v_mfma_f32_32x32x16_bf16 v[120:135],a[140:143],v[176:179],v[120:135]
 ds_write_b128 v18,v[104:107] offset:4096
 v_lshlrev_b32 v50,16,v51
 v_and_b32 v51,0xffff0000,v51
 v_lshlrev_b32 v52,16,v53
 v_mfma_f32_32x32x16_bf16 v[232:247],a[140:143],v[180:183],v[232:247]
 v_and_b32 v53,0xffff0000,v53
 v_lshlrev_b32 v54,16,v55
 v_and_b32 v55,0xffff0000,v55
 v_mfma_f32_32x32x16_bf16 v[120:135],a[148:151],v[184:187],v[120:135]
 ds_write_b128 v18,v[108:111] offset:5120
 v_mfma_f32_32x32x16_bf16 v[232:247],a[148:151],v[188:191],v[232:247]
 s_add_u32 s96,s95,5
 s_and_b32 s96,s96,7
 s_mul_i32 s96,s96,176128
 s_add_u32 s96,s96,s62
 s_add_u32 m0,s54,102400
 s_add_u32 s52,s96,0
 buffer_load_dwordx4 v8,s[20:23],s52 offen lds
 s_add_u32 s96,s96,s60
 s_add_u32 m0,s54,118784
 s_add_u32 s52,s96,0
 buffer_load_dwordx4 v8,s[20:23],s52 offen lds
 v_mfma_f32_32x32x16_bf16 v[120:135],a[156:159],v[192:195],v[120:135]
 ds_write_b128 v18,v[112:115] offset:6144
 v_mfma_f32_32x32x16_bf16 v[232:247],a[156:159],v[196:199],v[232:247]
 ds_write_b128 v18,v[116:119] offset:7168
 v_mfma_f32_32x32x16_bf16 v[120:135],a[164:167],v[200:203],v[120:135]
 s_waitcnt lgkmcnt(0)
 s_barrier
 ds_read_b128 v[56:59],v15 offset:0
 ds_read_b128 v[60:63],v15 offset:1024
 v_mfma_f32_32x32x16_bf16 v[232:247],a[164:167],v[204:207],v[232:247]
 ds_read_b128 v[64:67],v15 offset:8192
 ds_read_b128 v[68:71],v15 offset:9216
 ds_read_b128 v[72:75],v15 offset:16384
 v_mfma_f32_32x32x16_bf16 v[120:135],a[172:175],v[208:211],v[120:135]
 ds_read_b128 v[76:79],v15 offset:17408
 ds_read_b128 v[80:83],v15 offset:24576
 ds_read_b128 v[84:87],v15 offset:25600
 v_mfma_f32_32x32x16_bf16 v[232:247],a[172:175],v[212:215],v[232:247]
 s_waitcnt lgkmcnt(5)
 v_pk_add_f32 v[56:57],v[56:57],v[64:65]
 v_pk_add_f32 v[58:59],v[58:59],v[66:67]
 s_waitcnt lgkmcnt(4)
 v_pk_add_f32 v[60:61],v[60:61],v[68:69]
 v_pk_add_f32 v[62:63],v[62:63],v[70:71]
 s_waitcnt lgkmcnt(1)
 v_pk_add_f32 v[72:73],v[72:73],v[80:81]
 v_pk_add_f32 v[74:75],v[74:75],v[82:83]
 s_waitcnt lgkmcnt(0)
 v_pk_add_f32 v[76:77],v[76:77],v[84:85]
 v_pk_add_f32 v[78:79],v[78:79],v[86:87]
 s_barrier
 ds_write_b128 v18,v[120:123] offset:0
 v_pk_add_f32 v[56:57],v[56:57],v[72:73]
 v_pk_add_f32 v[58:59],v[58:59],v[74:75]
 v_pk_add_f32 v[60:61],v[60:61],v[76:77]
 v_pk_add_f32 v[62:63],v[62:63],v[78:79]
 s_add_u32 s96,s95,6
 s_and_b32 s96,s96,7
 s_mul_i32 s96,s96,176128
 s_add_u32 s96,s96,s62
 s_add_u32 m0,s54,106496
 s_add_u32 s52,s96,0
 buffer_load_dwordx4 v8,s[20:23],s52 offen lds
 s_add_u32 s96,s96,s60
 s_add_u32 m0,s54,122880
 s_add_u32 s52,s96,0
 buffer_load_dwordx4 v8,s[20:23],s52 offen lds
 ds_write_b128 v18,v[124:127] offset:1024
 v_pk_fma_f32 v[56:57],v[56:57],v[28:29],v[40:41] op_sel_hi:[1,0,1]
 v_pk_fma_f32 v[58:59],v[58:59],v[28:29],v[42:43] op_sel_hi:[1,0,1]
 v_pk_fma_f32 v[60:61],v[60:61],v[28:29],v[44:45] op_sel_hi:[1,0,1]
 v_pk_fma_f32 v[62:63],v[62:63],v[28:29],v[46:47] op_sel_hi:[1,0,1]
 ds_write_b128 v18,v[128:131] offset:2048
 v_cvt_pk_bf16_f32 v64,v56,v57
 v_cvt_pk_bf16_f32 v65,v58,v59
 v_cvt_pk_bf16_f32 v66,v60,v61
 v_cvt_pk_bf16_f32 v67,v62,v63
 ds_write_b128 v18,v[132:135] offset:3072
 v_accvgpr_write_b32 a240,v64
 v_and_b32 v64,-2,v64
 s_and_b32 s52,s6,1
 s_xor_b32 s52,s52,0
 s_lshl_b32 s52,s52,11
 s_add_u32 s52,s52,s67
 buffer_store_dwordx4 v[64:67],v3,s[32:35],s52 offen
 v_pk_add_f32 v[24:25],v[56:57],v[58:59]
 s_add_u32 s96,s95,7
 s_and_b32 s96,s96,7
 s_mul_i32 s96,s96,176128
 s_add_u32 s96,s96,s62
 s_add_u32 m0,s54,110592
 s_add_u32 s52,s96,0
 buffer_load_dwordx4 v8,s[20:23],s52 offen lds
 s_add_u32 s96,s96,s60
 s_add_u32 m0,s54,126976
 s_add_u32 s52,s96,0
 buffer_load_dwordx4 v8,s[20:23],s52 offen lds
 ds_write_b128 v18,v[232:235] offset:4096
 v_pk_mul_f32 v[26:27],v[56:57],v[56:57]
 v_pk_fma_f32 v[26:27],v[58:59],v[58:59],v[26:27]
 v_pk_add_f32 v[24:25],v[24:25],v[60:61]
 v_pk_fma_f32 v[26:27],v[60:61],v[60:61],v[26:27]
 ds_write_b128 v18,v[236:239] offset:5120
 v_pk_add_f32 v[24:25],v[24:25],v[62:63]
 v_pk_fma_f32 v[26:27],v[62:63],v[62:63],v[26:27]
 v_accvgpr_write_b32 a241,v65
 v_accvgpr_write_b32 a242,v66
 ds_write_b128 v18,v[240:243] offset:6144
 v_accvgpr_write_b32 a243,v67
 ds_write_b128 v18,v[244:247] offset:7168
 s_waitcnt lgkmcnt(0)
 s_barrier
 ds_read_b128 v[56:59],v15 offset:0
 ds_read_b128 v[60:63],v15 offset:1024
 ds_read_b128 v[64:67],v15 offset:8192
 ds_read_b128 v[68:71],v15 offset:9216
 ds_read_b128 v[72:75],v15 offset:16384
 ds_read_b128 v[76:79],v15 offset:17408
 ds_read_b128 v[80:83],v15 offset:24576
 ds_read_b128 v[84:87],v15 offset:25600
 s_add_u32 s52,s56,0
 v_add_u32 v2,s52,v1
 s_waitcnt lgkmcnt(5)
 v_pk_add_f32 v[56:57],v[56:57],v[64:65]
 v_pk_add_f32 v[58:59],v[58:59],v[66:67]
 s_waitcnt lgkmcnt(4)
 v_pk_add_f32 v[60:61],v[60:61],v[68:69]
 v_pk_add_f32 v[62:63],v[62:63],v[70:71]
 s_waitcnt lgkmcnt(1)
 v_pk_add_f32 v[72:73],v[72:73],v[80:81]
 v_pk_add_f32 v[74:75],v[74:75],v[82:83]
 s_waitcnt lgkmcnt(0)
 v_pk_add_f32 v[76:77],v[76:77],v[84:85]
 v_pk_add_f32 v[78:79],v[78:79],v[86:87]
 v_pk_add_f32 v[56:57],v[56:57],v[72:73]
 v_pk_add_f32 v[58:59],v[58:59],v[74:75]
 v_pk_add_f32 v[60:61],v[60:61],v[76:77]
 v_pk_add_f32 v[62:63],v[62:63],v[78:79]
 v_pk_fma_f32 v[56:57],v[56:57],v[28:29],v[48:49] op_sel_hi:[1,0,1]
 v_pk_fma_f32 v[58:59],v[58:59],v[28:29],v[50:51] op_sel_hi:[1,0,1]
 v_pk_fma_f32 v[60:61],v[60:61],v[28:29],v[52:53] op_sel_hi:[1,0,1]
 v_pk_fma_f32 v[62:63],v[62:63],v[28:29],v[54:55] op_sel_hi:[1,0,1]
 v_cvt_pk_bf16_f32 v64,v56,v57
 v_cvt_pk_bf16_f32 v65,v58,v59
 v_cvt_pk_bf16_f32 v66,v60,v61
 v_cvt_pk_bf16_f32 v67,v62,v63
 v_accvgpr_write_b32 a244,v64
 v_and_b32 v64,-2,v64
 s_and_b32 s52,s6,1
 s_xor_b32 s52,s52,1
 s_lshl_b32 s52,s52,11
 s_add_u32 s52,s52,s67
 buffer_store_dwordx4 v[64:67],v3,s[32:35],s52 offen
 v_pk_add_f32 v[24:25],v[24:25],v[56:57]
 v_pk_fma_f32 v[26:27],v[56:57],v[56:57],v[26:27]
 v_pk_add_f32 v[24:25],v[24:25],v[58:59]
 buffer_load_dwordx4 v[136:139],v2,s[32:35],s36 offen sc1
 v_pk_fma_f32 v[26:27],v[58:59],v[58:59],v[26:27]
 v_pk_add_f32 v[24:25],v[24:25],v[60:61]
 v_pk_fma_f32 v[26:27],v[60:61],v[60:61],v[26:27]
 buffer_load_dwordx4 v[140:143],v2,s[32:35],s36 offen offset:1024 sc1
 v_pk_add_f32 v[24:25],v[24:25],v[62:63]
 v_pk_fma_f32 v[26:27],v[62:63],v[62:63],v[26:27]
 v_accvgpr_write_b32 a245,v65
 buffer_load_dwordx4 v[152:155],v2,s[32:35],s37 offen sc1
 v_accvgpr_write_b32 a246,v66
 v_accvgpr_write_b32 a247,v67
 v_add_f32 v24,v24,v25
 buffer_load_dwordx4 v[156:159],v2,s[32:35],s37 offen offset:1024 sc1
 v_add_f32 v26,v26,v27
 v_and_b32 v27,512,v3
 v_add_u32 v27,v27,v3
 buffer_load_dwordx4 v[168:171],v2,s[32:35],s38 offen sc1
 v_permlane16_swap_b32 v24,v26
 v_add_f32 v24,v24,v26
 v_mov_b32 v25,v24
 buffer_load_dwordx4 v[172:175],v2,s[32:35],s38 offen offset:1024 sc1
 s_nop 0
 v_permlane32_swap_b32 v24,v25
 v_add_f32 v24,v24,v25
 v_or_b32 v24,1,v24
 buffer_load_dwordx4 v[184:187],v2,s[32:35],s39 offen sc1
 s_mov_b32 exec_hi,0
 s_add_u32 s52,s79,131072
 buffer_store_dword v24,v27,s[32:35],s52 offen
 s_mov_b64 exec,-1
 buffer_load_dwordx4 v[188:191],v2,s[32:35],s39 offen offset:1024 sc1
 buffer_load_dwordx4 v[200:203],v2,s[32:35],s40 offen sc1
 buffer_load_dwordx4 v[204:207],v2,s[32:35],s40 offen offset:1024 sc1
 buffer_load_dwordx4 v[216:219],v2,s[32:35],s41 offen sc1
 ds_read_b64_tr_b16 v[40:41],v4 offset:0
 ds_read_b64_tr_b16 v[42:43],v4 offset:512
 ds_read_b64_tr_b16 v[44:45],v4 offset:32768
 ds_read_b64_tr_b16 v[46:47],v4 offset:33280
 ds_read_b64_tr_b16 v[48:49],v4 offset:1024
 ds_read_b64_tr_b16 v[50:51],v4 offset:1536
 ds_read_b64_tr_b16 v[52:53],v4 offset:33792
 ds_read_b64_tr_b16 v[54:55],v4 offset:34304
 s_waitcnt vmcnt(10)
 v_bitop3_b32 v38,v136,v140,1 bitop3:0xa8
 v_cmp_ne_u32 vcc,0,v38
 s_cbranch_vccnz Lfix_158
Lret_159:
 s_waitcnt lgkmcnt(4)
 v_mfma_f32_32x32x16_bf16 v[88:103],v[136:139],v[40:43],0
 ds_read_b64_tr_b16 v[40:41],v4 offset:4096
 ds_read_b64_tr_b16 v[42:43],v4 offset:4608
 buffer_load_dwordx4 v[220:223],v2,s[32:35],s41 offen offset:1024 sc1
 v_mov_b32 v26,0
 v_mfma_f32_32x32x16_bf16 v[104:119],v[136:139],v[44:47],0
 ds_read_b64_tr_b16 v[44:45],v4 offset:36864
 ds_read_b64_tr_b16 v[46:47],v4 offset:37376
 v_mov_b32 v27,0
 s_waitcnt vmcnt(9) lgkmcnt(4)
 v_mfma_f32_32x32x16_bf16 v[88:103],v[140:143],v[48:51],v[88:103]
 ds_read_b64_tr_b16 v[48:49],v4 offset:5120
 ds_read_b64_tr_b16 v[50:51],v4 offset:5632
 buffer_load_dwordx4 v[232:235],v2,s[32:35],s42 offen sc1
 v_bitop3_b32 v38,v152,v156,1 bitop3:0xa8
 v_cmp_ne_u32 vcc,0,v38
 v_mfma_f32_32x32x16_bf16 v[104:119],v[140:143],v[52:55],v[104:119]
 ds_read_b64_tr_b16 v[52:53],v4 offset:37888
 ds_read_b64_tr_b16 v[54:55],v4 offset:38400
 v_mov_b32 v30,0
 s_cbranch_vccnz Lfix_161
Lret_162:
 s_waitcnt lgkmcnt(4)
 v_mfma_f32_32x32x16_bf16 v[88:103],v[152:155],v[40:43],v[88:103]
 ds_read_b64_tr_b16 v[40:41],v4 offset:8192
 ds_read_b64_tr_b16 v[42:43],v4 offset:8704
 buffer_load_dwordx4 v[236:239],v2,s[32:35],s42 offen offset:1024 sc1
 v_mov_b32 v31,0
 v_mfma_f32_32x32x16_bf16 v[104:119],v[152:155],v[44:47],v[104:119]
 ds_read_b64_tr_b16 v[44:45],v4 offset:40960
 ds_read_b64_tr_b16 v[46:47],v4 offset:41472
 v_mov_b32 v32,0x3f803f80
 s_waitcnt vmcnt(9) lgkmcnt(4)
 v_mfma_f32_32x32x16_bf16 v[88:103],v[156:159],v[48:51],v[88:103]
 ds_read_b64_tr_b16 v[48:49],v4 offset:9216
 ds_read_b64_tr_b16 v[50:51],v4 offset:9728
 buffer_load_dwordx4 v[248:251],v2,s[32:35],s43 offen sc1
 v_bitop3_b32 v38,v168,v172,1 bitop3:0xa8
 v_cmp_ne_u32 vcc,0,v38
 v_mfma_f32_32x32x16_bf16 v[104:119],v[156:159],v[52:55],v[104:119]
 ds_read_b64_tr_b16 v[52:53],v4 offset:41984
 ds_read_b64_tr_b16 v[54:55],v4 offset:42496
 v_mov_b32 v33,0x3f803f80
 s_cbranch_vccnz Lfix_164
Lret_165:
 s_waitcnt lgkmcnt(4)
 v_mfma_f32_32x32x16_bf16 v[88:103],v[168:171],v[40:43],v[88:103]
 ds_read_b64_tr_b16 v[40:41],v4 offset:12288
 ds_read_b64_tr_b16 v[42:43],v4 offset:12800
 buffer_load_dwordx4 v[252:255],v2,s[32:35],s43 offen offset:1024 sc1
 v_subrev_u32 v18,0x20000,v18
 v_mfma_f32_32x32x16_bf16 v[104:119],v[168:171],v[44:47],v[104:119]
 ds_read_b64_tr_b16 v[44:45],v4 offset:45056
 ds_read_b64_tr_b16 v[46:47],v4 offset:45568
 v_subrev_u32 v15,0x20000,v15
 s_waitcnt vmcnt(8) lgkmcnt(4)
 v_mfma_f32_32x32x16_bf16 v[88:103],v[172:175],v[48:51],v[88:103]
 ds_read_b64_tr_b16 v[48:49],v4 offset:13312
 ds_read_b64_tr_b16 v[50:51],v4 offset:13824
 buffer_load_dwordx4 v[144:147],v2,s[32:35],s8 offen sc1
 v_bitop3_b32 v38,v184,v188,1 bitop3:0xa8
 v_cmp_ne_u32 vcc,0,v38
 v_mfma_f32_32x32x16_bf16 v[104:119],v[172:175],v[52:55],v[104:119]
 ds_read_b64_tr_b16 v[52:53],v4 offset:46080
 ds_read_b64_tr_b16 v[54:55],v4 offset:46592
 s_cbranch_vccnz Lfix_167
Lret_168:
 s_waitcnt lgkmcnt(4)
 v_mfma_f32_32x32x16_bf16 v[88:103],v[184:187],v[40:43],v[88:103]
 ds_read_b64_tr_b16 v[40:41],v4 offset:16384
 ds_read_b64_tr_b16 v[42:43],v4 offset:16896
 buffer_load_dwordx4 v[148:151],v2,s[32:35],s8 offen offset:1024 sc1
 v_mfma_f32_32x32x16_bf16 v[104:119],v[184:187],v[44:47],v[104:119]
 ds_read_b64_tr_b16 v[44:45],v4 offset:49152
 ds_read_b64_tr_b16 v[46:47],v4 offset:49664
 s_waitcnt vmcnt(8) lgkmcnt(4)
 v_mfma_f32_32x32x16_bf16 v[88:103],v[188:191],v[48:51],v[88:103]
 ds_read_b64_tr_b16 v[48:49],v4 offset:17408
 ds_read_b64_tr_b16 v[50:51],v4 offset:17920
 buffer_load_dwordx4 v[160:163],v2,s[32:35],s9 offen sc1
 v_bitop3_b32 v38,v200,v204,1 bitop3:0xa8
 v_cmp_ne_u32 vcc,0,v38
 v_mfma_f32_32x32x16_bf16 v[104:119],v[188:191],v[52:55],v[104:119]
 ds_read_b64_tr_b16 v[52:53],v4 offset:50176
 ds_read_b64_tr_b16 v[54:55],v4 offset:50688
 s_cbranch_vccnz Lfix_170
Lret_171:
 s_waitcnt lgkmcnt(4)
 v_mfma_f32_32x32x16_bf16 v[88:103],v[200:203],v[40:43],v[88:103]
 ds_read_b64_tr_b16 v[40:41],v4 offset:20480
 ds_read_b64_tr_b16 v[42:43],v4 offset:20992
 buffer_load_dwordx4 v[164:167],v2,s[32:35],s9 offen offset:1024 sc1
 v_mfma_f32_32x32x16_bf16 v[104:119],v[200:203],v[44:47],v[104:119]
 ds_read_b64_tr_b16 v[44:45],v4 offset:53248
 ds_read_b64_tr_b16 v[46:47],v4 offset:53760
 s_waitcnt vmcnt(8) lgkmcnt(4)
 v_mfma_f32_32x32x16_bf16 v[88:103],v[204:207],v[48:51],v[88:103]
 ds_read_b64_tr_b16 v[48:49],v4 offset:21504
 ds_read_b64_tr_b16 v[50:51],v4 offset:22016
 s_add_u32 s84,s58,131072
 buffer_load_dwordx4 v[72:75],v13,s[32:35],s84 offen sc1
 buffer_load_dwordx4 v[76:79],v13,s[32:35],s84 offen offset:512 sc1
 buffer_load_dwordx4 v[176:179],v2,s[32:35],s10 offen sc1
 v_bitop3_b32 v38,v216,v220,1 bitop3:0xa8
 v_cmp_ne_u32 vcc,0,v38
 v_mfma_f32_32x32x16_bf16 v[104:119],v[204:207],v[52:55],v[104:119]
 ds_read_b64_tr_b16 v[52:53],v4 offset:54272
 ds_read_b64_tr_b16 v[54:55],v4 offset:54784
 s_cbranch_vccnz Lfix_173
Lret_174:
 s_waitcnt lgkmcnt(4)
 v_mfma_f32_32x32x16_bf16 v[88:103],v[216:219],v[40:43],v[88:103]
 ds_read_b64_tr_b16 v[40:41],v4 offset:24576
 ds_read_b64_tr_b16 v[42:43],v4 offset:25088
 buffer_load_dwordx4 v[180:183],v2,s[32:35],s10 offen offset:1024 sc1
 v_mfma_f32_32x32x16_bf16 v[104:119],v[216:219],v[44:47],v[104:119]
 ds_read_b64_tr_b16 v[44:45],v4 offset:57344
 ds_read_b64_tr_b16 v[46:47],v4 offset:57856
 s_waitcnt vmcnt(10) lgkmcnt(4)
 v_mfma_f32_32x32x16_bf16 v[88:103],v[220:223],v[48:51],v[88:103]
 ds_read_b64_tr_b16 v[48:49],v4 offset:25600
 ds_read_b64_tr_b16 v[50:51],v4 offset:26112
 buffer_load_dwordx4 v[192:195],v2,s[32:35],s11 offen sc1
 v_bitop3_b32 v38,v232,v236,1 bitop3:0xa8
 v_cmp_ne_u32 vcc,0,v38
 v_mfma_f32_32x32x16_bf16 v[104:119],v[220:223],v[52:55],v[104:119]
 ds_read_b64_tr_b16 v[52:53],v4 offset:58368
 ds_read_b64_tr_b16 v[54:55],v4 offset:58880
 s_cbranch_vccnz Lfix_176
Lret_177:
 s_waitcnt lgkmcnt(4)
 v_mfma_f32_32x32x16_bf16 v[88:103],v[232:235],v[40:43],v[88:103]
 ds_read_b64_tr_b16 v[40:41],v4 offset:28672
 ds_read_b64_tr_b16 v[42:43],v4 offset:29184
 buffer_load_dwordx4 v[196:199],v2,s[32:35],s11 offen offset:1024 sc1
 s_waitcnt lgkmcnt(0)
 s_barrier
 v_mfma_f32_32x32x16_bf16 v[104:119],v[232:235],v[44:47],v[104:119]
 ds_read_b64_tr_b16 v[44:45],v4 offset:61440
 ds_read_b64_tr_b16 v[46:47],v4 offset:61952
 s_waitcnt vmcnt(10)
 v_mfma_f32_32x32x16_bf16 v[88:103],v[236:239],v[48:51],v[88:103]
 ds_read_b64_tr_b16 v[48:49],v4 offset:29696
 ds_read_b64_tr_b16 v[50:51],v4 offset:30208
 buffer_load_dwordx4 v[208:211],v2,s[32:35],s57 offen sc1
 v_bitop3_b32 v38,v248,v252,1 bitop3:0xa8
 v_cmp_ne_u32 vcc,0,v38
 v_mfma_f32_32x32x16_bf16 v[104:119],v[236:239],v[52:55],v[104:119]
 ds_read_b64_tr_b16 v[52:53],v4 offset:62464
 ds_read_b64_tr_b16 v[54:55],v4 offset:62976
 s_cbranch_vccnz Lfix_179
Lret_180:
 s_waitcnt lgkmcnt(4)
 v_mfma_f32_32x32x16_bf16 v[88:103],v[248:251],v[40:43],v[88:103]
 ds_read_b64_tr_b16 v[40:41],v4 offset:2048
 ds_read_b64_tr_b16 v[42:43],v4 offset:2560
 buffer_load_dwordx4 v[212:215],v2,s[32:35],s57 offen offset:1024 sc1
 v_mfma_f32_32x32x16_bf16 v[104:119],v[248:251],v[44:47],v[104:119]
 ds_read_b64_tr_b16 v[44:45],v4 offset:34816
 ds_read_b64_tr_b16 v[46:47],v4 offset:35328
 s_waitcnt vmcnt(10) lgkmcnt(4)
 v_mfma_f32_32x32x16_bf16 v[88:103],v[252:255],v[48:51],v[88:103]
 ds_read_b64_tr_b16 v[48:49],v4 offset:3072
 ds_read_b64_tr_b16 v[50:51],v4 offset:3584
 buffer_load_dwordx4 v[224:227],v2,s[32:35],s77 offen sc1
 v_bitop3_b32 v38,v144,v148,1 bitop3:0xa8
 v_cmp_ne_u32 vcc,0,v38
 v_mfma_f32_32x32x16_bf16 v[104:119],v[252:255],v[52:55],v[104:119]
 ds_read_b64_tr_b16 v[52:53],v4 offset:35840
 ds_read_b64_tr_b16 v[54:55],v4 offset:36352
 s_cbranch_vccnz Lfix_182
Lret_183:
 s_waitcnt lgkmcnt(4)
 v_mfma_f32_32x32x16_bf16 v[88:103],v[144:147],v[40:43],v[88:103]
 ds_read_b64_tr_b16 v[40:41],v4 offset:6144
 ds_read_b64_tr_b16 v[42:43],v4 offset:6656
 buffer_load_dwordx4 v[228:231],v2,s[32:35],s77 offen offset:1024 sc1
 v_mfma_f32_32x32x16_bf16 v[104:119],v[144:147],v[44:47],v[104:119]
 ds_read_b64_tr_b16 v[44:45],v4 offset:38912
 ds_read_b64_tr_b16 v[46:47],v4 offset:39424
 s_waitcnt vmcnt(10) lgkmcnt(4)
 v_mfma_f32_32x32x16_bf16 v[88:103],v[148:151],v[48:51],v[88:103]
 ds_read_b64_tr_b16 v[48:49],v4 offset:7168
 ds_read_b64_tr_b16 v[50:51],v4 offset:7680
 buffer_load_dwordx4 v[240:243],v2,s[32:35],s81 offen sc1
 v_bitop3_b32 v38,v160,v164,1 bitop3:0xa8
 v_cmp_ne_u32 vcc,0,v38
 v_mfma_f32_32x32x16_bf16 v[104:119],v[148:151],v[52:55],v[104:119]
 ds_read_b64_tr_b16 v[52:53],v4 offset:39936
 ds_read_b64_tr_b16 v[54:55],v4 offset:40448
 s_cbranch_vccnz Lfix_185
Lret_186:
 s_waitcnt lgkmcnt(4)
 v_mfma_f32_32x32x16_bf16 v[88:103],v[160:163],v[40:43],v[88:103]
 ds_read_b64_tr_b16 v[40:41],v4 offset:10240
 ds_read_b64_tr_b16 v[42:43],v4 offset:10752
 buffer_load_dwordx4 v[244:247],v2,s[32:35],s81 offen offset:1024 sc1
 v_mfma_f32_32x32x16_bf16 v[104:119],v[160:163],v[44:47],v[104:119]
 ds_read_b64_tr_b16 v[44:45],v4 offset:43008
 ds_read_b64_tr_b16 v[46:47],v4 offset:43520
 s_waitcnt vmcnt(8) lgkmcnt(4)
 v_mfma_f32_32x32x16_bf16 v[88:103],v[164:167],v[48:51],v[88:103]
 ds_read_b64_tr_b16 v[48:49],v4 offset:11264
 ds_read_b64_tr_b16 v[50:51],v4 offset:11776
 buffer_load_dwordx4 a[248:251],v2,s[32:35],s99 offen sc1
 v_bitop3_b32 v38,v176,v180,1 bitop3:0xa8
 v_cmp_ne_u32 vcc,0,v38
 v_mfma_f32_32x32x16_bf16 v[104:119],v[164:167],v[52:55],v[104:119]
 ds_read_b64_tr_b16 v[52:53],v4 offset:44032
 ds_read_b64_tr_b16 v[54:55],v4 offset:44544
 v_and_b32 v38,v72,v73
 v_bitop3_b32 v38,v74,v75,v38 bitop3:0x80
 v_bitop3_b32 v38,v76,v77,v38 bitop3:0x80
 v_bitop3_b32 v38,v78,v79,v38 bitop3:0x80
 v_and_b32 v38,1,v38
 v_cmp_eq_u32 s[82:83],0,v38
 s_nop 0
 s_cmp_lg_u64 s[82:83],0
 s_cbranch_scc1 Lfix_191
Lret_192:
 v_add_f32 v72,v72,v73
 s_cbranch_vccnz Lfix_188
Lret_189:
 s_waitcnt lgkmcnt(4)
 v_mfma_f32_32x32x16_bf16 v[88:103],v[176:179],v[40:43],v[88:103]
 ds_read_b64_tr_b16 v[40:41],v4 offset:14336
 ds_read_b64_tr_b16 v[42:43],v4 offset:14848
 buffer_load_dwordx4 a[252:255],v2,s[32:35],s99 offen offset:1024 sc1
 v_add_f32 v74,v74,v75
 v_add_f32 v76,v76,v77
 v_mfma_f32_32x32x16_bf16 v[104:119],v[176:179],v[44:47],v[104:119]
 ds_read_b64_tr_b16 v[44:45],v4 offset:47104
 ds_read_b64_tr_b16 v[46:47],v4 offset:47616
 v_add_f32 v78,v78,v79
 v_add_f32 v72,v72,v74
 s_waitcnt vmcnt(8) lgkmcnt(4)
 v_mfma_f32_32x32x16_bf16 v[88:103],v[180:183],v[48:51],v[88:103]
 ds_read_b64_tr_b16 v[48:49],v4 offset:15360
 ds_read_b64_tr_b16 v[50:51],v4 offset:15872
 s_add_u32 s96,s95,0
 s_and_b32 s96,s96,7
 s_mul_i32 s96,s96,196608
 s_add_u32 s96,s96,s61
 s_add_u32 m0,s54,65536
 s_add_u32 s52,s96,0
 buffer_load_dwordx4 v7,s[12:15],s52 offen lds
 v_bitop3_b32 v38,v192,v196,1 bitop3:0xa8
 v_cmp_ne_u32 vcc,0,v38
 v_mfma_f32_32x32x16_bf16 v[104:119],v[180:183],v[52:55],v[104:119]
 ds_read_b64_tr_b16 v[52:53],v4 offset:48128
 ds_read_b64_tr_b16 v[54:55],v4 offset:48640
 v_add_f32 v76,v76,v78
 v_add_f32 v72,v72,v76
 s_cbranch_vccnz Lfix_194
Lret_195:
 s_waitcnt lgkmcnt(4)
 v_mfma_f32_32x32x16_bf16 v[88:103],v[192:195],v[40:43],v[88:103]
 ds_read_b64_tr_b16 v[40:41],v4 offset:18432
 ds_read_b64_tr_b16 v[42:43],v4 offset:18944
 s_add_u32 s96,s95,1
 s_and_b32 s96,s96,7
 s_mul_i32 s96,s96,196608
 s_add_u32 s96,s96,s61
 s_add_u32 m0,s54,69632
 s_add_u32 s52,s96,0
 buffer_load_dwordx4 v7,s[12:15],s52 offen lds
 v_mov_b32 v73,v72
 s_nop 1
 v_permlane32_swap_b32 v72,v73
 v_mfma_f32_32x32x16_bf16 v[104:119],v[192:195],v[44:47],v[104:119]
 ds_read_b64_tr_b16 v[44:45],v4 offset:51200
 ds_read_b64_tr_b16 v[46:47],v4 offset:51712
 v_mul_f32 v72,s74,v72
 v_mul_f32 v73,s74,v73
 s_waitcnt vmcnt(8) lgkmcnt(4)
 v_mfma_f32_32x32x16_bf16 v[88:103],v[196:199],v[48:51],v[88:103]
 ds_read_b64_tr_b16 v[48:49],v4 offset:19456
 ds_read_b64_tr_b16 v[50:51],v4 offset:19968
 s_add_u32 s96,s95,2
 s_and_b32 s96,s96,7
 s_mul_i32 s96,s96,196608
 s_add_u32 s96,s96,s61
 s_add_u32 m0,s54,73728
 s_add_u32 s52,s96,0
 buffer_load_dwordx4 v7,s[12:15],s52 offen lds
 v_bitop3_b32 v38,v208,v212,1 bitop3:0xa8
 v_cmp_ne_u32 vcc,0,v38
 v_mfma_f32_32x32x16_bf16 v[104:119],v[196:199],v[52:55],v[104:119]
 ds_read_b64_tr_b16 v[52:53],v4 offset:52224
 ds_read_b64_tr_b16 v[54:55],v4 offset:52736
 v_fma_f32 v73,-v72,v72,v73
 v_max_f32 v73,0,v73
 s_cbranch_vccnz Lfix_197
Lret_198:
 s_waitcnt lgkmcnt(4)
 v_mfma_f32_32x32x16_bf16 v[88:103],v[208:211],v[40:43],v[88:103]
 ds_read_b64_tr_b16 v[40:41],v4 offset:22528
 ds_read_b64_tr_b16 v[42:43],v4 offset:23040
 s_add_u32 s96,s95,3
 s_and_b32 s96,s96,7
 s_mul_i32 s96,s96,196608
 s_add_u32 s96,s96,s61
 s_add_u32 m0,s54,77824
 s_add_u32 s52,s96,0
 buffer_load_dwordx4 v7,s[12:15],s52 offen lds
 v_add_f32 v73,s75,v73
 v_rsq_f32 v73,v73
 v_mfma_f32_32x32x16_bf16 v[104:119],v[208:211],v[44:47],v[104:119]
 ds_read_b64_tr_b16 v[44:45],v4 offset:55296
 ds_read_b64_tr_b16 v[46:47],v4 offset:55808
 v_mul_f32 v16,s73,v73
 v_cndmask_b32_e64 v72,0,-v72,s[92:93]
 s_waitcnt vmcnt(8) lgkmcnt(4)
 v_mfma_f32_32x32x16_bf16 v[88:103],v[212:215],v[48:51],v[88:103]
 ds_read_b64_tr_b16 v[48:49],v4 offset:23552
 ds_read_b64_tr_b16 v[50:51],v4 offset:24064
 s_add_u32 s96,s95,4
 s_and_b32 s96,s96,7
 s_mul_i32 s96,s96,196608
 s_add_u32 s96,s96,s61
 s_add_u32 m0,s54,81920
 s_add_u32 s52,s96,0
 buffer_load_dwordx4 v7,s[12:15],s52 offen lds
 v_bitop3_b32 v38,v224,v228,1 bitop3:0xa8
 v_cmp_ne_u32 vcc,0,v38
 v_mfma_f32_32x32x16_bf16 v[104:119],v[212:215],v[52:55],v[104:119]
 ds_read_b64_tr_b16 v[52:53],v4 offset:56320
 ds_read_b64_tr_b16 v[54:55],v4 offset:56832
 v_cvt_pk_bf16_f32 v24,v72,v72
 v_lshlrev_b32 v74,16,v24
 s_cbranch_vccnz Lfix_200
Lret_201:
 s_waitcnt lgkmcnt(4)
 v_mfma_f32_32x32x16_bf16 v[88:103],v[224:227],v[40:43],v[88:103]
 ds_read_b64_tr_b16 v[40:41],v4 offset:26624
 ds_read_b64_tr_b16 v[42:43],v4 offset:27136
 s_add_u32 s96,s95,5
 s_and_b32 s96,s96,7
 s_mul_i32 s96,s96,196608
 s_add_u32 s96,s96,s61
 s_add_u32 m0,s54,86016
 s_add_u32 s52,s96,0
 buffer_load_dwordx4 v7,s[12:15],s52 offen lds
 v_sub_f32 v72,v72,v74
 v_cvt_pk_bf16_f32 v25,v72,v72
 v_mfma_f32_32x32x16_bf16 v[104:119],v[224:227],v[44:47],v[104:119]
 ds_read_b64_tr_b16 v[44:45],v4 offset:59392
 ds_read_b64_tr_b16 v[46:47],v4 offset:59904
 v_cndmask_b32 v73,0,v16,s[92:93]
 v_cvt_pk_bf16_f32 v74,v73,v73
 s_waitcnt vmcnt(8) lgkmcnt(4)
 v_mfma_f32_32x32x16_bf16 v[88:103],v[228:231],v[48:51],v[88:103]
 ds_read_b64_tr_b16 v[48:49],v4 offset:27648
 ds_read_b64_tr_b16 v[50:51],v4 offset:28160
 s_add_u32 s96,s95,6
 s_and_b32 s96,s96,7
 s_mul_i32 s96,s96,196608
 s_add_u32 s96,s96,s61
 s_add_u32 m0,s54,90112
 s_add_u32 s52,s96,0
 buffer_load_dwordx4 v7,s[12:15],s52 offen lds
 v_bitop3_b32 v38,v240,v244,1 bitop3:0xa8
 v_cmp_ne_u32 vcc,0,v38
 v_mfma_f32_32x32x16_bf16 v[104:119],v[228:231],v[52:55],v[104:119]
 ds_read_b64_tr_b16 v[52:53],v4 offset:60416
 ds_read_b64_tr_b16 v[54:55],v4 offset:60928
 v_lshlrev_b32 v74,16,v74
 v_sub_f32 v74,v73,v74
 s_cbranch_vccnz Lfix_203
Lret_204:
 s_waitcnt lgkmcnt(4)
 v_mfma_f32_32x32x16_bf16 v[88:103],v[240:243],v[40:43],v[88:103]
 ds_read_b64_tr_b16 v[40:41],v4 offset:30720
 ds_read_b64_tr_b16 v[42:43],v4 offset:31232
 s_add_u32 s96,s95,7
 s_and_b32 s96,s96,7
 s_mul_i32 s96,s96,196608
 s_add_u32 s96,s96,s61
 s_add_u32 m0,s54,94208
 s_add_u32 s52,s96,0
 buffer_load_dwordx4 v7,s[12:15],s52 offen lds
 v_cvt_pk_bf16_f32 v26,v73,v74
 s_nop 1
 v_mfma_f32_32x32x16_bf16 v[56:71],v[24:27],v[30:33],0
 v_mfma_f32_32x32x16_bf16 v[104:119],v[240:243],v[44:47],v[104:119]
 ds_read_b64_tr_b16 v[44:45],v4 offset:63488
 ds_read_b64_tr_b16 v[46:47],v4 offset:64000
 s_waitcnt vmcnt(8) lgkmcnt(4)
 v_mfma_f32_32x32x16_bf16 v[88:103],v[244:247],v[48:51],v[88:103]
 ds_read_b64_tr_b16 v[48:49],v4 offset:31744
 ds_read_b64_tr_b16 v[50:51],v4 offset:32256
 v_accvgpr_read_b32 v38,a248
 v_lshlrev_b32 v38,31,v38
 v_cmp_ne_u32 s[82:83],0,v38
 v_accvgpr_read_b32 v38,a252
 v_lshlrev_b32 v38,31,v38
 v_cmp_ne_u32 vcc,0,v38
 s_nop 1
 s_or_b64 vcc,vcc,s[82:83]
 v_mfma_f32_32x32x16_bf16 v[104:119],v[244:247],v[52:55],v[104:119]
 ds_read_b64_tr_b16 v[52:53],v4 offset:64512
 ds_read_b64_tr_b16 v[54:55],v4 offset:65024
 s_cbranch_vccnz Lfix_206
Lret_207:
 s_waitcnt lgkmcnt(4)
 v_mfma_f32_32x32x16_bf16 v[88:103],a[248:251],v[40:43],v[88:103]
 v_mfma_f32_32x32x16_bf16 v[104:119],a[248:251],v[44:47],v[104:119]
 s_waitcnt lgkmcnt(0)
 v_mfma_f32_32x32x16_bf16 v[88:103],a[252:255],v[48:51],v[88:103]
 v_mfma_f32_32x32x16_bf16 v[104:119],a[252:255],v[52:55],v[104:119]
 v_mov_b32 v28,v20
 v_mov_b32 v29,v20
 s_nop 1
 v_mfma_f32_32x32x16_bf16 v[88:103],v[24:27],v[28:31],v[88:103]
 v_mov_b32 v28,v21
 v_mov_b32 v29,v21
 s_nop 1
 v_mfma_f32_32x32x16_bf16 v[104:119],v[24:27],v[28:31],v[104:119]
 s_nop 6
 v_pk_fma_f32 v[88:89],v[88:89],v[56:57],s[88:89]
 v_pk_fma_f32 v[90:91],v[90:91],v[58:59],s[88:89]
 v_pk_fma_f32 v[92:93],v[92:93],v[60:61],s[88:89]
 v_pk_fma_f32 v[94:95],v[94:95],v[62:63],s[88:89]
 v_exp_f32_e64 v72,v88 clamp
 v_exp_f32_e64 v73,v89 clamp
 v_exp_f32_e64 v74,v90 clamp
 v_exp_f32_e64 v75,v91 clamp
 v_exp_f32_e64 v76,v92 clamp
 v_exp_f32_e64 v77,v93 clamp
 v_exp_f32_e64 v78,v94 clamp
 v_exp_f32_e64 v79,v95 clamp
 v_max_f32 v88,s88,v88
 v_max_f32 v89,s88,v89
 v_max_f32 v90,s88,v90
 v_max_f32 v91,s88,v91
 v_max_f32 v92,s88,v92
 v_max_f32 v93,s88,v93
 v_max_f32 v94,s88,v94
 v_max_f32 v95,s88,v95
 v_pk_fma_f32 v[88:89],v[88:89],s[90:91],v[72:73]
 v_pk_fma_f32 v[90:91],v[90:91],s[90:91],v[74:75]
 v_pk_fma_f32 v[92:93],v[92:93],s[90:91],v[76:77]
 v_pk_fma_f32 v[94:95],v[94:95],s[90:91],v[78:79]
 v_cvt_pk_bf16_f32 v88,v88,v89
 v_cvt_pk_bf16_f32 v89,v90,v91
 v_cvt_pk_bf16_f32 v90,v92,v93
 v_cvt_pk_bf16_f32 v91,v94,v95
 v_pk_fma_f32 v[96:97],v[96:97],v[64:65],s[88:89]
 v_pk_fma_f32 v[98:99],v[98:99],v[66:67],s[88:89]
 v_pk_fma_f32 v[100:101],v[100:101],v[68:69],s[88:89]
 v_pk_fma_f32 v[102:103],v[102:103],v[70:71],s[88:89]
 v_exp_f32_e64 v72,v96 clamp
 v_exp_f32_e64 v73,v97 clamp
 v_exp_f32_e64 v74,v98 clamp
 v_exp_f32_e64 v75,v99 clamp
 v_exp_f32_e64 v76,v100 clamp
 v_exp_f32_e64 v77,v101 clamp
 v_exp_f32_e64 v78,v102 clamp
 v_exp_f32_e64 v79,v103 clamp
 v_max_f32 v96,s88,v96
 v_max_f32 v97,s88,v97
 v_max_f32 v98,s88,v98
 v_max_f32 v99,s88,v99
 v_max_f32 v100,s88,v100
 v_max_f32 v101,s88,v101
 v_max_f32 v102,s88,v102
 v_max_f32 v103,s88,v103
 v_pk_fma_f32 v[96:97],v[96:97],s[90:91],v[72:73]
 v_pk_fma_f32 v[98:99],v[98:99],s[90:91],v[74:75]
 v_pk_fma_f32 v[100:101],v[100:101],s[90:91],v[76:77]
 v_pk_fma_f32 v[102:103],v[102:103],s[90:91],v[78:79]
 v_cvt_pk_bf16_f32 v92,v96,v97
 v_cvt_pk_bf16_f32 v93,v98,v99
 v_cvt_pk_bf16_f32 v94,v100,v101
 v_cvt_pk_bf16_f32 v95,v102,v103
 v_pk_mul_f32 v[104:105],v[104:105],v[56:57]
 v_pk_mul_f32 v[106:107],v[106:107],v[58:59]
 v_pk_mul_f32 v[108:109],v[108:109],v[60:61]
 v_pk_mul_f32 v[110:111],v[110:111],v[62:63]
 v_cvt_pk_bf16_f32 v104,v104,v105
 v_cvt_pk_bf16_f32 v105,v106,v107
 v_cvt_pk_bf16_f32 v106,v108,v109
 v_cvt_pk_bf16_f32 v107,v110,v111
 v_mov_b32 v96,v32
 v_mov_b32 v97,v32
 v_mov_b32 v98,v32
 v_mov_b32 v99,v32
 v_mov_b32 v100,v32
 v_mov_b32 v101,v32
 v_mov_b32 v102,v32
 v_mov_b32 v103,v32
 v_permlane16_swap_b32 v104,v96
 v_permlane16_swap_b32 v105,v97
 v_permlane16_swap_b32 v106,v98
 v_permlane16_swap_b32 v107,v99
 v_pk_mul_f32 v[112:113],v[112:113],v[64:65]
 v_pk_mul_f32 v[114:115],v[114:115],v[66:67]
 v_pk_mul_f32 v[116:117],v[116:117],v[68:69]
 v_pk_mul_f32 v[118:119],v[118:119],v[70:71]
 v_cvt_pk_bf16_f32 v108,v112,v113
 v_cvt_pk_bf16_f32 v109,v114,v115
 v_cvt_pk_bf16_f32 v110,v116,v117
 v_cvt_pk_bf16_f32 v111,v118,v119
 v_mfma_f32_32x32x16_bf16 v[72:87],v[88:91],v[96:99],0
 v_permlane16_swap_b32 v108,v100
 v_permlane16_swap_b32 v109,v101
 v_permlane16_swap_b32 v110,v102
 v_permlane16_swap_b32 v111,v103
 v_mfma_f32_32x32x16_bf16 v[56:71],v[88:91],v[104:107],0
 s_nop 0
 v_mfma_f32_32x32x16_bf16 v[72:87],v[92:95],v[100:103],v[72:87]
 v_mfma_f32_32x32x16_bf16 v[56:71],v[92:95],v[108:111],v[56:71]
 s_lshl_b32 s53,s4,12
 s_add_u32 s53,s53,147456
 v_add_u32 v112,s53,v1
 v_bfe_u32 v118,v0,1,4
 v_lshl_add_u32 v118,v17,5,v118
 v_lshlrev_b32 v118,4,v118
 s_lshl_b32 s53,s4,11
 v_add_u32 v118,s53,v118
 v_bfe_u32 v119,v0,1,2
 v_lshlrev_b32 v119,9,v119
 v_bfe_u32 v117,v0,2,1
 v_lshl_add_u32 v119,v117,10,v119
 v_add_u32 v119,256,v119
 s_cmp_eq_u32 s4,2
 s_cselect_b64 vcc,-1,0
 v_cndmask_b32 v113,v118,v119,vcc
 v_and_b32 v118,1,v0
 v_lshl_add_u32 v113,v118,10,v113
 v_add_u32 v113,0x24000,v113
 v_add_u32 v115,s54,v1
 s_and_b32 s53,s7,0xff
 v_mov_b32 v116,s53
 v_lshrrev_b32 v118,3,v0
 v_mul_u32_u24 v118,2560,v118
 v_and_b32 v119,7,v0
 v_lshl_add_u32 v114,v119,4,v118
 v_and_b32 v117,7,v0
 v_lshlrev_b32 v117,3,v117
 v_lshl_add_u32 v117,v17,2,v117
 s_cmp_eq_u32 s4,2
 s_cselect_b32 s53,128,0
 v_and_b32 v118,4,v0
 v_mad_u32_u24 v117,v118,s53,v117
 ds_write_b128 v112,v[80:83] offset:2048
 ds_write_b128 v112,v[84:87] offset:3072
 ds_write_b128 v112,v[56:59] offset:0
 ds_write_b128 v112,v[60:63] offset:1024
 s_waitcnt vmcnt(0)
 s_waitcnt lgkmcnt(0)
 s_barrier
 s_cmp_eq_u32 s4,3
 s_cbranch_scc1 Lw_209
 ds_read_b128 v[56:59],v113 offset:0
 ds_read_b128 v[60:63],v113 offset:4096
 ds_read_b128 v[64:67],v113 offset:8192
 ds_read_b128 v[68:71],v113 offset:12288
 s_waitcnt lgkmcnt(2)
 v_pk_add_f32 v[56:57],v[56:57],v[60:61]
 v_pk_add_f32 v[58:59],v[58:59],v[62:63]
 s_waitcnt lgkmcnt(0)
 v_pk_add_f32 v[64:65],v[64:65],v[68:69]
 v_pk_add_f32 v[66:67],v[66:67],v[70:71]
 v_pk_add_f32 v[56:57],v[56:57],v[64:65]
 v_pk_add_f32 v[58:59],v[58:59],v[66:67]
 v_cmp_gt_u32 vcc,2176,v115
 v_and_or_b32 v56,v56,s85,v116
 v_and_or_b32 v57,v57,s85,v116
 v_and_or_b32 v58,v58,s85,v116
 v_and_or_b32 v59,v59,s85,v116
 s_mul_i32 s53,s5,2560
 s_add_u32 s53,s53,s78
 s_mov_b64 exec,vcc
 s_add_u32 s52,s53,655360
 buffer_store_dwordx4 v[56:59],v115,s[32:35],s52 offen sc1
 s_mov_b64 exec,-1
Lw_209:
 s_xor_b32 s48,s49,1
 s_cmp_lg_u32 s48,0
 s_cbranch_scc1 Lp_210
 v_mov_b32 v60,v56
 v_mov_b32 v64,v56
 v_mov_b32 v61,v57
 v_mov_b32 v65,v57
 v_mov_b32 v62,v58
 v_mov_b32 v66,v58
 v_mov_b32 v63,v59
 v_mov_b32 v67,v59
 s_mov_b64 exec,s[100:101]
 s_add_u32 s52,s50,655360
 buffer_load_dwordx4 v[60:63],v114,s[32:35],s52 offen sc1
 s_mov_b64 exec,s[0:1]
 s_add_u32 s52,s50,675840
 buffer_load_dwordx4 v[64:67],v114,s[32:35],s52 offen sc1
 s_mov_b64 exec,-1
Lp_210:
 ds_read_b64_tr_b16 v[40:41],v5 offset:0
 ds_read_b64_tr_b16 v[42:43],v5 offset:512
 ds_read_b64_tr_b16 v[44:45],v5 offset:1024
 ds_read_b64_tr_b16 v[46:47],v5 offset:1536
 ds_read_b64_tr_b16 v[48:49],v5 offset:2048
 ds_read_b64_tr_b16 v[50:51],v5 offset:2560
 ds_read_b64_tr_b16 v[52:53],v5 offset:3072
 ds_read_b64_tr_b16 v[54:55],v5 offset:3584
 s_waitcnt lgkmcnt(6)
 v_mfma_f32_32x32x16_bf16 v[120:135],v[40:43],v[136:139],0
 ds_read_b64_tr_b16 v[40:41],v5 offset:4096
 ds_read_b64_tr_b16 v[42:43],v5 offset:4608
 s_waitcnt lgkmcnt(6)
 v_mfma_f32_32x32x16_bf16 v[120:135],v[44:47],v[140:143],v[120:135]
 ds_read_b64_tr_b16 v[44:45],v5 offset:5120
 ds_read_b64_tr_b16 v[46:47],v5 offset:5632
 s_waitcnt lgkmcnt(6)
 v_mfma_f32_32x32x16_bf16 v[120:135],v[48:51],v[144:147],v[120:135]
 ds_read_b64_tr_b16 v[48:49],v5 offset:6144
 ds_read_b64_tr_b16 v[50:51],v5 offset:6656
 s_waitcnt lgkmcnt(6)
 v_mfma_f32_32x32x16_bf16 v[120:135],v[52:55],v[148:151],v[120:135]
 ds_read_b64_tr_b16 v[52:53],v5 offset:7168
 ds_read_b64_tr_b16 v[54:55],v5 offset:7680
 s_waitcnt lgkmcnt(6)
 v_mfma_f32_32x32x16_bf16 v[120:135],v[40:43],v[152:155],v[120:135]
 ds_read_b64_tr_b16 v[40:41],v5 offset:8192
 ds_read_b64_tr_b16 v[42:43],v5 offset:8704
 s_waitcnt lgkmcnt(6)
 v_mfma_f32_32x32x16_bf16 v[120:135],v[44:47],v[156:159],v[120:135]
 ds_read_b64_tr_b16 v[44:45],v5 offset:9216
 ds_read_b64_tr_b16 v[46:47],v5 offset:9728
 s_waitcnt lgkmcnt(6)
 v_mfma_f32_32x32x16_bf16 v[120:135],v[48:51],v[160:163],v[120:135]
 ds_read_b64_tr_b16 v[48:49],v5 offset:10240
 ds_read_b64_tr_b16 v[50:51],v5 offset:10752
 s_waitcnt lgkmcnt(6)
 v_mfma_f32_32x32x16_bf16 v[120:135],v[52:55],v[164:167],v[120:135]
 ds_read_b64_tr_b16 v[52:53],v5 offset:11264
 ds_read_b64_tr_b16 v[54:55],v5 offset:11776
 s_waitcnt lgkmcnt(6)
 v_mfma_f32_32x32x16_bf16 v[120:135],v[40:43],v[168:171],v[120:135]
 ds_read_b64_tr_b16 v[40:41],v5 offset:12288
 ds_read_b64_tr_b16 v[42:43],v5 offset:12800
 s_waitcnt lgkmcnt(6)
 v_mfma_f32_32x32x16_bf16 v[120:135],v[44:47],v[172:175],v[120:135]
 ds_read_b64_tr_b16 v[44:45],v5 offset:13312
 ds_read_b64_tr_b16 v[46:47],v5 offset:13824
 s_waitcnt lgkmcnt(6)
 v_mfma_f32_32x32x16_bf16 v[120:135],v[48:51],v[176:179],v[120:135]
 ds_read_b64_tr_b16 v[48:49],v5 offset:14336
 ds_read_b64_tr_b16 v[50:51],v5 offset:14848
 s_waitcnt lgkmcnt(6)
 v_mfma_f32_32x32x16_bf16 v[120:135],v[52:55],v[180:183],v[120:135]
 ds_read_b64_tr_b16 v[52:53],v5 offset:15360
 ds_read_b64_tr_b16 v[54:55],v5 offset:15872
 s_waitcnt lgkmcnt(6)
 v_mfma_f32_32x32x16_bf16 v[120:135],v[40:43],v[184:187],v[120:135]
 ds_read_b64_tr_b16 v[40:41],v5 offset:16384
 ds_read_b64_tr_b16 v[42:43],v5 offset:16896
 s_waitcnt lgkmcnt(6)
 v_mfma_f32_32x32x16_bf16 v[120:135],v[44:47],v[188:191],v[120:135]
 ds_read_b64_tr_b16 v[44:45],v5 offset:17408
 ds_read_b64_tr_b16 v[46:47],v5 offset:17920
 s_waitcnt lgkmcnt(6)
 v_mfma_f32_32x32x16_bf16 v[120:135],v[48:51],v[192:195],v[120:135]
 ds_read_b64_tr_b16 v[48:49],v5 offset:18432
 ds_read_b64_tr_b16 v[50:51],v5 offset:18944
 s_waitcnt lgkmcnt(6)
 v_mfma_f32_32x32x16_bf16 v[120:135],v[52:55],v[196:199],v[120:135]
 ds_read_b64_tr_b16 v[52:53],v5 offset:19456
 ds_read_b64_tr_b16 v[54:55],v5 offset:19968
 s_waitcnt lgkmcnt(6)
 v_mfma_f32_32x32x16_bf16 v[120:135],v[40:43],v[200:203],v[120:135]
 ds_read_b64_tr_b16 v[40:41],v5 offset:20480
 ds_read_b64_tr_b16 v[42:43],v5 offset:20992
 s_waitcnt lgkmcnt(6)
 v_mfma_f32_32x32x16_bf16 v[120:135],v[44:47],v[204:207],v[120:135]
 ds_read_b64_tr_b16 v[44:45],v5 offset:21504
 ds_read_b64_tr_b16 v[46:47],v5 offset:22016
 s_waitcnt lgkmcnt(6)
 v_mfma_f32_32x32x16_bf16 v[120:135],v[48:51],v[208:211],v[120:135]
 ds_read_b64_tr_b16 v[48:49],v5 offset:22528
 ds_read_b64_tr_b16 v[50:51],v5 offset:23040
 s_waitcnt lgkmcnt(6)
 v_mfma_f32_32x32x16_bf16 v[120:135],v[52:55],v[212:215],v[120:135]
 ds_read_b64_tr_b16 v[52:53],v5 offset:23552
 ds_read_b64_tr_b16 v[54:55],v5 offset:24064
 s_waitcnt lgkmcnt(6)
 v_mfma_f32_32x32x16_bf16 v[120:135],v[40:43],v[216:219],v[120:135]
 ds_read_b64_tr_b16 v[40:41],v5 offset:24576
 ds_read_b64_tr_b16 v[42:43],v5 offset:25088
 s_waitcnt lgkmcnt(6)
 v_mfma_f32_32x32x16_bf16 v[120:135],v[44:47],v[220:223],v[120:135]
 ds_read_b64_tr_b16 v[44:45],v5 offset:25600
 ds_read_b64_tr_b16 v[46:47],v5 offset:26112
 s_waitcnt lgkmcnt(6)
 v_mfma_f32_32x32x16_bf16 v[120:135],v[48:51],v[224:227],v[120:135]
 ds_read_b64_tr_b16 v[48:49],v5 offset:26624
 ds_read_b64_tr_b16 v[50:51],v5 offset:27136
 s_waitcnt lgkmcnt(6)
 v_mfma_f32_32x32x16_bf16 v[120:135],v[52:55],v[228:231],v[120:135]
 ds_read_b64_tr_b16 v[52:53],v5 offset:27648
 ds_read_b64_tr_b16 v[54:55],v5 offset:28160
 s_waitcnt lgkmcnt(6)
 v_mfma_f32_32x32x16_bf16 v[120:135],v[40:43],v[232:235],v[120:135]
 s_cmp_lg_u32 s48,0
 s_cbranch_scc1 Lp_211
 s_waitcnt vmcnt(0)
 v_xor_b32 v118,v60,v116
 v_bitop3_b32 v118,v63,v116,v118 bitop3:0xbe
 v_bitop3_b32 v118,v64,v116,v118 bitop3:0xbe
 v_bitop3_b32 v118,v67,v116,v118 bitop3:0xbe
 v_and_b32 v118,0xff,v118
 v_cmp_ne_u32 vcc,0,v118
 s_cbranch_vccnz La_212
 v_pk_add_f32 v[60:61],v[60:61],v[64:65]
 v_pk_add_f32 v[62:63],v[62:63],v[66:67]
 s_nop 0
 v_add_f32_dpp v60,v60,v60 row_ror:8 row_mask:0xf bank_mask:0xf
 v_add_f32_dpp v61,v61,v61 row_ror:8 row_mask:0xf bank_mask:0xf
 v_add_f32_dpp v62,v62,v62 row_ror:8 row_mask:0xf bank_mask:0xf
 v_add_f32_dpp v63,v63,v63 row_ror:8 row_mask:0xf bank_mask:0xf
 v_permlane16_swap_b32 v60,v61
 s_nop 0
 v_permlane16_swap_b32 v62,v63
 v_add_f32 v60,v60,v61
 v_add_f32 v62,v62,v63
 s_nop 1
 v_permlane32_swap_b32 v60,v62
 v_add_f32 v60,v60,v62
 v_mul_f32 v60,s3,v60
 v_mov_b32 v61,v60
 s_nop 1
 v_permlane16_swap_b32 v60,v61
 v_cvt_pk_bf16_f32 v60,v60,v61
 s_mov_b32 exec_lo,0xff
 s_mov_b32 exec_hi,0xff
 s_add_u32 s52,s51,32768
 buffer_store_dword v60,v117,s[32:35],s52 offen sc1
 s_mov_b64 exec,-1
 s_mov_b32 s48,1
 s_branch Lb_213
La_212:
 s_mov_b64 exec,s[100:101]
 s_add_u32 s52,s50,655360
 buffer_load_dwordx4 v[60:63],v114,s[32:35],s52 offen sc1
 s_mov_b64 exec,s[0:1]
 s_add_u32 s52,s50,675840
 buffer_load_dwordx4 v[64:67],v114,s[32:35],s52 offen sc1
 s_mov_b64 exec,-1
Lb_213:
Lp_211:
 ds_read_b64_tr_b16 v[40:41],v5 offset:28672
 ds_read_b64_tr_b16 v[42:43],v5 offset:29184
 s_waitcnt lgkmcnt(6)
 v_mfma_f32_32x32x16_bf16 v[120:135],v[44:47],v[236:239],v[120:135]
 ds_read_b64_tr_b16 v[44:45],v5 offset:29696
 ds_read_b64_tr_b16 v[46:47],v5 offset:30208
 s_waitcnt lgkmcnt(6)
 v_mfma_f32_32x32x16_bf16 v[120:135],v[48:51],v[240:243],v[120:135]
 ds_read_b64_tr_b16 v[48:49],v5 offset:30720
 ds_read_b64_tr_b16 v[50:51],v5 offset:31232
 s_waitcnt lgkmcnt(6)
 v_mfma_f32_32x32x16_bf16 v[120:135],v[52:55],v[244:247],v[120:135]
 ds_read_b64_tr_b16 v[52:53],v5 offset:31744
 ds_read_b64_tr_b16 v[54:55],v5 offset:32256
 s_waitcnt lgkmcnt(6)
 v_mfma_f32_32x32x16_bf16 v[120:135],v[40:43],v[248:251],v[120:135]
 s_waitcnt lgkmcnt(4)
 v_mfma_f32_32x32x16_bf16 v[120:135],v[44:47],v[252:255],v[120:135]
 s_waitcnt lgkmcnt(2)
 v_mfma_f32_32x32x16_bf16 v[120:135],v[48:51],a[248:251],v[120:135]
 s_waitcnt lgkmcnt(0)
 v_mfma_f32_32x32x16_bf16 v[120:135],v[52:55],a[252:255],v[120:135]
 v_mov_b32 v28,v19
 v_mov_b32 v29,v19
 s_nop 1
 v_mfma_f32_32x32x16_bf16 v[120:135],v[28:31],v[24:27],v[120:135]
 s_barrier
 s_cmp_lg_u32 s48,0
 s_cbranch_scc1 Lp_214
 s_waitcnt vmcnt(0)
 v_xor_b32 v118,v60,v116
 v_bitop3_b32 v118,v63,v116,v118 bitop3:0xbe
 v_bitop3_b32 v118,v64,v116,v118 bitop3:0xbe
 v_bitop3_b32 v118,v67,v116,v118 bitop3:0xbe
 v_and_b32 v118,0xff,v118
 v_cmp_ne_u32 vcc,0,v118
 s_cbranch_vccnz La_215
 v_pk_add_f32 v[60:61],v[60:61],v[64:65]
 v_pk_add_f32 v[62:63],v[62:63],v[66:67]
 s_nop 0
 v_add_f32_dpp v60,v60,v60 row_ror:8 row_mask:0xf bank_mask:0xf
 v_add_f32_dpp v61,v61,v61 row_ror:8 row_mask:0xf bank_mask:0xf
 v_add_f32_dpp v62,v62,v62 row_ror:8 row_mask:0xf bank_mask:0xf
 v_add_f32_dpp v63,v63,v63 row_ror:8 row_mask:0xf bank_mask:0xf
 v_permlane16_swap_b32 v60,v61
 s_nop 0
 v_permlane16_swap_b32 v62,v63
 v_add_f32 v60,v60,v61
 v_add_f32 v62,v62,v63
 s_nop 1
 v_permlane32_swap_b32 v60,v62
 v_add_f32 v60,v60,v62
 v_mul_f32 v60,s3,v60
 v_mov_b32 v61,v60
 s_nop 1
 v_permlane16_swap_b32 v60,v61
 v_cvt_pk_bf16_f32 v60,v60,v61
 s_mov_b32 exec_lo,0xff
 s_mov_b32 exec_hi,0xff
 s_add_u32 s52,s51,32768
 buffer_store_dword v60,v117,s[32:35],s52 offen sc1
 s_mov_b64 exec,-1
 s_mov_b32 s48,1
 s_branch Lb_216
La_215:
 s_mov_b64 exec,s[100:101]
 s_add_u32 s52,s50,655360
 buffer_load_dwordx4 v[60:63],v114,s[32:35],s52 offen sc1
 s_mov_b64 exec,s[0:1]
 s_add_u32 s52,s50,675840
 buffer_load_dwordx4 v[64:67],v114,s[32:35],s52 offen sc1
 s_mov_b64 exec,-1
Lb_216:
Lp_214:
 v_fma_f32 v120,v120,v16,s88
 v_fma_f32 v121,v121,v16,s88
 v_fma_f32 v122,v122,v16,s88
 v_fma_f32 v123,v123,v16,s88
 v_fma_f32 v124,v124,v16,s88
 v_fma_f32 v125,v125,v16,s88
 v_fma_f32 v126,v126,v16,s88
 v_fma_f32 v127,v127,v16,s88
 v_exp_f32_e64 v72,v120 clamp
 v_exp_f32_e64 v73,v121 clamp
 v_exp_f32_e64 v74,v122 clamp
 v_exp_f32_e64 v75,v123 clamp
 v_exp_f32_e64 v76,v124 clamp
 v_exp_f32_e64 v77,v125 clamp
 v_exp_f32_e64 v78,v126 clamp
 v_exp_f32_e64 v79,v127 clamp
 v_max_f32 v120,s88,v120
 v_max_f32 v121,s88,v121
 v_max_f32 v122,s88,v122
 v_max_f32 v123,s88,v123
 v_max_f32 v124,s88,v124
 v_max_f32 v125,s88,v125
 v_max_f32 v126,s88,v126
 v_max_f32 v127,s88,v127
 v_pk_fma_f32 v[120:121],v[120:121],s[90:91],v[72:73]
 v_pk_fma_f32 v[122:123],v[122:123],s[90:91],v[74:75]
 v_pk_fma_f32 v[124:125],v[124:125],s[90:91],v[76:77]
 v_pk_fma_f32 v[126:127],v[126:127],s[90:91],v[78:79]
 v_cvt_pk_bf16_f32 v120,v120,v121
 v_cvt_pk_bf16_f32 v121,v122,v123
 v_cvt_pk_bf16_f32 v122,v124,v125
 v_cvt_pk_bf16_f32 v123,v126,v127
 v_fma_f32 v128,v128,v16,s88
 v_fma_f32 v129,v129,v16,s88
 v_fma_f32 v130,v130,v16,s88
 v_fma_f32 v131,v131,v16,s88
 v_fma_f32 v132,v132,v16,s88
 v_fma_f32 v133,v133,v16,s88
 v_fma_f32 v134,v134,v16,s88
 v_fma_f32 v135,v135,v16,s88
 v_exp_f32_e64 v72,v128 clamp
 v_exp_f32_e64 v73,v129 clamp
 v_exp_f32_e64 v74,v130 clamp
 v_exp_f32_e64 v75,v131 clamp
 v_exp_f32_e64 v76,v132 clamp
 v_exp_f32_e64 v77,v133 clamp
 v_exp_f32_e64 v78,v134 clamp
 v_exp_f32_e64 v79,v135 clamp
 v_max_f32 v128,s88,v128
 v_max_f32 v129,s88,v129
 v_max_f32 v130,s88,v130
 v_max_f32 v131,s88,v131
 v_max_f32 v132,s88,v132
 v_max_f32 v133,s88,v133
 v_max_f32 v134,s88,v134
 v_max_f32 v135,s88,v135
 v_pk_fma_f32 v[128:129],v[128:129],s[90:91],v[72:73]
 v_pk_fma_f32 v[130:131],v[130:131],s[90:91],v[74:75]
 v_pk_fma_f32 v[132:133],v[132:133],s[90:91],v[76:77]
 v_pk_fma_f32 v[134:135],v[134:135],s[90:91],v[78:79]
 v_cvt_pk_bf16_f32 v124,v128,v129
 v_cvt_pk_bf16_f32 v125,v130,v131
 v_cvt_pk_bf16_f32 v126,v132,v133
 v_cvt_pk_bf16_f32 v127,v134,v135
 s_add_u32 s52,s94,0
 buffer_store_dwordx4 v[120:123],v1,s[32:35],s52 offen
 s_add_u32 s52,s94,0
 buffer_store_dwordx4 v[124:127],v1,s[32:35],s52 offen offset:1024
 v_and_b32 v36,15,v0
 v_lshlrev_b32 v36,4,v36
 v_lshl_add_u32 v36,v17,8,v36
 v_lshlrev_b32 v37,4,v17
 v_add_u32 v37,512,v37
 v_and_b32 v38,16,v0
 v_cmp_ne_u32 vcc,0,v38
 s_nop 1
 v_cndmask_b32 v36,v36,v37,vcc
 s_mul_i32 s53,s4,544
 v_add_u32 v253,s53,v36
 s_cmp_lg_u32 s48,0
 s_cbranch_scc1 Lp_217
 s_waitcnt vmcnt(2)
Lg_218:
 v_xor_b32 v118,v60,v116
 v_bitop3_b32 v118,v63,v116,v118 bitop3:0xbe
 v_bitop3_b32 v118,v64,v116,v118 bitop3:0xbe
 v_bitop3_b32 v118,v67,v116,v118 bitop3:0xbe
 v_and_b32 v118,0xff,v118
 v_cmp_ne_u32 vcc,0,v118
 s_cbranch_vccz Lgd_219
 s_mov_b64 exec,s[100:101]
 s_add_u32 s52,s50,655360
 buffer_load_dwordx4 v[60:63],v114,s[32:35],s52 offen sc1
 s_mov_b64 exec,s[0:1]
 s_add_u32 s52,s50,675840
 buffer_load_dwordx4 v[64:67],v114,s[32:35],s52 offen sc1
 s_mov_b64 exec,-1
 s_waitcnt vmcnt(0)
 s_sub_u32 s55,s55,1
 s_cbranch_scc0 Lg_218
 s_mov_b32 s55,0
Lgd_219:
 v_pk_add_f32 v[60:61],v[60:61],v[64:65]
 v_pk_add_f32 v[62:63],v[62:63],v[66:67]
 s_nop 0
 v_add_f32_dpp v60,v60,v60 row_ror:8 row_mask:0xf bank_mask:0xf
 v_add_f32_dpp v61,v61,v61 row_ror:8 row_mask:0xf bank_mask:0xf
 v_add_f32_dpp v62,v62,v62 row_ror:8 row_mask:0xf bank_mask:0xf
 v_add_f32_dpp v63,v63,v63 row_ror:8 row_mask:0xf bank_mask:0xf
 v_permlane16_swap_b32 v60,v61
 s_nop 0
 v_permlane16_swap_b32 v62,v63
 v_add_f32 v60,v60,v61
 v_add_f32 v62,v62,v63
 s_nop 1
 v_permlane32_swap_b32 v60,v62
 v_add_f32 v60,v60,v62
 v_mul_f32 v60,s3,v60
 v_mov_b32 v61,v60
 s_nop 1
 v_permlane16_swap_b32 v60,v61
 v_cvt_pk_bf16_f32 v60,v60,v61
 s_mov_b32 exec_lo,0xff
 s_mov_b32 exec_hi,0xff
 s_add_u32 s52,s51,32768
 buffer_store_dword v60,v117,s[32:35],s52 offen sc1
 s_mov_b64 exec,-1
 s_mov_b32 s48,1
 s_waitcnt vmcnt(1)
 s_mov_b64 exec,1
 v_mov_b32 v118,s7
 s_add_u32 s53,s97,16384
 buffer_store_dword v118,off,s[32:35],s53
 s_mov_b64 exec,-1
 s_mov_b32 s48,0
Lp_217:
 s_cmp_eq_u32 s48,0
 s_cbranch_scc1 Lsk_220
 v_mov_b32 v35,s7
 s_add_u32 s53,s97,16384
 s_waitcnt vmcnt(0)
 s_mov_b64 s[82:83],exec
 s_mov_b64 exec,1
 buffer_store_dword v35,off,s[32:35],s53
 s_mov_b64 exec,s[82:83]
Lsk_220:
 s_add_u32 s96,s95,0
 s_and_b32 s96,s96,7
 s_mul_i32 s96,s96,176128
 s_add_u32 s96,s96,s62
 s_add_u32 m0,s54,65536
 s_add_u32 s52,s96,0
 buffer_load_dwordx4 v8,s[20:23],s52 offen lds
 s_add_u32 s96,s96,s60
 s_add_u32 m0,s54,81920
 s_add_u32 s52,s96,0
 buffer_load_dwordx4 v8,s[20:23],s52 offen lds
 s_add_u32 s96,s95,1
 s_and_b32 s96,s96,7
 s_mul_i32 s96,s96,176128
 s_add_u32 s96,s96,s62
 s_add_u32 m0,s54,69632
 s_add_u32 s52,s96,0
 buffer_load_dwordx4 v8,s[20:23],s52 offen lds
 s_add_u32 s96,s96,s60
 s_add_u32 m0,s54,86016
 s_add_u32 s52,s96,0
 buffer_load_dwordx4 v8,s[20:23],s52 offen lds
 s_add_u32 s53,s98,20480
 v_lshlrev_b32 v36,2,v0
Lpoll_221:
 buffer_load_dword v35,v36,s[32:35],s53 offen sc1
 s_waitcnt vmcnt(0)
 v_cmp_ne_u32 vcc,s7,v35
 s_cbranch_vccz Lpd_222
 s_sub_u32 s55,s55,1
 s_cbranch_scc0 Lpoll_221
 s_mov_b32 s55,0
Lpd_222:
 s_add_u32 s96,s59,0
 s_and_b32 s96,s96,7
 s_mul_i32 s96,s96,2176
 s_add_u32 s52,s96,1409024
 buffer_load_dwordx4 v[136:139],v253,s[32:35],s52 offen sc1
 s_add_u32 s96,s59,1
 s_and_b32 s96,s96,7
 s_mul_i32 s96,s96,2176
 s_add_u32 s52,s96,1409024
 buffer_load_dwordx4 v[140:143],v253,s[32:35],s52 offen sc1
 s_add_u32 s96,s59,2
 s_and_b32 s96,s96,7
 s_mul_i32 s96,s96,2176
 s_add_u32 s52,s96,1409024
 buffer_load_dwordx4 v[144:147],v253,s[32:35],s52 offen sc1
 s_add_u32 s96,s59,3
 s_and_b32 s96,s96,7
 s_mul_i32 s96,s96,2176
 s_add_u32 s52,s96,1409024
 buffer_load_dwordx4 v[148:151],v253,s[32:35],s52 offen sc1
 s_add_u32 s96,s59,4
 s_and_b32 s96,s96,7
 s_mul_i32 s96,s96,2176
 s_add_u32 s52,s96,1409024
 buffer_load_dwordx4 v[152:155],v253,s[32:35],s52 offen sc1
 s_add_u32 s96,s59,5
 s_and_b32 s96,s96,7
 s_mul_i32 s96,s96,2176
 s_add_u32 s52,s96,1409024
 buffer_load_dwordx4 v[156:159],v253,s[32:35],s52 offen sc1
 s_add_u32 s96,s59,6
 s_and_b32 s96,s96,7
 s_mul_i32 s96,s96,2176
 s_add_u32 s52,s96,1409024
 buffer_load_dwordx4 v[160:163],v253,s[32:35],s52 offen sc1
 s_add_u32 s96,s59,7
 s_and_b32 s96,s96,7
 s_mul_i32 s96,s96,2176
 s_add_u32 s52,s96,1409024
 buffer_load_dwordx4 v[164:167],v253,s[32:35],s52 offen sc1
 s_add_u32 s96,s59,0
 s_and_b32 s96,s96,7
 s_mul_i32 s96,s96,4096
 s_add_u32 s96,s96,s71
 s_add_u32 s52,s96,0
 buffer_load_dwordx4 v[168:171],v1,s[32:35],s52 offen sc1
 s_add_u32 s96,s59,1
 s_and_b32 s96,s96,7
 s_mul_i32 s96,s96,4096
 s_add_u32 s96,s96,s71
 s_add_u32 s52,s96,0
 buffer_load_dwordx4 v[172:175],v1,s[32:35],s52 offen sc1
 s_add_u32 s96,s59,2
 s_and_b32 s96,s96,7
 s_mul_i32 s96,s96,4096
 s_add_u32 s96,s96,s71
 s_add_u32 s52,s96,0
 buffer_load_dwordx4 v[176:179],v1,s[32:35],s52 offen sc1
 s_add_u32 s96,s59,3
 s_and_b32 s96,s96,7
 s_mul_i32 s96,s96,4096
 s_add_u32 s96,s96,s71
 s_add_u32 s52,s96,0
 buffer_load_dwordx4 v[180:183],v1,s[32:35],s52 offen sc1
 s_add_u32 s96,s59,4
 s_and_b32 s96,s96,7
 s_mul_i32 s96,s96,4096
 s_add_u32 s96,s96,s71
 s_add_u32 s52,s96,0
 buffer_load_dwordx4 v[184:187],v1,s[32:35],s52 offen sc1
 s_add_u32 s96,s59,5
 s_and_b32 s96,s96,7
 s_mul_i32 s96,s96,4096
 s_add_u32 s96,s96,s71
 s_add_u32 s52,s96,0
 buffer_load_dwordx4 v[188:191],v1,s[32:35],s52 offen sc1
 s_add_u32 s96,s59,6
 s_and_b32 s96,s96,7
 s_mul_i32 s96,s96,4096
 s_add_u32 s96,s96,s71
 s_add_u32 s52,s96,0
 buffer_load_dwordx4 v[192:195],v1,s[32:35],s52 offen sc1
 s_add_u32 s96,s59,7
 s_and_b32 s96,s96,7
 s_mul_i32 s96,s96,4096
 s_add_u32 s96,s96,s71
 s_add_u32 s52,s96,0
 buffer_load_dwordx4 v[196:199],v1,s[32:35],s52 offen sc1
 s_add_u32 s96,s59,0
 s_and_b32 s96,s96,7
 s_mul_i32 s96,s96,4096
 s_add_u32 s96,s96,s71
 s_add_u32 s52,s96,32768
 buffer_load_dwordx4 v[200:203],v1,s[32:35],s52 offen sc1
 s_add_u32 s96,s59,1
 s_and_b32 s96,s96,7
 s_mul_i32 s96,s96,4096
 s_add_u32 s96,s96,s71
 s_add_u32 s52,s96,32768
 buffer_load_dwordx4 v[204:207],v1,s[32:35],s52 offen sc1
 s_add_u32 s96,s59,2
 s_and_b32 s96,s96,7
 s_mul_i32 s96,s96,4096
 s_add_u32 s96,s96,s71
 s_add_u32 s52,s96,32768
 buffer_load_dwordx4 v[208:211],v1,s[32:35],s52 offen sc1
 s_add_u32 s96,s59,3
 s_and_b32 s96,s96,7
 s_mul_i32 s96,s96,4096
 s_add_u32 s96,s96,s71
 s_add_u32 s52,s96,32768
 buffer_load_dwordx4 v[212:215],v1,s[32:35],s52 offen sc1
 s_add_u32 s96,s59,4
 s_and_b32 s96,s96,7
 s_mul_i32 s96,s96,4096
 s_add_u32 s96,s96,s71
 s_add_u32 s52,s96,32768
 buffer_load_dwordx4 v[216:219],v1,s[32:35],s52 offen sc1
 s_add_u32 s96,s59,5
 s_and_b32 s96,s96,7
 s_mul_i32 s96,s96,4096
 s_add_u32 s96,s96,s71
 s_add_u32 s52,s96,32768
 buffer_load_dwordx4 v[220:223],v1,s[32:35],s52 offen sc1
 s_add_u32 s96,s59,6
 s_and_b32 s96,s96,7
 s_mul_i32 s96,s96,4096
 s_add_u32 s96,s96,s71
 s_add_u32 s52,s96,32768
 buffer_load_dwordx4 v[224:227],v1,s[32:35],s52 offen sc1
 s_add_u32 s96,s59,7
 s_and_b32 s96,s96,7
 s_mul_i32 s96,s96,4096
 s_add_u32 s96,s96,s71
 s_add_u32 s52,s96,32768
 buffer_load_dwordx4 v[228:231],v1,s[32:35],s52 offen sc1
Lk_223:
 s_waitcnt vmcnt(23)
 v_max_u32 v37,v136,v137
 v_max3_u32 v37,v138,v139,v37
 s_waitcnt vmcnt(22)
 v_max3_u32 v37,v140,v141,v37
 v_max3_u32 v37,v142,v143,v37
 s_waitcnt vmcnt(21)
 v_max3_u32 v37,v144,v145,v37
 v_max3_u32 v37,v146,v147,v37
 s_waitcnt vmcnt(20)
 v_max3_u32 v37,v148,v149,v37
 v_max3_u32 v37,v150,v151,v37
 s_waitcnt vmcnt(19)
 v_max3_u32 v37,v152,v153,v37
 v_max3_u32 v37,v154,v155,v37
 s_waitcnt vmcnt(18)
 v_max3_u32 v37,v156,v157,v37
 v_max3_u32 v37,v158,v159,v37
 s_waitcnt vmcnt(17)
 v_max3_u32 v37,v160,v161,v37
 v_max3_u32 v37,v162,v163,v37
 s_waitcnt vmcnt(16)
 v_max3_u32 v37,v164,v165,v37
 v_max3_u32 v37,v166,v167,v37
 v_cmp_eq_u32 vcc,-1,v37
 s_cbranch_vccz Lkd_224
 s_add_u32 s96,s59,0
 s_and_b32 s96,s96,7
 s_mul_i32 s96,s96,2176
 s_add_u32 s52,s96,1409024
 buffer_load_dwordx4 v[136:139],v253,s[32:35],s52 offen sc1
 s_add_u32 s96,s59,1
 s_and_b32 s96,s96,7
 s_mul_i32 s96,s96,2176
 s_add_u32 s52,s96,1409024
 buffer_load_dwordx4 v[140:143],v253,s[32:35],s52 offen sc1
 s_add_u32 s96,s59,2
 s_and_b32 s96,s96,7
 s_mul_i32 s96,s96,2176
 s_add_u32 s52,s96,1409024
 buffer_load_dwordx4 v[144:147],v253,s[32:35],s52 offen sc1
 s_add_u32 s96,s59,3
 s_and_b32 s96,s96,7
 s_mul_i32 s96,s96,2176
 s_add_u32 s52,s96,1409024
 buffer_load_dwordx4 v[148:151],v253,s[32:35],s52 offen sc1
 s_add_u32 s96,s59,4
 s_and_b32 s96,s96,7
 s_mul_i32 s96,s96,2176
 s_add_u32 s52,s96,1409024
 buffer_load_dwordx4 v[152:155],v253,s[32:35],s52 offen sc1
 s_add_u32 s96,s59,5
 s_and_b32 s96,s96,7
 s_mul_i32 s96,s96,2176
 s_add_u32 s52,s96,1409024
 buffer_load_dwordx4 v[156:159],v253,s[32:35],s52 offen sc1
 s_add_u32 s96,s59,6
 s_and_b32 s96,s96,7
 s_mul_i32 s96,s96,2176
 s_add_u32 s52,s96,1409024
 buffer_load_dwordx4 v[160:163],v253,s[32:35],s52 offen sc1
 s_add_u32 s96,s59,7
 s_and_b32 s96,s96,7
 s_mul_i32 s96,s96,2176
 s_add_u32 s52,s96,1409024
 buffer_load_dwordx4 v[164:167],v253,s[32:35],s52 offen sc1
 s_waitcnt vmcnt(0)
 s_sub_u32 s55,s55,1
 s_cbranch_scc0 Lk_223
 s_mov_b32 s55,0
Lkd_224:
 s_waitcnt vmcnt(15)
 v_mfma_f32_32x32x16_bf16 v[56:71],v[136:139],v[168:171],0
 s_waitcnt vmcnt(14)
 v_mfma_f32_32x32x16_bf16 v[72:87],v[140:143],v[172:175],0
 s_add_u32 s96,s95,2
 s_and_b32 s96,s96,7
 s_mul_i32 s96,s96,176128
 s_add_u32 s96,s96,s62
 s_add_u32 m0,s54,73728
 s_add_u32 s52,s96,0
 buffer_load_dwordx4 v8,s[20:23],s52 offen lds
 s_add_u32 s96,s96,s60
 s_add_u32 m0,s54,90112
 s_add_u32 s52,s96,0
 buffer_load_dwordx4 v8,s[20:23],s52 offen lds
 s_add_u32 s96,s95,3
 s_and_b32 s96,s96,7
 s_mul_i32 s96,s96,176128
 s_add_u32 s96,s96,s62
 s_add_u32 m0,s54,77824
 s_add_u32 s52,s96,0
 buffer_load_dwordx4 v8,s[20:23],s52 offen lds
 s_add_u32 s96,s96,s60
 s_add_u32 m0,s54,94208
 s_add_u32 s52,s96,0
 buffer_load_dwordx4 v8,s[20:23],s52 offen lds
 v_add_f32 v64,s76,v64
 v_rcp_f32 v64,v64
 s_nop 0
 v_mul_f32 v56,v56,v64
 v_mul_f32 v57,v57,v64
 v_mul_f32 v58,v58,v64
 v_mul_f32 v59,v59,v64
 v_mul_f32 v60,v60,v64
 v_mul_f32 v61,v61,v64
 v_mul_f32 v62,v62,v64
 v_mul_f32 v63,v63,v64
 v_cvt_pk_bf16_f32 v168,v56,v57
 v_cvt_pk_bf16_f32 v169,v58,v59
 v_cvt_pk_bf16_f32 v170,v60,v61
 v_cvt_pk_bf16_f32 v171,v62,v63
 s_waitcnt vmcnt(17)
 v_mfma_f32_32x32x16_bf16 v[40:55],v[144:147],v[176:179],0
 v_add_f32 v80,s76,v80
 v_rcp_f32 v80,v80
 s_add_u32 s96,s95,0
 s_and_b32 s96,s96,7
 s_mul_i32 s96,s96,176128
 s_add_u32 s96,s96,s63
 s_add_u32 m0,s54,131072
 s_add_u32 s52,s96,0
 buffer_load_dwordx4 v8,s[20:23],s52 offen lds
 v_mul_f32 v72,v72,v80
 v_mul_f32 v73,v73,v80
 v_mul_f32 v74,v74,v80
 v_mul_f32 v75,v75,v80
 v_mul_f32 v76,v76,v80
 v_mul_f32 v77,v77,v80
 v_mfma_f32_32x32x16_bf16 v[88:103],a[176:179],v[168:171],0
 v_mul_f32 v78,v78,v80
 v_mul_f32 v79,v79,v80
 v_cvt_pk_bf16_f32 v172,v72,v73
 v_cvt_pk_bf16_f32 v173,v74,v75
 v_cvt_pk_bf16_f32 v174,v76,v77
 v_cvt_pk_bf16_f32 v175,v78,v79
 s_waitcnt vmcnt(17)
 v_mfma_f32_32x32x16_bf16 v[56:71],v[148:151],v[180:183],0
 v_add_f32 v48,s76,v48
 v_rcp_f32 v48,v48
 s_nop 0
 v_mul_f32 v40,v40,v48
 v_mul_f32 v41,v41,v48
 v_mul_f32 v42,v42,v48
 v_mul_f32 v43,v43,v48
 v_mul_f32 v44,v44,v48
 v_mul_f32 v45,v45,v48
 v_mfma_f32_32x32x16_bf16 v[88:103],a[184:187],v[172:175],v[88:103]
 v_mul_f32 v46,v46,v48
 v_mul_f32 v47,v47,v48
 v_cvt_pk_bf16_f32 v176,v40,v41
 v_cvt_pk_bf16_f32 v177,v42,v43
 v_cvt_pk_bf16_f32 v178,v44,v45
 v_cvt_pk_bf16_f32 v179,v46,v47
 s_waitcnt vmcnt(16)
 v_mfma_f32_32x32x16_bf16 v[72:87],v[152:155],v[184:187],0
 v_add_f32 v64,s76,v64
 v_rcp_f32 v64,v64
 s_add_u32 s96,s95,1
 s_and_b32 s96,s96,7
 s_mul_i32 s96,s96,176128
 s_add_u32 s96,s96,s63
 s_add_u32 m0,s54,135168
 s_add_u32 s52,s96,0
 buffer_load_dwordx4 v8,s[20:23],s52 offen lds
 v_mul_f32 v56,v56,v64
 v_mul_f32 v57,v57,v64
 v_mul_f32 v58,v58,v64
 v_mul_f32 v59,v59,v64
 v_mul_f32 v60,v60,v64
 v_mul_f32 v61,v61,v64
 v_mfma_f32_32x32x16_bf16 v[88:103],a[192:195],v[176:179],v[88:103]
 v_mul_f32 v62,v62,v64
 v_mul_f32 v63,v63,v64
 v_cvt_pk_bf16_f32 v180,v56,v57
 v_cvt_pk_bf16_f32 v181,v58,v59
 v_cvt_pk_bf16_f32 v182,v60,v61
 v_cvt_pk_bf16_f32 v183,v62,v63
 s_waitcnt vmcnt(16)
 v_mfma_f32_32x32x16_bf16 v[40:55],v[156:159],v[188:191],0
 v_add_f32 v80,s76,v80
 v_rcp_f32 v80,v80
 s_nop 0
 v_mul_f32 v72,v72,v80
 v_mul_f32 v73,v73,v80
 v_mul_f32 v74,v74,v80
 v_mul_f32 v75,v75,v80
 v_mul_f32 v76,v76,v80
 v_mul_f32 v77,v77,v80
 v_mfma_f32_32x32x16_bf16 v[88:103],a[200:203],v[180:183],v[88:103]
 v_mul_f32 v78,v78,v80
 v_mul_f32 v79,v79,v80
 v_cvt_pk_bf16_f32 v184,v72,v73
 v_cvt_pk_bf16_f32 v185,v74,v75
 v_cvt_pk_bf16_f32 v186,v76,v77
 v_cvt_pk_bf16_f32 v187,v78,v79
 s_waitcnt vmcnt(15)
 v_mfma_f32_32x32x16_bf16 v[56:71],v[160:163],v[192:195],0
 v_add_f32 v48,s76,v48
 v_rcp_f32 v48,v48
 s_add_u32 s96,s95,2
 s_and_b32 s96,s96,7
 s_mul_i32 s96,s96,176128
 s_add_u32 s96,s96,s63
 s_add_u32 m0,s54,139264
 s_add_u32 s52,s96,0
 buffer_load_dwordx4 v8,s[20:23],s52 offen lds
 v_mul_f32 v40,v40,v48
 v_mul_f32 v41,v41,v48
 v_mul_f32 v42,v42,v48
 v_mul_f32 v43,v43,v48
 v_mul_f32 v44,v44,v48
 v_mul_f32 v45,v45,v48
 v_mfma_f32_32x32x16_bf16 v[88:103],a[208:211],v[184:187],v[88:103]
 v_mul_f32 v46,v46,v48
 v_mul_f32 v47,v47,v48
 v_cvt_pk_bf16_f32 v188,v40,v41
 v_cvt_pk_bf16_f32 v189,v42,v43
 v_cvt_pk_bf16_f32 v190,v44,v45
 v_cvt_pk_bf16_f32 v191,v46,v47
 s_waitcnt vmcnt(15)
 v_mfma_f32_32x32x16_bf16 v[72:87],v[164:167],v[196:199],0
 v_add_f32 v64,s76,v64
 v_rcp_f32 v64,v64
 s_nop 0
 v_mul_f32 v56,v56,v64
 v_mul_f32 v57,v57,v64
 v_mul_f32 v58,v58,v64
 v_mul_f32 v59,v59,v64
 v_mul_f32 v60,v60,v64
 v_mul_f32 v61,v61,v64
 v_mfma_f32_32x32x16_bf16 v[88:103],a[216:219],v[188:191],v[88:103]
 v_mul_f32 v62,v62,v64
 v_mul_f32 v63,v63,v64
 v_cvt_pk_bf16_f32 v192,v56,v57
 v_cvt_pk_bf16_f32 v193,v58,v59
 v_cvt_pk_bf16_f32 v194,v60,v61
 v_cvt_pk_bf16_f32 v195,v62,v63
 s_waitcnt vmcnt(14)
 v_mfma_f32_32x32x16_bf16 v[40:55],v[136:139],v[200:203],0
 v_add_f32 v80,s76,v80
 v_rcp_f32 v80,v80
 s_add_u32 s96,s95,3
 s_and_b32 s96,s96,7
 s_mul_i32 s96,s96,176128
 s_add_u32 s96,s96,s63
 s_add_u32 m0,s54,143360
 s_add_u32 s52,s96,0
 buffer_load_dwordx4 v8,s[20:23],s52 offen lds
 v_mul_f32 v72,v72,v80
 v_mul_f32 v73,v73,v80
 v_mul_f32 v74,v74,v80
 v_mul_f32 v75,v75,v80
 v_mul_f32 v76,v76,v80
 v_mul_f32 v77,v77,v80
 v_mfma_f32_32x32x16_bf16 v[88:103],a[224:227],v[192:195],v[88:103]
 v_mul_f32 v78,v78,v80
 v_mul_f32 v79,v79,v80
 v_cvt_pk_bf16_f32 v196,v72,v73
 v_cvt_pk_bf16_f32 v197,v74,v75
 v_cvt_pk_bf16_f32 v198,v76,v77
 v_cvt_pk_bf16_f32 v199,v78,v79
 s_waitcnt vmcnt(14)
 v_mfma_f32_32x32x16_bf16 v[56:71],v[140:143],v[204:207],0
 v_add_f32 v48,s76,v48
 v_rcp_f32 v48,v48
 s_nop 0
 v_mul_f32 v40,v40,v48
 v_mul_f32 v41,v41,v48
 v_mul_f32 v42,v42,v48
 v_mul_f32 v43,v43,v48
 v_mul_f32 v44,v44,v48
 v_mul_f32 v45,v45,v48
 v_mfma_f32_32x32x16_bf16 v[88:103],a[232:235],v[196:199],v[88:103]
 v_mul_f32 v46,v46,v48
 v_mul_f32 v47,v47,v48
 v_cvt_pk_bf16_f32 v200,v40,v41
 v_cvt_pk_bf16_f32 v201,v42,v43
 v_cvt_pk_bf16_f32 v202,v44,v45
 v_cvt_pk_bf16_f32 v203,v46,v47
 s_waitcnt vmcnt(13)
 v_mfma_f32_32x32x16_bf16 v[72:87],v[144:147],v[208:211],0
 v_add_f32 v64,s76,v64
 v_rcp_f32 v64,v64
 s_add_u32 s96,s95,4
 s_and_b32 s96,s96,7
 s_mul_i32 s96,s96,176128
 s_add_u32 s96,s96,s63
 s_add_u32 m0,s54,147456
 s_add_u32 s52,s96,0
 buffer_load_dwordx4 v8,s[20:23],s52 offen lds
 v_mul_f32 v56,v56,v64
 v_mul_f32 v57,v57,v64
 v_mul_f32 v58,v58,v64
 v_mul_f32 v59,v59,v64
 v_mul_f32 v60,v60,v64
 v_mul_f32 v61,v61,v64
 v_mfma_f32_32x32x16_bf16 v[104:119],a[176:179],v[200:203],0
 v_mul_f32 v62,v62,v64
 v_mul_f32 v63,v63,v64
 v_cvt_pk_bf16_f32 v204,v56,v57
 v_cvt_pk_bf16_f32 v205,v58,v59
 v_cvt_pk_bf16_f32 v206,v60,v61
 v_cvt_pk_bf16_f32 v207,v62,v63
 s_waitcnt vmcnt(13)
 v_mfma_f32_32x32x16_bf16 v[40:55],v[148:151],v[212:215],0
 v_add_f32 v80,s76,v80
 v_rcp_f32 v80,v80
 s_nop 0
 v_mul_f32 v72,v72,v80
 v_mul_f32 v73,v73,v80
 v_mul_f32 v74,v74,v80
 v_mul_f32 v75,v75,v80
 v_mul_f32 v76,v76,v80
 v_mul_f32 v77,v77,v80
 v_mfma_f32_32x32x16_bf16 v[104:119],a[184:187],v[204:207],v[104:119]
 v_mul_f32 v78,v78,v80
 v_mul_f32 v79,v79,v80
 v_cvt_pk_bf16_f32 v208,v72,v73
 v_cvt_pk_bf16_f32 v209,v74,v75
 v_cvt_pk_bf16_f32 v210,v76,v77
 v_cvt_pk_bf16_f32 v211,v78,v79
 s_waitcnt vmcnt(12)
 v_mfma_f32_32x32x16_bf16 v[56:71],v[152:155],v[216:219],0
 v_add_f32 v48,s76,v48
 v_rcp_f32 v48,v48
 s_add_u32 s96,s95,5
 s_and_b32 s96,s96,7
 s_mul_i32 s96,s96,176128
 s_add_u32 s96,s96,s63
 s_add_u32 m0,s54,151552
 s_add_u32 s52,s96,0
 buffer_load_dwordx4 v8,s[20:23],s52 offen lds
 v_mul_f32 v40,v40,v48
 v_mul_f32 v41,v41,v48
 v_mul_f32 v42,v42,v48
 v_mul_f32 v43,v43,v48
 v_mul_f32 v44,v44,v48
 v_mul_f32 v45,v45,v48
 v_mfma_f32_32x32x16_bf16 v[104:119],a[192:195],v[208:211],v[104:119]
 v_mul_f32 v46,v46,v48
 v_mul_f32 v47,v47,v48
 v_cvt_pk_bf16_f32 v212,v40,v41
 v_cvt_pk_bf16_f32 v213,v42,v43
 v_cvt_pk_bf16_f32 v214,v44,v45
 v_cvt_pk_bf16_f32 v215,v46,v47
 s_waitcnt vmcnt(12)
 v_mfma_f32_32x32x16_bf16 v[72:87],v[156:159],v[220:223],0
 v_add_f32 v64,s76,v64
 v_rcp_f32 v64,v64
 s_nop 0
 v_mul_f32 v56,v56,v64
 v_mul_f32 v57,v57,v64
 v_mul_f32 v58,v58,v64
 v_mul_f32 v59,v59,v64
 v_mul_f32 v60,v60,v64
 v_mul_f32 v61,v61,v64
 v_mfma_f32_32x32x16_bf16 v[104:119],a[200:203],v[212:215],v[104:119]
 v_mul_f32 v62,v62,v64
 v_mul_f32 v63,v63,v64
 v_cvt_pk_bf16_f32 v216,v56,v57
 v_cvt_pk_bf16_f32 v217,v58,v59
 v_cvt_pk_bf16_f32 v218,v60,v61
 v_cvt_pk_bf16_f32 v219,v62,v63
 s_waitcnt vmcnt(11)
 v_mfma_f32_32x32x16_bf16 v[40:55],v[160:163],v[224:227],0
 v_add_f32 v80,s76,v80
 v_rcp_f32 v80,v80
 s_add_u32 s96,s95,6
 s_and_b32 s96,s96,7
 s_mul_i32 s96,s96,176128
 s_add_u32 s96,s96,s63
 s_add_u32 m0,s54,155648
 s_add_u32 s52,s96,0
 buffer_load_dwordx4 v8,s[20:23],s52 offen lds
 v_mul_f32 v72,v72,v80
 v_mul_f32 v73,v73,v80
 v_mul_f32 v74,v74,v80
 v_mul_f32 v75,v75,v80
 v_mul_f32 v76,v76,v80
 v_mul_f32 v77,v77,v80
 v_mfma_f32_32x32x16_bf16 v[104:119],a[208:211],v[216:219],v[104:119]
 v_mul_f32 v78,v78,v80
 v_mul_f32 v79,v79,v80
 v_cvt_pk_bf16_f32 v220,v72,v73
 v_cvt_pk_bf16_f32 v221,v74,v75
 v_cvt_pk_bf16_f32 v222,v76,v77
 v_cvt_pk_bf16_f32 v223,v78,v79
 s_waitcnt vmcnt(11)
 v_mfma_f32_32x32x16_bf16 v[56:71],v[164:167],v[228:231],0
 v_add_f32 v48,s76,v48
 v_rcp_f32 v48,v48
 s_nop 0
 v_mul_f32 v40,v40,v48
 v_mul_f32 v41,v41,v48
 v_mul_f32 v42,v42,v48
 v_mul_f32 v43,v43,v48
 v_mul_f32 v44,v44,v48
 v_mul_f32 v45,v45,v48
 v_mfma_f32_32x32x16_bf16 v[104:119],a[216:219],v[220:223],v[104:119]
 v_mul_f32 v46,v46,v48
 v_mul_f32 v47,v47,v48
 v_cvt_pk_bf16_f32 v224,v40,v41
 v_cvt_pk_bf16_f32 v225,v42,v43
 v_cvt_pk_bf16_f32 v226,v44,v45
 v_cvt_pk_bf16_f32 v227,v46,v47
 v_add_f32 v64,s76,v64
 v_rcp_f32 v64,v64
 s_add_u32 s96,s95,7
 s_and_b32 s96,s96,7
 s_mul_i32 s96,s96,176128
 s_add_u32 s96,s96,s63
 s_add_u32 m0,s54,159744
 s_add_u32 s52,s96,0
 buffer_load_dwordx4 v8,s[20:23],s52 offen lds
 v_mul_f32 v56,v56,v64
 v_mul_f32 v57,v57,v64
 v_mul_f32 v58,v58,v64
 v_mul_f32 v59,v59,v64
 v_mul_f32 v60,v60,v64
 v_mul_f32 v61,v61,v64
 v_mfma_f32_32x32x16_bf16 v[104:119],a[224:227],v[224:227],v[104:119]
 v_mul_f32 v62,v62,v64
 v_mul_f32 v63,v63,v64
 v_cvt_pk_bf16_f32 v228,v56,v57
 v_cvt_pk_bf16_f32 v229,v58,v59
 v_cvt_pk_bf16_f32 v230,v60,v61
 v_cvt_pk_bf16_f32 v231,v62,v63
 s_nop 1
 v_mfma_f32_32x32x16_bf16 v[104:119],a[232:235],v[228:231],v[104:119]
 v_mfma_f32_32x32x16_bf16 v[120:135],a[180:183],v[168:171],0
 ds_write_b128 v18,v[88:91] offset:0
 v_accvgpr_read_b32 v41,a240
 v_accvgpr_read_b32 v43,a241
 v_accvgpr_read_b32 v45,a242
 v_mfma_f32_32x32x16_bf16 v[120:135],a[188:191],v[172:175],v[120:135]
 v_accvgpr_read_b32 v47,a243
 v_lshlrev_b32 v40,16,v41
 v_and_b32 v41,0xffff0000,v41
 v_mfma_f32_32x32x16_bf16 v[120:135],a[196:199],v[176:179],v[120:135]
 ds_write_b128 v18,v[92:95] offset:1024
 v_lshlrev_b32 v42,16,v43
 v_and_b32 v43,0xffff0000,v43
 v_lshlrev_b32 v44,16,v45
 v_mfma_f32_32x32x16_bf16 v[120:135],a[204:207],v[180:183],v[120:135]
 ds_write_b128 v18,v[96:99] offset:2048
 v_and_b32 v45,0xffff0000,v45
 v_lshlrev_b32 v46,16,v47
 v_and_b32 v47,0xffff0000,v47
 v_mfma_f32_32x32x16_bf16 v[120:135],a[212:215],v[184:187],v[120:135]
 v_accvgpr_read_b32 v49,a244
 v_accvgpr_read_b32 v51,a245
 v_accvgpr_read_b32 v53,a246
 v_mfma_f32_32x32x16_bf16 v[120:135],a[220:223],v[188:191],v[120:135]
 ds_write_b128 v18,v[100:103] offset:3072
 v_accvgpr_read_b32 v55,a247
 v_lshlrev_b32 v48,16,v49
 v_and_b32 v49,0xffff0000,v49
 v_mfma_f32_32x32x16_bf16 v[120:135],a[228:231],v[192:195],v[120:135]
 ds_write_b128 v18,v[104:107] offset:4096
 v_lshlrev_b32 v50,16,v51
 v_and_b32 v51,0xffff0000,v51
 v_lshlrev_b32 v52,16,v53
 v_mfma_f32_32x32x16_bf16 v[120:135],a[236:239],v[196:199],v[120:135]
 v_and_b32 v53,0xffff0000,v53
 v_lshlrev_b32 v54,16,v55
 v_and_b32 v55,0xffff0000,v55
 v_mfma_f32_32x32x16_bf16 v[232:247],a[180:183],v[200:203],0
 ds_write_b128 v18,v[108:111] offset:5120
 v_mfma_f32_32x32x16_bf16 v[232:247],a[188:191],v[204:207],v[232:247]
 v_mfma_f32_32x32x16_bf16 v[232:247],a[196:199],v[208:211],v[232:247]
 ds_write_b128 v18,v[112:115] offset:6144
 v_mfma_f32_32x32x16_bf16 v[232:247],a[204:207],v[212:215],v[232:247]
 ds_write_b128 v18,v[116:119] offset:7168
 v_mfma_f32_32x32x16_bf16 v[232:247],a[212:215],v[216:219],v[232:247]
 s_waitcnt lgkmcnt(0)
 s_barrier
 ds_read_b128 v[56:59],v15 offset:0
 ds_read_b128 v[60:63],v15 offset:1024
 v_mfma_f32_32x32x16_bf16 v[232:247],a[220:223],v[220:223],v[232:247]
 ds_read_b128 v[64:67],v15 offset:8192
 ds_read_b128 v[68:71],v15 offset:9216
 ds_read_b128 v[72:75],v15 offset:16384
 v_mfma_f32_32x32x16_bf16 v[232:247],a[228:231],v[224:227],v[232:247]
 ds_read_b128 v[76:79],v15 offset:17408
 ds_read_b128 v[80:83],v15 offset:24576
 ds_read_b128 v[84:87],v15 offset:25600
 v_mfma_f32_32x32x16_bf16 v[232:247],a[236:239],v[228:231],v[232:247]
 s_waitcnt lgkmcnt(7)
 v_pk_add_f32 v[56:57],v[56:57],v[40:41]
 v_pk_add_f32 v[58:59],v[58:59],v[42:43]
 s_waitcnt lgkmcnt(6)
 v_pk_add_f32 v[60:61],v[60:61],v[44:45]
 v_pk_add_f32 v[62:63],v[62:63],v[46:47]
 s_waitcnt lgkmcnt(5)
 v_pk_add_f32 v[56:57],v[56:57],v[64:65]
 v_pk_add_f32 v[58:59],v[58:59],v[66:67]
 s_waitcnt lgkmcnt(4)
 v_pk_add_f32 v[60:61],v[60:61],v[68:69]
 v_pk_add_f32 v[62:63],v[62:63],v[70:71]
 s_waitcnt lgkmcnt(1)
 v_pk_add_f32 v[72:73],v[72:73],v[80:81]
 v_pk_add_f32 v[74:75],v[74:75],v[82:83]
 s_waitcnt lgkmcnt(0)
 v_pk_add_f32 v[76:77],v[76:77],v[84:85]
 v_pk_add_f32 v[78:79],v[78:79],v[86:87]
 s_barrier
 ds_write_b128 v18,v[120:123] offset:0
 v_pk_add_f32 v[56:57],v[56:57],v[72:73]
 v_pk_add_f32 v[58:59],v[58:59],v[74:75]
 v_pk_add_f32 v[60:61],v[60:61],v[76:77]
 v_pk_add_f32 v[62:63],v[62:63],v[78:79]
 ds_write_b128 v18,v[124:127] offset:1024
 v_cvt_pk_bf16_f32 v64,v56,v57
 v_cvt_pk_bf16_f32 v65,v58,v59
 v_cvt_pk_bf16_f32 v66,v60,v61
 v_cvt_pk_bf16_f32 v67,v62,v63
 ds_write_b128 v18,v[128:131] offset:2048
 v_accvgpr_write_b32 a240,v64
 v_or_b32 v64,1,v64
 s_and_b32 s52,s6,1
 s_xor_b32 s52,s52,0
 s_lshl_b32 s52,s52,11
 s_add_u32 s52,s52,s67
 buffer_store_dwordx4 v[64:67],v3,s[32:35],s52 offen
 v_pk_add_f32 v[24:25],v[56:57],v[58:59]
 ds_write_b128 v18,v[132:135] offset:3072
 v_pk_mul_f32 v[26:27],v[56:57],v[56:57]
 v_pk_fma_f32 v[26:27],v[58:59],v[58:59],v[26:27]
 v_pk_add_f32 v[24:25],v[24:25],v[60:61]
 v_pk_fma_f32 v[26:27],v[60:61],v[60:61],v[26:27]
 ds_write_b128 v18,v[232:235] offset:4096
 v_pk_add_f32 v[24:25],v[24:25],v[62:63]
 v_pk_fma_f32 v[26:27],v[62:63],v[62:63],v[26:27]
 v_accvgpr_write_b32 a241,v65
 v_accvgpr_write_b32 a242,v66
 ds_write_b128 v18,v[236:239] offset:5120
 v_accvgpr_write_b32 a243,v67
 ds_write_b128 v18,v[240:243] offset:6144
 ds_write_b128 v18,v[244:247] offset:7168
 s_waitcnt lgkmcnt(0)
 s_barrier
 ds_read_b128 v[56:59],v15 offset:0
 ds_read_b128 v[60:63],v15 offset:1024
 ds_read_b128 v[64:67],v15 offset:8192
 ds_read_b128 v[68:71],v15 offset:9216
 ds_read_b128 v[72:75],v15 offset:16384
 ds_read_b128 v[76:79],v15 offset:17408
 ds_read_b128 v[80:83],v15 offset:24576
 ds_read_b128 v[84:87],v15 offset:25600
 s_add_u32 s52,s56,0
 v_add_u32 v2,s52,v1
 s_waitcnt lgkmcnt(7)
 v_pk_add_f32 v[56:57],v[56:57],v[48:49]
 v_pk_add_f32 v[58:59],v[58:59],v[50:51]
 s_waitcnt lgkmcnt(6)
 v_pk_add_f32 v[60:61],v[60:61],v[52:53]
 v_pk_add_f32 v[62:63],v[62:63],v[54:55]
 s_waitcnt lgkmcnt(5)
 v_pk_add_f32 v[56:57],v[56:57],v[64:65]
 v_pk_add_f32 v[58:59],v[58:59],v[66:67]
 s_waitcnt lgkmcnt(4)
 v_pk_add_f32 v[60:61],v[60:61],v[68:69]
 v_pk_add_f32 v[62:63],v[62:63],v[70:71]
 s_waitcnt lgkmcnt(1)
 v_pk_add_f32 v[72:73],v[72:73],v[80:81]
 v_pk_add_f32 v[74:75],v[74:75],v[82:83]
 s_waitcnt lgkmcnt(0)
 v_pk_add_f32 v[76:77],v[76:77],v[84:85]
 v_pk_add_f32 v[78:79],v[78:79],v[86:87]
 v_pk_add_f32 v[56:57],v[56:57],v[72:73]
 v_pk_add_f32 v[58:59],v[58:59],v[74:75]
 v_pk_add_f32 v[60:61],v[60:61],v[76:77]
 v_pk_add_f32 v[62:63],v[62:63],v[78:79]
 v_cvt_pk_bf16_f32 v64,v56,v57
 v_cvt_pk_bf16_f32 v65,v58,v59
 v_cvt_pk_bf16_f32 v66,v60,v61
 v_cvt_pk_bf16_f32 v67,v62,v63
 v_accvgpr_write_b32 a244,v64
 v_or_b32 v64,1,v64
 s_and_b32 s52,s6,1
 s_xor_b32 s52,s52,1
 s_lshl_b32 s52,s52,11
 s_add_u32 s52,s52,s67
 buffer_store_dwordx4 v[64:67],v3,s[32:35],s52 offen
 v_pk_add_f32 v[24:25],v[24:25],v[56:57]
 v_pk_fma_f32 v[26:27],v[56:57],v[56:57],v[26:27]
 v_pk_add_f32 v[24:25],v[24:25],v[58:59]
 buffer_load_dwordx4 v[136:139],v2,s[32:35],s36 offen sc1
 v_pk_fma_f32 v[26:27],v[58:59],v[58:59],v[26:27]
 v_pk_add_f32 v[24:25],v[24:25],v[60:61]
 v_pk_fma_f32 v[26:27],v[60:61],v[60:61],v[26:27]
 buffer_load_dwordx4 v[140:143],v2,s[32:35],s36 offen offset:1024 sc1
 v_pk_add_f32 v[24:25],v[24:25],v[62:63]
 v_pk_fma_f32 v[26:27],v[62:63],v[62:63],v[26:27]
 v_accvgpr_write_b32 a245,v65
 buffer_load_dwordx4 v[152:155],v2,s[32:35],s37 offen sc1
 v_accvgpr_write_b32 a246,v66
 v_accvgpr_write_b32 a247,v67
 v_add_f32 v24,v24,v25
 buffer_load_dwordx4 v[156:159],v2,s[32:35],s37 offen offset:1024 sc1
 v_add_f32 v26,v26,v27
 v_and_b32 v27,512,v3
 v_add_u32 v27,v27,v3
 buffer_load_dwordx4 v[168:171],v2,s[32:35],s38 offen sc1
 v_permlane16_swap_b32 v24,v26
 v_add_f32 v24,v24,v26
 v_mov_b32 v25,v24
 buffer_load_dwordx4 v[172:175],v2,s[32:35],s38 offen offset:1024 sc1
 s_nop 0
 v_permlane32_swap_b32 v24,v25
 v_add_f32 v24,v24,v25
 v_or_b32 v24,1,v24
 buffer_load_dwordx4 v[184:187],v2,s[32:35],s39 offen sc1
 s_mov_b32 exec_hi,0
 s_add_u32 s52,s79,262144
 buffer_store_dword v24,v27,s[32:35],s52 offen
 s_mov_b64 exec,-1
 buffer_load_dwordx4 v[188:191],v2,s[32:35],s39 offen offset:1024 sc1
 buffer_load_dwordx4 v[200:203],v2,s[32:35],s40 offen sc1
 buffer_load_dwordx4 v[204:207],v2,s[32:35],s40 offen offset:1024 sc1
 buffer_load_dwordx4 v[216:219],v2,s[32:35],s41 offen sc1
 s_waitcnt vmcnt(14)
 s_barrier
 ds_read_b64_tr_b16 v[40:41],v5 offset:0
 ds_read_b64_tr_b16 v[42:43],v5 offset:512
 ds_read_b64_tr_b16 v[44:45],v5 offset:16384
 ds_read_b64_tr_b16 v[46:47],v5 offset:16896
 ds_read_b64_tr_b16 v[48:49],v5 offset:1024
 ds_read_b64_tr_b16 v[50:51],v5 offset:1536
 ds_read_b64_tr_b16 v[52:53],v5 offset:17408
 ds_read_b64_tr_b16 v[54:55],v5 offset:17920
 s_waitcnt vmcnt(10)
 v_bitop3_b32 v38,v136,v140,1 bitop3:0x80
 v_cmp_eq_u32 vcc,0,v38
 s_cbranch_vccnz Lfix_226
Lret_227:
 s_waitcnt lgkmcnt(4)
 v_mfma_f32_32x32x16_bf16 v[88:103],v[40:43],v[136:139],0
 ds_read_b64_tr_b16 v[40:41],v5 offset:4096
 ds_read_b64_tr_b16 v[42:43],v5 offset:4608
 buffer_load_dwordx4 v[220:223],v2,s[32:35],s41 offen offset:1024 sc1
 v_mov_b32 v26,0
 v_mfma_f32_32x32x16_bf16 v[104:119],v[44:47],v[136:139],0
 ds_read_b64_tr_b16 v[44:45],v5 offset:20480
 ds_read_b64_tr_b16 v[46:47],v5 offset:20992
 v_mov_b32 v27,0
 s_waitcnt vmcnt(9) lgkmcnt(4)
 v_mfma_f32_32x32x16_bf16 v[88:103],v[48:51],v[140:143],v[88:103]
 ds_read_b64_tr_b16 v[48:49],v5 offset:5120
 ds_read_b64_tr_b16 v[50:51],v5 offset:5632
 buffer_load_dwordx4 v[232:235],v2,s[32:35],s42 offen sc1
 v_bitop3_b32 v38,v152,v156,1 bitop3:0x80
 v_cmp_eq_u32 vcc,0,v38
 v_mfma_f32_32x32x16_bf16 v[104:119],v[52:55],v[140:143],v[104:119]
 ds_read_b64_tr_b16 v[52:53],v5 offset:21504
 ds_read_b64_tr_b16 v[54:55],v5 offset:22016
 v_mov_b32 v30,0
 s_cbranch_vccnz Lfix_229
Lret_230:
 s_waitcnt lgkmcnt(4)
 v_mfma_f32_32x32x16_bf16 v[88:103],v[40:43],v[152:155],v[88:103]
 ds_read_b64_tr_b16 v[40:41],v5 offset:8192
 ds_read_b64_tr_b16 v[42:43],v5 offset:8704
 buffer_load_dwordx4 v[236:239],v2,s[32:35],s42 offen offset:1024 sc1
 v_mov_b32 v31,0
 v_mfma_f32_32x32x16_bf16 v[104:119],v[44:47],v[152:155],v[104:119]
 ds_read_b64_tr_b16 v[44:45],v5 offset:24576
 ds_read_b64_tr_b16 v[46:47],v5 offset:25088
 v_mov_b32 v32,0x3f803f80
 s_waitcnt vmcnt(9) lgkmcnt(4)
 v_mfma_f32_32x32x16_bf16 v[88:103],v[48:51],v[156:159],v[88:103]
 ds_read_b64_tr_b16 v[48:49],v5 offset:9216
 ds_read_b64_tr_b16 v[50:51],v5 offset:9728
 buffer_load_dwordx4 v[248:251],v2,s[32:35],s43 offen sc1
 v_bitop3_b32 v38,v168,v172,1 bitop3:0x80
 v_cmp_eq_u32 vcc,0,v38
 v_mfma_f32_32x32x16_bf16 v[104:119],v[52:55],v[156:159],v[104:119]
 ds_read_b64_tr_b16 v[52:53],v5 offset:25600
 ds_read_b64_tr_b16 v[54:55],v5 offset:26112
 v_mov_b32 v33,0x3f803f80
 s_cbranch_vccnz Lfix_232
Lret_233:
 s_waitcnt lgkmcnt(4)
 v_mfma_f32_32x32x16_bf16 v[88:103],v[40:43],v[168:171],v[88:103]
 ds_read_b64_tr_b16 v[40:41],v5 offset:12288
 ds_read_b64_tr_b16 v[42:43],v5 offset:12800
 buffer_load_dwordx4 v[252:255],v2,s[32:35],s43 offen offset:1024 sc1
 v_and_b32 v35,15,v0
 v_mfma_f32_32x32x16_bf16 v[104:119],v[44:47],v[168:171],v[104:119]
 ds_read_b64_tr_b16 v[44:45],v5 offset:28672
 ds_read_b64_tr_b16 v[46:47],v5 offset:29184
 v_mul_u32_u24 v35,144,v35
 s_waitcnt vmcnt(8) lgkmcnt(4)
 v_mfma_f32_32x32x16_bf16 v[88:103],v[48:51],v[172:175],v[88:103]
 ds_read_b64_tr_b16 v[48:49],v5 offset:13312
 ds_read_b64_tr_b16 v[50:51],v5 offset:13824
 buffer_load_dwordx4 v[144:147],v2,s[32:35],s8 offen sc1
 v_bitop3_b32 v38,v184,v188,1 bitop3:0x80
 v_cmp_eq_u32 vcc,0,v38
 v_mfma_f32_32x32x16_bf16 v[104:119],v[52:55],v[172:175],v[104:119]
 ds_read_b64_tr_b16 v[52:53],v5 offset:29696
 ds_read_b64_tr_b16 v[54:55],v5 offset:30208
 v_lshl_add_u32 v35,v17,5,v35
 s_cbranch_vccnz Lfix_235
Lret_236:
 s_waitcnt lgkmcnt(4)
 v_mfma_f32_32x32x16_bf16 v[88:103],v[40:43],v[184:187],v[88:103]
 ds_read_b64_tr_b16 v[40:41],v5 offset:32768
 ds_read_b64_tr_b16 v[42:43],v5 offset:33280
 buffer_load_dwordx4 v[148:151],v2,s[32:35],s8 offen offset:1024 sc1
 v_bfe_u32 v36,v0,4,1
 v_mfma_f32_32x32x16_bf16 v[104:119],v[44:47],v[184:187],v[104:119]
 ds_read_b64_tr_b16 v[44:45],v5 offset:49152
 ds_read_b64_tr_b16 v[46:47],v5 offset:49664
 v_lshl_add_u32 v35,v36,3,v35
 s_waitcnt vmcnt(8) lgkmcnt(4)
 v_mfma_f32_32x32x16_bf16 v[88:103],v[48:51],v[188:191],v[88:103]
 ds_read_b64_tr_b16 v[48:49],v5 offset:33792
 ds_read_b64_tr_b16 v[50:51],v5 offset:34304
 buffer_load_dwordx4 v[160:163],v2,s[32:35],s9 offen sc1
 v_bitop3_b32 v38,v200,v204,1 bitop3:0x80
 v_cmp_eq_u32 vcc,0,v38
 v_mfma_f32_32x32x16_bf16 v[104:119],v[52:55],v[188:191],v[104:119]
 ds_read_b64_tr_b16 v[52:53],v5 offset:50176
 ds_read_b64_tr_b16 v[54:55],v5 offset:50688
 s_mul_i32 s53,s4,2304
 s_cbranch_vccnz Lfix_238
Lret_239:
 s_waitcnt lgkmcnt(4)
 v_mfma_f32_32x32x16_bf16 v[88:103],v[40:43],v[200:203],v[88:103]
 ds_read_b64_tr_b16 v[40:41],v5 offset:36864
 ds_read_b64_tr_b16 v[42:43],v5 offset:37376
 buffer_load_dwordx4 v[164:167],v2,s[32:35],s9 offen offset:1024 sc1
 s_add_u32 s53,s53,32768
 v_mfma_f32_32x32x16_bf16 v[104:119],v[44:47],v[200:203],v[104:119]
 ds_read_b64_tr_b16 v[44:45],v5 offset:53248
 ds_read_b64_tr_b16 v[46:47],v5 offset:53760
 v_add_u32 v35,s53,v35
 s_waitcnt vmcnt(8) lgkmcnt(4)
 v_mfma_f32_32x32x16_bf16 v[88:103],v[48:51],v[204:207],v[88:103]
 ds_read_b64_tr_b16 v[48:49],v5 offset:37888
 ds_read_b64_tr_b16 v[50:51],v5 offset:38400
 s_add_u32 s84,s58,262144
 buffer_load_dwordx4 v[72:75],v13,s[32:35],s84 offen sc1
 buffer_load_dwordx4 v[76:79],v13,s[32:35],s84 offen offset:512 sc1
 buffer_load_dwordx4 v[176:179],v2,s[32:35],s10 offen sc1
 v_bitop3_b32 v38,v216,v220,1 bitop3:0x80
 v_cmp_eq_u32 vcc,0,v38
 v_mfma_f32_32x32x16_bf16 v[104:119],v[52:55],v[204:207],v[104:119]
 ds_read_b64_tr_b16 v[52:53],v5 offset:54272
 ds_read_b64_tr_b16 v[54:55],v5 offset:54784
 v_lshrrev_b32 v36,3,v0
 s_cbranch_vccnz Lfix_241
Lret_242:
 s_waitcnt lgkmcnt(4)
 v_mfma_f32_32x32x16_bf16 v[88:103],v[40:43],v[216:219],v[88:103]
 ds_read_b64_tr_b16 v[40:41],v5 offset:40960
 ds_read_b64_tr_b16 v[42:43],v5 offset:41472
 buffer_load_dwordx4 v[180:183],v2,s[32:35],s10 offen offset:1024 sc1
 v_mul_u32_u24 v36,144,v36
 v_mfma_f32_32x32x16_bf16 v[104:119],v[44:47],v[216:219],v[104:119]
 ds_read_b64_tr_b16 v[44:45],v5 offset:57344
 ds_read_b64_tr_b16 v[46:47],v5 offset:57856
 v_and_b32 v37,7,v0
 s_waitcnt vmcnt(10) lgkmcnt(4)
 v_mfma_f32_32x32x16_bf16 v[88:103],v[48:51],v[220:223],v[88:103]
 ds_read_b64_tr_b16 v[48:49],v5 offset:41984
 ds_read_b64_tr_b16 v[50:51],v5 offset:42496
 buffer_load_dwordx4 v[192:195],v2,s[32:35],s11 offen sc1
 v_bitop3_b32 v38,v232,v236,1 bitop3:0x80
 v_cmp_eq_u32 vcc,0,v38
 v_mfma_f32_32x32x16_bf16 v[104:119],v[52:55],v[220:223],v[104:119]
 ds_read_b64_tr_b16 v[52:53],v5 offset:58368
 ds_read_b64_tr_b16 v[54:55],v5 offset:58880
 v_lshl_add_u32 v36,v37,4,v36
 s_cbranch_vccnz Lfix_244
Lret_245:
 s_waitcnt lgkmcnt(4)
 v_mfma_f32_32x32x16_bf16 v[88:103],v[40:43],v[232:235],v[88:103]
 ds_read_b64_tr_b16 v[40:41],v5 offset:45056
 ds_read_b64_tr_b16 v[42:43],v5 offset:45568
 buffer_load_dwordx4 v[196:199],v2,s[32:35],s11 offen offset:1024 sc1
 s_mul_i32 s53,s4,1152
 v_mfma_f32_32x32x16_bf16 v[104:119],v[44:47],v[232:235],v[104:119]
 ds_read_b64_tr_b16 v[44:45],v5 offset:61440
 ds_read_b64_tr_b16 v[46:47],v5 offset:61952
 s_add_u32 s53,s53,32768
 s_waitcnt vmcnt(10) lgkmcnt(4)
 v_mfma_f32_32x32x16_bf16 v[88:103],v[48:51],v[236:239],v[88:103]
 ds_read_b64_tr_b16 v[48:49],v5 offset:46080
 ds_read_b64_tr_b16 v[50:51],v5 offset:46592
 buffer_load_dwordx4 v[208:211],v2,s[32:35],s57 offen sc1
 v_bitop3_b32 v38,v248,v252,1 bitop3:0x80
 v_cmp_eq_u32 vcc,0,v38
 v_mfma_f32_32x32x16_bf16 v[104:119],v[52:55],v[236:239],v[104:119]
 ds_read_b64_tr_b16 v[52:53],v5 offset:62464
 ds_read_b64_tr_b16 v[54:55],v5 offset:62976
 v_add_u32 v36,s53,v36
 s_cbranch_vccnz Lfix_247
Lret_248:
 s_waitcnt lgkmcnt(4)
 v_mfma_f32_32x32x16_bf16 v[88:103],v[40:43],v[248:251],v[88:103]
 ds_read_b64_tr_b16 v[40:41],v5 offset:2048
 ds_read_b64_tr_b16 v[42:43],v5 offset:2560
 buffer_load_dwordx4 v[212:215],v2,s[32:35],s57 offen offset:1024 sc1
 ds_write_b64 v35,a[240:241] offset:0
 v_mfma_f32_32x32x16_bf16 v[104:119],v[44:47],v[248:251],v[104:119]
 ds_read_b64_tr_b16 v[44:45],v5 offset:18432
 ds_read_b64_tr_b16 v[46:47],v5 offset:18944
 ds_write_b64 v35,a[242:243] offset:16
 s_waitcnt vmcnt(10) lgkmcnt(6)
 v_mfma_f32_32x32x16_bf16 v[88:103],v[48:51],v[252:255],v[88:103]
 ds_read_b64_tr_b16 v[48:49],v5 offset:3072
 ds_read_b64_tr_b16 v[50:51],v5 offset:3584
 buffer_load_dwordx4 v[224:227],v2,s[32:35],s77 offen sc1
 v_bitop3_b32 v38,v144,v148,1 bitop3:0x80
 v_cmp_eq_u32 vcc,0,v38
 v_mfma_f32_32x32x16_bf16 v[104:119],v[52:55],v[252:255],v[104:119]
 ds_read_b64_tr_b16 v[52:53],v5 offset:19456
 ds_read_b64_tr_b16 v[54:55],v5 offset:19968
 ds_write_b64 v35,a[244:245] offset:64
 s_cbranch_vccnz Lfix_250
Lret_251:
 s_waitcnt lgkmcnt(6)
 v_mfma_f32_32x32x16_bf16 v[88:103],v[40:43],v[144:147],v[88:103]
 ds_read_b64_tr_b16 v[40:41],v5 offset:6144
 ds_read_b64_tr_b16 v[42:43],v5 offset:6656
 buffer_load_dwordx4 v[228:231],v2,s[32:35],s77 offen offset:1024 sc1
 ds_write_b64 v35,a[246:247] offset:80
 v_mfma_f32_32x32x16_bf16 v[104:119],v[44:47],v[144:147],v[104:119]
 ds_read_b64_tr_b16 v[44:45],v5 offset:22528
 ds_read_b64_tr_b16 v[46:47],v5 offset:23040
 s_waitcnt vmcnt(10) lgkmcnt(6)
 v_mfma_f32_32x32x16_bf16 v[88:103],v[48:51],v[148:151],v[88:103]
 ds_read_b64_tr_b16 v[48:49],v5 offset:7168
 ds_read_b64_tr_b16 v[50:51],v5 offset:7680
 buffer_load_dwordx4 v[240:243],v2,s[32:35],s81 offen sc1
 v_bitop3_b32 v38,v160,v164,1 bitop3:0x80
 v_cmp_eq_u32 vcc,0,v38
 v_mfma_f32_32x32x16_bf16 v[104:119],v[52:55],v[148:151],v[104:119]
 ds_read_b64_tr_b16 v[52:53],v5 offset:23552
 ds_read_b64_tr_b16 v[54:55],v5 offset:24064
 s_cbranch_vccnz Lfix_253
Lret_254:
 s_waitcnt lgkmcnt(4)
 v_mfma_f32_32x32x16_bf16 v[88:103],v[40:43],v[160:163],v[88:103]
 ds_read_b64_tr_b16 v[40:41],v5 offset:10240
 ds_read_b64_tr_b16 v[42:43],v5 offset:10752
 buffer_load_dwordx4 v[244:247],v2,s[32:35],s81 offen offset:1024 sc1
 v_mfma_f32_32x32x16_bf16 v[104:119],v[44:47],v[160:163],v[104:119]
 ds_read_b64_tr_b16 v[44:45],v5 offset:26624
 ds_read_b64_tr_b16 v[46:47],v5 offset:27136
 s_waitcnt vmcnt(8) lgkmcnt(4)
 v_mfma_f32_32x32x16_bf16 v[88:103],v[48:51],v[164:167],v[88:103]
 ds_read_b64_tr_b16 v[48:49],v5 offset:11264
 ds_read_b64_tr_b16 v[50:51],v5 offset:11776
 buffer_load_dwordx4 a[248:251],v2,s[32:35],s99 offen sc1
 v_bitop3_b32 v38,v176,v180,1 bitop3:0x80
 v_cmp_eq_u32 vcc,0,v38
 v_mfma_f32_32x32x16_bf16 v[104:119],v[52:55],v[164:167],v[104:119]
 ds_read_b64_tr_b16 v[52:53],v5 offset:27648
 ds_read_b64_tr_b16 v[54:55],v5 offset:28160
 v_and_b32 v38,v72,v73
 v_bitop3_b32 v38,v74,v75,v38 bitop3:0x80
 v_bitop3_b32 v38,v76,v77,v38 bitop3:0x80
 v_bitop3_b32 v38,v78,v79,v38 bitop3:0x80
 v_and_b32 v38,1,v38
 v_cmp_eq_u32 s[82:83],0,v38
 s_nop 0
 s_cmp_lg_u64 s[82:83],0
 s_cbranch_scc1 Lfix_259
Lret_260:
 v_add_f32 v72,v72,v73
 s_cbranch_vccnz Lfix_256
Lret_257:
 s_waitcnt lgkmcnt(4)
 v_mfma_f32_32x32x16_bf16 v[88:103],v[40:43],v[176:179],v[88:103]
 ds_read_b64_tr_b16 v[40:41],v5 offset:14336
 ds_read_b64_tr_b16 v[42:43],v5 offset:14848
 buffer_load_dwordx4 a[252:255],v2,s[32:35],s99 offen offset:1024 sc1
 v_add_f32 v74,v74,v75
 v_add_f32 v76,v76,v77
 v_mfma_f32_32x32x16_bf16 v[104:119],v[44:47],v[176:179],v[104:119]
 ds_read_b64_tr_b16 v[44:45],v5 offset:30720
 ds_read_b64_tr_b16 v[46:47],v5 offset:31232
 v_add_f32 v78,v78,v79
 v_add_f32 v72,v72,v74
 s_waitcnt vmcnt(8) lgkmcnt(4)
 v_mfma_f32_32x32x16_bf16 v[88:103],v[48:51],v[180:183],v[88:103]
 ds_read_b64_tr_b16 v[48:49],v5 offset:15360
 ds_read_b64_tr_b16 v[50:51],v5 offset:15872
 v_bitop3_b32 v38,v192,v196,1 bitop3:0x80
 v_cmp_eq_u32 vcc,0,v38
 v_mfma_f32_32x32x16_bf16 v[104:119],v[52:55],v[180:183],v[104:119]
 ds_read_b64_tr_b16 v[52:53],v5 offset:31744
 ds_read_b64_tr_b16 v[54:55],v5 offset:32256
 v_add_f32 v76,v76,v78
 v_add_f32 v72,v72,v76
 s_cbranch_vccnz Lfix_262
Lret_263:
 s_waitcnt lgkmcnt(4)
 v_mfma_f32_32x32x16_bf16 v[88:103],v[40:43],v[192:195],v[88:103]
 ds_read_b64_tr_b16 v[40:41],v5 offset:34816
 ds_read_b64_tr_b16 v[42:43],v5 offset:35328
 v_mov_b32 v73,v72
 s_nop 1
 v_permlane32_swap_b32 v72,v73
 v_mfma_f32_32x32x16_bf16 v[104:119],v[44:47],v[192:195],v[104:119]
 ds_read_b64_tr_b16 v[44:45],v5 offset:51200
 ds_read_b64_tr_b16 v[46:47],v5 offset:51712
 v_mul_f32 v72,s74,v72
 v_cndmask_b32_e64 v72,0,-v72,s[92:93]
 s_waitcnt vmcnt(6) lgkmcnt(4)
 v_mfma_f32_32x32x16_bf16 v[88:103],v[48:51],v[196:199],v[88:103]
 ds_read_b64_tr_b16 v[48:49],v5 offset:35840
 ds_read_b64_tr_b16 v[50:51],v5 offset:36352
 v_bitop3_b32 v38,v208,v212,1 bitop3:0x80
 v_cmp_eq_u32 vcc,0,v38
 v_mfma_f32_32x32x16_bf16 v[104:119],v[52:55],v[196:199],v[104:119]
 ds_read_b64_tr_b16 v[52:53],v5 offset:52224
 ds_read_b64_tr_b16 v[54:55],v5 offset:52736
 v_cvt_pk_bf16_f32 v24,v72,v72
 v_lshlrev_b32 v74,16,v24
 s_cbranch_vccnz Lfix_265
Lret_266:
 s_waitcnt lgkmcnt(4)
 v_mfma_f32_32x32x16_bf16 v[88:103],v[40:43],v[208:211],v[88:103]
 ds_read_b64_tr_b16 v[40:41],v5 offset:38912
 ds_read_b64_tr_b16 v[42:43],v5 offset:39424
 v_sub_f32 v72,v72,v74
 v_cvt_pk_bf16_f32 v25,v72,v72
 v_mfma_f32_32x32x16_bf16 v[104:119],v[44:47],v[208:211],v[104:119]
 ds_read_b64_tr_b16 v[44:45],v5 offset:55296
 ds_read_b64_tr_b16 v[46:47],v5 offset:55808
 s_waitcnt vmcnt(4) lgkmcnt(4)
 v_mfma_f32_32x32x16_bf16 v[88:103],v[48:51],v[212:215],v[88:103]
 ds_read_b64_tr_b16 v[48:49],v5 offset:39936
 ds_read_b64_tr_b16 v[50:51],v5 offset:40448
 v_bitop3_b32 v38,v224,v228,1 bitop3:0x80
 v_cmp_eq_u32 vcc,0,v38
 v_mfma_f32_32x32x16_bf16 v[104:119],v[52:55],v[212:215],v[104:119]
 ds_read_b64_tr_b16 v[52:53],v5 offset:56320
 ds_read_b64_tr_b16 v[54:55],v5 offset:56832
 s_cbranch_vccnz Lfix_268
Lret_269:
 s_waitcnt lgkmcnt(4)
 v_mfma_f32_32x32x16_bf16 v[88:103],v[40:43],v[224:227],v[88:103]
 ds_read_b64_tr_b16 v[40:41],v5 offset:43008
 ds_read_b64_tr_b16 v[42:43],v5 offset:43520
 v_mfma_f32_32x32x16_bf16 v[104:119],v[44:47],v[224:227],v[104:119]
 ds_read_b64_tr_b16 v[44:45],v5 offset:59392
 ds_read_b64_tr_b16 v[46:47],v5 offset:59904
 s_waitcnt vmcnt(2) lgkmcnt(4)
 v_mfma_f32_32x32x16_bf16 v[88:103],v[48:51],v[228:231],v[88:103]
 ds_read_b64_tr_b16 v[48:49],v5 offset:44032
 ds_read_b64_tr_b16 v[50:51],v5 offset:44544
 v_bitop3_b32 v38,v240,v244,1 bitop3:0x80
 v_cmp_eq_u32 vcc,0,v38
 v_mfma_f32_32x32x16_bf16 v[104:119],v[52:55],v[228:231],v[104:119]
 ds_read_b64_tr_b16 v[52:53],v5 offset:60416
 ds_read_b64_tr_b16 v[54:55],v5 offset:60928
 s_cbranch_vccnz Lfix_271
Lret_272:
 s_waitcnt lgkmcnt(4)
 v_mfma_f32_32x32x16_bf16 v[88:103],v[40:43],v[240:243],v[88:103]
 ds_read_b64_tr_b16 v[40:41],v5 offset:47104
 ds_read_b64_tr_b16 v[42:43],v5 offset:47616
 v_mfma_f32_32x32x16_bf16 v[104:119],v[44:47],v[240:243],v[104:119]
 ds_read_b64_tr_b16 v[44:45],v5 offset:63488
 ds_read_b64_tr_b16 v[46:47],v5 offset:64000
 s_waitcnt vmcnt(0) lgkmcnt(4)
 v_mfma_f32_32x32x16_bf16 v[88:103],v[48:51],v[244:247],v[88:103]
 ds_read_b64_tr_b16 v[48:49],v5 offset:48128
 ds_read_b64_tr_b16 v[50:51],v5 offset:48640
 v_accvgpr_read_b32 v38,a248
 v_lshlrev_b32 v38,31,v38
 v_cmp_eq_u32 s[82:83],0,v38
 v_accvgpr_read_b32 v38,a252
 v_lshlrev_b32 v38,31,v38
 v_cmp_eq_u32 vcc,0,v38
 s_nop 1
 s_or_b64 vcc,vcc,s[82:83]
 v_mfma_f32_32x32x16_bf16 v[104:119],v[52:55],v[244:247],v[104:119]
 ds_read_b64_tr_b16 v[52:53],v5 offset:64512
 ds_read_b64_tr_b16 v[54:55],v5 offset:65024
 s_cbranch_vccnz Lfix_274
Lret_275:
 s_waitcnt lgkmcnt(4)
 v_mfma_f32_32x32x16_bf16 v[88:103],v[40:43],a[248:251],v[88:103]
 v_mfma_f32_32x32x16_bf16 v[104:119],v[44:47],a[248:251],v[104:119]
 s_waitcnt lgkmcnt(0)
 v_mfma_f32_32x32x16_bf16 v[88:103],v[48:51],a[252:255],v[88:103]
 v_mfma_f32_32x32x16_bf16 v[104:119],v[52:55],a[252:255],v[104:119]
 v_mov_b32 v28,v22
 v_mov_b32 v29,v22
 s_nop 1
 v_mfma_f32_32x32x16_bf16 v[88:103],v[28:31],v[24:27],v[88:103]
 v_mov_b32 v28,v23
 v_mov_b32 v29,v23
 s_nop 1
 v_mfma_f32_32x32x16_bf16 v[104:119],v[28:31],v[24:27],v[104:119]
 s_barrier
 ds_read_b128 a[240:243],v36 offset:0
 ds_read_b128 a[244:247],v36 offset:4608
 ds_read_b64_tr_b16 v[40:41],v6 offset:0
 ds_read_b64_tr_b16 v[42:43],v6 offset:512
 ds_read_b64_tr_b16 v[44:45],v6 offset:1024
 ds_read_b64_tr_b16 v[46:47],v6 offset:1536
 ds_read_b64_tr_b16 v[48:49],v6 offset:2048
 ds_read_b64_tr_b16 v[50:51],v6 offset:2560
 ds_read_b64_tr_b16 v[52:53],v6 offset:3072
 ds_read_b64_tr_b16 v[54:55],v6 offset:3584
 s_waitcnt lgkmcnt(6)
 v_mfma_f32_32x32x16_bf16 v[120:135],v[40:43],v[136:139],0
 ds_read_b64_tr_b16 v[40:41],v6 offset:4096
 ds_read_b64_tr_b16 v[42:43],v6 offset:4608
 s_waitcnt lgkmcnt(6)
 v_mfma_f32_32x32x16_bf16 v[120:135],v[44:47],v[140:143],v[120:135]
 ds_read_b64_tr_b16 v[44:45],v6 offset:5120
 ds_read_b64_tr_b16 v[46:47],v6 offset:5632
 s_waitcnt lgkmcnt(6)
 v_mfma_f32_32x32x16_bf16 v[120:135],v[48:51],v[144:147],v[120:135]
 v_cvt_pk_bf16_f32 v88,v88,v89
 v_cvt_pk_bf16_f32 v89,v90,v91
 v_cvt_pk_bf16_f32 v90,v92,v93
 ds_read_b64_tr_b16 v[48:49],v6 offset:6144
 ds_read_b64_tr_b16 v[50:51],v6 offset:6656
 s_waitcnt lgkmcnt(6)
 v_mfma_f32_32x32x16_bf16 v[120:135],v[52:55],v[148:151],v[120:135]
 v_cvt_pk_bf16_f32 v91,v94,v95
 v_cvt_pk_bf16_f32 v92,v96,v97
 v_cvt_pk_bf16_f32 v93,v98,v99
 ds_read_b64_tr_b16 v[52:53],v6 offset:7168
 ds_read_b64_tr_b16 v[54:55],v6 offset:7680
 s_waitcnt lgkmcnt(6)
 v_mfma_f32_32x32x16_bf16 v[120:135],v[40:43],v[152:155],v[120:135]
 v_cvt_pk_bf16_f32 v94,v100,v101
 v_cvt_pk_bf16_f32 v95,v102,v103
 v_pk_max_i16 v88,v88,0
 ds_read_b64_tr_b16 v[40:41],v6 offset:8192
 ds_read_b64_tr_b16 v[42:43],v6 offset:8704
 s_waitcnt lgkmcnt(6)
 v_mfma_f32_32x32x16_bf16 v[120:135],v[44:47],v[156:159],v[120:135]
 v_pk_max_i16 v89,v89,0
 v_pk_max_i16 v90,v90,0
 v_pk_max_i16 v91,v91,0
 ds_read_b64_tr_b16 v[44:45],v6 offset:9216
 ds_read_b64_tr_b16 v[46:47],v6 offset:9728
 s_waitcnt lgkmcnt(6)
 v_mfma_f32_32x32x16_bf16 v[120:135],v[48:51],v[160:163],v[120:135]
 v_pk_max_i16 v92,v92,0
 v_pk_max_i16 v93,v93,0
 v_pk_max_i16 v94,v94,0
 ds_read_b64_tr_b16 v[48:49],v6 offset:10240
 ds_read_b64_tr_b16 v[50:51],v6 offset:10752
 s_waitcnt lgkmcnt(6)
 v_mfma_f32_32x32x16_bf16 v[120:135],v[52:55],v[164:167],v[120:135]
 v_pk_max_i16 v95,v95,0
 s_add_u32 s52,s64,0
 buffer_store_dwordx4 v[88:91],v1,s[32:35],s52 offen
 s_add_u32 s52,s64,0
 buffer_store_dwordx4 v[92:95],v1,s[32:35],s52 offen offset:1024
 v_cvt_pk_bf16_f32 v104,v104,v105
 ds_read_b64_tr_b16 v[52:53],v6 offset:11264
 ds_read_b64_tr_b16 v[54:55],v6 offset:11776
 s_waitcnt lgkmcnt(6)
 v_mfma_f32_32x32x16_bf16 v[120:135],v[40:43],v[168:171],v[120:135]
 v_cvt_pk_bf16_f32 v105,v106,v107
 v_cvt_pk_bf16_f32 v106,v108,v109
 v_cvt_pk_bf16_f32 v107,v110,v111
 ds_read_b64_tr_b16 v[40:41],v6 offset:12288
 ds_read_b64_tr_b16 v[42:43],v6 offset:12800
 s_waitcnt lgkmcnt(6)
 v_mfma_f32_32x32x16_bf16 v[120:135],v[44:47],v[172:175],v[120:135]
 v_cvt_pk_bf16_f32 v108,v112,v113
 v_cvt_pk_bf16_f32 v109,v114,v115
 v_cvt_pk_bf16_f32 v110,v116,v117
 ds_read_b64_tr_b16 v[44:45],v6 offset:13312
 ds_read_b64_tr_b16 v[46:47],v6 offset:13824
 s_waitcnt lgkmcnt(6)
 v_mfma_f32_32x32x16_bf16 v[120:135],v[48:51],v[176:179],v[120:135]
 v_cvt_pk_bf16_f32 v111,v118,v119
 v_pk_max_i16 v104,v104,0
 v_pk_max_i16 v105,v105,0
 ds_read_b64_tr_b16 v[48:49],v6 offset:14336
 ds_read_b64_tr_b16 v[50:51],v6 offset:14848
 s_waitcnt lgkmcnt(6)
 v_mfma_f32_32x32x16_bf16 v[120:135],v[52:55],v[180:183],v[120:135]
 v_pk_max_i16 v106,v106,0
 v_pk_max_i16 v107,v107,0
 v_pk_max_i16 v108,v108,0
 ds_read_b64_tr_b16 v[52:53],v6 offset:15360
 ds_read_b64_tr_b16 v[54:55],v6 offset:15872
 s_waitcnt lgkmcnt(6)
 v_mfma_f32_32x32x16_bf16 v[120:135],v[40:43],v[184:187],v[120:135]
 v_pk_max_i16 v109,v109,0
 v_pk_max_i16 v110,v110,0
 v_pk_max_i16 v111,v111,0
 ds_read_b64_tr_b16 v[40:41],v6 offset:16384
 ds_read_b64_tr_b16 v[42:43],v6 offset:16896
 s_waitcnt lgkmcnt(6)
 v_mfma_f32_32x32x16_bf16 v[120:135],v[44:47],v[188:191],v[120:135]
 s_lshl_b32 s53,s60,5
 s_add_u32 s53,s53,s64
 s_add_u32 s52,s53,0
 buffer_store_dwordx4 v[104:107],v1,s[32:35],s52 offen
 s_add_u32 s52,s53,0
 buffer_store_dwordx4 v[108:111],v1,s[32:35],s52 offen offset:1024
 v_add_u32 v32,s68,v1
 v_add_u32 v33,88064,v32
 ds_read_b64_tr_b16 v[44:45],v6 offset:17408
 ds_read_b64_tr_b16 v[46:47],v6 offset:17920
 s_waitcnt lgkmcnt(6)
 v_mfma_f32_32x32x16_bf16 v[120:135],v[48:51],v[192:195],v[120:135]
 s_lshl_b32 s53,s4,13
 s_add_u32 s53,s53,0
 v_add_u32 v7,s53,v1
 ds_read_b64_tr_b16 v[48:49],v6 offset:18432
 ds_read_b64_tr_b16 v[50:51],v6 offset:18944
 s_waitcnt lgkmcnt(6)
 v_mfma_f32_32x32x16_bf16 v[120:135],v[52:55],v[196:199],v[120:135]
 v_xor_b32 v8,64,v7
 v_xor_b32 v9,128,v7
 v_xor_b32 v10,192,v7
 ds_read_b64_tr_b16 v[52:53],v6 offset:19456
 ds_read_b64_tr_b16 v[54:55],v6 offset:19968
 s_waitcnt lgkmcnt(6)
 v_mfma_f32_32x32x16_bf16 v[120:135],v[40:43],v[200:203],v[120:135]
 v_and_b32 v21,7,v0
 s_lshl_b32 s53,s4,3
 v_add_u32 v20,s53,v21
 ds_read_b64_tr_b16 v[40:41],v6 offset:20480
 ds_read_b64_tr_b16 v[42:43],v6 offset:20992
 s_waitcnt lgkmcnt(6)
 v_mfma_f32_32x32x16_bf16 v[120:135],v[44:47],v[204:207],v[120:135]
 v_lshrrev_b32 v56,3,v0
 v_lshlrev_b32 v19,2,v56
 v_lshlrev_b32 v14,9,v56
 ds_read_b64_tr_b16 v[44:45],v6 offset:21504
 ds_read_b64_tr_b16 v[46:47],v6 offset:22016
 s_waitcnt lgkmcnt(6)
 v_mfma_f32_32x32x16_bf16 v[120:135],v[48:51],v[208:211],v[120:135]
 v_lshl_add_u32 v14,v20,4,v14
 s_lshl_b32 s53,s4,3
 v_add_u32 v20,s53,v56
 ds_read_b64_tr_b16 v[48:49],v6 offset:22528
 ds_read_b64_tr_b16 v[50:51],v6 offset:23040
 s_waitcnt lgkmcnt(6)
 v_mfma_f32_32x32x16_bf16 v[120:135],v[52:55],v[212:215],v[120:135]
 v_lshlrev_b32 v12,10,v20
 v_lshl_add_u32 v12,v21,4,v12
 v_and_b32 v56,3,v0
 ds_read_b64_tr_b16 v[52:53],v6 offset:23552
 ds_read_b64_tr_b16 v[54:55],v6 offset:24064
 s_waitcnt lgkmcnt(6)
 v_mfma_f32_32x32x16_bf16 v[120:135],v[40:43],v[216:219],v[120:135]
 v_lshlrev_b32 v56,2,v56
 v_xor_b32 v56,v56,v20
 v_lshlrev_b32 v56,4,v56
 v_lshl_add_u32 v11,v21,10,v56
 v_add_u32 v11,0x0,v11
 s_bfe_u32 s84,s44,0x50000
 s_lshl_b32 s84,s84,12
 buffer_load_dwordx4 v[136:139],v32,s[32:35],s84 offen sc1
 ds_read_b64_tr_b16 v[40:41],v6 offset:24576
 ds_read_b64_tr_b16 v[42:43],v6 offset:25088
 s_waitcnt lgkmcnt(6)
 v_mfma_f32_32x32x16_bf16 v[120:135],v[44:47],v[220:223],v[120:135]
 s_bfe_u32 s84,s44,0x50005
 s_lshl_b32 s84,s84,12
 buffer_load_dwordx4 v[140:143],v32,s[32:35],s84 offen sc1
 ds_read_b64_tr_b16 v[44:45],v6 offset:25600
 ds_read_b64_tr_b16 v[46:47],v6 offset:26112
 s_waitcnt lgkmcnt(6)
 v_mfma_f32_32x32x16_bf16 v[120:135],v[48:51],v[224:227],v[120:135]
 s_bfe_u32 s84,s44,0x5000a
 s_lshl_b32 s84,s84,12
 buffer_load_dwordx4 v[144:147],v32,s[32:35],s84 offen sc1
 ds_read_b64_tr_b16 v[48:49],v6 offset:26624
 ds_read_b64_tr_b16 v[50:51],v6 offset:27136
 s_waitcnt lgkmcnt(6)
 v_mfma_f32_32x32x16_bf16 v[120:135],v[52:55],v[228:231],v[120:135]
 s_bfe_u32 s84,s44,0x5000f
 s_lshl_b32 s84,s84,12
 buffer_load_dwordx4 v[148:151],v32,s[32:35],s84 offen sc1
 ds_read_b64_tr_b16 v[52:53],v6 offset:27648
 ds_read_b64_tr_b16 v[54:55],v6 offset:28160
 s_waitcnt lgkmcnt(6)
 v_mfma_f32_32x32x16_bf16 v[120:135],v[40:43],v[232:235],v[120:135]
 s_bfe_u32 s84,s44,0x50014
 s_lshl_b32 s84,s84,12
 buffer_load_dwordx4 v[152:155],v32,s[32:35],s84 offen sc1
 ds_read_b64_tr_b16 v[40:41],v6 offset:28672
 ds_read_b64_tr_b16 v[42:43],v6 offset:29184
 s_waitcnt lgkmcnt(6)
 v_mfma_f32_32x32x16_bf16 v[120:135],v[44:47],v[236:239],v[120:135]
 s_bfe_u32 s84,s44,0x50019
 s_lshl_b32 s84,s84,12
 buffer_load_dwordx4 v[156:159],v32,s[32:35],s84 offen sc1
 ds_read_b64_tr_b16 v[44:45],v6 offset:29696
 ds_read_b64_tr_b16 v[46:47],v6 offset:30208
 s_waitcnt lgkmcnt(6)
 v_mfma_f32_32x32x16_bf16 v[120:135],v[48:51],v[240:243],v[120:135]
 s_bfe_u32 s84,s45,0x50000
 s_lshl_b32 s84,s84,12
 buffer_load_dwordx4 v[160:163],v32,s[32:35],s84 offen sc1
 ds_read_b64_tr_b16 v[48:49],v6 offset:30720
 ds_read_b64_tr_b16 v[50:51],v6 offset:31232
 s_waitcnt lgkmcnt(6)
 v_mfma_f32_32x32x16_bf16 v[120:135],v[52:55],v[244:247],v[120:135]
 s_bfe_u32 s84,s45,0x50005
 s_lshl_b32 s84,s84,12
 buffer_load_dwordx4 v[164:167],v32,s[32:35],s84 offen sc1
 ds_read_b64_tr_b16 v[52:53],v6 offset:31744
 ds_read_b64_tr_b16 v[54:55],v6 offset:32256
 s_waitcnt lgkmcnt(6)
 v_mfma_f32_32x32x16_bf16 v[120:135],v[40:43],v[248:251],v[120:135]
 s_bfe_u32 s84,s45,0x5000a
 s_lshl_b32 s84,s84,12
 buffer_load_dwordx4 v[168:171],v32,s[32:35],s84 offen sc1
 s_waitcnt lgkmcnt(4)
 v_mfma_f32_32x32x16_bf16 v[120:135],v[44:47],v[252:255],v[120:135]
 s_bfe_u32 s84,s45,0x5000f
 s_lshl_b32 s84,s84,12
 buffer_load_dwordx4 v[172:175],v32,s[32:35],s84 offen sc1
 s_waitcnt lgkmcnt(2)
 v_mfma_f32_32x32x16_bf16 v[120:135],v[48:51],a[248:251],v[120:135]
 s_waitcnt lgkmcnt(0)
 v_mfma_f32_32x32x16_bf16 v[120:135],v[52:55],a[252:255],v[120:135]
 v_mov_b32 v28,v34
 v_mov_b32 v29,v34
 s_nop 1
 v_mfma_f32_32x32x16_bf16 v[120:135],v[28:31],v[24:27],v[120:135]
 s_nop 11
 v_cvt_pk_bf16_f32 v120,v120,v121
 v_cvt_pk_bf16_f32 v121,v122,v123
 v_cvt_pk_bf16_f32 v122,v124,v125
 v_cvt_pk_bf16_f32 v123,v126,v127
 v_cvt_pk_bf16_f32 v124,v128,v129
 v_cvt_pk_bf16_f32 v125,v130,v131
 v_cvt_pk_bf16_f32 v126,v132,v133
 v_cvt_pk_bf16_f32 v127,v134,v135
 v_pk_max_i16 v120,v120,0
 v_pk_max_i16 v121,v121,0
 v_pk_max_i16 v122,v122,0
 v_pk_max_i16 v123,v123,0
 v_pk_max_i16 v124,v124,0
 v_pk_max_i16 v125,v125,0
 v_pk_max_i16 v126,v126,0
 v_pk_max_i16 v127,v127,0
 s_cmp_ge_u32 s6,11
 s_cbranch_scc1 Lh3_277
 s_add_u32 s52,s64,2048
 buffer_store_dwordx4 v[120:123],v1,s[32:35],s52 offen
 s_add_u32 s52,s64,2048
 buffer_store_dwordx4 v[124:127],v1,s[32:35],s52 offen offset:1024
Lh3_277:
 s_add_u32 s84,s69,262144
 buffer_load_dwordx4 v[24:27],v14,s[32:35],s84 offen sc1
 s_waitcnt vmcnt(9)
 v_or_b32 v38,v136,v140
 v_cmp_gt_i32 vcc,0,v38
 s_cbranch_vccnz Lfix_278
Lret_279:
 v_mfma_f32_32x32x16_bf16 v[88:103],a[0:3],v[136:139],0
 s_bfe_u32 s84,s45,0x50014
 s_lshl_b32 s84,s84,12
 buffer_load_dwordx4 v[176:179],v32,s[32:35],s84 offen sc1
 v_mfma_f32_32x32x16_bf16 v[104:119],a[4:7],v[136:139],0
 v_mfma_f32_32x32x16_bf16 v[88:103],a[8:11],v[140:143],v[88:103]
 s_bfe_u32 s84,s45,0x50019
 s_lshl_b32 s84,s84,12
 buffer_load_dwordx4 v[180:183],v32,s[32:35],s84 offen sc1
 s_waitcnt vmcnt(9)
 v_or_b32 v38,v144,v148
 v_cmp_gt_i32 vcc,0,v38
 v_mfma_f32_32x32x16_bf16 v[104:119],a[12:15],v[140:143],v[104:119]
 s_cbranch_vccnz Lfix_281
Lret_282:
 v_mfma_f32_32x32x16_bf16 v[88:103],a[16:19],v[144:147],v[88:103]
 s_bfe_u32 s84,s46,0x50000
 s_lshl_b32 s84,s84,12
 buffer_load_dwordx4 v[184:187],v32,s[32:35],s84 offen sc1
 v_mfma_f32_32x32x16_bf16 v[104:119],a[20:23],v[144:147],v[104:119]
 v_mfma_f32_32x32x16_bf16 v[88:103],a[24:27],v[148:151],v[88:103]
 s_bfe_u32 s84,s46,0x50005
 s_lshl_b32 s84,s84,12
 buffer_load_dwordx4 v[188:191],v32,s[32:35],s84 offen sc1
 s_waitcnt vmcnt(9)
 v_or_b32 v38,v152,v156
 v_cmp_gt_i32 vcc,0,v38
 v_mfma_f32_32x32x16_bf16 v[104:119],a[28:31],v[148:151],v[104:119]
 s_cbranch_vccnz Lfix_284
Lret_285:
 v_mfma_f32_32x32x16_bf16 v[88:103],a[32:35],v[152:155],v[88:103]
 s_bfe_u32 s84,s46,0x5000a
 s_lshl_b32 s84,s84,12
 buffer_load_dwordx4 v[192:195],v32,s[32:35],s84 offen sc1
 v_mfma_f32_32x32x16_bf16 v[104:119],a[36:39],v[152:155],v[104:119]
 v_mfma_f32_32x32x16_bf16 v[88:103],a[40:43],v[156:159],v[88:103]
 s_bfe_u32 s84,s46,0x5000f
 s_lshl_b32 s84,s84,12
 buffer_load_dwordx4 v[196:199],v32,s[32:35],s84 offen sc1
 s_waitcnt vmcnt(9)
 v_or_b32 v38,v160,v164
 v_cmp_gt_i32 vcc,0,v38
 v_mfma_f32_32x32x16_bf16 v[104:119],a[44:47],v[156:159],v[104:119]
 s_cbranch_vccnz Lfix_287
Lret_288:
 v_mfma_f32_32x32x16_bf16 v[88:103],a[48:51],v[160:163],v[88:103]
 s_bfe_u32 s84,s46,0x50014
 s_lshl_b32 s84,s84,12
 buffer_load_dwordx4 v[200:203],v32,s[32:35],s84 offen sc1
 v_mfma_f32_32x32x16_bf16 v[104:119],a[52:55],v[160:163],v[104:119]
 v_mfma_f32_32x32x16_bf16 v[88:103],a[56:59],v[164:167],v[88:103]
 s_bfe_u32 s84,s46,0x50019
 s_lshl_b32 s84,s84,12
 buffer_load_dwordx4 v[204:207],v32,s[32:35],s84 offen sc1
 s_waitcnt vmcnt(9)
 v_or_b32 v38,v168,v172
 v_cmp_gt_i32 vcc,0,v38
 v_mfma_f32_32x32x16_bf16 v[104:119],a[60:63],v[164:167],v[104:119]
 s_cbranch_vccnz Lfix_290
Lret_291:
 v_mfma_f32_32x32x16_bf16 v[88:103],a[64:67],v[168:171],v[88:103]
 s_bfe_u32 s84,s47,0x50000
 s_lshl_b32 s84,s84,12
 buffer_load_dwordx4 v[208:211],v32,s[32:35],s84 offen sc1
 s_waitcnt vmcnt(9)
 v_and_b32 v30,v24,v25
 v_bitop3_b32 v30,v26,v27,v30 bitop3:0x80
 v_and_b32 v30,1,v30
 v_cmp_eq_u32 s[82:83],0,v30
 s_nop 0
 s_cmp_lg_u64 s[82:83],0
 s_cbranch_scc1 Lfix_293
Lret_294:
 v_mfma_f32_32x32x16_bf16 v[104:119],a[68:71],v[168:171],v[104:119]
 v_add_f32 v24,v24,v25
 v_mfma_f32_32x32x16_bf16 v[88:103],a[72:75],v[172:175],v[88:103]
 s_bfe_u32 s84,s47,0x50005
 s_lshl_b32 s84,s84,12
 buffer_load_dwordx4 v[212:215],v32,s[32:35],s84 offen sc1
 s_waitcnt vmcnt(8)
 v_or_b32 v38,v176,v180
 v_cmp_gt_i32 vcc,0,v38
 v_add_f32 v26,v26,v27
 v_mfma_f32_32x32x16_bf16 v[104:119],a[76:79],v[172:175],v[104:119]
 v_add_f32 v24,v24,v26
 s_nop 1
 v_add_f32_dpp v24,v24,v24 row_ror:8 row_mask:0xf bank_mask:0xf
 v_mov_b32 v25,v24
 s_nop 1
 v_permlane16_swap_b32 v24,v25
 v_mul_f32 v24,s74,v24
 v_mul_f32 v25,s74,v25
 s_cbranch_vccnz Lfix_296
Lret_297:
 v_mfma_f32_32x32x16_bf16 v[88:103],a[80:83],v[176:179],v[88:103]
 s_bfe_u32 s84,s47,0x5000a
 s_lshl_b32 s84,s84,12
 buffer_load_dwordx4 v[216:219],v32,s[32:35],s84 offen sc1
 v_fma_f32 v25,-v24,v24,v25
 v_mfma_f32_32x32x16_bf16 v[104:119],a[84:87],v[176:179],v[104:119]
 v_max_f32 v25,0,v25
 v_add_f32 v25,s75,v25
 v_rsq_f32 v28,v25
 s_nop 0
 v_mov_b32 v30,v28
 s_nop 1
 v_permlane32_swap_b32 v30,v28
 v_mfma_f32_32x32x16_bf16 v[88:103],a[88:91],v[180:183],v[88:103]
 buffer_load_dwordx4 v[220:223],v32,s[32:35],s70 offen sc1
 s_waitcnt vmcnt(8)
 v_or_b32 v38,v184,v188
 v_cmp_gt_i32 vcc,0,v38
 ds_bpermute_b32 v30,v19,v30
 v_mfma_f32_32x32x16_bf16 v[104:119],a[92:95],v[180:183],v[104:119]
 ds_bpermute_b32 v28,v19,v28
 s_cbranch_vccnz Lfix_299
Lret_300:
 v_mfma_f32_32x32x16_bf16 v[88:103],a[96:99],v[184:187],v[88:103]
 s_bfe_u32 s84,s44,0x50000
 s_lshl_b32 s84,s84,12
 buffer_load_dwordx4 v[224:227],v33,s[32:35],s84 offen sc1
 v_mfma_f32_32x32x16_bf16 v[104:119],a[100:103],v[184:187],v[104:119]
 v_mfma_f32_32x32x16_bf16 v[88:103],a[104:107],v[188:191],v[88:103]
 s_bfe_u32 s84,s44,0x50005
 s_lshl_b32 s84,s84,12
 buffer_load_dwordx4 v[228:231],v33,s[32:35],s84 offen sc1
 s_waitcnt vmcnt(8)
 v_or_b32 v38,v192,v196
 v_cmp_gt_i32 vcc,0,v38
 v_mfma_f32_32x32x16_bf16 v[104:119],a[108:111],v[188:191],v[104:119]
 s_cbranch_vccnz Lfix_302
Lret_303:
 v_mfma_f32_32x32x16_bf16 v[88:103],a[112:115],v[192:195],v[88:103]
 s_bfe_u32 s84,s44,0x5000a
 s_lshl_b32 s84,s84,12
 buffer_load_dwordx4 v[136:139],v33,s[32:35],s84 offen sc1
 v_mfma_f32_32x32x16_bf16 v[104:119],a[116:119],v[192:195],v[104:119]
 v_mfma_f32_32x32x16_bf16 v[88:103],a[120:123],v[196:199],v[88:103]
 s_bfe_u32 s84,s44,0x5000f
 s_lshl_b32 s84,s84,12
 buffer_load_dwordx4 v[140:143],v33,s[32:35],s84 offen sc1
 s_waitcnt vmcnt(8)
 v_or_b32 v38,v200,v204
 v_cmp_gt_i32 vcc,0,v38
 v_mfma_f32_32x32x16_bf16 v[104:119],a[124:127],v[196:199],v[104:119]
 s_cbranch_vccnz Lfix_305
Lret_306:
 v_mfma_f32_32x32x16_bf16 v[88:103],a[128:131],v[200:203],v[88:103]
 s_bfe_u32 s84,s44,0x50014
 s_lshl_b32 s84,s84,12
 buffer_load_dwordx4 v[144:147],v33,s[32:35],s84 offen sc1
 v_mfma_f32_32x32x16_bf16 v[104:119],a[132:135],v[200:203],v[104:119]
 v_mfma_f32_32x32x16_bf16 v[88:103],a[136:139],v[204:207],v[88:103]
 s_bfe_u32 s84,s44,0x50019
 s_lshl_b32 s84,s84,12
 buffer_load_dwordx4 v[148:151],v33,s[32:35],s84 offen sc1
 s_waitcnt vmcnt(8)
 v_or_b32 v38,v208,v212
 v_cmp_gt_i32 vcc,0,v38
 v_mfma_f32_32x32x16_bf16 v[104:119],a[140:143],v[204:207],v[104:119]
 s_cbranch_vccnz Lfix_308
Lret_309:
 v_mfma_f32_32x32x16_bf16 v[88:103],a[144:147],v[208:211],v[88:103]
 s_bfe_u32 s84,s45,0x50000
 s_lshl_b32 s84,s84,12
 buffer_load_dwordx4 v[152:155],v33,s[32:35],s84 offen sc1
 v_mfma_f32_32x32x16_bf16 v[104:119],a[148:151],v[208:211],v[104:119]
 v_mfma_f32_32x32x16_bf16 v[88:103],a[152:155],v[212:215],v[88:103]
 s_bfe_u32 s84,s45,0x50005
 s_lshl_b32 s84,s84,12
 buffer_load_dwordx4 v[156:159],v33,s[32:35],s84 offen sc1
 s_waitcnt vmcnt(8)
 v_or_b32 v38,v216,v220
 v_cmp_gt_i32 vcc,0,v38
 v_mfma_f32_32x32x16_bf16 v[104:119],a[156:159],v[212:215],v[104:119]
 s_cbranch_vccnz Lfix_311
Lret_312:
 v_mfma_f32_32x32x16_bf16 v[88:103],a[160:163],v[216:219],v[88:103]
 s_bfe_u32 s84,s45,0x5000a
 s_lshl_b32 s84,s84,12
 buffer_load_dwordx4 v[160:163],v33,s[32:35],s84 offen sc1
 v_mfma_f32_32x32x16_bf16 v[104:119],a[164:167],v[216:219],v[104:119]
 v_mfma_f32_32x32x16_bf16 v[88:103],a[168:171],v[220:223],v[88:103]
 s_bfe_u32 s84,s45,0x5000f
 s_lshl_b32 s84,s84,12
 buffer_load_dwordx4 v[164:167],v33,s[32:35],s84 offen sc1
 s_waitcnt vmcnt(8)
 v_or_b32 v38,v224,v228
 v_cmp_gt_i32 vcc,0,v38
 v_mfma_f32_32x32x16_bf16 v[104:119],a[172:175],v[220:223],v[104:119]
 s_cbranch_vccnz Lfix_314
Lret_315:
 v_mfma_f32_32x32x16_bf16 v[120:135],a[0:3],v[224:227],0
 s_bfe_u32 s84,s45,0x50014
 s_lshl_b32 s84,s84,12
 buffer_load_dwordx4 v[168:171],v33,s[32:35],s84 offen sc1
 v_mfma_f32_32x32x16_bf16 v[232:247],a[4:7],v[224:227],0
 v_mfma_f32_32x32x16_bf16 v[120:135],a[8:11],v[228:231],v[120:135]
 s_bfe_u32 s84,s45,0x50019
 s_lshl_b32 s84,s84,12
 buffer_load_dwordx4 v[172:175],v33,s[32:35],s84 offen sc1
 s_waitcnt vmcnt(8)
 v_or_b32 v38,v136,v140
 v_cmp_gt_i32 vcc,0,v38
 ds_write_b128 v7,v[88:91] offset:0
 v_mfma_f32_32x32x16_bf16 v[232:247],a[12:15],v[228:231],v[232:247]
 s_cbranch_vccnz Lfix_317
Lret_318:
 v_mfma_f32_32x32x16_bf16 v[120:135],a[16:19],v[136:139],v[120:135]
 s_bfe_u32 s84,s46,0x50000
 s_lshl_b32 s84,s84,12
 buffer_load_dwordx4 v[176:179],v33,s[32:35],s84 offen sc1
 v_mfma_f32_32x32x16_bf16 v[232:247],a[20:23],v[136:139],v[232:247]
 v_mfma_f32_32x32x16_bf16 v[120:135],a[24:27],v[140:143],v[120:135]
 s_bfe_u32 s84,s46,0x50005
 s_lshl_b32 s84,s84,12
 buffer_load_dwordx4 v[180:183],v33,s[32:35],s84 offen sc1
 s_waitcnt vmcnt(8)
 v_or_b32 v38,v144,v148
 v_cmp_gt_i32 vcc,0,v38
 ds_write_b128 v8,v[92:95] offset:1024
 v_mfma_f32_32x32x16_bf16 v[232:247],a[28:31],v[140:143],v[232:247]
 s_cbranch_vccnz Lfix_320
Lret_321:
 v_mfma_f32_32x32x16_bf16 v[120:135],a[32:35],v[144:147],v[120:135]
 s_bfe_u32 s84,s46,0x5000a
 s_lshl_b32 s84,s84,12
 buffer_load_dwordx4 v[184:187],v33,s[32:35],s84 offen sc1
 v_mfma_f32_32x32x16_bf16 v[232:247],a[36:39],v[144:147],v[232:247]
 v_mfma_f32_32x32x16_bf16 v[120:135],a[40:43],v[148:151],v[120:135]
 s_bfe_u32 s84,s46,0x5000f
 s_lshl_b32 s84,s84,12
 buffer_load_dwordx4 v[188:191],v33,s[32:35],s84 offen sc1
 s_waitcnt vmcnt(8)
 v_or_b32 v38,v152,v156
 v_cmp_gt_i32 vcc,0,v38
 ds_write_b128 v9,v[96:99] offset:2048
 v_mfma_f32_32x32x16_bf16 v[232:247],a[44:47],v[148:151],v[232:247]
 s_cbranch_vccnz Lfix_323
Lret_324:
 v_mfma_f32_32x32x16_bf16 v[120:135],a[48:51],v[152:155],v[120:135]
 s_bfe_u32 s84,s46,0x50014
 s_lshl_b32 s84,s84,12
 buffer_load_dwordx4 v[192:195],v33,s[32:35],s84 offen sc1
 v_mfma_f32_32x32x16_bf16 v[232:247],a[52:55],v[152:155],v[232:247]
 v_mfma_f32_32x32x16_bf16 v[120:135],a[56:59],v[156:159],v[120:135]
 s_bfe_u32 s84,s46,0x50019
 s_lshl_b32 s84,s84,12
 buffer_load_dwordx4 v[196:199],v33,s[32:35],s84 offen sc1
 s_waitcnt vmcnt(8)
 v_or_b32 v38,v160,v164
 v_cmp_gt_i32 vcc,0,v38
 ds_write_b128 v10,v[100:103] offset:3072
 v_mfma_f32_32x32x16_bf16 v[232:247],a[60:63],v[156:159],v[232:247]
 s_cbranch_vccnz Lfix_326
Lret_327:
 v_mfma_f32_32x32x16_bf16 v[120:135],a[64:67],v[160:163],v[120:135]
 s_bfe_u32 s84,s47,0x50000
 s_lshl_b32 s84,s84,12
 buffer_load_dwordx4 v[200:203],v33,s[32:35],s84 offen sc1
 v_mfma_f32_32x32x16_bf16 v[232:247],a[68:71],v[160:163],v[232:247]
 v_mfma_f32_32x32x16_bf16 v[120:135],a[72:75],v[164:167],v[120:135]
 s_bfe_u32 s84,s47,0x50005
 s_lshl_b32 s84,s84,12
 buffer_load_dwordx4 v[204:207],v33,s[32:35],s84 offen sc1
 s_waitcnt vmcnt(8)
 v_or_b32 v38,v168,v172
 v_cmp_gt_i32 vcc,0,v38
 ds_write_b128 v7,v[104:107] offset:4096
 v_mfma_f32_32x32x16_bf16 v[232:247],a[76:79],v[164:167],v[232:247]
 s_cbranch_vccnz Lfix_329
Lret_330:
 v_mfma_f32_32x32x16_bf16 v[120:135],a[80:83],v[168:171],v[120:135]
 s_bfe_u32 s84,s47,0x5000a
 s_lshl_b32 s84,s84,12
 buffer_load_dwordx4 v[208:211],v33,s[32:35],s84 offen sc1
 v_mfma_f32_32x32x16_bf16 v[232:247],a[84:87],v[168:171],v[232:247]
 v_mfma_f32_32x32x16_bf16 v[120:135],a[88:91],v[172:175],v[120:135]
 buffer_load_dwordx4 v[212:215],v33,s[32:35],s70 offen sc1
 s_waitcnt vmcnt(8)
 v_or_b32 v38,v176,v180
 v_cmp_gt_i32 vcc,0,v38
 ds_write_b128 v8,v[108:111] offset:5120
 v_mfma_f32_32x32x16_bf16 v[232:247],a[92:95],v[172:175],v[232:247]
 s_cbranch_vccnz Lfix_332
Lret_333:
 v_mfma_f32_32x32x16_bf16 v[120:135],a[96:99],v[176:179],v[120:135]
 v_mfma_f32_32x32x16_bf16 v[232:247],a[100:103],v[176:179],v[232:247]
 v_mfma_f32_32x32x16_bf16 v[120:135],a[104:107],v[180:183],v[120:135]
 s_waitcnt vmcnt(6)
 v_or_b32 v38,v184,v188
 v_cmp_gt_i32 vcc,0,v38
 ds_write_b128 v9,v[112:115] offset:6144
 v_mfma_f32_32x32x16_bf16 v[232:247],a[108:111],v[180:183],v[232:247]
 s_cbranch_vccnz Lfix_335
Lret_336:
 v_mfma_f32_32x32x16_bf16 v[120:135],a[112:115],v[184:187],v[120:135]
 v_mfma_f32_32x32x16_bf16 v[232:247],a[116:119],v[184:187],v[232:247]
 s_lshr_b32 s52,s2,3
 s_or_b32 s52,s52,s4
 s_cmp_lg_u32 s52,0
 s_cbranch_scc1 Lwb_338
 buffer_wbl2 sc1
Lwb_338:
 v_mfma_f32_32x32x16_bf16 v[120:135],a[120:123],v[188:191],v[120:135]
 s_waitcnt vmcnt(4)
 v_or_b32 v38,v192,v196
 v_cmp_gt_i32 vcc,0,v38
 ds_write_b128 v10,v[116:119] offset:7168
 v_mfma_f32_32x32x16_bf16 v[232:247],a[124:127],v[188:191],v[232:247]
 s_cbranch_vccnz Lfix_339
Lret_340:
 v_mfma_f32_32x32x16_bf16 v[120:135],a[128:131],v[192:195],v[120:135]
 v_mfma_f32_32x32x16_bf16 v[232:247],a[132:135],v[192:195],v[232:247]
 v_mfma_f32_32x32x16_bf16 v[120:135],a[136:139],v[196:199],v[120:135]
 s_waitcnt vmcnt(2)
 v_or_b32 v38,v200,v204
 v_cmp_gt_i32 vcc,0,v38
 s_waitcnt lgkmcnt(0)
 s_barrier
 v_mfma_f32_32x32x16_bf16 v[232:247],a[140:143],v[196:199],v[232:247]
 ds_read_b128 v[56:59],v11 offset:0
 s_cbranch_vccnz Lfix_342
Lret_343:
 v_mfma_f32_32x32x16_bf16 v[120:135],a[144:147],v[200:203],v[120:135]
 ds_read_b128 v[60:63],v11 offset:512
 ds_read_b128 v[64:67],v11 offset:8192
 ds_read_b128 v[68:71],v11 offset:8704
 ds_read_b128 v[72:75],v11 offset:16384
 ds_read_b128 v[76:79],v11 offset:16896
 ds_read_b128 v[80:83],v11 offset:24576
 v_mfma_f32_32x32x16_bf16 v[120:135],a[152:155],v[204:207],v[120:135]
 s_waitcnt vmcnt(0)
 v_or_b32 v38,v208,v212
 v_cmp_gt_i32 vcc,0,v38
 ds_read_b128 v[84:87],v11 offset:25088
 v_accvgpr_read_b32 v89,a240
 v_accvgpr_read_b32 v91,a241
 v_accvgpr_read_b32 v93,a242
 v_accvgpr_read_b32 v95,a243
 v_lshlrev_b32 v88,16,v89
 s_cbranch_vccnz Lfix_345
Lret_346:
 v_mfma_f32_32x32x16_bf16 v[120:135],a[160:163],v[208:211],v[120:135]
 v_and_b32 v89,0xffff0000,v89
 v_lshlrev_b32 v90,16,v91
 v_and_b32 v91,0xffff0000,v91
 v_lshlrev_b32 v92,16,v93
 v_and_b32 v93,0xffff0000,v93
 v_lshlrev_b32 v94,16,v95
 v_mfma_f32_32x32x16_bf16 v[120:135],a[168:171],v[212:215],v[120:135]
 v_and_b32 v95,0xffff0000,v95
 s_waitcnt lgkmcnt(5)
 v_pk_add_f32 v[56:57],v[56:57],v[64:65]
 v_pk_add_f32 v[58:59],v[58:59],v[66:67]
 s_waitcnt lgkmcnt(4)
 v_pk_add_f32 v[60:61],v[60:61],v[68:69]
 v_pk_add_f32 v[62:63],v[62:63],v[70:71]
 s_waitcnt lgkmcnt(1)
 v_pk_add_f32 v[72:73],v[72:73],v[80:81]
 v_pk_add_f32 v[74:75],v[74:75],v[82:83]
 s_waitcnt lgkmcnt(0)
 v_pk_add_f32 v[76:77],v[76:77],v[84:85]
 v_pk_add_f32 v[78:79],v[78:79],v[86:87]
 v_pk_add_f32 v[56:57],v[56:57],v[72:73]
 v_pk_add_f32 v[58:59],v[58:59],v[74:75]
 v_pk_add_f32 v[60:61],v[60:61],v[76:77]
 v_pk_add_f32 v[62:63],v[62:63],v[78:79]
 v_pk_fma_f32 v[56:57],v[56:57],v[30:31],v[88:89] op_sel_hi:[1,0,1]
 v_pk_fma_f32 v[58:59],v[58:59],v[30:31],v[90:91] op_sel_hi:[1,0,1]
 v_pk_fma_f32 v[60:61],v[60:61],v[30:31],v[92:93] op_sel_hi:[1,0,1]
 v_pk_fma_f32 v[62:63],v[62:63],v[30:31],v[94:95] op_sel_hi:[1,0,1]
 v_cvt_pk_bf16_f32 v64,v56,v57
 v_cvt_pk_bf16_f32 v65,v58,v59
 v_cvt_pk_bf16_f32 v66,v60,v61
 v_cvt_pk_bf16_f32 v67,v62,v63
 s_add_u32 s52,s80,0
 buffer_store_dwordx4 v[64:67],v12,s[28:31],s52 offen sc1
 v_accvgpr_read_b32 v105,a244
 v_accvgpr_read_b32 v107,a245
 v_accvgpr_read_b32 v109,a246
 v_accvgpr_read_b32 v111,a247
 v_lshlrev_b32 v104,16,v105
 v_and_b32 v105,0xffff0000,v105
 v_lshlrev_b32 v106,16,v107
 v_and_b32 v107,0xffff0000,v107
 v_lshlrev_b32 v108,16,v109
 v_and_b32 v109,0xffff0000,v109
 v_lshlrev_b32 v110,16,v111
 v_and_b32 v111,0xffff0000,v111
 s_barrier
 v_mfma_f32_32x32x16_bf16 v[232:247],a[148:151],v[200:203],v[232:247]
 v_mfma_f32_32x32x16_bf16 v[232:247],a[156:159],v[204:207],v[232:247]
 ds_write_b128 v7,v[120:123] offset:0
 v_mfma_f32_32x32x16_bf16 v[232:247],a[164:167],v[208:211],v[232:247]
 ds_write_b128 v8,v[124:127] offset:1024
 v_mfma_f32_32x32x16_bf16 v[232:247],a[172:175],v[212:215],v[232:247]
 ds_write_b128 v9,v[128:131] offset:2048
 ds_write_b128 v10,v[132:135] offset:3072
 s_nop 9
 ds_write_b128 v7,v[232:235] offset:4096
 ds_write_b128 v8,v[236:239] offset:5120
 ds_write_b128 v9,v[240:243] offset:6144
 ds_write_b128 v10,v[244:247] offset:7168
 s_waitcnt lgkmcnt(0)
 s_barrier
 ds_read_b128 v[56:59],v11 offset:0
 ds_read_b128 v[60:63],v11 offset:512
 ds_read_b128 v[64:67],v11 offset:8192
 ds_read_b128 v[68:71],v11 offset:8704
 ds_read_b128 v[72:75],v11 offset:16384
 ds_read_b128 v[76:79],v11 offset:16896
 ds_read_b128 v[80:83],v11 offset:24576
 ds_read_b128 v[84:87],v11 offset:25088
 s_waitcnt lgkmcnt(5)
 v_pk_add_f32 v[56:57],v[56:57],v[64:65]
 v_pk_add_f32 v[58:59],v[58:59],v[66:67]
 s_waitcnt lgkmcnt(4)
 v_pk_add_f32 v[60:61],v[60:61],v[68:69]
 v_pk_add_f32 v[62:63],v[62:63],v[70:71]
 s_waitcnt lgkmcnt(1)
 v_pk_add_f32 v[72:73],v[72:73],v[80:81]
 v_pk_add_f32 v[74:75],v[74:75],v[82:83]
 s_waitcnt lgkmcnt(0)
 v_pk_add_f32 v[76:77],v[76:77],v[84:85]
 v_pk_add_f32 v[78:79],v[78:79],v[86:87]
 v_pk_add_f32 v[56:57],v[56:57],v[72:73]
 v_pk_add_f32 v[58:59],v[58:59],v[74:75]
 v_pk_add_f32 v[60:61],v[60:61],v[76:77]
 v_pk_add_f32 v[62:63],v[62:63],v[78:79]
 v_pk_fma_f32 v[56:57],v[56:57],v[28:29],v[104:105] op_sel_hi:[1,0,1]
 v_pk_fma_f32 v[58:59],v[58:59],v[28:29],v[106:107] op_sel_hi:[1,0,1]
 v_pk_fma_f32 v[60:61],v[60:61],v[28:29],v[108:109] op_sel_hi:[1,0,1]
 v_pk_fma_f32 v[62:63],v[62:63],v[28:29],v[110:111] op_sel_hi:[1,0,1]
 v_cvt_pk_bf16_f32 v64,v56,v57
 v_cvt_pk_bf16_f32 v65,v58,v59
 v_cvt_pk_bf16_f32 v66,v60,v61
 v_cvt_pk_bf16_f32 v67,v62,v63
 s_add_u32 s52,s80,32768
 buffer_store_dwordx4 v[64:67],v12,s[28:31],s52 offen sc1
 s_or_b32 s52,s2,s4
 s_cmp_lg_u32 s52,0
 s_cbranch_scc1 Le_348
 s_mov_b64 exec,1
 v_mov_b32 v24,s7
 buffer_store_dword v24,off,s[32:35],0 sc1
 s_mov_b64 exec,-1
Le_348:
 s_endpgm
Lfix_33:
 v_and_b32 v255,31,v0
 v_lshlrev_b32 v255,2,v255
 s_mul_i32 s84,s6,384
 s_add_u32 s84,s84,1441792
 buffer_load_dword v22,v255,s[32:35],s84 offen sc1
 buffer_load_dword v23,v255,s[32:35],s84 offen offset:256 sc1
 buffer_load_dword v34,v255,s[32:35],s84 offen offset:128 sc1
 s_waitcnt vmcnt(0)
 v_max_u32 v35,v22,v23
 v_max3_u32 v35,v34,v34,v35
 v_cmp_eq_u32 s[82:83],-1,v35
 s_nop 0
 s_cmp_eq_u64 s[82:83],0
 s_cbranch_scc1 Lok_35
 s_sub_u32 s55,s55,1
 s_cbranch_scc0 Lfix_33
 s_mov_b32 s55,0
Lok_35:
 s_branch Lret_34
Lfix_36:
 buffer_load_dwordx4 v[136:139],v2,s[32:35],s36 offen sc1
 buffer_load_dwordx4 v[140:143],v2,s[32:35],s36 offen offset:1024 sc1
 buffer_load_dwordx4 v[152:155],v2,s[32:35],s37 offen sc1
 buffer_load_dwordx4 v[156:159],v2,s[32:35],s37 offen offset:1024 sc1
 buffer_load_dwordx4 v[168:171],v2,s[32:35],s38 offen sc1
 buffer_load_dwordx4 v[172:175],v2,s[32:35],s38 offen offset:1024 sc1
 buffer_load_dwordx4 v[184:187],v2,s[32:35],s39 offen sc1
 s_add_u32 s84,s97,32768
 buffer_store_dword v38,off,s[32:35],s84
 buffer_load_dwordx4 v[188:191],v2,s[32:35],s39 offen offset:1024 sc1
 buffer_load_dwordx4 v[200:203],v2,s[32:35],s40 offen sc1
 buffer_load_dwordx4 v[204:207],v2,s[32:35],s40 offen offset:1024 sc1
 buffer_load_dwordx4 v[216:219],v2,s[32:35],s41 offen sc1
 s_waitcnt vmcnt(10)
 v_bitop3_b32 v38,v136,v140,1 bitop3:0x80
 v_cmp_eq_u32 vcc,0,v38
 s_cbranch_vccz Lok_38
 s_sub_u32 s55,s55,1
 s_cbranch_scc0 Lfix_36
 s_mov_b32 s55,0
Lok_38:
 s_branch Lret_37
Lfix_39:
 buffer_load_dwordx4 v[152:155],v2,s[32:35],s37 offen sc1
 buffer_load_dwordx4 v[156:159],v2,s[32:35],s37 offen offset:1024 sc1
 buffer_load_dwordx4 v[168:171],v2,s[32:35],s38 offen sc1
 buffer_load_dwordx4 v[172:175],v2,s[32:35],s38 offen offset:1024 sc1
 buffer_load_dwordx4 v[184:187],v2,s[32:35],s39 offen sc1
 s_add_u32 s84,s97,32768
 buffer_store_dword v38,off,s[32:35],s84
 buffer_load_dwordx4 v[188:191],v2,s[32:35],s39 offen offset:1024 sc1
 buffer_load_dwordx4 v[200:203],v2,s[32:35],s40 offen sc1
 buffer_load_dwordx4 v[204:207],v2,s[32:35],s40 offen offset:1024 sc1
 buffer_load_dwordx4 v[216:219],v2,s[32:35],s41 offen sc1
 buffer_load_dwordx4 v[220:223],v2,s[32:35],s41 offen offset:1024 sc1
 buffer_load_dwordx4 v[232:235],v2,s[32:35],s42 offen sc1
 s_waitcnt vmcnt(10)
 v_bitop3_b32 v38,v152,v156,1 bitop3:0x80
 v_cmp_eq_u32 vcc,0,v38
 s_cbranch_vccz Lok_41
 s_sub_u32 s55,s55,1
 s_cbranch_scc0 Lfix_39
 s_mov_b32 s55,0
Lok_41:
 s_branch Lret_40
Lfix_42:
 buffer_load_dwordx4 v[168:171],v2,s[32:35],s38 offen sc1
 buffer_load_dwordx4 v[172:175],v2,s[32:35],s38 offen offset:1024 sc1
 buffer_load_dwordx4 v[184:187],v2,s[32:35],s39 offen sc1
 s_add_u32 s84,s97,32768
 buffer_store_dword v38,off,s[32:35],s84
 buffer_load_dwordx4 v[188:191],v2,s[32:35],s39 offen offset:1024 sc1
 buffer_load_dwordx4 v[200:203],v2,s[32:35],s40 offen sc1
 buffer_load_dwordx4 v[204:207],v2,s[32:35],s40 offen offset:1024 sc1
 buffer_load_dwordx4 v[216:219],v2,s[32:35],s41 offen sc1
 buffer_load_dwordx4 v[220:223],v2,s[32:35],s41 offen offset:1024 sc1
 buffer_load_dwordx4 v[232:235],v2,s[32:35],s42 offen sc1
 buffer_load_dwordx4 v[236:239],v2,s[32:35],s42 offen offset:1024 sc1
 buffer_load_dwordx4 v[248:251],v2,s[32:35],s43 offen sc1
 s_waitcnt vmcnt(10)
 v_bitop3_b32 v38,v168,v172,1 bitop3:0x80
 v_cmp_eq_u32 vcc,0,v38
 s_cbranch_vccz Lok_44
 s_sub_u32 s55,s55,1
 s_cbranch_scc0 Lfix_42
 s_mov_b32 s55,0
Lok_44:
 s_branch Lret_43
Lfix_45:
 buffer_load_dwordx4 v[184:187],v2,s[32:35],s39 offen sc1
 buffer_load_dwordx4 v[188:191],v2,s[32:35],s39 offen offset:1024 sc1
 buffer_load_dwordx4 v[200:203],v2,s[32:35],s40 offen sc1
 buffer_load_dwordx4 v[204:207],v2,s[32:35],s40 offen offset:1024 sc1
 buffer_load_dwordx4 v[216:219],v2,s[32:35],s41 offen sc1
 buffer_load_dwordx4 v[220:223],v2,s[32:35],s41 offen offset:1024 sc1
 buffer_load_dwordx4 v[232:235],v2,s[32:35],s42 offen sc1
 buffer_load_dwordx4 v[236:239],v2,s[32:35],s42 offen offset:1024 sc1
 buffer_load_dwordx4 v[248:251],v2,s[32:35],s43 offen sc1
 buffer_load_dwordx4 v[252:255],v2,s[32:35],s43 offen offset:1024 sc1
 buffer_load_dwordx4 v[144:147],v2,s[32:35],s8 offen sc1
 s_waitcnt vmcnt(9)
 v_bitop3_b32 v38,v184,v188,1 bitop3:0x80
 v_cmp_eq_u32 vcc,0,v38
 s_cbranch_vccz Lok_47
 s_sub_u32 s55,s55,1
 s_cbranch_scc0 Lfix_45
 s_mov_b32 s55,0
Lok_47:
 s_branch Lret_46
Lfix_48:
 buffer_load_dwordx4 v[200:203],v2,s[32:35],s40 offen sc1
 buffer_load_dwordx4 v[204:207],v2,s[32:35],s40 offen offset:1024 sc1
 buffer_load_dwordx4 v[216:219],v2,s[32:35],s41 offen sc1
 buffer_load_dwordx4 v[220:223],v2,s[32:35],s41 offen offset:1024 sc1
 buffer_load_dwordx4 v[232:235],v2,s[32:35],s42 offen sc1
 buffer_load_dwordx4 v[236:239],v2,s[32:35],s42 offen offset:1024 sc1
 buffer_load_dwordx4 v[248:251],v2,s[32:35],s43 offen sc1
 buffer_load_dwordx4 v[252:255],v2,s[32:35],s43 offen offset:1024 sc1
 buffer_load_dwordx4 v[144:147],v2,s[32:35],s8 offen sc1
 buffer_load_dwordx4 v[148:151],v2,s[32:35],s8 offen offset:1024 sc1
 buffer_load_dwordx4 v[160:163],v2,s[32:35],s9 offen sc1
 s_waitcnt vmcnt(9)
 v_bitop3_b32 v38,v200,v204,1 bitop3:0x80
 v_cmp_eq_u32 vcc,0,v38
 s_cbranch_vccz Lok_50
 s_sub_u32 s55,s55,1
 s_cbranch_scc0 Lfix_48
 s_mov_b32 s55,0
Lok_50:
 s_branch Lret_49
Lfix_51:
 buffer_load_dwordx4 v[216:219],v2,s[32:35],s41 offen sc1
 buffer_load_dwordx4 v[220:223],v2,s[32:35],s41 offen offset:1024 sc1
 buffer_load_dwordx4 v[232:235],v2,s[32:35],s42 offen sc1
 buffer_load_dwordx4 v[236:239],v2,s[32:35],s42 offen offset:1024 sc1
 buffer_load_dwordx4 v[248:251],v2,s[32:35],s43 offen sc1
 buffer_load_dwordx4 v[252:255],v2,s[32:35],s43 offen offset:1024 sc1
 buffer_load_dwordx4 v[144:147],v2,s[32:35],s8 offen sc1
 buffer_load_dwordx4 v[148:151],v2,s[32:35],s8 offen offset:1024 sc1
 buffer_load_dwordx4 v[160:163],v2,s[32:35],s9 offen sc1
 buffer_load_dwordx4 v[164:167],v2,s[32:35],s9 offen offset:1024 sc1
 s_add_u32 s84,s97,32768
 buffer_store_dword v38,off,s[32:35],s84
 s_add_u32 s84,s97,32768
 buffer_store_dword v38,off,s[32:35],s84
 buffer_load_dwordx4 v[176:179],v2,s[32:35],s10 offen sc1
 s_waitcnt vmcnt(11)
 v_bitop3_b32 v38,v216,v220,1 bitop3:0x80
 v_cmp_eq_u32 vcc,0,v38
 s_cbranch_vccz Lok_53
 s_sub_u32 s55,s55,1
 s_cbranch_scc0 Lfix_51
 s_mov_b32 s55,0
Lok_53:
 s_branch Lret_52
Lfix_54:
 buffer_load_dwordx4 v[232:235],v2,s[32:35],s42 offen sc1
 buffer_load_dwordx4 v[236:239],v2,s[32:35],s42 offen offset:1024 sc1
 buffer_load_dwordx4 v[248:251],v2,s[32:35],s43 offen sc1
 buffer_load_dwordx4 v[252:255],v2,s[32:35],s43 offen offset:1024 sc1
 buffer_load_dwordx4 v[144:147],v2,s[32:35],s8 offen sc1
 buffer_load_dwordx4 v[148:151],v2,s[32:35],s8 offen offset:1024 sc1
 buffer_load_dwordx4 v[160:163],v2,s[32:35],s9 offen sc1
 buffer_load_dwordx4 v[164:167],v2,s[32:35],s9 offen offset:1024 sc1
 s_add_u32 s84,s97,32768
 buffer_store_dword v38,off,s[32:35],s84
 s_add_u32 s84,s97,32768
 buffer_store_dword v38,off,s[32:35],s84
 buffer_load_dwordx4 v[176:179],v2,s[32:35],s10 offen sc1
 buffer_load_dwordx4 v[180:183],v2,s[32:35],s10 offen offset:1024 sc1
 buffer_load_dwordx4 v[192:195],v2,s[32:35],s11 offen sc1
 s_waitcnt vmcnt(11)
 v_bitop3_b32 v38,v232,v236,1 bitop3:0x80
 v_cmp_eq_u32 vcc,0,v38
 s_cbranch_vccz Lok_56
 s_sub_u32 s55,s55,1
 s_cbranch_scc0 Lfix_54
 s_mov_b32 s55,0
Lok_56:
 s_branch Lret_55
Lfix_57:
 buffer_load_dwordx4 v[248:251],v2,s[32:35],s43 offen sc1
 buffer_load_dwordx4 v[252:255],v2,s[32:35],s43 offen offset:1024 sc1
 buffer_load_dwordx4 v[144:147],v2,s[32:35],s8 offen sc1
 buffer_load_dwordx4 v[148:151],v2,s[32:35],s8 offen offset:1024 sc1
 buffer_load_dwordx4 v[160:163],v2,s[32:35],s9 offen sc1
 buffer_load_dwordx4 v[164:167],v2,s[32:35],s9 offen offset:1024 sc1
 s_add_u32 s84,s97,32768
 buffer_store_dword v38,off,s[32:35],s84
 s_add_u32 s84,s97,32768
 buffer_store_dword v38,off,s[32:35],s84
 buffer_load_dwordx4 v[176:179],v2,s[32:35],s10 offen sc1
 buffer_load_dwordx4 v[180:183],v2,s[32:35],s10 offen offset:1024 sc1
 buffer_load_dwordx4 v[192:195],v2,s[32:35],s11 offen sc1
 buffer_load_dwordx4 v[196:199],v2,s[32:35],s11 offen offset:1024 sc1
 buffer_load_dwordx4 v[208:211],v2,s[32:35],s57 offen sc1
 s_waitcnt vmcnt(11)
 v_bitop3_b32 v38,v248,v252,1 bitop3:0x80
 v_cmp_eq_u32 vcc,0,v38
 s_cbranch_vccz Lok_59
 s_sub_u32 s55,s55,1
 s_cbranch_scc0 Lfix_57
 s_mov_b32 s55,0
Lok_59:
 s_branch Lret_58
Lfix_60:
 buffer_load_dwordx4 v[144:147],v2,s[32:35],s8 offen sc1
 buffer_load_dwordx4 v[148:151],v2,s[32:35],s8 offen offset:1024 sc1
 buffer_load_dwordx4 v[160:163],v2,s[32:35],s9 offen sc1
 buffer_load_dwordx4 v[164:167],v2,s[32:35],s9 offen offset:1024 sc1
 s_add_u32 s84,s97,32768
 buffer_store_dword v38,off,s[32:35],s84
 s_add_u32 s84,s97,32768
 buffer_store_dword v38,off,s[32:35],s84
 buffer_load_dwordx4 v[176:179],v2,s[32:35],s10 offen sc1
 buffer_load_dwordx4 v[180:183],v2,s[32:35],s10 offen offset:1024 sc1
 buffer_load_dwordx4 v[192:195],v2,s[32:35],s11 offen sc1
 buffer_load_dwordx4 v[196:199],v2,s[32:35],s11 offen offset:1024 sc1
 buffer_load_dwordx4 v[208:211],v2,s[32:35],s57 offen sc1
 buffer_load_dwordx4 v[212:215],v2,s[32:35],s57 offen offset:1024 sc1
 buffer_load_dwordx4 v[224:227],v2,s[32:35],s77 offen sc1
 s_waitcnt vmcnt(11)
 v_bitop3_b32 v38,v144,v148,1 bitop3:0x80
 v_cmp_eq_u32 vcc,0,v38
 s_cbranch_vccz Lok_62
 s_sub_u32 s55,s55,1
 s_cbranch_scc0 Lfix_60
 s_mov_b32 s55,0
Lok_62:
 s_branch Lret_61
Lfix_63:
 buffer_load_dwordx4 v[160:163],v2,s[32:35],s9 offen sc1
 buffer_load_dwordx4 v[164:167],v2,s[32:35],s9 offen offset:1024 sc1
 s_add_u32 s84,s97,32768
 buffer_store_dword v38,off,s[32:35],s84
 s_add_u32 s84,s97,32768
 buffer_store_dword v38,off,s[32:35],s84
 buffer_load_dwordx4 v[176:179],v2,s[32:35],s10 offen sc1
 buffer_load_dwordx4 v[180:183],v2,s[32:35],s10 offen offset:1024 sc1
 buffer_load_dwordx4 v[192:195],v2,s[32:35],s11 offen sc1
 buffer_load_dwordx4 v[196:199],v2,s[32:35],s11 offen offset:1024 sc1
 buffer_load_dwordx4 v[208:211],v2,s[32:35],s57 offen sc1
 buffer_load_dwordx4 v[212:215],v2,s[32:35],s57 offen offset:1024 sc1
 buffer_load_dwordx4 v[224:227],v2,s[32:35],s77 offen sc1
 buffer_load_dwordx4 v[228:231],v2,s[32:35],s77 offen offset:1024 sc1
 s_add_u32 s84,s97,32768
 buffer_store_dword v38,off,s[32:35],s84
 buffer_load_dwordx4 v[240:243],v2,s[32:35],s81 offen sc1
 s_add_u32 s84,s97,32768
 buffer_store_dword v38,off,s[32:35],s84
 s_waitcnt vmcnt(13)
 v_bitop3_b32 v38,v160,v164,1 bitop3:0x80
 v_cmp_eq_u32 vcc,0,v38
 s_cbranch_vccz Lok_65
 s_sub_u32 s55,s55,1
 s_cbranch_scc0 Lfix_63
 s_mov_b32 s55,0
Lok_65:
 s_branch Lret_64
Lfix_69:
 s_add_u32 s84,s58,0
 buffer_load_dwordx4 v[72:75],v13,s[32:35],s84 offen sc1
 buffer_load_dwordx4 v[76:79],v13,s[32:35],s84 offen offset:512 sc1
 s_waitcnt vmcnt(0)
 v_and_b32 v38,v72,v73
 v_bitop3_b32 v38,v74,v75,v38 bitop3:0x80
 v_bitop3_b32 v38,v76,v77,v38 bitop3:0x80
 v_bitop3_b32 v38,v78,v79,v38 bitop3:0x80
 v_and_b32 v38,1,v38
 v_cmp_eq_u32 s[82:83],0,v38
 s_nop 0
 s_cmp_eq_u64 s[82:83],0
 s_cbranch_scc1 Lok_71
 s_sub_u32 s55,s55,1
 s_cbranch_scc0 Lfix_69
 s_mov_b32 s55,0
Lok_71:
 s_branch Lret_70
Lfix_66:
 buffer_load_dwordx4 v[176:179],v2,s[32:35],s10 offen sc1
 buffer_load_dwordx4 v[180:183],v2,s[32:35],s10 offen offset:1024 sc1
 buffer_load_dwordx4 v[192:195],v2,s[32:35],s11 offen sc1
 buffer_load_dwordx4 v[196:199],v2,s[32:35],s11 offen offset:1024 sc1
 buffer_load_dwordx4 v[208:211],v2,s[32:35],s57 offen sc1
 buffer_load_dwordx4 v[212:215],v2,s[32:35],s57 offen offset:1024 sc1
 buffer_load_dwordx4 v[224:227],v2,s[32:35],s77 offen sc1
 buffer_load_dwordx4 v[228:231],v2,s[32:35],s77 offen offset:1024 sc1
 s_add_u32 s84,s97,32768
 buffer_store_dword v38,off,s[32:35],s84
 buffer_load_dwordx4 v[240:243],v2,s[32:35],s81 offen sc1
 s_add_u32 s84,s97,32768
 buffer_store_dword v38,off,s[32:35],s84
 buffer_load_dwordx4 v[244:247],v2,s[32:35],s81 offen offset:1024 sc1
 s_add_u32 s84,s97,32768
 buffer_store_dword v38,off,s[32:35],s84
 buffer_load_dwordx4 a[248:251],v2,s[32:35],s99 offen sc1
 s_add_u32 s84,s97,32768
 buffer_store_dword v38,off,s[32:35],s84
 s_waitcnt vmcnt(13)
 v_bitop3_b32 v38,v176,v180,1 bitop3:0x80
 v_cmp_eq_u32 vcc,0,v38
 s_cbranch_vccz Lok_68
 s_sub_u32 s55,s55,1
 s_cbranch_scc0 Lfix_66
 s_mov_b32 s55,0
Lok_68:
 s_branch Lret_67
Lfix_72:
 buffer_load_dwordx4 v[192:195],v2,s[32:35],s11 offen sc1
 buffer_load_dwordx4 v[196:199],v2,s[32:35],s11 offen offset:1024 sc1
 buffer_load_dwordx4 v[208:211],v2,s[32:35],s57 offen sc1
 buffer_load_dwordx4 v[212:215],v2,s[32:35],s57 offen offset:1024 sc1
 buffer_load_dwordx4 v[224:227],v2,s[32:35],s77 offen sc1
 buffer_load_dwordx4 v[228:231],v2,s[32:35],s77 offen offset:1024 sc1
 s_add_u32 s84,s97,32768
 buffer_store_dword v38,off,s[32:35],s84
 buffer_load_dwordx4 v[240:243],v2,s[32:35],s81 offen sc1
 s_add_u32 s84,s97,32768
 buffer_store_dword v38,off,s[32:35],s84
 buffer_load_dwordx4 v[244:247],v2,s[32:35],s81 offen offset:1024 sc1
 s_add_u32 s84,s97,32768
 buffer_store_dword v38,off,s[32:35],s84
 buffer_load_dwordx4 a[248:251],v2,s[32:35],s99 offen sc1
 s_add_u32 s84,s97,32768
 buffer_store_dword v38,off,s[32:35],s84
 buffer_load_dwordx4 a[252:255],v2,s[32:35],s99 offen offset:1024 sc1
 s_add_u32 s84,s97,32768
 buffer_store_dword v38,off,s[32:35],s84
 s_add_u32 s84,s97,32768
 buffer_store_dword v38,off,s[32:35],s84
 s_waitcnt vmcnt(14)
 v_bitop3_b32 v38,v192,v196,1 bitop3:0x80
 v_cmp_eq_u32 vcc,0,v38
 s_cbranch_vccz Lok_74
 s_sub_u32 s55,s55,1
 s_cbranch_scc0 Lfix_72
 s_mov_b32 s55,0
Lok_74:
 s_branch Lret_73
Lfix_75:
 buffer_load_dwordx4 v[208:211],v2,s[32:35],s57 offen sc1
 buffer_load_dwordx4 v[212:215],v2,s[32:35],s57 offen offset:1024 sc1
 buffer_load_dwordx4 v[224:227],v2,s[32:35],s77 offen sc1
 buffer_load_dwordx4 v[228:231],v2,s[32:35],s77 offen offset:1024 sc1
 s_add_u32 s84,s97,32768
 buffer_store_dword v38,off,s[32:35],s84
 buffer_load_dwordx4 v[240:243],v2,s[32:35],s81 offen sc1
 s_add_u32 s84,s97,32768
 buffer_store_dword v38,off,s[32:35],s84
 buffer_load_dwordx4 v[244:247],v2,s[32:35],s81 offen offset:1024 sc1
 s_add_u32 s84,s97,32768
 buffer_store_dword v38,off,s[32:35],s84
 buffer_load_dwordx4 a[248:251],v2,s[32:35],s99 offen sc1
 s_add_u32 s84,s97,32768
 buffer_store_dword v38,off,s[32:35],s84
 buffer_load_dwordx4 a[252:255],v2,s[32:35],s99 offen offset:1024 sc1
 s_add_u32 s84,s97,32768
 buffer_store_dword v38,off,s[32:35],s84
 s_add_u32 s84,s97,32768
 buffer_store_dword v38,off,s[32:35],s84
 s_add_u32 s84,s97,32768
 buffer_store_dword v38,off,s[32:35],s84
 s_add_u32 s84,s97,32768
 buffer_store_dword v38,off,s[32:35],s84
 s_waitcnt vmcnt(14)
 v_bitop3_b32 v38,v208,v212,1 bitop3:0x80
 v_cmp_eq_u32 vcc,0,v38
 s_cbranch_vccz Lok_77
 s_sub_u32 s55,s55,1
 s_cbranch_scc0 Lfix_75
 s_mov_b32 s55,0
Lok_77:
 s_branch Lret_76
Lfix_78:
 buffer_load_dwordx4 v[224:227],v2,s[32:35],s77 offen sc1
 buffer_load_dwordx4 v[228:231],v2,s[32:35],s77 offen offset:1024 sc1
 s_add_u32 s84,s97,32768
 buffer_store_dword v38,off,s[32:35],s84
 buffer_load_dwordx4 v[240:243],v2,s[32:35],s81 offen sc1
 s_add_u32 s84,s97,32768
 buffer_store_dword v38,off,s[32:35],s84
 buffer_load_dwordx4 v[244:247],v2,s[32:35],s81 offen offset:1024 sc1
 s_add_u32 s84,s97,32768
 buffer_store_dword v38,off,s[32:35],s84
 buffer_load_dwordx4 a[248:251],v2,s[32:35],s99 offen sc1
 s_add_u32 s84,s97,32768
 buffer_store_dword v38,off,s[32:35],s84
 buffer_load_dwordx4 a[252:255],v2,s[32:35],s99 offen offset:1024 sc1
 s_add_u32 s84,s97,32768
 buffer_store_dword v38,off,s[32:35],s84
 s_add_u32 s84,s97,32768
 buffer_store_dword v38,off,s[32:35],s84
 s_add_u32 s84,s97,32768
 buffer_store_dword v38,off,s[32:35],s84
 s_add_u32 s84,s97,32768
 buffer_store_dword v38,off,s[32:35],s84
 s_waitcnt vmcnt(12)
 v_bitop3_b32 v38,v224,v228,1 bitop3:0x80
 v_cmp_eq_u32 vcc,0,v38
 s_cbranch_vccz Lok_80
 s_sub_u32 s55,s55,1
 s_cbranch_scc0 Lfix_78
 s_mov_b32 s55,0
Lok_80:
 s_branch Lret_79
Lfix_81:
 buffer_load_dwordx4 v[240:243],v2,s[32:35],s81 offen sc1
 buffer_load_dwordx4 v[244:247],v2,s[32:35],s81 offen offset:1024 sc1
 s_add_u32 s84,s97,32768
 buffer_store_dword v38,off,s[32:35],s84
 buffer_load_dwordx4 a[248:251],v2,s[32:35],s99 offen sc1
 s_add_u32 s84,s97,32768
 buffer_store_dword v38,off,s[32:35],s84
 buffer_load_dwordx4 a[252:255],v2,s[32:35],s99 offen offset:1024 sc1
 s_add_u32 s84,s97,32768
 buffer_store_dword v38,off,s[32:35],s84
 s_add_u32 s84,s97,32768
 buffer_store_dword v38,off,s[32:35],s84
 s_add_u32 s84,s97,32768
 buffer_store_dword v38,off,s[32:35],s84
 s_add_u32 s84,s97,32768
 buffer_store_dword v38,off,s[32:35],s84
 s_add_u32 s84,s97,32768
 buffer_store_dword v38,off,s[32:35],s84
 s_add_u32 s84,s97,32768
 buffer_store_dword v38,off,s[32:35],s84
 s_add_u32 s84,s97,32768
 buffer_store_dword v38,off,s[32:35],s84
 s_add_u32 s84,s97,32768
 buffer_store_dword v38,off,s[32:35],s84
 s_add_u32 s84,s97,32768
 buffer_store_dword v38,off,s[32:35],s84
 s_add_u32 s84,s97,32768
 buffer_store_dword v38,off,s[32:35],s84
 s_add_u32 s84,s97,32768
 buffer_store_dword v38,off,s[32:35],s84
 s_add_u32 s84,s97,32768
 buffer_store_dword v38,off,s[32:35],s84
 s_waitcnt vmcnt(16)
 v_bitop3_b32 v38,v240,v244,1 bitop3:0x80
 v_cmp_eq_u32 vcc,0,v38
 s_cbranch_vccz Lok_83
 s_sub_u32 s55,s55,1
 s_cbranch_scc0 Lfix_81
 s_mov_b32 s55,0
Lok_83:
 s_branch Lret_82
Lfix_84:
 buffer_load_dwordx4 a[248:251],v2,s[32:35],s99 offen sc1
 buffer_load_dwordx4 a[252:255],v2,s[32:35],s99 offen offset:1024 sc1
 s_add_u32 s84,s97,32768
 buffer_store_dword v38,off,s[32:35],s84
 s_add_u32 s84,s97,32768
 buffer_store_dword v38,off,s[32:35],s84
 s_add_u32 s84,s97,32768
 buffer_store_dword v38,off,s[32:35],s84
 s_add_u32 s84,s97,32768
 buffer_store_dword v38,off,s[32:35],s84
 s_add_u32 s84,s97,32768
 buffer_store_dword v38,off,s[32:35],s84
 s_add_u32 s84,s97,32768
 buffer_store_dword v38,off,s[32:35],s84
 s_add_u32 s84,s97,32768
 buffer_store_dword v38,off,s[32:35],s84
 s_add_u32 s84,s97,32768
 buffer_store_dword v38,off,s[32:35],s84
 s_add_u32 s84,s97,32768
 buffer_store_dword v38,off,s[32:35],s84
 s_add_u32 s84,s97,32768
 buffer_store_dword v38,off,s[32:35],s84
 s_add_u32 s84,s97,32768
 buffer_store_dword v38,off,s[32:35],s84
 s_add_u32 s84,s97,32768
 buffer_store_dword v38,off,s[32:35],s84
 s_waitcnt vmcnt(12)
 v_accvgpr_read_b32 v38,a248
 v_lshlrev_b32 v38,31,v38
 v_cmp_eq_u32 s[82:83],0,v38
 v_accvgpr_read_b32 v38,a252
 v_lshlrev_b32 v38,31,v38
 v_cmp_eq_u32 vcc,0,v38
 s_nop 1
 s_or_b64 vcc,vcc,s[82:83]
 s_cbranch_vccz Lok_86
 s_sub_u32 s55,s55,1
 s_cbranch_scc0 Lfix_84
 s_mov_b32 s55,0
Lok_86:
 s_branch Lret_85
Lfix_89:
 s_bfe_u32 s84,s44,0x50000
 s_lshl_b32 s84,s84,12
 buffer_load_dwordx4 v[136:139],v32,s[32:35],s84 offen sc1
 s_bfe_u32 s84,s44,0x50000
 s_lshl_b32 s84,s84,12
 buffer_load_dwordx4 v[140:143],v33,s[32:35],s84 offen sc1
 s_bfe_u32 s84,s44,0x50005
 s_lshl_b32 s84,s84,12
 buffer_load_dwordx4 v[144:147],v32,s[32:35],s84 offen sc1
 s_bfe_u32 s84,s44,0x50005
 s_lshl_b32 s84,s84,12
 buffer_load_dwordx4 v[148:151],v33,s[32:35],s84 offen sc1
 s_bfe_u32 s84,s44,0x5000a
 s_lshl_b32 s84,s84,12
 buffer_load_dwordx4 v[152:155],v32,s[32:35],s84 offen sc1
 s_bfe_u32 s84,s44,0x5000a
 s_lshl_b32 s84,s84,12
 buffer_load_dwordx4 v[156:159],v33,s[32:35],s84 offen sc1
 s_bfe_u32 s84,s44,0x5000f
 s_lshl_b32 s84,s84,12
 buffer_load_dwordx4 v[160:163],v32,s[32:35],s84 offen sc1
 s_bfe_u32 s84,s44,0x5000f
 s_lshl_b32 s84,s84,12
 buffer_load_dwordx4 v[164:167],v33,s[32:35],s84 offen sc1
 s_bfe_u32 s84,s44,0x50014
 s_lshl_b32 s84,s84,12
 buffer_load_dwordx4 v[168:171],v32,s[32:35],s84 offen sc1
 s_bfe_u32 s84,s44,0x50014
 s_lshl_b32 s84,s84,12
 buffer_load_dwordx4 v[172:175],v33,s[32:35],s84 offen sc1
 s_add_u32 s84,s97,32768
 buffer_store_dword v38,off,s[32:35],s84
 s_add_u32 s84,s97,32768
 buffer_store_dword v38,off,s[32:35],s84
 s_add_u32 s84,s97,32768
 buffer_store_dword v38,off,s[32:35],s84
 s_add_u32 s84,s97,32768
 buffer_store_dword v38,off,s[32:35],s84
 s_add_u32 s84,s97,32768
 buffer_store_dword v38,off,s[32:35],s84
 s_add_u32 s84,s97,32768
 buffer_store_dword v38,off,s[32:35],s84
 s_add_u32 s84,s97,32768
 buffer_store_dword v38,off,s[32:35],s84
 s_add_u32 s84,s97,32768
 buffer_store_dword v38,off,s[32:35],s84
 s_add_u32 s84,s97,32768
 buffer_store_dword v38,off,s[32:35],s84
 s_add_u32 s84,s97,32768
 buffer_store_dword v38,off,s[32:35],s84
 s_add_u32 s84,s97,32768
 buffer_store_dword v38,off,s[32:35],s84
 s_add_u32 s84,s97,32768
 buffer_store_dword v38,off,s[32:35],s84
 s_add_u32 s84,s97,32768
 buffer_store_dword v38,off,s[32:35],s84
 s_add_u32 s84,s97,32768
 buffer_store_dword v38,off,s[32:35],s84
 s_waitcnt vmcnt(22)
 v_xor_b32 v136,0x80000000,v136
 v_xor_b32 v140,0x80000000,v140
 v_or_b32 v38,v136,v140
 v_cmp_gt_i32 vcc,0,v38
 s_cbranch_vccz Lok_91
 s_sub_u32 s55,s55,1
 s_cbranch_scc0 Lfix_89
 s_mov_b32 s55,0
Lok_91:
 s_branch Lret_90
Lfix_92:
 s_bfe_u32 s84,s44,0x50005
 s_lshl_b32 s84,s84,12
 buffer_load_dwordx4 v[144:147],v32,s[32:35],s84 offen sc1
 s_bfe_u32 s84,s44,0x50005
 s_lshl_b32 s84,s84,12
 buffer_load_dwordx4 v[148:151],v33,s[32:35],s84 offen sc1
 s_bfe_u32 s84,s44,0x5000a
 s_lshl_b32 s84,s84,12
 buffer_load_dwordx4 v[152:155],v32,s[32:35],s84 offen sc1
 s_bfe_u32 s84,s44,0x5000a
 s_lshl_b32 s84,s84,12
 buffer_load_dwordx4 v[156:159],v33,s[32:35],s84 offen sc1
 s_bfe_u32 s84,s44,0x5000f
 s_lshl_b32 s84,s84,12
 buffer_load_dwordx4 v[160:163],v32,s[32:35],s84 offen sc1
 s_bfe_u32 s84,s44,0x5000f
 s_lshl_b32 s84,s84,12
 buffer_load_dwordx4 v[164:167],v33,s[32:35],s84 offen sc1
 s_bfe_u32 s84,s44,0x50014
 s_lshl_b32 s84,s84,12
 buffer_load_dwordx4 v[168:171],v32,s[32:35],s84 offen sc1
 s_bfe_u32 s84,s44,0x50014
 s_lshl_b32 s84,s84,12
 buffer_load_dwordx4 v[172:175],v33,s[32:35],s84 offen sc1
 s_add_u32 s84,s97,32768
 buffer_store_dword v38,off,s[32:35],s84
 s_add_u32 s84,s97,32768
 buffer_store_dword v38,off,s[32:35],s84
 s_add_u32 s84,s97,32768
 buffer_store_dword v38,off,s[32:35],s84
 s_add_u32 s84,s97,32768
 buffer_store_dword v38,off,s[32:35],s84
 s_add_u32 s84,s97,32768
 buffer_store_dword v38,off,s[32:35],s84
 s_add_u32 s84,s97,32768
 buffer_store_dword v38,off,s[32:35],s84
 s_add_u32 s84,s97,32768
 buffer_store_dword v38,off,s[32:35],s84
 s_add_u32 s84,s97,32768
 buffer_store_dword v38,off,s[32:35],s84
 s_add_u32 s84,s97,32768
 buffer_store_dword v38,off,s[32:35],s84
 s_add_u32 s84,s97,32768
 buffer_store_dword v38,off,s[32:35],s84
 s_add_u32 s84,s97,32768
 buffer_store_dword v38,off,s[32:35],s84
 s_add_u32 s84,s97,32768
 buffer_store_dword v38,off,s[32:35],s84
 s_add_u32 s84,s97,32768
 buffer_store_dword v38,off,s[32:35],s84
 s_add_u32 s84,s97,32768
 buffer_store_dword v38,off,s[32:35],s84
 s_bfe_u32 s84,s44,0x50019
 s_lshl_b32 s84,s84,12
 buffer_load_dwordx4 v[176:179],v32,s[32:35],s84 offen sc1
 s_bfe_u32 s84,s44,0x50019
 s_lshl_b32 s84,s84,12
 buffer_load_dwordx4 v[180:183],v33,s[32:35],s84 offen sc1
 s_waitcnt vmcnt(22)
 v_xor_b32 v144,0x80000000,v144
 v_xor_b32 v148,0x80000000,v148
 v_or_b32 v38,v144,v148
 v_cmp_gt_i32 vcc,0,v38
 s_cbranch_vccz Lok_94
 s_sub_u32 s55,s55,1
 s_cbranch_scc0 Lfix_92
 s_mov_b32 s55,0
Lok_94:
 s_branch Lret_93
Lfix_95:
 s_bfe_u32 s84,s44,0x5000a
 s_lshl_b32 s84,s84,12
 buffer_load_dwordx4 v[152:155],v32,s[32:35],s84 offen sc1
 s_bfe_u32 s84,s44,0x5000a
 s_lshl_b32 s84,s84,12
 buffer_load_dwordx4 v[156:159],v33,s[32:35],s84 offen sc1
 s_bfe_u32 s84,s44,0x5000f
 s_lshl_b32 s84,s84,12
 buffer_load_dwordx4 v[160:163],v32,s[32:35],s84 offen sc1
 s_bfe_u32 s84,s44,0x5000f
 s_lshl_b32 s84,s84,12
 buffer_load_dwordx4 v[164:167],v33,s[32:35],s84 offen sc1
 s_bfe_u32 s84,s44,0x50014
 s_lshl_b32 s84,s84,12
 buffer_load_dwordx4 v[168:171],v32,s[32:35],s84 offen sc1
 s_bfe_u32 s84,s44,0x50014
 s_lshl_b32 s84,s84,12
 buffer_load_dwordx4 v[172:175],v33,s[32:35],s84 offen sc1
 s_add_u32 s84,s97,32768
 buffer_store_dword v38,off,s[32:35],s84
 s_add_u32 s84,s97,32768
 buffer_store_dword v38,off,s[32:35],s84
 s_add_u32 s84,s97,32768
 buffer_store_dword v38,off,s[32:35],s84
 s_add_u32 s84,s97,32768
 buffer_store_dword v38,off,s[32:35],s84
 s_add_u32 s84,s97,32768
 buffer_store_dword v38,off,s[32:35],s84
 s_add_u32 s84,s97,32768
 buffer_store_dword v38,off,s[32:35],s84
 s_add_u32 s84,s97,32768
 buffer_store_dword v38,off,s[32:35],s84
 s_add_u32 s84,s97,32768
 buffer_store_dword v38,off,s[32:35],s84
 s_add_u32 s84,s97,32768
 buffer_store_dword v38,off,s[32:35],s84
 s_add_u32 s84,s97,32768
 buffer_store_dword v38,off,s[32:35],s84
 s_add_u32 s84,s97,32768
 buffer_store_dword v38,off,s[32:35],s84
 s_add_u32 s84,s97,32768
 buffer_store_dword v38,off,s[32:35],s84
 s_add_u32 s84,s97,32768
 buffer_store_dword v38,off,s[32:35],s84
 s_add_u32 s84,s97,32768
 buffer_store_dword v38,off,s[32:35],s84
 s_bfe_u32 s84,s44,0x50019
 s_lshl_b32 s84,s84,12
 buffer_load_dwordx4 v[176:179],v32,s[32:35],s84 offen sc1
 s_bfe_u32 s84,s44,0x50019
 s_lshl_b32 s84,s84,12
 buffer_load_dwordx4 v[180:183],v33,s[32:35],s84 offen sc1
 s_bfe_u32 s84,s45,0x50000
 s_lshl_b32 s84,s84,12
 buffer_load_dwordx4 v[184:187],v32,s[32:35],s84 offen sc1
 s_bfe_u32 s84,s45,0x50000
 s_lshl_b32 s84,s84,12
 buffer_load_dwordx4 v[188:191],v33,s[32:35],s84 offen sc1
 s_waitcnt vmcnt(22)
 v_xor_b32 v152,0x80000000,v152
 v_xor_b32 v156,0x80000000,v156
 v_or_b32 v38,v152,v156
 v_cmp_gt_i32 vcc,0,v38
 s_cbranch_vccz Lok_97
 s_sub_u32 s55,s55,1
 s_cbranch_scc0 Lfix_95
 s_mov_b32 s55,0
Lok_97:
 s_branch Lret_96
Lfix_98:
 s_bfe_u32 s84,s44,0x5000f
 s_lshl_b32 s84,s84,12
 buffer_load_dwordx4 v[160:163],v32,s[32:35],s84 offen sc1
 s_bfe_u32 s84,s44,0x5000f
 s_lshl_b32 s84,s84,12
 buffer_load_dwordx4 v[164:167],v33,s[32:35],s84 offen sc1
 s_add_u32 s84,s97,32768
 buffer_store_dword v38,off,s[32:35],s84
 s_add_u32 s84,s97,32768
 buffer_store_dword v38,off,s[32:35],s84
 s_bfe_u32 s84,s44,0x50019
 s_lshl_b32 s84,s84,12
 buffer_load_dwordx4 v[176:179],v32,s[32:35],s84 offen sc1
 s_bfe_u32 s84,s44,0x50019
 s_lshl_b32 s84,s84,12
 buffer_load_dwordx4 v[180:183],v33,s[32:35],s84 offen sc1
 s_bfe_u32 s84,s45,0x50000
 s_lshl_b32 s84,s84,12
 buffer_load_dwordx4 v[184:187],v32,s[32:35],s84 offen sc1
 s_bfe_u32 s84,s45,0x50000
 s_lshl_b32 s84,s84,12
 buffer_load_dwordx4 v[188:191],v33,s[32:35],s84 offen sc1
 s_bfe_u32 s84,s45,0x50005
 s_lshl_b32 s84,s84,12
 buffer_load_dwordx4 v[192:195],v32,s[32:35],s84 offen sc1
 s_bfe_u32 s84,s45,0x50005
 s_lshl_b32 s84,s84,12
 buffer_load_dwordx4 v[196:199],v33,s[32:35],s84 offen sc1
 s_waitcnt vmcnt(8)
 v_xor_b32 v160,0x80000000,v160
 v_xor_b32 v164,0x80000000,v164
 v_or_b32 v38,v160,v164
 v_cmp_gt_i32 vcc,0,v38
 s_cbranch_vccz Lok_100
 s_sub_u32 s55,s55,1
 s_cbranch_scc0 Lfix_98
 s_mov_b32 s55,0
Lok_100:
 s_branch Lret_99
Lfix_101:
 s_bfe_u32 s84,s44,0x50014
 s_lshl_b32 s84,s84,12
 buffer_load_dwordx4 v[168:171],v32,s[32:35],s84 offen sc1
 s_bfe_u32 s84,s44,0x50014
 s_lshl_b32 s84,s84,12
 buffer_load_dwordx4 v[172:175],v33,s[32:35],s84 offen sc1
 s_add_u32 s84,s97,32768
 buffer_store_dword v38,off,s[32:35],s84
 s_add_u32 s84,s97,32768
 buffer_store_dword v38,off,s[32:35],s84
 s_bfe_u32 s84,s44,0x50019
 s_lshl_b32 s84,s84,12
 buffer_load_dwordx4 v[176:179],v32,s[32:35],s84 offen sc1
 s_bfe_u32 s84,s44,0x50019
 s_lshl_b32 s84,s84,12
 buffer_load_dwordx4 v[180:183],v33,s[32:35],s84 offen sc1
 s_bfe_u32 s84,s45,0x50000
 s_lshl_b32 s84,s84,12
 buffer_load_dwordx4 v[184:187],v32,s[32:35],s84 offen sc1
 s_bfe_u32 s84,s45,0x50000
 s_lshl_b32 s84,s84,12
 buffer_load_dwordx4 v[188:191],v33,s[32:35],s84 offen sc1
 s_bfe_u32 s84,s45,0x50005
 s_lshl_b32 s84,s84,12
 buffer_load_dwordx4 v[192:195],v32,s[32:35],s84 offen sc1
 s_bfe_u32 s84,s45,0x50005
 s_lshl_b32 s84,s84,12
 buffer_load_dwordx4 v[196:199],v33,s[32:35],s84 offen sc1
 s_bfe_u32 s84,s45,0x5000a
 s_lshl_b32 s84,s84,12
 buffer_load_dwordx4 v[200:203],v32,s[32:35],s84 offen sc1
 s_bfe_u32 s84,s45,0x5000a
 s_lshl_b32 s84,s84,12
 buffer_load_dwordx4 v[204:207],v33,s[32:35],s84 offen sc1
 s_waitcnt vmcnt(10)
 v_xor_b32 v168,0x80000000,v168
 v_xor_b32 v172,0x80000000,v172
 v_or_b32 v38,v168,v172
 v_cmp_gt_i32 vcc,0,v38
 s_cbranch_vccz Lok_103
 s_sub_u32 s55,s55,1
 s_cbranch_scc0 Lfix_101
 s_mov_b32 s55,0
Lok_103:
 s_branch Lret_102
Lfix_104:
 s_bfe_u32 s84,s44,0x50019
 s_lshl_b32 s84,s84,12
 buffer_load_dwordx4 v[176:179],v32,s[32:35],s84 offen sc1
 s_bfe_u32 s84,s44,0x50019
 s_lshl_b32 s84,s84,12
 buffer_load_dwordx4 v[180:183],v33,s[32:35],s84 offen sc1
 s_bfe_u32 s84,s45,0x50000
 s_lshl_b32 s84,s84,12
 buffer_load_dwordx4 v[184:187],v32,s[32:35],s84 offen sc1
 s_bfe_u32 s84,s45,0x50000
 s_lshl_b32 s84,s84,12
 buffer_load_dwordx4 v[188:191],v33,s[32:35],s84 offen sc1
 s_bfe_u32 s84,s45,0x50005
 s_lshl_b32 s84,s84,12
 buffer_load_dwordx4 v[192:195],v32,s[32:35],s84 offen sc1
 s_bfe_u32 s84,s45,0x50005
 s_lshl_b32 s84,s84,12
 buffer_load_dwordx4 v[196:199],v33,s[32:35],s84 offen sc1
 s_bfe_u32 s84,s45,0x5000a
 s_lshl_b32 s84,s84,12
 buffer_load_dwordx4 v[200:203],v32,s[32:35],s84 offen sc1
 s_bfe_u32 s84,s45,0x5000a
 s_lshl_b32 s84,s84,12
 buffer_load_dwordx4 v[204:207],v33,s[32:35],s84 offen sc1
 s_bfe_u32 s84,s45,0x5000f
 s_lshl_b32 s84,s84,12
 buffer_load_dwordx4 v[208:211],v32,s[32:35],s84 offen sc1
 s_bfe_u32 s84,s45,0x5000f
 s_lshl_b32 s84,s84,12
 buffer_load_dwordx4 v[212:215],v33,s[32:35],s84 offen sc1
 s_waitcnt vmcnt(8)
 v_xor_b32 v176,0x80000000,v176
 v_xor_b32 v180,0x80000000,v180
 v_or_b32 v38,v176,v180
 v_cmp_gt_i32 vcc,0,v38
 s_cbranch_vccz Lok_106
 s_sub_u32 s55,s55,1
 s_cbranch_scc0 Lfix_104
 s_mov_b32 s55,0
Lok_106:
 s_branch Lret_105
Lfix_107:
 s_bfe_u32 s84,s45,0x50000
 s_lshl_b32 s84,s84,12
 buffer_load_dwordx4 v[184:187],v32,s[32:35],s84 offen sc1
 s_bfe_u32 s84,s45,0x50000
 s_lshl_b32 s84,s84,12
 buffer_load_dwordx4 v[188:191],v33,s[32:35],s84 offen sc1
 s_bfe_u32 s84,s45,0x50005
 s_lshl_b32 s84,s84,12
 buffer_load_dwordx4 v[192:195],v32,s[32:35],s84 offen sc1
 s_bfe_u32 s84,s45,0x50005
 s_lshl_b32 s84,s84,12
 buffer_load_dwordx4 v[196:199],v33,s[32:35],s84 offen sc1
 s_bfe_u32 s84,s45,0x5000a
 s_lshl_b32 s84,s84,12
 buffer_load_dwordx4 v[200:203],v32,s[32:35],s84 offen sc1
 s_bfe_u32 s84,s45,0x5000a
 s_lshl_b32 s84,s84,12
 buffer_load_dwordx4 v[204:207],v33,s[32:35],s84 offen sc1
 s_bfe_u32 s84,s45,0x5000f
 s_lshl_b32 s84,s84,12
 buffer_load_dwordx4 v[208:211],v32,s[32:35],s84 offen sc1
 s_bfe_u32 s84,s45,0x5000f
 s_lshl_b32 s84,s84,12
 buffer_load_dwordx4 v[212:215],v33,s[32:35],s84 offen sc1
 s_bfe_u32 s84,s45,0x50014
 s_lshl_b32 s84,s84,12
 buffer_load_dwordx4 v[216:219],v32,s[32:35],s84 offen sc1
 s_bfe_u32 s84,s45,0x50014
 s_lshl_b32 s84,s84,12
 buffer_load_dwordx4 v[220:223],v33,s[32:35],s84 offen sc1
 s_waitcnt vmcnt(8)
 v_xor_b32 v184,0x80000000,v184
 v_xor_b32 v188,0x80000000,v188
 v_or_b32 v38,v184,v188
 v_cmp_gt_i32 vcc,0,v38
 s_cbranch_vccz Lok_109
 s_sub_u32 s55,s55,1
 s_cbranch_scc0 Lfix_107
 s_mov_b32 s55,0
Lok_109:
 s_branch Lret_108
Lfix_110:
 s_bfe_u32 s84,s45,0x50005
 s_lshl_b32 s84,s84,12
 buffer_load_dwordx4 v[192:195],v32,s[32:35],s84 offen sc1
 s_bfe_u32 s84,s45,0x50005
 s_lshl_b32 s84,s84,12
 buffer_load_dwordx4 v[196:199],v33,s[32:35],s84 offen sc1
 s_bfe_u32 s84,s45,0x5000a
 s_lshl_b32 s84,s84,12
 buffer_load_dwordx4 v[200:203],v32,s[32:35],s84 offen sc1
 s_bfe_u32 s84,s45,0x5000a
 s_lshl_b32 s84,s84,12
 buffer_load_dwordx4 v[204:207],v33,s[32:35],s84 offen sc1
 s_bfe_u32 s84,s45,0x5000f
 s_lshl_b32 s84,s84,12
 buffer_load_dwordx4 v[208:211],v32,s[32:35],s84 offen sc1
 s_bfe_u32 s84,s45,0x5000f
 s_lshl_b32 s84,s84,12
 buffer_load_dwordx4 v[212:215],v33,s[32:35],s84 offen sc1
 s_bfe_u32 s84,s45,0x50014
 s_lshl_b32 s84,s84,12
 buffer_load_dwordx4 v[216:219],v32,s[32:35],s84 offen sc1
 s_bfe_u32 s84,s45,0x50014
 s_lshl_b32 s84,s84,12
 buffer_load_dwordx4 v[220:223],v33,s[32:35],s84 offen sc1
 s_bfe_u32 s84,s45,0x50019
 s_lshl_b32 s84,s84,12
 buffer_load_dwordx4 v[224:227],v32,s[32:35],s84 offen sc1
 s_bfe_u32 s84,s45,0x50019
 s_lshl_b32 s84,s84,12
 buffer_load_dwordx4 v[228:231],v33,s[32:35],s84 offen sc1
 s_waitcnt vmcnt(8)
 v_xor_b32 v192,0x80000000,v192
 v_xor_b32 v196,0x80000000,v196
 v_or_b32 v38,v192,v196
 v_cmp_gt_i32 vcc,0,v38
 s_cbranch_vccz Lok_112
 s_sub_u32 s55,s55,1
 s_cbranch_scc0 Lfix_110
 s_mov_b32 s55,0
Lok_112:
 s_branch Lret_111
Lfix_113:
 s_bfe_u32 s84,s45,0x5000a
 s_lshl_b32 s84,s84,12
 buffer_load_dwordx4 v[200:203],v32,s[32:35],s84 offen sc1
 s_bfe_u32 s84,s45,0x5000a
 s_lshl_b32 s84,s84,12
 buffer_load_dwordx4 v[204:207],v33,s[32:35],s84 offen sc1
 s_bfe_u32 s84,s45,0x5000f
 s_lshl_b32 s84,s84,12
 buffer_load_dwordx4 v[208:211],v32,s[32:35],s84 offen sc1
 s_bfe_u32 s84,s45,0x5000f
 s_lshl_b32 s84,s84,12
 buffer_load_dwordx4 v[212:215],v33,s[32:35],s84 offen sc1
 s_bfe_u32 s84,s45,0x50014
 s_lshl_b32 s84,s84,12
 buffer_load_dwordx4 v[216:219],v32,s[32:35],s84 offen sc1
 s_bfe_u32 s84,s45,0x50014
 s_lshl_b32 s84,s84,12
 buffer_load_dwordx4 v[220:223],v33,s[32:35],s84 offen sc1
 s_bfe_u32 s84,s45,0x50019
 s_lshl_b32 s84,s84,12
 buffer_load_dwordx4 v[224:227],v32,s[32:35],s84 offen sc1
 s_bfe_u32 s84,s45,0x50019
 s_lshl_b32 s84,s84,12
 buffer_load_dwordx4 v[228:231],v33,s[32:35],s84 offen sc1
 s_bfe_u32 s84,s46,0x50000
 s_lshl_b32 s84,s84,12
 buffer_load_dwordx4 v[136:139],v32,s[32:35],s84 offen sc1
 s_bfe_u32 s84,s46,0x50000
 s_lshl_b32 s84,s84,12
 buffer_load_dwordx4 v[140:143],v33,s[32:35],s84 offen sc1
 s_waitcnt vmcnt(8)
 v_xor_b32 v200,0x80000000,v200
 v_xor_b32 v204,0x80000000,v204
 v_or_b32 v38,v200,v204
 v_cmp_gt_i32 vcc,0,v38
 s_cbranch_vccz Lok_115
 s_sub_u32 s55,s55,1
 s_cbranch_scc0 Lfix_113
 s_mov_b32 s55,0
Lok_115:
 s_branch Lret_114
Lfix_116:
 s_add_u32 s84,s72,0
 buffer_load_dwordx4 v[24:27],v3,s[32:35],s84 offen sc1
 s_waitcnt vmcnt(0)
 v_and_b32 v30,v24,v25
 v_bitop3_b32 v30,v26,v27,v30 bitop3:0x80
 v_and_b32 v30,1,v30
 v_cmp_eq_u32 s[82:83],0,v30
 s_nop 0
 s_cmp_eq_u64 s[82:83],0
 s_cbranch_scc1 Lok_118
 s_sub_u32 s55,s55,1
 s_cbranch_scc0 Lfix_116
 s_mov_b32 s55,0
Lok_118:
 s_branch Lret_117
Lfix_119:
 s_bfe_u32 s84,s45,0x5000f
 s_lshl_b32 s84,s84,12
 buffer_load_dwordx4 v[208:211],v32,s[32:35],s84 offen sc1
 s_bfe_u32 s84,s45,0x5000f
 s_lshl_b32 s84,s84,12
 buffer_load_dwordx4 v[212:215],v33,s[32:35],s84 offen sc1
 s_bfe_u32 s84,s45,0x50014
 s_lshl_b32 s84,s84,12
 buffer_load_dwordx4 v[216:219],v32,s[32:35],s84 offen sc1
 s_bfe_u32 s84,s45,0x50014
 s_lshl_b32 s84,s84,12
 buffer_load_dwordx4 v[220:223],v33,s[32:35],s84 offen sc1
 s_bfe_u32 s84,s45,0x50019
 s_lshl_b32 s84,s84,12
 buffer_load_dwordx4 v[224:227],v32,s[32:35],s84 offen sc1
 s_bfe_u32 s84,s45,0x50019
 s_lshl_b32 s84,s84,12
 buffer_load_dwordx4 v[228:231],v33,s[32:35],s84 offen sc1
 s_bfe_u32 s84,s46,0x50000
 s_lshl_b32 s84,s84,12
 buffer_load_dwordx4 v[136:139],v32,s[32:35],s84 offen sc1
 s_bfe_u32 s84,s46,0x50000
 s_lshl_b32 s84,s84,12
 buffer_load_dwordx4 v[140:143],v33,s[32:35],s84 offen sc1
 s_bfe_u32 s84,s46,0x50005
 s_lshl_b32 s84,s84,12
 buffer_load_dwordx4 v[144:147],v32,s[32:35],s84 offen sc1
 s_bfe_u32 s84,s46,0x50005
 s_lshl_b32 s84,s84,12
 buffer_load_dwordx4 v[148:151],v33,s[32:35],s84 offen sc1
 s_waitcnt vmcnt(8)
 v_xor_b32 v208,0x80000000,v208
 v_xor_b32 v212,0x80000000,v212
 v_or_b32 v38,v208,v212
 v_cmp_gt_i32 vcc,0,v38
 s_cbranch_vccz Lok_121
 s_sub_u32 s55,s55,1
 s_cbranch_scc0 Lfix_119
 s_mov_b32 s55,0
Lok_121:
 s_branch Lret_120
Lfix_122:
 s_bfe_u32 s84,s45,0x50014
 s_lshl_b32 s84,s84,12
 buffer_load_dwordx4 v[216:219],v32,s[32:35],s84 offen sc1
 s_bfe_u32 s84,s45,0x50014
 s_lshl_b32 s84,s84,12
 buffer_load_dwordx4 v[220:223],v33,s[32:35],s84 offen sc1
 s_bfe_u32 s84,s45,0x50019
 s_lshl_b32 s84,s84,12
 buffer_load_dwordx4 v[224:227],v32,s[32:35],s84 offen sc1
 s_bfe_u32 s84,s45,0x50019
 s_lshl_b32 s84,s84,12
 buffer_load_dwordx4 v[228:231],v33,s[32:35],s84 offen sc1
 s_bfe_u32 s84,s46,0x50000
 s_lshl_b32 s84,s84,12
 buffer_load_dwordx4 v[136:139],v32,s[32:35],s84 offen sc1
 s_bfe_u32 s84,s46,0x50000
 s_lshl_b32 s84,s84,12
 buffer_load_dwordx4 v[140:143],v33,s[32:35],s84 offen sc1
 s_bfe_u32 s84,s46,0x50005
 s_lshl_b32 s84,s84,12
 buffer_load_dwordx4 v[144:147],v32,s[32:35],s84 offen sc1
 s_bfe_u32 s84,s46,0x50005
 s_lshl_b32 s84,s84,12
 buffer_load_dwordx4 v[148:151],v33,s[32:35],s84 offen sc1
 s_bfe_u32 s84,s46,0x5000a
 s_lshl_b32 s84,s84,12
 buffer_load_dwordx4 v[152:155],v32,s[32:35],s84 offen sc1
 s_bfe_u32 s84,s46,0x5000a
 s_lshl_b32 s84,s84,12
 buffer_load_dwordx4 v[156:159],v33,s[32:35],s84 offen sc1
 s_waitcnt vmcnt(8)
 v_xor_b32 v216,0x80000000,v216
 v_xor_b32 v220,0x80000000,v220
 v_or_b32 v38,v216,v220
 v_cmp_gt_i32 vcc,0,v38
 s_cbranch_vccz Lok_124
 s_sub_u32 s55,s55,1
 s_cbranch_scc0 Lfix_122
 s_mov_b32 s55,0
Lok_124:
 s_branch Lret_123
Lfix_125:
 s_bfe_u32 s84,s45,0x50019
 s_lshl_b32 s84,s84,12
 buffer_load_dwordx4 v[224:227],v32,s[32:35],s84 offen sc1
 s_bfe_u32 s84,s45,0x50019
 s_lshl_b32 s84,s84,12
 buffer_load_dwordx4 v[228:231],v33,s[32:35],s84 offen sc1
 s_bfe_u32 s84,s46,0x50000
 s_lshl_b32 s84,s84,12
 buffer_load_dwordx4 v[136:139],v32,s[32:35],s84 offen sc1
 s_bfe_u32 s84,s46,0x50000
 s_lshl_b32 s84,s84,12
 buffer_load_dwordx4 v[140:143],v33,s[32:35],s84 offen sc1
 s_bfe_u32 s84,s46,0x50005
 s_lshl_b32 s84,s84,12
 buffer_load_dwordx4 v[144:147],v32,s[32:35],s84 offen sc1
 s_bfe_u32 s84,s46,0x50005
 s_lshl_b32 s84,s84,12
 buffer_load_dwordx4 v[148:151],v33,s[32:35],s84 offen sc1
 s_bfe_u32 s84,s46,0x5000a
 s_lshl_b32 s84,s84,12
 buffer_load_dwordx4 v[152:155],v32,s[32:35],s84 offen sc1
 s_bfe_u32 s84,s46,0x5000a
 s_lshl_b32 s84,s84,12
 buffer_load_dwordx4 v[156:159],v33,s[32:35],s84 offen sc1
 s_bfe_u32 s84,s46,0x5000f
 s_lshl_b32 s84,s84,12
 buffer_load_dwordx4 v[160:163],v32,s[32:35],s84 offen sc1
 s_bfe_u32 s84,s46,0x5000f
 s_lshl_b32 s84,s84,12
 buffer_load_dwordx4 v[164:167],v33,s[32:35],s84 offen sc1
 s_waitcnt vmcnt(8)
 v_xor_b32 v224,0x80000000,v224
 v_xor_b32 v228,0x80000000,v228
 v_or_b32 v38,v224,v228
 v_cmp_gt_i32 vcc,0,v38
 s_cbranch_vccz Lok_127
 s_sub_u32 s55,s55,1
 s_cbranch_scc0 Lfix_125
 s_mov_b32 s55,0
Lok_127:
 s_branch Lret_126
Lfix_128:
 s_bfe_u32 s84,s46,0x50000
 s_lshl_b32 s84,s84,12
 buffer_load_dwordx4 v[136:139],v32,s[32:35],s84 offen sc1
 s_bfe_u32 s84,s46,0x50000
 s_lshl_b32 s84,s84,12
 buffer_load_dwordx4 v[140:143],v33,s[32:35],s84 offen sc1
 s_bfe_u32 s84,s46,0x50005
 s_lshl_b32 s84,s84,12
 buffer_load_dwordx4 v[144:147],v32,s[32:35],s84 offen sc1
 s_bfe_u32 s84,s46,0x50005
 s_lshl_b32 s84,s84,12
 buffer_load_dwordx4 v[148:151],v33,s[32:35],s84 offen sc1
 s_bfe_u32 s84,s46,0x5000a
 s_lshl_b32 s84,s84,12
 buffer_load_dwordx4 v[152:155],v32,s[32:35],s84 offen sc1
 s_bfe_u32 s84,s46,0x5000a
 s_lshl_b32 s84,s84,12
 buffer_load_dwordx4 v[156:159],v33,s[32:35],s84 offen sc1
 s_bfe_u32 s84,s46,0x5000f
 s_lshl_b32 s84,s84,12
 buffer_load_dwordx4 v[160:163],v32,s[32:35],s84 offen sc1
 s_bfe_u32 s84,s46,0x5000f
 s_lshl_b32 s84,s84,12
 buffer_load_dwordx4 v[164:167],v33,s[32:35],s84 offen sc1
 s_bfe_u32 s84,s46,0x50014
 s_lshl_b32 s84,s84,12
 buffer_load_dwordx4 v[168:171],v32,s[32:35],s84 offen sc1
 s_bfe_u32 s84,s46,0x50014
 s_lshl_b32 s84,s84,12
 buffer_load_dwordx4 v[172:175],v33,s[32:35],s84 offen sc1
 s_waitcnt vmcnt(8)
 v_xor_b32 v136,0x80000000,v136
 v_xor_b32 v140,0x80000000,v140
 v_or_b32 v38,v136,v140
 v_cmp_gt_i32 vcc,0,v38
 s_cbranch_vccz Lok_130
 s_sub_u32 s55,s55,1
 s_cbranch_scc0 Lfix_128
 s_mov_b32 s55,0
Lok_130:
 s_branch Lret_129
Lfix_131:
 s_bfe_u32 s84,s46,0x50005
 s_lshl_b32 s84,s84,12
 buffer_load_dwordx4 v[144:147],v32,s[32:35],s84 offen sc1
 s_bfe_u32 s84,s46,0x50005
 s_lshl_b32 s84,s84,12
 buffer_load_dwordx4 v[148:151],v33,s[32:35],s84 offen sc1
 s_bfe_u32 s84,s46,0x5000a
 s_lshl_b32 s84,s84,12
 buffer_load_dwordx4 v[152:155],v32,s[32:35],s84 offen sc1
 s_bfe_u32 s84,s46,0x5000a
 s_lshl_b32 s84,s84,12
 buffer_load_dwordx4 v[156:159],v33,s[32:35],s84 offen sc1
 s_bfe_u32 s84,s46,0x5000f
 s_lshl_b32 s84,s84,12
 buffer_load_dwordx4 v[160:163],v32,s[32:35],s84 offen sc1
 s_bfe_u32 s84,s46,0x5000f
 s_lshl_b32 s84,s84,12
 buffer_load_dwordx4 v[164:167],v33,s[32:35],s84 offen sc1
 s_bfe_u32 s84,s46,0x50014
 s_lshl_b32 s84,s84,12
 buffer_load_dwordx4 v[168:171],v32,s[32:35],s84 offen sc1
 s_bfe_u32 s84,s46,0x50014
 s_lshl_b32 s84,s84,12
 buffer_load_dwordx4 v[172:175],v33,s[32:35],s84 offen sc1
 s_bfe_u32 s84,s46,0x50019
 s_lshl_b32 s84,s84,12
 buffer_load_dwordx4 v[176:179],v32,s[32:35],s84 offen sc1
 s_bfe_u32 s84,s46,0x50019
 s_lshl_b32 s84,s84,12
 buffer_load_dwordx4 v[180:183],v33,s[32:35],s84 offen sc1
 s_waitcnt vmcnt(8)
 v_xor_b32 v144,0x80000000,v144
 v_xor_b32 v148,0x80000000,v148
 v_or_b32 v38,v144,v148
 v_cmp_gt_i32 vcc,0,v38
 s_cbranch_vccz Lok_133
 s_sub_u32 s55,s55,1
 s_cbranch_scc0 Lfix_131
 s_mov_b32 s55,0
Lok_133:
 s_branch Lret_132
Lfix_134:
 s_bfe_u32 s84,s46,0x5000a
 s_lshl_b32 s84,s84,12
 buffer_load_dwordx4 v[152:155],v32,s[32:35],s84 offen sc1
 s_bfe_u32 s84,s46,0x5000a
 s_lshl_b32 s84,s84,12
 buffer_load_dwordx4 v[156:159],v33,s[32:35],s84 offen sc1
 s_bfe_u32 s84,s46,0x5000f
 s_lshl_b32 s84,s84,12
 buffer_load_dwordx4 v[160:163],v32,s[32:35],s84 offen sc1
 s_bfe_u32 s84,s46,0x5000f
 s_lshl_b32 s84,s84,12
 buffer_load_dwordx4 v[164:167],v33,s[32:35],s84 offen sc1
 s_bfe_u32 s84,s46,0x50014
 s_lshl_b32 s84,s84,12
 buffer_load_dwordx4 v[168:171],v32,s[32:35],s84 offen sc1
 s_bfe_u32 s84,s46,0x50014
 s_lshl_b32 s84,s84,12
 buffer_load_dwordx4 v[172:175],v33,s[32:35],s84 offen sc1
 s_bfe_u32 s84,s46,0x50019
 s_lshl_b32 s84,s84,12
 buffer_load_dwordx4 v[176:179],v32,s[32:35],s84 offen sc1
 s_bfe_u32 s84,s46,0x50019
 s_lshl_b32 s84,s84,12
 buffer_load_dwordx4 v[180:183],v33,s[32:35],s84 offen sc1
 s_bfe_u32 s84,s47,0x50000
 s_lshl_b32 s84,s84,12
 buffer_load_dwordx4 v[184:187],v32,s[32:35],s84 offen sc1
 s_bfe_u32 s84,s47,0x50000
 s_lshl_b32 s84,s84,12
 buffer_load_dwordx4 v[188:191],v33,s[32:35],s84 offen sc1
 s_waitcnt vmcnt(8)
 v_xor_b32 v152,0x80000000,v152
 v_xor_b32 v156,0x80000000,v156
 v_or_b32 v38,v152,v156
 v_cmp_gt_i32 vcc,0,v38
 s_cbranch_vccz Lok_136
 s_sub_u32 s55,s55,1
 s_cbranch_scc0 Lfix_134
 s_mov_b32 s55,0
Lok_136:
 s_branch Lret_135
Lfix_137:
 s_bfe_u32 s84,s46,0x5000f
 s_lshl_b32 s84,s84,12
 buffer_load_dwordx4 v[160:163],v32,s[32:35],s84 offen sc1
 s_bfe_u32 s84,s46,0x5000f
 s_lshl_b32 s84,s84,12
 buffer_load_dwordx4 v[164:167],v33,s[32:35],s84 offen sc1
 s_bfe_u32 s84,s46,0x50014
 s_lshl_b32 s84,s84,12
 buffer_load_dwordx4 v[168:171],v32,s[32:35],s84 offen sc1
 s_bfe_u32 s84,s46,0x50014
 s_lshl_b32 s84,s84,12
 buffer_load_dwordx4 v[172:175],v33,s[32:35],s84 offen sc1
 s_bfe_u32 s84,s46,0x50019
 s_lshl_b32 s84,s84,12
 buffer_load_dwordx4 v[176:179],v32,s[32:35],s84 offen sc1
 s_bfe_u32 s84,s46,0x50019
 s_lshl_b32 s84,s84,12
 buffer_load_dwordx4 v[180:183],v33,s[32:35],s84 offen sc1
 s_bfe_u32 s84,s47,0x50000
 s_lshl_b32 s84,s84,12
 buffer_load_dwordx4 v[184:187],v32,s[32:35],s84 offen sc1
 s_bfe_u32 s84,s47,0x50000
 s_lshl_b32 s84,s84,12
 buffer_load_dwordx4 v[188:191],v33,s[32:35],s84 offen sc1
 s_bfe_u32 s84,s47,0x50005
 s_lshl_b32 s84,s84,12
 buffer_load_dwordx4 v[192:195],v32,s[32:35],s84 offen sc1
 s_bfe_u32 s84,s47,0x50005
 s_lshl_b32 s84,s84,12
 buffer_load_dwordx4 v[196:199],v33,s[32:35],s84 offen sc1
 s_waitcnt vmcnt(8)
 v_xor_b32 v160,0x80000000,v160
 v_xor_b32 v164,0x80000000,v164
 v_or_b32 v38,v160,v164
 v_cmp_gt_i32 vcc,0,v38
 s_cbranch_vccz Lok_139
 s_sub_u32 s55,s55,1
 s_cbranch_scc0 Lfix_137
 s_mov_b32 s55,0
Lok_139:
 s_branch Lret_138
Lfix_140:
 s_bfe_u32 s84,s46,0x50014
 s_lshl_b32 s84,s84,12
 buffer_load_dwordx4 v[168:171],v32,s[32:35],s84 offen sc1
 s_bfe_u32 s84,s46,0x50014
 s_lshl_b32 s84,s84,12
 buffer_load_dwordx4 v[172:175],v33,s[32:35],s84 offen sc1
 s_bfe_u32 s84,s46,0x50019
 s_lshl_b32 s84,s84,12
 buffer_load_dwordx4 v[176:179],v32,s[32:35],s84 offen sc1
 s_bfe_u32 s84,s46,0x50019
 s_lshl_b32 s84,s84,12
 buffer_load_dwordx4 v[180:183],v33,s[32:35],s84 offen sc1
 s_bfe_u32 s84,s47,0x50000
 s_lshl_b32 s84,s84,12
 buffer_load_dwordx4 v[184:187],v32,s[32:35],s84 offen sc1
 s_bfe_u32 s84,s47,0x50000
 s_lshl_b32 s84,s84,12
 buffer_load_dwordx4 v[188:191],v33,s[32:35],s84 offen sc1
 s_bfe_u32 s84,s47,0x50005
 s_lshl_b32 s84,s84,12
 buffer_load_dwordx4 v[192:195],v32,s[32:35],s84 offen sc1
 s_bfe_u32 s84,s47,0x50005
 s_lshl_b32 s84,s84,12
 buffer_load_dwordx4 v[196:199],v33,s[32:35],s84 offen sc1
 s_bfe_u32 s84,s47,0x5000a
 s_lshl_b32 s84,s84,12
 buffer_load_dwordx4 v[200:203],v32,s[32:35],s84 offen sc1
 s_bfe_u32 s84,s47,0x5000a
 s_lshl_b32 s84,s84,12
 buffer_load_dwordx4 v[204:207],v33,s[32:35],s84 offen sc1
 s_waitcnt vmcnt(8)
 v_xor_b32 v168,0x80000000,v168
 v_xor_b32 v172,0x80000000,v172
 v_or_b32 v38,v168,v172
 v_cmp_gt_i32 vcc,0,v38
 s_cbranch_vccz Lok_142
 s_sub_u32 s55,s55,1
 s_cbranch_scc0 Lfix_140
 s_mov_b32 s55,0
Lok_142:
 s_branch Lret_141
Lfix_143:
 s_bfe_u32 s84,s46,0x50019
 s_lshl_b32 s84,s84,12
 buffer_load_dwordx4 v[176:179],v32,s[32:35],s84 offen sc1
 s_bfe_u32 s84,s46,0x50019
 s_lshl_b32 s84,s84,12
 buffer_load_dwordx4 v[180:183],v33,s[32:35],s84 offen sc1
 s_bfe_u32 s84,s47,0x50000
 s_lshl_b32 s84,s84,12
 buffer_load_dwordx4 v[184:187],v32,s[32:35],s84 offen sc1
 s_bfe_u32 s84,s47,0x50000
 s_lshl_b32 s84,s84,12
 buffer_load_dwordx4 v[188:191],v33,s[32:35],s84 offen sc1
 s_bfe_u32 s84,s47,0x50005
 s_lshl_b32 s84,s84,12
 buffer_load_dwordx4 v[192:195],v32,s[32:35],s84 offen sc1
 s_bfe_u32 s84,s47,0x50005
 s_lshl_b32 s84,s84,12
 buffer_load_dwordx4 v[196:199],v33,s[32:35],s84 offen sc1
 s_bfe_u32 s84,s47,0x5000a
 s_lshl_b32 s84,s84,12
 buffer_load_dwordx4 v[200:203],v32,s[32:35],s84 offen sc1
 s_bfe_u32 s84,s47,0x5000a
 s_lshl_b32 s84,s84,12
 buffer_load_dwordx4 v[204:207],v33,s[32:35],s84 offen sc1
 buffer_load_dwordx4 v[208:211],v32,s[32:35],s70 offen sc1
 buffer_load_dwordx4 v[212:215],v33,s[32:35],s70 offen sc1
 s_waitcnt vmcnt(8)
 v_xor_b32 v176,0x80000000,v176
 v_xor_b32 v180,0x80000000,v180
 v_or_b32 v38,v176,v180
 v_cmp_gt_i32 vcc,0,v38
 s_cbranch_vccz Lok_145
 s_sub_u32 s55,s55,1
 s_cbranch_scc0 Lfix_143
 s_mov_b32 s55,0
Lok_145:
 s_branch Lret_144
Lfix_146:
 s_bfe_u32 s84,s47,0x50000
 s_lshl_b32 s84,s84,12
 buffer_load_dwordx4 v[184:187],v32,s[32:35],s84 offen sc1
 s_bfe_u32 s84,s47,0x50000
 s_lshl_b32 s84,s84,12
 buffer_load_dwordx4 v[188:191],v33,s[32:35],s84 offen sc1
 s_bfe_u32 s84,s47,0x50005
 s_lshl_b32 s84,s84,12
 buffer_load_dwordx4 v[192:195],v32,s[32:35],s84 offen sc1
 s_bfe_u32 s84,s47,0x50005
 s_lshl_b32 s84,s84,12
 buffer_load_dwordx4 v[196:199],v33,s[32:35],s84 offen sc1
 s_bfe_u32 s84,s47,0x5000a
 s_lshl_b32 s84,s84,12
 buffer_load_dwordx4 v[200:203],v32,s[32:35],s84 offen sc1
 s_bfe_u32 s84,s47,0x5000a
 s_lshl_b32 s84,s84,12
 buffer_load_dwordx4 v[204:207],v33,s[32:35],s84 offen sc1
 buffer_load_dwordx4 v[208:211],v32,s[32:35],s70 offen sc1
 buffer_load_dwordx4 v[212:215],v33,s[32:35],s70 offen sc1
 s_waitcnt vmcnt(6)
 v_xor_b32 v184,0x80000000,v184
 v_xor_b32 v188,0x80000000,v188
 v_or_b32 v38,v184,v188
 v_cmp_gt_i32 vcc,0,v38
 s_cbranch_vccz Lok_148
 s_sub_u32 s55,s55,1
 s_cbranch_scc0 Lfix_146
 s_mov_b32 s55,0
Lok_148:
 s_branch Lret_147
Lfix_149:
 s_bfe_u32 s84,s47,0x50005
 s_lshl_b32 s84,s84,12
 buffer_load_dwordx4 v[192:195],v32,s[32:35],s84 offen sc1
 s_bfe_u32 s84,s47,0x50005
 s_lshl_b32 s84,s84,12
 buffer_load_dwordx4 v[196:199],v33,s[32:35],s84 offen sc1
 s_bfe_u32 s84,s47,0x5000a
 s_lshl_b32 s84,s84,12
 buffer_load_dwordx4 v[200:203],v32,s[32:35],s84 offen sc1
 s_bfe_u32 s84,s47,0x5000a
 s_lshl_b32 s84,s84,12
 buffer_load_dwordx4 v[204:207],v33,s[32:35],s84 offen sc1
 buffer_load_dwordx4 v[208:211],v32,s[32:35],s70 offen sc1
 buffer_load_dwordx4 v[212:215],v33,s[32:35],s70 offen sc1
 s_waitcnt vmcnt(4)
 v_xor_b32 v192,0x80000000,v192
 v_xor_b32 v196,0x80000000,v196
 v_or_b32 v38,v192,v196
 v_cmp_gt_i32 vcc,0,v38
 s_cbranch_vccz Lok_151
 s_sub_u32 s55,s55,1
 s_cbranch_scc0 Lfix_149
 s_mov_b32 s55,0
Lok_151:
 s_branch Lret_150
Lfix_152:
 s_bfe_u32 s84,s47,0x5000a
 s_lshl_b32 s84,s84,12
 buffer_load_dwordx4 v[200:203],v32,s[32:35],s84 offen sc1
 s_bfe_u32 s84,s47,0x5000a
 s_lshl_b32 s84,s84,12
 buffer_load_dwordx4 v[204:207],v33,s[32:35],s84 offen sc1
 buffer_load_dwordx4 v[208:211],v32,s[32:35],s70 offen sc1
 buffer_load_dwordx4 v[212:215],v33,s[32:35],s70 offen sc1
 s_waitcnt vmcnt(2)
 v_xor_b32 v200,0x80000000,v200
 v_xor_b32 v204,0x80000000,v204
 v_or_b32 v38,v200,v204
 v_cmp_gt_i32 vcc,0,v38
 s_cbranch_vccz Lok_154
 s_sub_u32 s55,s55,1
 s_cbranch_scc0 Lfix_152
 s_mov_b32 s55,0
Lok_154:
 s_branch Lret_153
Lfix_155:
 buffer_load_dwordx4 v[208:211],v32,s[32:35],s70 offen sc1
 buffer_load_dwordx4 v[212:215],v33,s[32:35],s70 offen sc1
 s_waitcnt vmcnt(0)
 v_xor_b32 v208,0x80000000,v208
 v_xor_b32 v212,0x80000000,v212
 v_or_b32 v38,v208,v212
 v_cmp_gt_i32 vcc,0,v38
 s_cbranch_vccz Lok_157
 s_sub_u32 s55,s55,1
 s_cbranch_scc0 Lfix_155
 s_mov_b32 s55,0
Lok_157:
 s_branch Lret_156
Lfix_158:
 buffer_load_dwordx4 v[136:139],v2,s[32:35],s36 offen sc1
 buffer_load_dwordx4 v[140:143],v2,s[32:35],s36 offen offset:1024 sc1
 buffer_load_dwordx4 v[152:155],v2,s[32:35],s37 offen sc1
 buffer_load_dwordx4 v[156:159],v2,s[32:35],s37 offen offset:1024 sc1
 buffer_load_dwordx4 v[168:171],v2,s[32:35],s38 offen sc1
 buffer_load_dwordx4 v[172:175],v2,s[32:35],s38 offen offset:1024 sc1
 buffer_load_dwordx4 v[184:187],v2,s[32:35],s39 offen sc1
 s_add_u32 s84,s97,32768
 buffer_store_dword v38,off,s[32:35],s84
 buffer_load_dwordx4 v[188:191],v2,s[32:35],s39 offen offset:1024 sc1
 buffer_load_dwordx4 v[200:203],v2,s[32:35],s40 offen sc1
 buffer_load_dwordx4 v[204:207],v2,s[32:35],s40 offen offset:1024 sc1
 buffer_load_dwordx4 v[216:219],v2,s[32:35],s41 offen sc1
 s_waitcnt vmcnt(10)
 v_bitop3_b32 v38,v136,v140,1 bitop3:0xa8
 v_cmp_ne_u32 vcc,0,v38
 s_cbranch_vccz Lok_160
 s_sub_u32 s55,s55,1
 s_cbranch_scc0 Lfix_158
 s_mov_b32 s55,0
Lok_160:
 s_branch Lret_159
Lfix_161:
 buffer_load_dwordx4 v[152:155],v2,s[32:35],s37 offen sc1
 buffer_load_dwordx4 v[156:159],v2,s[32:35],s37 offen offset:1024 sc1
 buffer_load_dwordx4 v[168:171],v2,s[32:35],s38 offen sc1
 buffer_load_dwordx4 v[172:175],v2,s[32:35],s38 offen offset:1024 sc1
 buffer_load_dwordx4 v[184:187],v2,s[32:35],s39 offen sc1
 s_add_u32 s84,s97,32768
 buffer_store_dword v38,off,s[32:35],s84
 buffer_load_dwordx4 v[188:191],v2,s[32:35],s39 offen offset:1024 sc1
 buffer_load_dwordx4 v[200:203],v2,s[32:35],s40 offen sc1
 buffer_load_dwordx4 v[204:207],v2,s[32:35],s40 offen offset:1024 sc1
 buffer_load_dwordx4 v[216:219],v2,s[32:35],s41 offen sc1
 buffer_load_dwordx4 v[220:223],v2,s[32:35],s41 offen offset:1024 sc1
 buffer_load_dwordx4 v[232:235],v2,s[32:35],s42 offen sc1
 s_waitcnt vmcnt(10)
 v_bitop3_b32 v38,v152,v156,1 bitop3:0xa8
 v_cmp_ne_u32 vcc,0,v38
 s_cbranch_vccz Lok_163
 s_sub_u32 s55,s55,1
 s_cbranch_scc0 Lfix_161
 s_mov_b32 s55,0
Lok_163:
 s_branch Lret_162
Lfix_164:
 buffer_load_dwordx4 v[168:171],v2,s[32:35],s38 offen sc1
 buffer_load_dwordx4 v[172:175],v2,s[32:35],s38 offen offset:1024 sc1
 buffer_load_dwordx4 v[184:187],v2,s[32:35],s39 offen sc1
 s_add_u32 s84,s97,32768
 buffer_store_dword v38,off,s[32:35],s84
 buffer_load_dwordx4 v[188:191],v2,s[32:35],s39 offen offset:1024 sc1
 buffer_load_dwordx4 v[200:203],v2,s[32:35],s40 offen sc1
 buffer_load_dwordx4 v[204:207],v2,s[32:35],s40 offen offset:1024 sc1
 buffer_load_dwordx4 v[216:219],v2,s[32:35],s41 offen sc1
 buffer_load_dwordx4 v[220:223],v2,s[32:35],s41 offen offset:1024 sc1
 buffer_load_dwordx4 v[232:235],v2,s[32:35],s42 offen sc1
 buffer_load_dwordx4 v[236:239],v2,s[32:35],s42 offen offset:1024 sc1
 buffer_load_dwordx4 v[248:251],v2,s[32:35],s43 offen sc1
 s_waitcnt vmcnt(10)
 v_bitop3_b32 v38,v168,v172,1 bitop3:0xa8
 v_cmp_ne_u32 vcc,0,v38
 s_cbranch_vccz Lok_166
 s_sub_u32 s55,s55,1
 s_cbranch_scc0 Lfix_164
 s_mov_b32 s55,0
Lok_166:
 s_branch Lret_165
Lfix_167:
 buffer_load_dwordx4 v[184:187],v2,s[32:35],s39 offen sc1
 buffer_load_dwordx4 v[188:191],v2,s[32:35],s39 offen offset:1024 sc1
 buffer_load_dwordx4 v[200:203],v2,s[32:35],s40 offen sc1
 buffer_load_dwordx4 v[204:207],v2,s[32:35],s40 offen offset:1024 sc1
 buffer_load_dwordx4 v[216:219],v2,s[32:35],s41 offen sc1
 buffer_load_dwordx4 v[220:223],v2,s[32:35],s41 offen offset:1024 sc1
 buffer_load_dwordx4 v[232:235],v2,s[32:35],s42 offen sc1
 buffer_load_dwordx4 v[236:239],v2,s[32:35],s42 offen offset:1024 sc1
 buffer_load_dwordx4 v[248:251],v2,s[32:35],s43 offen sc1
 buffer_load_dwordx4 v[252:255],v2,s[32:35],s43 offen offset:1024 sc1
 buffer_load_dwordx4 v[144:147],v2,s[32:35],s8 offen sc1
 s_waitcnt vmcnt(9)
 v_bitop3_b32 v38,v184,v188,1 bitop3:0xa8
 v_cmp_ne_u32 vcc,0,v38
 s_cbranch_vccz Lok_169
 s_sub_u32 s55,s55,1
 s_cbranch_scc0 Lfix_167
 s_mov_b32 s55,0
Lok_169:
 s_branch Lret_168
Lfix_170:
 buffer_load_dwordx4 v[200:203],v2,s[32:35],s40 offen sc1
 buffer_load_dwordx4 v[204:207],v2,s[32:35],s40 offen offset:1024 sc1
 buffer_load_dwordx4 v[216:219],v2,s[32:35],s41 offen sc1
 buffer_load_dwordx4 v[220:223],v2,s[32:35],s41 offen offset:1024 sc1
 buffer_load_dwordx4 v[232:235],v2,s[32:35],s42 offen sc1
 buffer_load_dwordx4 v[236:239],v2,s[32:35],s42 offen offset:1024 sc1
 buffer_load_dwordx4 v[248:251],v2,s[32:35],s43 offen sc1
 buffer_load_dwordx4 v[252:255],v2,s[32:35],s43 offen offset:1024 sc1
 buffer_load_dwordx4 v[144:147],v2,s[32:35],s8 offen sc1
 buffer_load_dwordx4 v[148:151],v2,s[32:35],s8 offen offset:1024 sc1
 buffer_load_dwordx4 v[160:163],v2,s[32:35],s9 offen sc1
 s_waitcnt vmcnt(9)
 v_bitop3_b32 v38,v200,v204,1 bitop3:0xa8
 v_cmp_ne_u32 vcc,0,v38
 s_cbranch_vccz Lok_172
 s_sub_u32 s55,s55,1
 s_cbranch_scc0 Lfix_170
 s_mov_b32 s55,0
Lok_172:
 s_branch Lret_171
Lfix_173:
 buffer_load_dwordx4 v[216:219],v2,s[32:35],s41 offen sc1
 buffer_load_dwordx4 v[220:223],v2,s[32:35],s41 offen offset:1024 sc1
 buffer_load_dwordx4 v[232:235],v2,s[32:35],s42 offen sc1
 buffer_load_dwordx4 v[236:239],v2,s[32:35],s42 offen offset:1024 sc1
 buffer_load_dwordx4 v[248:251],v2,s[32:35],s43 offen sc1
 buffer_load_dwordx4 v[252:255],v2,s[32:35],s43 offen offset:1024 sc1
 buffer_load_dwordx4 v[144:147],v2,s[32:35],s8 offen sc1
 buffer_load_dwordx4 v[148:151],v2,s[32:35],s8 offen offset:1024 sc1
 buffer_load_dwordx4 v[160:163],v2,s[32:35],s9 offen sc1
 buffer_load_dwordx4 v[164:167],v2,s[32:35],s9 offen offset:1024 sc1
 s_add_u32 s84,s97,32768
 buffer_store_dword v38,off,s[32:35],s84
 s_add_u32 s84,s97,32768
 buffer_store_dword v38,off,s[32:35],s84
 buffer_load_dwordx4 v[176:179],v2,s[32:35],s10 offen sc1
 s_waitcnt vmcnt(11)
 v_bitop3_b32 v38,v216,v220,1 bitop3:0xa8
 v_cmp_ne_u32 vcc,0,v38
 s_cbranch_vccz Lok_175
 s_sub_u32 s55,s55,1
 s_cbranch_scc0 Lfix_173
 s_mov_b32 s55,0
Lok_175:
 s_branch Lret_174
Lfix_176:
 buffer_load_dwordx4 v[232:235],v2,s[32:35],s42 offen sc1
 buffer_load_dwordx4 v[236:239],v2,s[32:35],s42 offen offset:1024 sc1
 buffer_load_dwordx4 v[248:251],v2,s[32:35],s43 offen sc1
 buffer_load_dwordx4 v[252:255],v2,s[32:35],s43 offen offset:1024 sc1
 buffer_load_dwordx4 v[144:147],v2,s[32:35],s8 offen sc1
 buffer_load_dwordx4 v[148:151],v2,s[32:35],s8 offen offset:1024 sc1
 buffer_load_dwordx4 v[160:163],v2,s[32:35],s9 offen sc1
 buffer_load_dwordx4 v[164:167],v2,s[32:35],s9 offen offset:1024 sc1
 s_add_u32 s84,s97,32768
 buffer_store_dword v38,off,s[32:35],s84
 s_add_u32 s84,s97,32768
 buffer_store_dword v38,off,s[32:35],s84
 buffer_load_dwordx4 v[176:179],v2,s[32:35],s10 offen sc1
 buffer_load_dwordx4 v[180:183],v2,s[32:35],s10 offen offset:1024 sc1
 buffer_load_dwordx4 v[192:195],v2,s[32:35],s11 offen sc1
 s_waitcnt vmcnt(11)
 v_bitop3_b32 v38,v232,v236,1 bitop3:0xa8
 v_cmp_ne_u32 vcc,0,v38
 s_cbranch_vccz Lok_178
 s_sub_u32 s55,s55,1
 s_cbranch_scc0 Lfix_176
 s_mov_b32 s55,0
Lok_178:
 s_branch Lret_177
Lfix_179:
 buffer_load_dwordx4 v[248:251],v2,s[32:35],s43 offen sc1
 buffer_load_dwordx4 v[252:255],v2,s[32:35],s43 offen offset:1024 sc1
 buffer_load_dwordx4 v[144:147],v2,s[32:35],s8 offen sc1
 buffer_load_dwordx4 v[148:151],v2,s[32:35],s8 offen offset:1024 sc1
 buffer_load_dwordx4 v[160:163],v2,s[32:35],s9 offen sc1
 buffer_load_dwordx4 v[164:167],v2,s[32:35],s9 offen offset:1024 sc1
 s_add_u32 s84,s97,32768
 buffer_store_dword v38,off,s[32:35],s84
 s_add_u32 s84,s97,32768
 buffer_store_dword v38,off,s[32:35],s84
 buffer_load_dwordx4 v[176:179],v2,s[32:35],s10 offen sc1
 buffer_load_dwordx4 v[180:183],v2,s[32:35],s10 offen offset:1024 sc1
 buffer_load_dwordx4 v[192:195],v2,s[32:35],s11 offen sc1
 buffer_load_dwordx4 v[196:199],v2,s[32:35],s11 offen offset:1024 sc1
 buffer_load_dwordx4 v[208:211],v2,s[32:35],s57 offen sc1
 s_waitcnt vmcnt(11)
 v_bitop3_b32 v38,v248,v252,1 bitop3:0xa8
 v_cmp_ne_u32 vcc,0,v38
 s_cbranch_vccz Lok_181
 s_sub_u32 s55,s55,1
 s_cbranch_scc0 Lfix_179
 s_mov_b32 s55,0
Lok_181:
 s_branch Lret_180
Lfix_182:
 buffer_load_dwordx4 v[144:147],v2,s[32:35],s8 offen sc1
 buffer_load_dwordx4 v[148:151],v2,s[32:35],s8 offen offset:1024 sc1
 buffer_load_dwordx4 v[160:163],v2,s[32:35],s9 offen sc1
 buffer_load_dwordx4 v[164:167],v2,s[32:35],s9 offen offset:1024 sc1
 s_add_u32 s84,s97,32768
 buffer_store_dword v38,off,s[32:35],s84
 s_add_u32 s84,s97,32768
 buffer_store_dword v38,off,s[32:35],s84
 buffer_load_dwordx4 v[176:179],v2,s[32:35],s10 offen sc1
 buffer_load_dwordx4 v[180:183],v2,s[32:35],s10 offen offset:1024 sc1
 buffer_load_dwordx4 v[192:195],v2,s[32:35],s11 offen sc1
 buffer_load_dwordx4 v[196:199],v2,s[32:35],s11 offen offset:1024 sc1
 buffer_load_dwordx4 v[208:211],v2,s[32:35],s57 offen sc1
 buffer_load_dwordx4 v[212:215],v2,s[32:35],s57 offen offset:1024 sc1
 buffer_load_dwordx4 v[224:227],v2,s[32:35],s77 offen sc1
 s_waitcnt vmcnt(11)
 v_bitop3_b32 v38,v144,v148,1 bitop3:0xa8
 v_cmp_ne_u32 vcc,0,v38
 s_cbranch_vccz Lok_184
 s_sub_u32 s55,s55,1
 s_cbranch_scc0 Lfix_182
 s_mov_b32 s55,0
Lok_184:
 s_branch Lret_183
Lfix_185:
 buffer_load_dwordx4 v[160:163],v2,s[32:35],s9 offen sc1
 buffer_load_dwordx4 v[164:167],v2,s[32:35],s9 offen offset:1024 sc1
 s_add_u32 s84,s97,32768
 buffer_store_dword v38,off,s[32:35],s84
 s_add_u32 s84,s97,32768
 buffer_store_dword v38,off,s[32:35],s84
 buffer_load_dwordx4 v[176:179],v2,s[32:35],s10 offen sc1
 buffer_load_dwordx4 v[180:183],v2,s[32:35],s10 offen offset:1024 sc1
 buffer_load_dwordx4 v[192:195],v2,s[32:35],s11 offen sc1
 buffer_load_dwordx4 v[196:199],v2,s[32:35],s11 offen offset:1024 sc1
 buffer_load_dwordx4 v[208:211],v2,s[32:35],s57 offen sc1
 buffer_load_dwordx4 v[212:215],v2,s[32:35],s57 offen offset:1024 sc1
 buffer_load_dwordx4 v[224:227],v2,s[32:35],s77 offen sc1
 buffer_load_dwordx4 v[228:231],v2,s[32:35],s77 offen offset:1024 sc1
 buffer_load_dwordx4 v[240:243],v2,s[32:35],s81 offen sc1
 s_waitcnt vmcnt(11)
 v_bitop3_b32 v38,v160,v164,1 bitop3:0xa8
 v_cmp_ne_u32 vcc,0,v38
 s_cbranch_vccz Lok_187
 s_sub_u32 s55,s55,1
 s_cbranch_scc0 Lfix_185
 s_mov_b32 s55,0
Lok_187:
 s_branch Lret_186
Lfix_191:
 s_add_u32 s84,s58,131072
 buffer_load_dwordx4 v[72:75],v13,s[32:35],s84 offen sc1
 buffer_load_dwordx4 v[76:79],v13,s[32:35],s84 offen offset:512 sc1
 s_waitcnt vmcnt(0)
 v_and_b32 v38,v72,v73
 v_bitop3_b32 v38,v74,v75,v38 bitop3:0x80
 v_bitop3_b32 v38,v76,v77,v38 bitop3:0x80
 v_bitop3_b32 v38,v78,v79,v38 bitop3:0x80
 v_and_b32 v38,1,v38
 v_cmp_eq_u32 s[82:83],0,v38
 s_nop 0
 s_cmp_eq_u64 s[82:83],0
 s_cbranch_scc1 Lok_193
 s_sub_u32 s55,s55,1
 s_cbranch_scc0 Lfix_191
 s_mov_b32 s55,0
Lok_193:
 s_branch Lret_192
Lfix_188:
 buffer_load_dwordx4 v[176:179],v2,s[32:35],s10 offen sc1
 buffer_load_dwordx4 v[180:183],v2,s[32:35],s10 offen offset:1024 sc1
 buffer_load_dwordx4 v[192:195],v2,s[32:35],s11 offen sc1
 buffer_load_dwordx4 v[196:199],v2,s[32:35],s11 offen offset:1024 sc1
 buffer_load_dwordx4 v[208:211],v2,s[32:35],s57 offen sc1
 buffer_load_dwordx4 v[212:215],v2,s[32:35],s57 offen offset:1024 sc1
 buffer_load_dwordx4 v[224:227],v2,s[32:35],s77 offen sc1
 buffer_load_dwordx4 v[228:231],v2,s[32:35],s77 offen offset:1024 sc1
 buffer_load_dwordx4 v[240:243],v2,s[32:35],s81 offen sc1
 buffer_load_dwordx4 v[244:247],v2,s[32:35],s81 offen offset:1024 sc1
 buffer_load_dwordx4 a[248:251],v2,s[32:35],s99 offen sc1
 s_waitcnt vmcnt(9)
 v_bitop3_b32 v38,v176,v180,1 bitop3:0xa8
 v_cmp_ne_u32 vcc,0,v38
 s_cbranch_vccz Lok_190
 s_sub_u32 s55,s55,1
 s_cbranch_scc0 Lfix_188
 s_mov_b32 s55,0
Lok_190:
 s_branch Lret_189
Lfix_194:
 buffer_load_dwordx4 v[192:195],v2,s[32:35],s11 offen sc1
 buffer_load_dwordx4 v[196:199],v2,s[32:35],s11 offen offset:1024 sc1
 buffer_load_dwordx4 v[208:211],v2,s[32:35],s57 offen sc1
 buffer_load_dwordx4 v[212:215],v2,s[32:35],s57 offen offset:1024 sc1
 buffer_load_dwordx4 v[224:227],v2,s[32:35],s77 offen sc1
 buffer_load_dwordx4 v[228:231],v2,s[32:35],s77 offen offset:1024 sc1
 buffer_load_dwordx4 v[240:243],v2,s[32:35],s81 offen sc1
 buffer_load_dwordx4 v[244:247],v2,s[32:35],s81 offen offset:1024 sc1
 buffer_load_dwordx4 a[248:251],v2,s[32:35],s99 offen sc1
 buffer_load_dwordx4 a[252:255],v2,s[32:35],s99 offen offset:1024 sc1
 s_add_u32 s84,s97,32768
 buffer_store_dword v38,off,s[32:35],s84
 s_waitcnt vmcnt(9)
 v_bitop3_b32 v38,v192,v196,1 bitop3:0xa8
 v_cmp_ne_u32 vcc,0,v38
 s_cbranch_vccz Lok_196
 s_sub_u32 s55,s55,1
 s_cbranch_scc0 Lfix_194
 s_mov_b32 s55,0
Lok_196:
 s_branch Lret_195
Lfix_197:
 buffer_load_dwordx4 v[208:211],v2,s[32:35],s57 offen sc1
 buffer_load_dwordx4 v[212:215],v2,s[32:35],s57 offen offset:1024 sc1
 buffer_load_dwordx4 v[224:227],v2,s[32:35],s77 offen sc1
 buffer_load_dwordx4 v[228:231],v2,s[32:35],s77 offen offset:1024 sc1
 buffer_load_dwordx4 v[240:243],v2,s[32:35],s81 offen sc1
 buffer_load_dwordx4 v[244:247],v2,s[32:35],s81 offen offset:1024 sc1
 buffer_load_dwordx4 a[248:251],v2,s[32:35],s99 offen sc1
 buffer_load_dwordx4 a[252:255],v2,s[32:35],s99 offen offset:1024 sc1
 s_add_u32 s84,s97,32768
 buffer_store_dword v38,off,s[32:35],s84
 s_add_u32 s84,s97,32768
 buffer_store_dword v38,off,s[32:35],s84
 s_add_u32 s84,s97,32768
 buffer_store_dword v38,off,s[32:35],s84
 s_waitcnt vmcnt(9)
 v_bitop3_b32 v38,v208,v212,1 bitop3:0xa8
 v_cmp_ne_u32 vcc,0,v38
 s_cbranch_vccz Lok_199
 s_sub_u32 s55,s55,1
 s_cbranch_scc0 Lfix_197
 s_mov_b32 s55,0
Lok_199:
 s_branch Lret_198
Lfix_200:
 buffer_load_dwordx4 v[224:227],v2,s[32:35],s77 offen sc1
 buffer_load_dwordx4 v[228:231],v2,s[32:35],s77 offen offset:1024 sc1
 buffer_load_dwordx4 v[240:243],v2,s[32:35],s81 offen sc1
 buffer_load_dwordx4 v[244:247],v2,s[32:35],s81 offen offset:1024 sc1
 buffer_load_dwordx4 a[248:251],v2,s[32:35],s99 offen sc1
 buffer_load_dwordx4 a[252:255],v2,s[32:35],s99 offen offset:1024 sc1
 s_add_u32 s84,s97,32768
 buffer_store_dword v38,off,s[32:35],s84
 s_add_u32 s84,s97,32768
 buffer_store_dword v38,off,s[32:35],s84
 s_add_u32 s84,s97,32768
 buffer_store_dword v38,off,s[32:35],s84
 s_add_u32 s84,s97,32768
 buffer_store_dword v38,off,s[32:35],s84
 s_add_u32 s84,s97,32768
 buffer_store_dword v38,off,s[32:35],s84
 s_waitcnt vmcnt(9)
 v_bitop3_b32 v38,v224,v228,1 bitop3:0xa8
 v_cmp_ne_u32 vcc,0,v38
 s_cbranch_vccz Lok_202
 s_sub_u32 s55,s55,1
 s_cbranch_scc0 Lfix_200
 s_mov_b32 s55,0
Lok_202:
 s_branch Lret_201
Lfix_203:
 buffer_load_dwordx4 v[240:243],v2,s[32:35],s81 offen sc1
 buffer_load_dwordx4 v[244:247],v2,s[32:35],s81 offen offset:1024 sc1
 buffer_load_dwordx4 a[248:251],v2,s[32:35],s99 offen sc1
 buffer_load_dwordx4 a[252:255],v2,s[32:35],s99 offen offset:1024 sc1
 s_add_u32 s84,s97,32768
 buffer_store_dword v38,off,s[32:35],s84
 s_add_u32 s84,s97,32768
 buffer_store_dword v38,off,s[32:35],s84
 s_add_u32 s84,s97,32768
 buffer_store_dword v38,off,s[32:35],s84
 s_add_u32 s84,s97,32768
 buffer_store_dword v38,off,s[32:35],s84
 s_add_u32 s84,s97,32768
 buffer_store_dword v38,off,s[32:35],s84
 s_add_u32 s84,s97,32768
 buffer_store_dword v38,off,s[32:35],s84
 s_add_u32 s84,s97,32768
 buffer_store_dword v38,off,s[32:35],s84
 s_waitcnt vmcnt(9)
 v_bitop3_b32 v38,v240,v244,1 bitop3:0xa8
 v_cmp_ne_u32 vcc,0,v38
 s_cbranch_vccz Lok_205
 s_sub_u32 s55,s55,1
 s_cbranch_scc0 Lfix_203
 s_mov_b32 s55,0
Lok_205:
 s_branch Lret_204
Lfix_206:
 buffer_load_dwordx4 a[248:251],v2,s[32:35],s99 offen sc1
 buffer_load_dwordx4 a[252:255],v2,s[32:35],s99 offen offset:1024 sc1
 s_add_u32 s84,s97,32768
 buffer_store_dword v38,off,s[32:35],s84
 s_add_u32 s84,s97,32768
 buffer_store_dword v38,off,s[32:35],s84
 s_add_u32 s84,s97,32768
 buffer_store_dword v38,off,s[32:35],s84
 s_add_u32 s84,s97,32768
 buffer_store_dword v38,off,s[32:35],s84
 s_add_u32 s84,s97,32768
 buffer_store_dword v38,off,s[32:35],s84
 s_add_u32 s84,s97,32768
 buffer_store_dword v38,off,s[32:35],s84
 s_add_u32 s84,s97,32768
 buffer_store_dword v38,off,s[32:35],s84
 s_add_u32 s84,s97,32768
 buffer_store_dword v38,off,s[32:35],s84
 s_waitcnt vmcnt(8)
 v_accvgpr_read_b32 v38,a248
 v_lshlrev_b32 v38,31,v38
 v_cmp_ne_u32 s[82:83],0,v38
 v_accvgpr_read_b32 v38,a252
 v_lshlrev_b32 v38,31,v38
 v_cmp_ne_u32 vcc,0,v38
 s_nop 1
 s_or_b64 vcc,vcc,s[82:83]
 s_cbranch_vccz Lok_208
 s_sub_u32 s55,s55,1
 s_cbranch_scc0 Lfix_206
 s_mov_b32 s55,0
Lok_208:
 s_branch Lret_207
Lfix_226:
 buffer_load_dwordx4 v[136:139],v2,s[32:35],s36 offen sc1
 buffer_load_dwordx4 v[140:143],v2,s[32:35],s36 offen offset:1024 sc1
 buffer_load_dwordx4 v[152:155],v2,s[32:35],s37 offen sc1
 buffer_load_dwordx4 v[156:159],v2,s[32:35],s37 offen offset:1024 sc1
 buffer_load_dwordx4 v[168:171],v2,s[32:35],s38 offen sc1
 buffer_load_dwordx4 v[172:175],v2,s[32:35],s38 offen offset:1024 sc1
 buffer_load_dwordx4 v[184:187],v2,s[32:35],s39 offen sc1
 s_add_u32 s84,s97,32768
 buffer_store_dword v38,off,s[32:35],s84
 buffer_load_dwordx4 v[188:191],v2,s[32:35],s39 offen offset:1024 sc1
 buffer_load_dwordx4 v[200:203],v2,s[32:35],s40 offen sc1
 buffer_load_dwordx4 v[204:207],v2,s[32:35],s40 offen offset:1024 sc1
 buffer_load_dwordx4 v[216:219],v2,s[32:35],s41 offen sc1
 s_waitcnt vmcnt(10)
 v_bitop3_b32 v38,v136,v140,1 bitop3:0x80
 v_cmp_eq_u32 vcc,0,v38
 s_cbranch_vccz Lok_228
 s_sub_u32 s55,s55,1
 s_cbranch_scc0 Lfix_226
 s_mov_b32 s55,0
Lok_228:
 s_branch Lret_227
Lfix_229:
 buffer_load_dwordx4 v[152:155],v2,s[32:35],s37 offen sc1
 buffer_load_dwordx4 v[156:159],v2,s[32:35],s37 offen offset:1024 sc1
 buffer_load_dwordx4 v[168:171],v2,s[32:35],s38 offen sc1
 buffer_load_dwordx4 v[172:175],v2,s[32:35],s38 offen offset:1024 sc1
 buffer_load_dwordx4 v[184:187],v2,s[32:35],s39 offen sc1
 s_add_u32 s84,s97,32768
 buffer_store_dword v38,off,s[32:35],s84
 buffer_load_dwordx4 v[188:191],v2,s[32:35],s39 offen offset:1024 sc1
 buffer_load_dwordx4 v[200:203],v2,s[32:35],s40 offen sc1
 buffer_load_dwordx4 v[204:207],v2,s[32:35],s40 offen offset:1024 sc1
 buffer_load_dwordx4 v[216:219],v2,s[32:35],s41 offen sc1
 buffer_load_dwordx4 v[220:223],v2,s[32:35],s41 offen offset:1024 sc1
 buffer_load_dwordx4 v[232:235],v2,s[32:35],s42 offen sc1
 s_waitcnt vmcnt(10)
 v_bitop3_b32 v38,v152,v156,1 bitop3:0x80
 v_cmp_eq_u32 vcc,0,v38
 s_cbranch_vccz Lok_231
 s_sub_u32 s55,s55,1
 s_cbranch_scc0 Lfix_229
 s_mov_b32 s55,0
Lok_231:
 s_branch Lret_230
Lfix_232:
 buffer_load_dwordx4 v[168:171],v2,s[32:35],s38 offen sc1
 buffer_load_dwordx4 v[172:175],v2,s[32:35],s38 offen offset:1024 sc1
 buffer_load_dwordx4 v[184:187],v2,s[32:35],s39 offen sc1
 s_add_u32 s84,s97,32768
 buffer_store_dword v38,off,s[32:35],s84
 buffer_load_dwordx4 v[188:191],v2,s[32:35],s39 offen offset:1024 sc1
 buffer_load_dwordx4 v[200:203],v2,s[32:35],s40 offen sc1
 buffer_load_dwordx4 v[204:207],v2,s[32:35],s40 offen offset:1024 sc1
 buffer_load_dwordx4 v[216:219],v2,s[32:35],s41 offen sc1
 buffer_load_dwordx4 v[220:223],v2,s[32:35],s41 offen offset:1024 sc1
 buffer_load_dwordx4 v[232:235],v2,s[32:35],s42 offen sc1
 buffer_load_dwordx4 v[236:239],v2,s[32:35],s42 offen offset:1024 sc1
 buffer_load_dwordx4 v[248:251],v2,s[32:35],s43 offen sc1
 s_waitcnt vmcnt(10)
 v_bitop3_b32 v38,v168,v172,1 bitop3:0x80
 v_cmp_eq_u32 vcc,0,v38
 s_cbranch_vccz Lok_234
 s_sub_u32 s55,s55,1
 s_cbranch_scc0 Lfix_232
 s_mov_b32 s55,0
Lok_234:
 s_branch Lret_233
Lfix_235:
 buffer_load_dwordx4 v[184:187],v2,s[32:35],s39 offen sc1
 buffer_load_dwordx4 v[188:191],v2,s[32:35],s39 offen offset:1024 sc1
 buffer_load_dwordx4 v[200:203],v2,s[32:35],s40 offen sc1
 buffer_load_dwordx4 v[204:207],v2,s[32:35],s40 offen offset:1024 sc1
 buffer_load_dwordx4 v[216:219],v2,s[32:35],s41 offen sc1
 buffer_load_dwordx4 v[220:223],v2,s[32:35],s41 offen offset:1024 sc1
 buffer_load_dwordx4 v[232:235],v2,s[32:35],s42 offen sc1
 buffer_load_dwordx4 v[236:239],v2,s[32:35],s42 offen offset:1024 sc1
 buffer_load_dwordx4 v[248:251],v2,s[32:35],s43 offen sc1
 buffer_load_dwordx4 v[252:255],v2,s[32:35],s43 offen offset:1024 sc1
 buffer_load_dwordx4 v[144:147],v2,s[32:35],s8 offen sc1
 s_waitcnt vmcnt(9)
 v_bitop3_b32 v38,v184,v188,1 bitop3:0x80
 v_cmp_eq_u32 vcc,0,v38
 s_cbranch_vccz Lok_237
 s_sub_u32 s55,s55,1
 s_cbranch_scc0 Lfix_235
 s_mov_b32 s55,0
Lok_237:
 s_branch Lret_236
Lfix_238:
 buffer_load_dwordx4 v[200:203],v2,s[32:35],s40 offen sc1
 buffer_load_dwordx4 v[204:207],v2,s[32:35],s40 offen offset:1024 sc1
 buffer_load_dwordx4 v[216:219],v2,s[32:35],s41 offen sc1
 buffer_load_dwordx4 v[220:223],v2,s[32:35],s41 offen offset:1024 sc1
 buffer_load_dwordx4 v[232:235],v2,s[32:35],s42 offen sc1
 buffer_load_dwordx4 v[236:239],v2,s[32:35],s42 offen offset:1024 sc1
 buffer_load_dwordx4 v[248:251],v2,s[32:35],s43 offen sc1
 buffer_load_dwordx4 v[252:255],v2,s[32:35],s43 offen offset:1024 sc1
 buffer_load_dwordx4 v[144:147],v2,s[32:35],s8 offen sc1
 buffer_load_dwordx4 v[148:151],v2,s[32:35],s8 offen offset:1024 sc1
 buffer_load_dwordx4 v[160:163],v2,s[32:35],s9 offen sc1
 s_waitcnt vmcnt(9)
 v_bitop3_b32 v38,v200,v204,1 bitop3:0x80
 v_cmp_eq_u32 vcc,0,v38
 s_cbranch_vccz Lok_240
 s_sub_u32 s55,s55,1
 s_cbranch_scc0 Lfix_238
 s_mov_b32 s55,0
Lok_240:
 s_branch Lret_239
Lfix_241:
 buffer_load_dwordx4 v[216:219],v2,s[32:35],s41 offen sc1
 buffer_load_dwordx4 v[220:223],v2,s[32:35],s41 offen offset:1024 sc1
 buffer_load_dwordx4 v[232:235],v2,s[32:35],s42 offen sc1
 buffer_load_dwordx4 v[236:239],v2,s[32:35],s42 offen offset:1024 sc1
 buffer_load_dwordx4 v[248:251],v2,s[32:35],s43 offen sc1
 buffer_load_dwordx4 v[252:255],v2,s[32:35],s43 offen offset:1024 sc1
 buffer_load_dwordx4 v[144:147],v2,s[32:35],s8 offen sc1
 buffer_load_dwordx4 v[148:151],v2,s[32:35],s8 offen offset:1024 sc1
 buffer_load_dwordx4 v[160:163],v2,s[32:35],s9 offen sc1
 buffer_load_dwordx4 v[164:167],v2,s[32:35],s9 offen offset:1024 sc1
 s_add_u32 s84,s97,32768
 buffer_store_dword v38,off,s[32:35],s84
 s_add_u32 s84,s97,32768
 buffer_store_dword v38,off,s[32:35],s84
 buffer_load_dwordx4 v[176:179],v2,s[32:35],s10 offen sc1
 s_waitcnt vmcnt(11)
 v_bitop3_b32 v38,v216,v220,1 bitop3:0x80
 v_cmp_eq_u32 vcc,0,v38
 s_cbranch_vccz Lok_243
 s_sub_u32 s55,s55,1
 s_cbranch_scc0 Lfix_241
 s_mov_b32 s55,0
Lok_243:
 s_branch Lret_242
Lfix_244:
 buffer_load_dwordx4 v[232:235],v2,s[32:35],s42 offen sc1
 buffer_load_dwordx4 v[236:239],v2,s[32:35],s42 offen offset:1024 sc1
 buffer_load_dwordx4 v[248:251],v2,s[32:35],s43 offen sc1
 buffer_load_dwordx4 v[252:255],v2,s[32:35],s43 offen offset:1024 sc1
 buffer_load_dwordx4 v[144:147],v2,s[32:35],s8 offen sc1
 buffer_load_dwordx4 v[148:151],v2,s[32:35],s8 offen offset:1024 sc1
 buffer_load_dwordx4 v[160:163],v2,s[32:35],s9 offen sc1
 buffer_load_dwordx4 v[164:167],v2,s[32:35],s9 offen offset:1024 sc1
 s_add_u32 s84,s97,32768
 buffer_store_dword v38,off,s[32:35],s84
 s_add_u32 s84,s97,32768
 buffer_store_dword v38,off,s[32:35],s84
 buffer_load_dwordx4 v[176:179],v2,s[32:35],s10 offen sc1
 buffer_load_dwordx4 v[180:183],v2,s[32:35],s10 offen offset:1024 sc1
 buffer_load_dwordx4 v[192:195],v2,s[32:35],s11 offen sc1
 s_waitcnt vmcnt(11)
 v_bitop3_b32 v38,v232,v236,1 bitop3:0x80
 v_cmp_eq_u32 vcc,0,v38
 s_cbranch_vccz Lok_246
 s_sub_u32 s55,s55,1
 s_cbranch_scc0 Lfix_244
 s_mov_b32 s55,0
Lok_246:
 s_branch Lret_245
Lfix_247:
 buffer_load_dwordx4 v[248:251],v2,s[32:35],s43 offen sc1
 buffer_load_dwordx4 v[252:255],v2,s[32:35],s43 offen offset:1024 sc1
 buffer_load_dwordx4 v[144:147],v2,s[32:35],s8 offen sc1
 buffer_load_dwordx4 v[148:151],v2,s[32:35],s8 offen offset:1024 sc1
 buffer_load_dwordx4 v[160:163],v2,s[32:35],s9 offen sc1
 buffer_load_dwordx4 v[164:167],v2,s[32:35],s9 offen offset:1024 sc1
 s_add_u32 s84,s97,32768
 buffer_store_dword v38,off,s[32:35],s84
 s_add_u32 s84,s97,32768
 buffer_store_dword v38,off,s[32:35],s84
 buffer_load_dwordx4 v[176:179],v2,s[32:35],s10 offen sc1
 buffer_load_dwordx4 v[180:183],v2,s[32:35],s10 offen offset:1024 sc1
 buffer_load_dwordx4 v[192:195],v2,s[32:35],s11 offen sc1
 buffer_load_dwordx4 v[196:199],v2,s[32:35],s11 offen offset:1024 sc1
 buffer_load_dwordx4 v[208:211],v2,s[32:35],s57 offen sc1
 s_waitcnt vmcnt(11)
 v_bitop3_b32 v38,v248,v252,1 bitop3:0x80
 v_cmp_eq_u32 vcc,0,v38
 s_cbranch_vccz Lok_249
 s_sub_u32 s55,s55,1
 s_cbranch_scc0 Lfix_247
 s_mov_b32 s55,0
Lok_249:
 s_branch Lret_248
Lfix_250:
 buffer_load_dwordx4 v[144:147],v2,s[32:35],s8 offen sc1
 buffer_load_dwordx4 v[148:151],v2,s[32:35],s8 offen offset:1024 sc1
 buffer_load_dwordx4 v[160:163],v2,s[32:35],s9 offen sc1
 buffer_load_dwordx4 v[164:167],v2,s[32:35],s9 offen offset:1024 sc1
 s_add_u32 s84,s97,32768
 buffer_store_dword v38,off,s[32:35],s84
 s_add_u32 s84,s97,32768
 buffer_store_dword v38,off,s[32:35],s84
 buffer_load_dwordx4 v[176:179],v2,s[32:35],s10 offen sc1
 buffer_load_dwordx4 v[180:183],v2,s[32:35],s10 offen offset:1024 sc1
 buffer_load_dwordx4 v[192:195],v2,s[32:35],s11 offen sc1
 buffer_load_dwordx4 v[196:199],v2,s[32:35],s11 offen offset:1024 sc1
 buffer_load_dwordx4 v[208:211],v2,s[32:35],s57 offen sc1
 buffer_load_dwordx4 v[212:215],v2,s[32:35],s57 offen offset:1024 sc1
 buffer_load_dwordx4 v[224:227],v2,s[32:35],s77 offen sc1
 s_waitcnt vmcnt(11)
 v_bitop3_b32 v38,v144,v148,1 bitop3:0x80
 v_cmp_eq_u32 vcc,0,v38
 s_cbranch_vccz Lok_252
 s_sub_u32 s55,s55,1
 s_cbranch_scc0 Lfix_250
 s_mov_b32 s55,0
Lok_252:
 s_branch Lret_251
Lfix_253:
 buffer_load_dwordx4 v[160:163],v2,s[32:35],s9 offen sc1
 buffer_load_dwordx4 v[164:167],v2,s[32:35],s9 offen offset:1024 sc1
 s_add_u32 s84,s97,32768
 buffer_store_dword v38,off,s[32:35],s84
 s_add_u32 s84,s97,32768
 buffer_store_dword v38,off,s[32:35],s84
 buffer_load_dwordx4 v[176:179],v2,s[32:35],s10 offen sc1
 buffer_load_dwordx4 v[180:183],v2,s[32:35],s10 offen offset:1024 sc1
 buffer_load_dwordx4 v[192:195],v2,s[32:35],s11 offen sc1
 buffer_load_dwordx4 v[196:199],v2,s[32:35],s11 offen offset:1024 sc1
 buffer_load_dwordx4 v[208:211],v2,s[32:35],s57 offen sc1
 buffer_load_dwordx4 v[212:215],v2,s[32:35],s57 offen offset:1024 sc1
 buffer_load_dwordx4 v[224:227],v2,s[32:35],s77 offen sc1
 buffer_load_dwordx4 v[228:231],v2,s[32:35],s77 offen offset:1024 sc1
 buffer_load_dwordx4 v[240:243],v2,s[32:35],s81 offen sc1
 s_waitcnt vmcnt(11)
 v_bitop3_b32 v38,v160,v164,1 bitop3:0x80
 v_cmp_eq_u32 vcc,0,v38
 s_cbranch_vccz Lok_255
 s_sub_u32 s55,s55,1
 s_cbranch_scc0 Lfix_253
 s_mov_b32 s55,0
Lok_255:
 s_branch Lret_254
Lfix_259:
 s_add_u32 s84,s58,262144
 buffer_load_dwordx4 v[72:75],v13,s[32:35],s84 offen sc1
 buffer_load_dwordx4 v[76:79],v13,s[32:35],s84 offen offset:512 sc1
 s_waitcnt vmcnt(0)
 v_and_b32 v38,v72,v73
 v_bitop3_b32 v38,v74,v75,v38 bitop3:0x80
 v_bitop3_b32 v38,v76,v77,v38 bitop3:0x80
 v_bitop3_b32 v38,v78,v79,v38 bitop3:0x80
 v_and_b32 v38,1,v38
 v_cmp_eq_u32 s[82:83],0,v38
 s_nop 0
 s_cmp_eq_u64 s[82:83],0
 s_cbranch_scc1 Lok_261
 s_sub_u32 s55,s55,1
 s_cbranch_scc0 Lfix_259
 s_mov_b32 s55,0
Lok_261:
 s_branch Lret_260
Lfix_256:
 buffer_load_dwordx4 v[176:179],v2,s[32:35],s10 offen sc1
 buffer_load_dwordx4 v[180:183],v2,s[32:35],s10 offen offset:1024 sc1
 buffer_load_dwordx4 v[192:195],v2,s[32:35],s11 offen sc1
 buffer_load_dwordx4 v[196:199],v2,s[32:35],s11 offen offset:1024 sc1
 buffer_load_dwordx4 v[208:211],v2,s[32:35],s57 offen sc1
 buffer_load_dwordx4 v[212:215],v2,s[32:35],s57 offen offset:1024 sc1
 buffer_load_dwordx4 v[224:227],v2,s[32:35],s77 offen sc1
 buffer_load_dwordx4 v[228:231],v2,s[32:35],s77 offen offset:1024 sc1
 buffer_load_dwordx4 v[240:243],v2,s[32:35],s81 offen sc1
 buffer_load_dwordx4 v[244:247],v2,s[32:35],s81 offen offset:1024 sc1
 buffer_load_dwordx4 a[248:251],v2,s[32:35],s99 offen sc1
 s_waitcnt vmcnt(9)
 v_bitop3_b32 v38,v176,v180,1 bitop3:0x80
 v_cmp_eq_u32 vcc,0,v38
 s_cbranch_vccz Lok_258
 s_sub_u32 s55,s55,1
 s_cbranch_scc0 Lfix_256
 s_mov_b32 s55,0
Lok_258:
 s_branch Lret_257
Lfix_262:
 buffer_load_dwordx4 v[192:195],v2,s[32:35],s11 offen sc1
 buffer_load_dwordx4 v[196:199],v2,s[32:35],s11 offen offset:1024 sc1
 buffer_load_dwordx4 v[208:211],v2,s[32:35],s57 offen sc1
 buffer_load_dwordx4 v[212:215],v2,s[32:35],s57 offen offset:1024 sc1
 buffer_load_dwordx4 v[224:227],v2,s[32:35],s77 offen sc1
 buffer_load_dwordx4 v[228:231],v2,s[32:35],s77 offen offset:1024 sc1
 buffer_load_dwordx4 v[240:243],v2,s[32:35],s81 offen sc1
 buffer_load_dwordx4 v[244:247],v2,s[32:35],s81 offen offset:1024 sc1
 buffer_load_dwordx4 a[248:251],v2,s[32:35],s99 offen sc1
 buffer_load_dwordx4 a[252:255],v2,s[32:35],s99 offen offset:1024 sc1
 s_waitcnt vmcnt(8)
 v_bitop3_b32 v38,v192,v196,1 bitop3:0x80
 v_cmp_eq_u32 vcc,0,v38
 s_cbranch_vccz Lok_264
 s_sub_u32 s55,s55,1
 s_cbranch_scc0 Lfix_262
 s_mov_b32 s55,0
Lok_264:
 s_branch Lret_263
Lfix_265:
 buffer_load_dwordx4 v[208:211],v2,s[32:35],s57 offen sc1
 buffer_load_dwordx4 v[212:215],v2,s[32:35],s57 offen offset:1024 sc1
 buffer_load_dwordx4 v[224:227],v2,s[32:35],s77 offen sc1
 buffer_load_dwordx4 v[228:231],v2,s[32:35],s77 offen offset:1024 sc1
 buffer_load_dwordx4 v[240:243],v2,s[32:35],s81 offen sc1
 buffer_load_dwordx4 v[244:247],v2,s[32:35],s81 offen offset:1024 sc1
 buffer_load_dwordx4 a[248:251],v2,s[32:35],s99 offen sc1
 buffer_load_dwordx4 a[252:255],v2,s[32:35],s99 offen offset:1024 sc1
 s_waitcnt vmcnt(6)
 v_bitop3_b32 v38,v208,v212,1 bitop3:0x80
 v_cmp_eq_u32 vcc,0,v38
 s_cbranch_vccz Lok_267
 s_sub_u32 s55,s55,1
 s_cbranch_scc0 Lfix_265
 s_mov_b32 s55,0
Lok_267:
 s_branch Lret_266
Lfix_268:
 buffer_load_dwordx4 v[224:227],v2,s[32:35],s77 offen sc1
 buffer_load_dwordx4 v[228:231],v2,s[32:35],s77 offen offset:1024 sc1
 buffer_load_dwordx4 v[240:243],v2,s[32:35],s81 offen sc1
 buffer_load_dwordx4 v[244:247],v2,s[32:35],s81 offen offset:1024 sc1
 buffer_load_dwordx4 a[248:251],v2,s[32:35],s99 offen sc1
 buffer_load_dwordx4 a[252:255],v2,s[32:35],s99 offen offset:1024 sc1
 s_waitcnt vmcnt(4)
 v_bitop3_b32 v38,v224,v228,1 bitop3:0x80
 v_cmp_eq_u32 vcc,0,v38
 s_cbranch_vccz Lok_270
 s_sub_u32 s55,s55,1
 s_cbranch_scc0 Lfix_268
 s_mov_b32 s55,0
Lok_270:
 s_branch Lret_269
Lfix_271:
 buffer_load_dwordx4 v[240:243],v2,s[32:35],s81 offen sc1
 buffer_load_dwordx4 v[244:247],v2,s[32:35],s81 offen offset:1024 sc1
 buffer_load_dwordx4 a[248:251],v2,s[32:35],s99 offen sc1
 buffer_load_dwordx4 a[252:255],v2,s[32:35],s99 offen offset:1024 sc1
 s_waitcnt vmcnt(2)
 v_bitop3_b32 v38,v240,v244,1 bitop3:0x80
 v_cmp_eq_u32 vcc,0,v38
 s_cbranch_vccz Lok_273
 s_sub_u32 s55,s55,1
 s_cbranch_scc0 Lfix_271
 s_mov_b32 s55,0
Lok_273:
 s_branch Lret_272
Lfix_274:
 buffer_load_dwordx4 a[248:251],v2,s[32:35],s99 offen sc1
 buffer_load_dwordx4 a[252:255],v2,s[32:35],s99 offen offset:1024 sc1
 s_waitcnt vmcnt(0)
 v_accvgpr_read_b32 v38,a248
 v_lshlrev_b32 v38,31,v38
 v_cmp_eq_u32 s[82:83],0,v38
 v_accvgpr_read_b32 v38,a252
 v_lshlrev_b32 v38,31,v38
 v_cmp_eq_u32 vcc,0,v38
 s_nop 1
 s_or_b64 vcc,vcc,s[82:83]
 s_cbranch_vccz Lok_276
 s_sub_u32 s55,s55,1
 s_cbranch_scc0 Lfix_274
 s_mov_b32 s55,0
Lok_276:
 s_branch Lret_275
Lfix_278:
 s_bfe_u32 s84,s44,0x50000
 s_lshl_b32 s84,s84,12
 buffer_load_dwordx4 v[136:139],v32,s[32:35],s84 offen sc1
 s_bfe_u32 s84,s44,0x50005
 s_lshl_b32 s84,s84,12
 buffer_load_dwordx4 v[140:143],v32,s[32:35],s84 offen sc1
 s_bfe_u32 s84,s44,0x5000a
 s_lshl_b32 s84,s84,12
 buffer_load_dwordx4 v[144:147],v32,s[32:35],s84 offen sc1
 s_bfe_u32 s84,s44,0x5000f
 s_lshl_b32 s84,s84,12
 buffer_load_dwordx4 v[148:151],v32,s[32:35],s84 offen sc1
 s_bfe_u32 s84,s44,0x50014
 s_lshl_b32 s84,s84,12
 buffer_load_dwordx4 v[152:155],v32,s[32:35],s84 offen sc1
 s_bfe_u32 s84,s44,0x50019
 s_lshl_b32 s84,s84,12
 buffer_load_dwordx4 v[156:159],v32,s[32:35],s84 offen sc1
 s_bfe_u32 s84,s45,0x50000
 s_lshl_b32 s84,s84,12
 buffer_load_dwordx4 v[160:163],v32,s[32:35],s84 offen sc1
 s_bfe_u32 s84,s45,0x50005
 s_lshl_b32 s84,s84,12
 buffer_load_dwordx4 v[164:167],v32,s[32:35],s84 offen sc1
 s_bfe_u32 s84,s45,0x5000a
 s_lshl_b32 s84,s84,12
 buffer_load_dwordx4 v[168:171],v32,s[32:35],s84 offen sc1
 s_bfe_u32 s84,s45,0x5000f
 s_lshl_b32 s84,s84,12
 buffer_load_dwordx4 v[172:175],v32,s[32:35],s84 offen sc1
 s_add_u32 s84,s97,32768
 buffer_store_dword v38,off,s[32:35],s84
 s_waitcnt vmcnt(9)
 v_or_b32 v38,v136,v140
 v_cmp_gt_i32 vcc,0,v38
 s_cbranch_vccz Lok_280
 s_sub_u32 s55,s55,1
 s_cbranch_scc0 Lfix_278
 s_mov_b32 s55,0
Lok_280:
 s_branch Lret_279
Lfix_281:
 s_bfe_u32 s84,s44,0x5000a
 s_lshl_b32 s84,s84,12
 buffer_load_dwordx4 v[144:147],v32,s[32:35],s84 offen sc1
 s_bfe_u32 s84,s44,0x5000f
 s_lshl_b32 s84,s84,12
 buffer_load_dwordx4 v[148:151],v32,s[32:35],s84 offen sc1
 s_bfe_u32 s84,s44,0x50014
 s_lshl_b32 s84,s84,12
 buffer_load_dwordx4 v[152:155],v32,s[32:35],s84 offen sc1
 s_bfe_u32 s84,s44,0x50019
 s_lshl_b32 s84,s84,12
 buffer_load_dwordx4 v[156:159],v32,s[32:35],s84 offen sc1
 s_bfe_u32 s84,s45,0x50000
 s_lshl_b32 s84,s84,12
 buffer_load_dwordx4 v[160:163],v32,s[32:35],s84 offen sc1
 s_bfe_u32 s84,s45,0x50005
 s_lshl_b32 s84,s84,12
 buffer_load_dwordx4 v[164:167],v32,s[32:35],s84 offen sc1
 s_bfe_u32 s84,s45,0x5000a
 s_lshl_b32 s84,s84,12
 buffer_load_dwordx4 v[168:171],v32,s[32:35],s84 offen sc1
 s_bfe_u32 s84,s45,0x5000f
 s_lshl_b32 s84,s84,12
 buffer_load_dwordx4 v[172:175],v32,s[32:35],s84 offen sc1
 s_add_u32 s84,s97,32768
 buffer_store_dword v38,off,s[32:35],s84
 s_bfe_u32 s84,s45,0x50014
 s_lshl_b32 s84,s84,12
 buffer_load_dwordx4 v[176:179],v32,s[32:35],s84 offen sc1
 s_bfe_u32 s84,s45,0x50019
 s_lshl_b32 s84,s84,12
 buffer_load_dwordx4 v[180:183],v32,s[32:35],s84 offen sc1
 s_waitcnt vmcnt(9)
 v_or_b32 v38,v144,v148
 v_cmp_gt_i32 vcc,0,v38
 s_cbranch_vccz Lok_283
 s_sub_u32 s55,s55,1
 s_cbranch_scc0 Lfix_281
 s_mov_b32 s55,0
Lok_283:
 s_branch Lret_282
Lfix_284:
 s_bfe_u32 s84,s44,0x50014
 s_lshl_b32 s84,s84,12
 buffer_load_dwordx4 v[152:155],v32,s[32:35],s84 offen sc1
 s_bfe_u32 s84,s44,0x50019
 s_lshl_b32 s84,s84,12
 buffer_load_dwordx4 v[156:159],v32,s[32:35],s84 offen sc1
 s_bfe_u32 s84,s45,0x50000
 s_lshl_b32 s84,s84,12
 buffer_load_dwordx4 v[160:163],v32,s[32:35],s84 offen sc1
 s_bfe_u32 s84,s45,0x50005
 s_lshl_b32 s84,s84,12
 buffer_load_dwordx4 v[164:167],v32,s[32:35],s84 offen sc1
 s_bfe_u32 s84,s45,0x5000a
 s_lshl_b32 s84,s84,12
 buffer_load_dwordx4 v[168:171],v32,s[32:35],s84 offen sc1
 s_bfe_u32 s84,s45,0x5000f
 s_lshl_b32 s84,s84,12
 buffer_load_dwordx4 v[172:175],v32,s[32:35],s84 offen sc1
 s_add_u32 s84,s97,32768
 buffer_store_dword v38,off,s[32:35],s84
 s_bfe_u32 s84,s45,0x50014
 s_lshl_b32 s84,s84,12
 buffer_load_dwordx4 v[176:179],v32,s[32:35],s84 offen sc1
 s_bfe_u32 s84,s45,0x50019
 s_lshl_b32 s84,s84,12
 buffer_load_dwordx4 v[180:183],v32,s[32:35],s84 offen sc1
 s_bfe_u32 s84,s46,0x50000
 s_lshl_b32 s84,s84,12
 buffer_load_dwordx4 v[184:187],v32,s[32:35],s84 offen sc1
 s_bfe_u32 s84,s46,0x50005
 s_lshl_b32 s84,s84,12
 buffer_load_dwordx4 v[188:191],v32,s[32:35],s84 offen sc1
 s_waitcnt vmcnt(9)
 v_or_b32 v38,v152,v156
 v_cmp_gt_i32 vcc,0,v38
 s_cbranch_vccz Lok_286
 s_sub_u32 s55,s55,1
 s_cbranch_scc0 Lfix_284
 s_mov_b32 s55,0
Lok_286:
 s_branch Lret_285
Lfix_287:
 s_bfe_u32 s84,s45,0x50000
 s_lshl_b32 s84,s84,12
 buffer_load_dwordx4 v[160:163],v32,s[32:35],s84 offen sc1
 s_bfe_u32 s84,s45,0x50005
 s_lshl_b32 s84,s84,12
 buffer_load_dwordx4 v[164:167],v32,s[32:35],s84 offen sc1
 s_bfe_u32 s84,s45,0x5000a
 s_lshl_b32 s84,s84,12
 buffer_load_dwordx4 v[168:171],v32,s[32:35],s84 offen sc1
 s_bfe_u32 s84,s45,0x5000f
 s_lshl_b32 s84,s84,12
 buffer_load_dwordx4 v[172:175],v32,s[32:35],s84 offen sc1
 s_add_u32 s84,s97,32768
 buffer_store_dword v38,off,s[32:35],s84
 s_bfe_u32 s84,s45,0x50014
 s_lshl_b32 s84,s84,12
 buffer_load_dwordx4 v[176:179],v32,s[32:35],s84 offen sc1
 s_bfe_u32 s84,s45,0x50019
 s_lshl_b32 s84,s84,12
 buffer_load_dwordx4 v[180:183],v32,s[32:35],s84 offen sc1
 s_bfe_u32 s84,s46,0x50000
 s_lshl_b32 s84,s84,12
 buffer_load_dwordx4 v[184:187],v32,s[32:35],s84 offen sc1
 s_bfe_u32 s84,s46,0x50005
 s_lshl_b32 s84,s84,12
 buffer_load_dwordx4 v[188:191],v32,s[32:35],s84 offen sc1
 s_bfe_u32 s84,s46,0x5000a
 s_lshl_b32 s84,s84,12
 buffer_load_dwordx4 v[192:195],v32,s[32:35],s84 offen sc1
 s_bfe_u32 s84,s46,0x5000f
 s_lshl_b32 s84,s84,12
 buffer_load_dwordx4 v[196:199],v32,s[32:35],s84 offen sc1
 s_waitcnt vmcnt(9)
 v_or_b32 v38,v160,v164
 v_cmp_gt_i32 vcc,0,v38
 s_cbranch_vccz Lok_289
 s_sub_u32 s55,s55,1
 s_cbranch_scc0 Lfix_287
 s_mov_b32 s55,0
Lok_289:
 s_branch Lret_288
Lfix_290:
 s_bfe_u32 s84,s45,0x5000a
 s_lshl_b32 s84,s84,12
 buffer_load_dwordx4 v[168:171],v32,s[32:35],s84 offen sc1
 s_bfe_u32 s84,s45,0x5000f
 s_lshl_b32 s84,s84,12
 buffer_load_dwordx4 v[172:175],v32,s[32:35],s84 offen sc1
 s_add_u32 s84,s97,32768
 buffer_store_dword v38,off,s[32:35],s84
 s_bfe_u32 s84,s45,0x50014
 s_lshl_b32 s84,s84,12
 buffer_load_dwordx4 v[176:179],v32,s[32:35],s84 offen sc1
 s_bfe_u32 s84,s45,0x50019
 s_lshl_b32 s84,s84,12
 buffer_load_dwordx4 v[180:183],v32,s[32:35],s84 offen sc1
 s_bfe_u32 s84,s46,0x50000
 s_lshl_b32 s84,s84,12
 buffer_load_dwordx4 v[184:187],v32,s[32:35],s84 offen sc1
 s_bfe_u32 s84,s46,0x50005
 s_lshl_b32 s84,s84,12
 buffer_load_dwordx4 v[188:191],v32,s[32:35],s84 offen sc1
 s_bfe_u32 s84,s46,0x5000a
 s_lshl_b32 s84,s84,12
 buffer_load_dwordx4 v[192:195],v32,s[32:35],s84 offen sc1
 s_bfe_u32 s84,s46,0x5000f
 s_lshl_b32 s84,s84,12
 buffer_load_dwordx4 v[196:199],v32,s[32:35],s84 offen sc1
 s_bfe_u32 s84,s46,0x50014
 s_lshl_b32 s84,s84,12
 buffer_load_dwordx4 v[200:203],v32,s[32:35],s84 offen sc1
 s_bfe_u32 s84,s46,0x50019
 s_lshl_b32 s84,s84,12
 buffer_load_dwordx4 v[204:207],v32,s[32:35],s84 offen sc1
 s_waitcnt vmcnt(9)
 v_or_b32 v38,v168,v172
 v_cmp_gt_i32 vcc,0,v38
 s_cbranch_vccz Lok_292
 s_sub_u32 s55,s55,1
 s_cbranch_scc0 Lfix_290
 s_mov_b32 s55,0
Lok_292:
 s_branch Lret_291
Lfix_293:
 s_add_u32 s84,s69,262144
 buffer_load_dwordx4 v[24:27],v14,s[32:35],s84 offen sc1
 s_waitcnt vmcnt(0)
 v_and_b32 v30,v24,v25
 v_bitop3_b32 v30,v26,v27,v30 bitop3:0x80
 v_and_b32 v30,1,v30
 v_cmp_eq_u32 s[82:83],0,v30
 s_nop 0
 s_cmp_eq_u64 s[82:83],0
 s_cbranch_scc1 Lok_295
 s_sub_u32 s55,s55,1
 s_cbranch_scc0 Lfix_293
 s_mov_b32 s55,0
Lok_295:
 s_branch Lret_294
Lfix_296:
 s_bfe_u32 s84,s45,0x50014
 s_lshl_b32 s84,s84,12
 buffer_load_dwordx4 v[176:179],v32,s[32:35],s84 offen sc1
 s_bfe_u32 s84,s45,0x50019
 s_lshl_b32 s84,s84,12
 buffer_load_dwordx4 v[180:183],v32,s[32:35],s84 offen sc1
 s_bfe_u32 s84,s46,0x50000
 s_lshl_b32 s84,s84,12
 buffer_load_dwordx4 v[184:187],v32,s[32:35],s84 offen sc1
 s_bfe_u32 s84,s46,0x50005
 s_lshl_b32 s84,s84,12
 buffer_load_dwordx4 v[188:191],v32,s[32:35],s84 offen sc1
 s_bfe_u32 s84,s46,0x5000a
 s_lshl_b32 s84,s84,12
 buffer_load_dwordx4 v[192:195],v32,s[32:35],s84 offen sc1
 s_bfe_u32 s84,s46,0x5000f
 s_lshl_b32 s84,s84,12
 buffer_load_dwordx4 v[196:199],v32,s[32:35],s84 offen sc1
 s_bfe_u32 s84,s46,0x50014
 s_lshl_b32 s84,s84,12
 buffer_load_dwordx4 v[200:203],v32,s[32:35],s84 offen sc1
 s_bfe_u32 s84,s46,0x50019
 s_lshl_b32 s84,s84,12
 buffer_load_dwordx4 v[204:207],v32,s[32:35],s84 offen sc1
 s_bfe_u32 s84,s47,0x50000
 s_lshl_b32 s84,s84,12
 buffer_load_dwordx4 v[208:211],v32,s[32:35],s84 offen sc1
 s_bfe_u32 s84,s47,0x50005
 s_lshl_b32 s84,s84,12
 buffer_load_dwordx4 v[212:215],v32,s[32:35],s84 offen sc1
 s_waitcnt vmcnt(8)
 v_or_b32 v38,v176,v180
 v_cmp_gt_i32 vcc,0,v38
 s_cbranch_vccz Lok_298
 s_sub_u32 s55,s55,1
 s_cbranch_scc0 Lfix_296
 s_mov_b32 s55,0
Lok_298:
 s_branch Lret_297
Lfix_299:
 s_bfe_u32 s84,s46,0x50000
 s_lshl_b32 s84,s84,12
 buffer_load_dwordx4 v[184:187],v32,s[32:35],s84 offen sc1
 s_bfe_u32 s84,s46,0x50005
 s_lshl_b32 s84,s84,12
 buffer_load_dwordx4 v[188:191],v32,s[32:35],s84 offen sc1
 s_bfe_u32 s84,s46,0x5000a
 s_lshl_b32 s84,s84,12
 buffer_load_dwordx4 v[192:195],v32,s[32:35],s84 offen sc1
 s_bfe_u32 s84,s46,0x5000f
 s_lshl_b32 s84,s84,12
 buffer_load_dwordx4 v[196:199],v32,s[32:35],s84 offen sc1
 s_bfe_u32 s84,s46,0x50014
 s_lshl_b32 s84,s84,12
 buffer_load_dwordx4 v[200:203],v32,s[32:35],s84 offen sc1
 s_bfe_u32 s84,s46,0x50019
 s_lshl_b32 s84,s84,12
 buffer_load_dwordx4 v[204:207],v32,s[32:35],s84 offen sc1
 s_bfe_u32 s84,s47,0x50000
 s_lshl_b32 s84,s84,12
 buffer_load_dwordx4 v[208:211],v32,s[32:35],s84 offen sc1
 s_bfe_u32 s84,s47,0x50005
 s_lshl_b32 s84,s84,12
 buffer_load_dwordx4 v[212:215],v32,s[32:35],s84 offen sc1
 s_bfe_u32 s84,s47,0x5000a
 s_lshl_b32 s84,s84,12
 buffer_load_dwordx4 v[216:219],v32,s[32:35],s84 offen sc1
 buffer_load_dwordx4 v[220:223],v32,s[32:35],s70 offen sc1
 s_waitcnt vmcnt(8)
 v_or_b32 v38,v184,v188
 v_cmp_gt_i32 vcc,0,v38
 s_cbranch_vccz Lok_301
 s_sub_u32 s55,s55,1
 s_cbranch_scc0 Lfix_299
 s_mov_b32 s55,0
Lok_301:
 s_branch Lret_300
Lfix_302:
 s_bfe_u32 s84,s46,0x5000a
 s_lshl_b32 s84,s84,12
 buffer_load_dwordx4 v[192:195],v32,s[32:35],s84 offen sc1
 s_bfe_u32 s84,s46,0x5000f
 s_lshl_b32 s84,s84,12
 buffer_load_dwordx4 v[196:199],v32,s[32:35],s84 offen sc1
 s_bfe_u32 s84,s46,0x50014
 s_lshl_b32 s84,s84,12
 buffer_load_dwordx4 v[200:203],v32,s[32:35],s84 offen sc1
 s_bfe_u32 s84,s46,0x50019
 s_lshl_b32 s84,s84,12
 buffer_load_dwordx4 v[204:207],v32,s[32:35],s84 offen sc1
 s_bfe_u32 s84,s47,0x50000
 s_lshl_b32 s84,s84,12
 buffer_load_dwordx4 v[208:211],v32,s[32:35],s84 offen sc1
 s_bfe_u32 s84,s47,0x50005
 s_lshl_b32 s84,s84,12
 buffer_load_dwordx4 v[212:215],v32,s[32:35],s84 offen sc1
 s_bfe_u32 s84,s47,0x5000a
 s_lshl_b32 s84,s84,12
 buffer_load_dwordx4 v[216:219],v32,s[32:35],s84 offen sc1
 buffer_load_dwordx4 v[220:223],v32,s[32:35],s70 offen sc1
 s_bfe_u32 s84,s44,0x50000
 s_lshl_b32 s84,s84,12
 buffer_load_dwordx4 v[224:227],v33,s[32:35],s84 offen sc1
 s_bfe_u32 s84,s44,0x50005
 s_lshl_b32 s84,s84,12
 buffer_load_dwordx4 v[228:231],v33,s[32:35],s84 offen sc1
 s_waitcnt vmcnt(8)
 v_or_b32 v38,v192,v196
 v_cmp_gt_i32 vcc,0,v38
 s_cbranch_vccz Lok_304
 s_sub_u32 s55,s55,1
 s_cbranch_scc0 Lfix_302
 s_mov_b32 s55,0
Lok_304:
 s_branch Lret_303
Lfix_305:
 s_bfe_u32 s84,s46,0x50014
 s_lshl_b32 s84,s84,12
 buffer_load_dwordx4 v[200:203],v32,s[32:35],s84 offen sc1
 s_bfe_u32 s84,s46,0x50019
 s_lshl_b32 s84,s84,12
 buffer_load_dwordx4 v[204:207],v32,s[32:35],s84 offen sc1
 s_bfe_u32 s84,s47,0x50000
 s_lshl_b32 s84,s84,12
 buffer_load_dwordx4 v[208:211],v32,s[32:35],s84 offen sc1
 s_bfe_u32 s84,s47,0x50005
 s_lshl_b32 s84,s84,12
 buffer_load_dwordx4 v[212:215],v32,s[32:35],s84 offen sc1
 s_bfe_u32 s84,s47,0x5000a
 s_lshl_b32 s84,s84,12
 buffer_load_dwordx4 v[216:219],v32,s[32:35],s84 offen sc1
 buffer_load_dwordx4 v[220:223],v32,s[32:35],s70 offen sc1
 s_bfe_u32 s84,s44,0x50000
 s_lshl_b32 s84,s84,12
 buffer_load_dwordx4 v[224:227],v33,s[32:35],s84 offen sc1
 s_bfe_u32 s84,s44,0x50005
 s_lshl_b32 s84,s84,12
 buffer_load_dwordx4 v[228:231],v33,s[32:35],s84 offen sc1
 s_bfe_u32 s84,s44,0x5000a
 s_lshl_b32 s84,s84,12
 buffer_load_dwordx4 v[136:139],v33,s[32:35],s84 offen sc1
 s_bfe_u32 s84,s44,0x5000f
 s_lshl_b32 s84,s84,12
 buffer_load_dwordx4 v[140:143],v33,s[32:35],s84 offen sc1
 s_waitcnt vmcnt(8)
 v_or_b32 v38,v200,v204
 v_cmp_gt_i32 vcc,0,v38
 s_cbranch_vccz Lok_307
 s_sub_u32 s55,s55,1
 s_cbranch_scc0 Lfix_305
 s_mov_b32 s55,0
Lok_307:
 s_branch Lret_306
Lfix_308:
 s_bfe_u32 s84,s47,0x50000
 s_lshl_b32 s84,s84,12
 buffer_load_dwordx4 v[208:211],v32,s[32:35],s84 offen sc1
 s_bfe_u32 s84,s47,0x50005
 s_lshl_b32 s84,s84,12
 buffer_load_dwordx4 v[212:215],v32,s[32:35],s84 offen sc1
 s_bfe_u32 s84,s47,0x5000a
 s_lshl_b32 s84,s84,12
 buffer_load_dwordx4 v[216:219],v32,s[32:35],s84 offen sc1
 buffer_load_dwordx4 v[220:223],v32,s[32:35],s70 offen sc1
 s_bfe_u32 s84,s44,0x50000
 s_lshl_b32 s84,s84,12
 buffer_load_dwordx4 v[224:227],v33,s[32:35],s84 offen sc1
 s_bfe_u32 s84,s44,0x50005
 s_lshl_b32 s84,s84,12
 buffer_load_dwordx4 v[228:231],v33,s[32:35],s84 offen sc1
 s_bfe_u32 s84,s44,0x5000a
 s_lshl_b32 s84,s84,12
 buffer_load_dwordx4 v[136:139],v33,s[32:35],s84 offen sc1
 s_bfe_u32 s84,s44,0x5000f
 s_lshl_b32 s84,s84,12
 buffer_load_dwordx4 v[140:143],v33,s[32:35],s84 offen sc1
 s_bfe_u32 s84,s44,0x50014
 s_lshl_b32 s84,s84,12
 buffer_load_dwordx4 v[144:147],v33,s[32:35],s84 offen sc1
 s_bfe_u32 s84,s44,0x50019
 s_lshl_b32 s84,s84,12
 buffer_load_dwordx4 v[148:151],v33,s[32:35],s84 offen sc1
 s_waitcnt vmcnt(8)
 v_or_b32 v38,v208,v212
 v_cmp_gt_i32 vcc,0,v38
 s_cbranch_vccz Lok_310
 s_sub_u32 s55,s55,1
 s_cbranch_scc0 Lfix_308
 s_mov_b32 s55,0
Lok_310:
 s_branch Lret_309
Lfix_311:
 s_bfe_u32 s84,s47,0x5000a
 s_lshl_b32 s84,s84,12
 buffer_load_dwordx4 v[216:219],v32,s[32:35],s84 offen sc1
 buffer_load_dwordx4 v[220:223],v32,s[32:35],s70 offen sc1
 s_bfe_u32 s84,s44,0x50000
 s_lshl_b32 s84,s84,12
 buffer_load_dwordx4 v[224:227],v33,s[32:35],s84 offen sc1
 s_bfe_u32 s84,s44,0x50005
 s_lshl_b32 s84,s84,12
 buffer_load_dwordx4 v[228:231],v33,s[32:35],s84 offen sc1
 s_bfe_u32 s84,s44,0x5000a
 s_lshl_b32 s84,s84,12
 buffer_load_dwordx4 v[136:139],v33,s[32:35],s84 offen sc1
 s_bfe_u32 s84,s44,0x5000f
 s_lshl_b32 s84,s84,12
 buffer_load_dwordx4 v[140:143],v33,s[32:35],s84 offen sc1
 s_bfe_u32 s84,s44,0x50014
 s_lshl_b32 s84,s84,12
 buffer_load_dwordx4 v[144:147],v33,s[32:35],s84 offen sc1
 s_bfe_u32 s84,s44,0x50019
 s_lshl_b32 s84,s84,12
 buffer_load_dwordx4 v[148:151],v33,s[32:35],s84 offen sc1
 s_bfe_u32 s84,s45,0x50000
 s_lshl_b32 s84,s84,12
 buffer_load_dwordx4 v[152:155],v33,s[32:35],s84 offen sc1
 s_bfe_u32 s84,s45,0x50005
 s_lshl_b32 s84,s84,12
 buffer_load_dwordx4 v[156:159],v33,s[32:35],s84 offen sc1
 s_waitcnt vmcnt(8)
 v_or_b32 v38,v216,v220
 v_cmp_gt_i32 vcc,0,v38
 s_cbranch_vccz Lok_313
 s_sub_u32 s55,s55,1
 s_cbranch_scc0 Lfix_311
 s_mov_b32 s55,0
Lok_313:
 s_branch Lret_312
Lfix_314:
 s_bfe_u32 s84,s44,0x50000
 s_lshl_b32 s84,s84,12
 buffer_load_dwordx4 v[224:227],v33,s[32:35],s84 offen sc1
 s_bfe_u32 s84,s44,0x50005
 s_lshl_b32 s84,s84,12
 buffer_load_dwordx4 v[228:231],v33,s[32:35],s84 offen sc1
 s_bfe_u32 s84,s44,0x5000a
 s_lshl_b32 s84,s84,12
 buffer_load_dwordx4 v[136:139],v33,s[32:35],s84 offen sc1
 s_bfe_u32 s84,s44,0x5000f
 s_lshl_b32 s84,s84,12
 buffer_load_dwordx4 v[140:143],v33,s[32:35],s84 offen sc1
 s_bfe_u32 s84,s44,0x50014
 s_lshl_b32 s84,s84,12
 buffer_load_dwordx4 v[144:147],v33,s[32:35],s84 offen sc1
 s_bfe_u32 s84,s44,0x50019
 s_lshl_b32 s84,s84,12
 buffer_load_dwordx4 v[148:151],v33,s[32:35],s84 offen sc1
 s_bfe_u32 s84,s45,0x50000
 s_lshl_b32 s84,s84,12
 buffer_load_dwordx4 v[152:155],v33,s[32:35],s84 offen sc1
 s_bfe_u32 s84,s45,0x50005
 s_lshl_b32 s84,s84,12
 buffer_load_dwordx4 v[156:159],v33,s[32:35],s84 offen sc1
 s_bfe_u32 s84,s45,0x5000a
 s_lshl_b32 s84,s84,12
 buffer_load_dwordx4 v[160:163],v33,s[32:35],s84 offen sc1
 s_bfe_u32 s84,s45,0x5000f
 s_lshl_b32 s84,s84,12
 buffer_load_dwordx4 v[164:167],v33,s[32:35],s84 offen sc1
 s_waitcnt vmcnt(8)
 v_or_b32 v38,v224,v228
 v_cmp_gt_i32 vcc,0,v38
 s_cbranch_vccz Lok_316
 s_sub_u32 s55,s55,1
 s_cbranch_scc0 Lfix_314
 s_mov_b32 s55,0
Lok_316:
 s_branch Lret_315
Lfix_317:
 s_bfe_u32 s84,s44,0x5000a
 s_lshl_b32 s84,s84,12
 buffer_load_dwordx4 v[136:139],v33,s[32:35],s84 offen sc1
 s_bfe_u32 s84,s44,0x5000f
 s_lshl_b32 s84,s84,12
 buffer_load_dwordx4 v[140:143],v33,s[32:35],s84 offen sc1
 s_bfe_u32 s84,s44,0x50014
 s_lshl_b32 s84,s84,12
 buffer_load_dwordx4 v[144:147],v33,s[32:35],s84 offen sc1
 s_bfe_u32 s84,s44,0x50019
 s_lshl_b32 s84,s84,12
 buffer_load_dwordx4 v[148:151],v33,s[32:35],s84 offen sc1
 s_bfe_u32 s84,s45,0x50000
 s_lshl_b32 s84,s84,12
 buffer_load_dwordx4 v[152:155],v33,s[32:35],s84 offen sc1
 s_bfe_u32 s84,s45,0x50005
 s_lshl_b32 s84,s84,12
 buffer_load_dwordx4 v[156:159],v33,s[32:35],s84 offen sc1
 s_bfe_u32 s84,s45,0x5000a
 s_lshl_b32 s84,s84,12
 buffer_load_dwordx4 v[160:163],v33,s[32:35],s84 offen sc1
 s_bfe_u32 s84,s45,0x5000f
 s_lshl_b32 s84,s84,12
 buffer_load_dwordx4 v[164:167],v33,s[32:35],s84 offen sc1
 s_bfe_u32 s84,s45,0x50014
 s_lshl_b32 s84,s84,12
 buffer_load_dwordx4 v[168:171],v33,s[32:35],s84 offen sc1
 s_bfe_u32 s84,s45,0x50019
 s_lshl_b32 s84,s84,12
 buffer_load_dwordx4 v[172:175],v33,s[32:35],s84 offen sc1
 s_waitcnt vmcnt(8)
 v_or_b32 v38,v136,v140
 v_cmp_gt_i32 vcc,0,v38
 s_cbranch_vccz Lok_319
 s_sub_u32 s55,s55,1
 s_cbranch_scc0 Lfix_317
 s_mov_b32 s55,0
Lok_319:
 s_branch Lret_318
Lfix_320:
 s_bfe_u32 s84,s44,0x50014
 s_lshl_b32 s84,s84,12
 buffer_load_dwordx4 v[144:147],v33,s[32:35],s84 offen sc1
 s_bfe_u32 s84,s44,0x50019
 s_lshl_b32 s84,s84,12
 buffer_load_dwordx4 v[148:151],v33,s[32:35],s84 offen sc1
 s_bfe_u32 s84,s45,0x50000
 s_lshl_b32 s84,s84,12
 buffer_load_dwordx4 v[152:155],v33,s[32:35],s84 offen sc1
 s_bfe_u32 s84,s45,0x50005
 s_lshl_b32 s84,s84,12
 buffer_load_dwordx4 v[156:159],v33,s[32:35],s84 offen sc1
 s_bfe_u32 s84,s45,0x5000a
 s_lshl_b32 s84,s84,12
 buffer_load_dwordx4 v[160:163],v33,s[32:35],s84 offen sc1
 s_bfe_u32 s84,s45,0x5000f
 s_lshl_b32 s84,s84,12
 buffer_load_dwordx4 v[164:167],v33,s[32:35],s84 offen sc1
 s_bfe_u32 s84,s45,0x50014
 s_lshl_b32 s84,s84,12
 buffer_load_dwordx4 v[168:171],v33,s[32:35],s84 offen sc1
 s_bfe_u32 s84,s45,0x50019
 s_lshl_b32 s84,s84,12
 buffer_load_dwordx4 v[172:175],v33,s[32:35],s84 offen sc1
 s_bfe_u32 s84,s46,0x50000
 s_lshl_b32 s84,s84,12
 buffer_load_dwordx4 v[176:179],v33,s[32:35],s84 offen sc1
 s_bfe_u32 s84,s46,0x50005
 s_lshl_b32 s84,s84,12
 buffer_load_dwordx4 v[180:183],v33,s[32:35],s84 offen sc1
 s_waitcnt vmcnt(8)
 v_or_b32 v38,v144,v148
 v_cmp_gt_i32 vcc,0,v38
 s_cbranch_vccz Lok_322
 s_sub_u32 s55,s55,1
 s_cbranch_scc0 Lfix_320
 s_mov_b32 s55,0
Lok_322:
 s_branch Lret_321
Lfix_323:
 s_bfe_u32 s84,s45,0x50000
 s_lshl_b32 s84,s84,12
 buffer_load_dwordx4 v[152:155],v33,s[32:35],s84 offen sc1
 s_bfe_u32 s84,s45,0x50005
 s_lshl_b32 s84,s84,12
 buffer_load_dwordx4 v[156:159],v33,s[32:35],s84 offen sc1
 s_bfe_u32 s84,s45,0x5000a
 s_lshl_b32 s84,s84,12
 buffer_load_dwordx4 v[160:163],v33,s[32:35],s84 offen sc1
 s_bfe_u32 s84,s45,0x5000f
 s_lshl_b32 s84,s84,12
 buffer_load_dwordx4 v[164:167],v33,s[32:35],s84 offen sc1
 s_bfe_u32 s84,s45,0x50014
 s_lshl_b32 s84,s84,12
 buffer_load_dwordx4 v[168:171],v33,s[32:35],s84 offen sc1
 s_bfe_u32 s84,s45,0x50019
 s_lshl_b32 s84,s84,12
 buffer_load_dwordx4 v[172:175],v33,s[32:35],s84 offen sc1
 s_bfe_u32 s84,s46,0x50000
 s_lshl_b32 s84,s84,12
 buffer_load_dwordx4 v[176:179],v33,s[32:35],s84 offen sc1
 s_bfe_u32 s84,s46,0x50005
 s_lshl_b32 s84,s84,12
 buffer_load_dwordx4 v[180:183],v33,s[32:35],s84 offen sc1
 s_bfe_u32 s84,s46,0x5000a
 s_lshl_b32 s84,s84,12
 buffer_load_dwordx4 v[184:187],v33,s[32:35],s84 offen sc1
 s_bfe_u32 s84,s46,0x5000f
 s_lshl_b32 s84,s84,12
 buffer_load_dwordx4 v[188:191],v33,s[32:35],s84 offen sc1
 s_waitcnt vmcnt(8)
 v_or_b32 v38,v152,v156
 v_cmp_gt_i32 vcc,0,v38
 s_cbranch_vccz Lok_325
 s_sub_u32 s55,s55,1
 s_cbranch_scc0 Lfix_323
 s_mov_b32 s55,0
Lok_325:
 s_branch Lret_324
Lfix_326:
 s_bfe_u32 s84,s45,0x5000a
 s_lshl_b32 s84,s84,12
 buffer_load_dwordx4 v[160:163],v33,s[32:35],s84 offen sc1
 s_bfe_u32 s84,s45,0x5000f
 s_lshl_b32 s84,s84,12
 buffer_load_dwordx4 v[164:167],v33,s[32:35],s84 offen sc1
 s_bfe_u32 s84,s45,0x50014
 s_lshl_b32 s84,s84,12
 buffer_load_dwordx4 v[168:171],v33,s[32:35],s84 offen sc1
 s_bfe_u32 s84,s45,0x50019
 s_lshl_b32 s84,s84,12
 buffer_load_dwordx4 v[172:175],v33,s[32:35],s84 offen sc1
 s_bfe_u32 s84,s46,0x50000
 s_lshl_b32 s84,s84,12
 buffer_load_dwordx4 v[176:179],v33,s[32:35],s84 offen sc1
 s_bfe_u32 s84,s46,0x50005
 s_lshl_b32 s84,s84,12
 buffer_load_dwordx4 v[180:183],v33,s[32:35],s84 offen sc1
 s_bfe_u32 s84,s46,0x5000a
 s_lshl_b32 s84,s84,12
 buffer_load_dwordx4 v[184:187],v33,s[32:35],s84 offen sc1
 s_bfe_u32 s84,s46,0x5000f
 s_lshl_b32 s84,s84,12
 buffer_load_dwordx4 v[188:191],v33,s[32:35],s84 offen sc1
 s_bfe_u32 s84,s46,0x50014
 s_lshl_b32 s84,s84,12
 buffer_load_dwordx4 v[192:195],v33,s[32:35],s84 offen sc1
 s_bfe_u32 s84,s46,0x50019
 s_lshl_b32 s84,s84,12
 buffer_load_dwordx4 v[196:199],v33,s[32:35],s84 offen sc1
 s_waitcnt vmcnt(8)
 v_or_b32 v38,v160,v164
 v_cmp_gt_i32 vcc,0,v38
 s_cbranch_vccz Lok_328
 s_sub_u32 s55,s55,1
 s_cbranch_scc0 Lfix_326
 s_mov_b32 s55,0
Lok_328:
 s_branch Lret_327
Lfix_329:
 s_bfe_u32 s84,s45,0x50014
 s_lshl_b32 s84,s84,12
 buffer_load_dwordx4 v[168:171],v33,s[32:35],s84 offen sc1
 s_bfe_u32 s84,s45,0x50019
 s_lshl_b32 s84,s84,12
 buffer_load_dwordx4 v[172:175],v33,s[32:35],s84 offen sc1
 s_bfe_u32 s84,s46,0x50000
 s_lshl_b32 s84,s84,12
 buffer_load_dwordx4 v[176:179],v33,s[32:35],s84 offen sc1
 s_bfe_u32 s84,s46,0x50005
 s_lshl_b32 s84,s84,12
 buffer_load_dwordx4 v[180:183],v33,s[32:35],s84 offen sc1
 s_bfe_u32 s84,s46,0x5000a
 s_lshl_b32 s84,s84,12
 buffer_load_dwordx4 v[184:187],v33,s[32:35],s84 offen sc1
 s_bfe_u32 s84,s46,0x5000f
 s_lshl_b32 s84,s84,12
 buffer_load_dwordx4 v[188:191],v33,s[32:35],s84 offen sc1
 s_bfe_u32 s84,s46,0x50014
 s_lshl_b32 s84,s84,12
 buffer_load_dwordx4 v[192:195],v33,s[32:35],s84 offen sc1
 s_bfe_u32 s84,s46,0x50019
 s_lshl_b32 s84,s84,12
 buffer_load_dwordx4 v[196:199],v33,s[32:35],s84 offen sc1
 s_bfe_u32 s84,s47,0x50000
 s_lshl_b32 s84,s84,12
 buffer_load_dwordx4 v[200:203],v33,s[32:35],s84 offen sc1
 s_bfe_u32 s84,s47,0x50005
 s_lshl_b32 s84,s84,12
 buffer_load_dwordx4 v[204:207],v33,s[32:35],s84 offen sc1
 s_waitcnt vmcnt(8)
 v_or_b32 v38,v168,v172
 v_cmp_gt_i32 vcc,0,v38
 s_cbranch_vccz Lok_331
 s_sub_u32 s55,s55,1
 s_cbranch_scc0 Lfix_329
 s_mov_b32 s55,0
Lok_331:
 s_branch Lret_330
Lfix_332:
 s_bfe_u32 s84,s46,0x50000
 s_lshl_b32 s84,s84,12
 buffer_load_dwordx4 v[176:179],v33,s[32:35],s84 offen sc1
 s_bfe_u32 s84,s46,0x50005
 s_lshl_b32 s84,s84,12
 buffer_load_dwordx4 v[180:183],v33,s[32:35],s84 offen sc1
 s_bfe_u32 s84,s46,0x5000a
 s_lshl_b32 s84,s84,12
 buffer_load_dwordx4 v[184:187],v33,s[32:35],s84 offen sc1
 s_bfe_u32 s84,s46,0x5000f
 s_lshl_b32 s84,s84,12
 buffer_load_dwordx4 v[188:191],v33,s[32:35],s84 offen sc1
 s_bfe_u32 s84,s46,0x50014
 s_lshl_b32 s84,s84,12
 buffer_load_dwordx4 v[192:195],v33,s[32:35],s84 offen sc1
 s_bfe_u32 s84,s46,0x50019
 s_lshl_b32 s84,s84,12
 buffer_load_dwordx4 v[196:199],v33,s[32:35],s84 offen sc1
 s_bfe_u32 s84,s47,0x50000
 s_lshl_b32 s84,s84,12
 buffer_load_dwordx4 v[200:203],v33,s[32:35],s84 offen sc1
 s_bfe_u32 s84,s47,0x50005
 s_lshl_b32 s84,s84,12
 buffer_load_dwordx4 v[204:207],v33,s[32:35],s84 offen sc1
 s_bfe_u32 s84,s47,0x5000a
 s_lshl_b32 s84,s84,12
 buffer_load_dwordx4 v[208:211],v33,s[32:35],s84 offen sc1
 buffer_load_dwordx4 v[212:215],v33,s[32:35],s70 offen sc1
 s_waitcnt vmcnt(8)
 v_or_b32 v38,v176,v180
 v_cmp_gt_i32 vcc,0,v38
 s_cbranch_vccz Lok_334
 s_sub_u32 s55,s55,1
 s_cbranch_scc0 Lfix_332
 s_mov_b32 s55,0
Lok_334:
 s_branch Lret_333
Lfix_335:
 s_bfe_u32 s84,s46,0x5000a
 s_lshl_b32 s84,s84,12
 buffer_load_dwordx4 v[184:187],v33,s[32:35],s84 offen sc1
 s_bfe_u32 s84,s46,0x5000f
 s_lshl_b32 s84,s84,12
 buffer_load_dwordx4 v[188:191],v33,s[32:35],s84 offen sc1
 s_bfe_u32 s84,s46,0x50014
 s_lshl_b32 s84,s84,12
 buffer_load_dwordx4 v[192:195],v33,s[32:35],s84 offen sc1
 s_bfe_u32 s84,s46,0x50019
 s_lshl_b32 s84,s84,12
 buffer_load_dwordx4 v[196:199],v33,s[32:35],s84 offen sc1
 s_bfe_u32 s84,s47,0x50000
 s_lshl_b32 s84,s84,12
 buffer_load_dwordx4 v[200:203],v33,s[32:35],s84 offen sc1
 s_bfe_u32 s84,s47,0x50005
 s_lshl_b32 s84,s84,12
 buffer_load_dwordx4 v[204:207],v33,s[32:35],s84 offen sc1
 s_bfe_u32 s84,s47,0x5000a
 s_lshl_b32 s84,s84,12
 buffer_load_dwordx4 v[208:211],v33,s[32:35],s84 offen sc1
 buffer_load_dwordx4 v[212:215],v33,s[32:35],s70 offen sc1
 s_waitcnt vmcnt(6)
 v_or_b32 v38,v184,v188
 v_cmp_gt_i32 vcc,0,v38
 s_cbranch_vccz Lok_337
 s_sub_u32 s55,s55,1
 s_cbranch_scc0 Lfix_335
 s_mov_b32 s55,0
Lok_337:
 s_branch Lret_336
Lfix_339:
 s_bfe_u32 s84,s46,0x50014
 s_lshl_b32 s84,s84,12
 buffer_load_dwordx4 v[192:195],v33,s[32:35],s84 offen sc1
 s_bfe_u32 s84,s46,0x50019
 s_lshl_b32 s84,s84,12
 buffer_load_dwordx4 v[196:199],v33,s[32:35],s84 offen sc1
 s_bfe_u32 s84,s47,0x50000
 s_lshl_b32 s84,s84,12
 buffer_load_dwordx4 v[200:203],v33,s[32:35],s84 offen sc1
 s_bfe_u32 s84,s47,0x50005
 s_lshl_b32 s84,s84,12
 buffer_load_dwordx4 v[204:207],v33,s[32:35],s84 offen sc1
 s_bfe_u32 s84,s47,0x5000a
 s_lshl_b32 s84,s84,12
 buffer_load_dwordx4 v[208:211],v33,s[32:35],s84 offen sc1
 buffer_load_dwordx4 v[212:215],v33,s[32:35],s70 offen sc1
 s_waitcnt vmcnt(4)
 v_or_b32 v38,v192,v196
 v_cmp_gt_i32 vcc,0,v38
 s_cbranch_vccz Lok_341
 s_sub_u32 s55,s55,1
 s_cbranch_scc0 Lfix_339
 s_mov_b32 s55,0
Lok_341:
 s_branch Lret_340
Lfix_342:
 s_bfe_u32 s84,s47,0x50000
 s_lshl_b32 s84,s84,12
 buffer_load_dwordx4 v[200:203],v33,s[32:35],s84 offen sc1
 s_bfe_u32 s84,s47,0x50005
 s_lshl_b32 s84,s84,12
 buffer_load_dwordx4 v[204:207],v33,s[32:35],s84 offen sc1
 s_bfe_u32 s84,s47,0x5000a
 s_lshl_b32 s84,s84,12
 buffer_load_dwordx4 v[208:211],v33,s[32:35],s84 offen sc1
 buffer_load_dwordx4 v[212:215],v33,s[32:35],s70 offen sc1
 s_waitcnt vmcnt(2)
 v_or_b32 v38,v200,v204
 v_cmp_gt_i32 vcc,0,v38
 s_cbranch_vccz Lok_344
 s_sub_u32 s55,s55,1
 s_cbranch_scc0 Lfix_342
 s_mov_b32 s55,0
Lok_344:
 s_branch Lret_343
Lfix_345:
 s_bfe_u32 s84,s47,0x5000a
 s_lshl_b32 s84,s84,12
 buffer_load_dwordx4 v[208:211],v33,s[32:35],s84 offen sc1
 buffer_load_dwordx4 v[212:215],v33,s[32:35],s70 offen sc1
 s_waitcnt vmcnt(0)
 v_or_b32 v38,v208,v212
 v_cmp_gt_i32 vcc,0,v38
 s_cbranch_vccz Lok_347
 s_sub_u32 s55,s55,1
 s_cbranch_scc0 Lfix_345
 s_mov_b32 s55,0
Lok_347:
 s_branch Lret_346
L_slow:
 s_nop 5
 v_pk_fma_f32 v[88:89],v[88:89],v[56:57],s[88:89]
 v_pk_fma_f32 v[90:91],v[90:91],v[58:59],s[88:89]
 v_pk_fma_f32 v[92:93],v[92:93],v[60:61],s[88:89]
 v_pk_fma_f32 v[94:95],v[94:95],v[62:63],s[88:89]
 v_exp_f32_e64 v72,v88 clamp
 v_exp_f32_e64 v73,v89 clamp
 v_exp_f32_e64 v74,v90 clamp
 v_exp_f32_e64 v75,v91 clamp
 v_exp_f32_e64 v76,v92 clamp
 v_exp_f32_e64 v77,v93 clamp
 v_exp_f32_e64 v78,v94 clamp
 v_exp_f32_e64 v79,v95 clamp
 v_max_f32 v88,s88,v88
 v_max_f32 v89,s88,v89
 v_max_f32 v90,s88,v90
 v_max_f32 v91,s88,v91
 v_max_f32 v92,s88,v92
 v_max_f32 v93,s88,v93
 v_max_f32 v94,s88,v94
 v_max_f32 v95,s88,v95
 v_pk_fma_f32 v[88:89],v[88:89],s[90:91],v[72:73]
 v_pk_fma_f32 v[90:91],v[90:91],s[90:91],v[74:75]
 v_pk_fma_f32 v[92:93],v[92:93],s[90:91],v[76:77]
 v_pk_fma_f32 v[94:95],v[94:95],s[90:91],v[78:79]
 v_cvt_pk_bf16_f32 v88,v88,v89
 v_cvt_pk_bf16_f32 v89,v90,v91
 v_cvt_pk_bf16_f32 v90,v92,v93
 v_cvt_pk_bf16_f32 v91,v94,v95
 v_pk_fma_f32 v[96:97],v[96:97],v[64:65],s[88:89]
 v_pk_fma_f32 v[98:99],v[98:99],v[66:67],s[88:89]
 v_pk_fma_f32 v[100:101],v[100:101],v[68:69],s[88:89]
 v_pk_fma_f32 v[102:103],v[102:103],v[70:71],s[88:89]
 v_exp_f32_e64 v72,v96 clamp
 v_exp_f32_e64 v73,v97 clamp
 v_exp_f32_e64 v74,v98 clamp
 v_exp_f32_e64 v75,v99 clamp
 v_exp_f32_e64 v76,v100 clamp
 v_exp_f32_e64 v77,v101 clamp
 v_exp_f32_e64 v78,v102 clamp
 v_exp_f32_e64 v79,v103 clamp
 v_max_f32 v96,s88,v96
 v_max_f32 v97,s88,v97
 v_max_f32 v98,s88,v98
 v_max_f32 v99,s88,v99
 v_max_f32 v100,s88,v100
 v_max_f32 v101,s88,v101
 v_max_f32 v102,s88,v102
 v_max_f32 v103,s88,v103
 v_pk_fma_f32 v[96:97],v[96:97],s[90:91],v[72:73]
 v_pk_fma_f32 v[98:99],v[98:99],s[90:91],v[74:75]
 v_pk_fma_f32 v[100:101],v[100:101],s[90:91],v[76:77]
 v_pk_fma_f32 v[102:103],v[102:103],s[90:91],v[78:79]
 v_cvt_pk_bf16_f32 v92,v96,v97
 v_cvt_pk_bf16_f32 v93,v98,v99
 v_cvt_pk_bf16_f32 v94,v100,v101
 v_cvt_pk_bf16_f32 v95,v102,v103
 v_mov_b32 v48,v32
 v_mov_b32 v49,v32
 v_mov_b32 v50,v32
 v_mov_b32 v51,v32
 v_pk_mul_f32 v[104:105],v[104:105],v[56:57]
 s_waitcnt vmcnt(0)
 v_pk_mul_f32 v[106:107],v[106:107],v[58:59]
 ds_read_b64_tr_b16 v[40:41],v36 offset:0
 v_pk_mul_f32 v[108:109],v[108:109],v[60:61]
 ds_read_b64_tr_b16 v[42:43],v36 offset:256
 v_pk_mul_f32 v[110:111],v[110:111],v[62:63]
 ds_read_b64_tr_b16 v[44:45],v36 offset:4096
 v_cvt_pk_bf16_f32 v104,v104,v105
 ds_read_b64_tr_b16 v[46:47],v36 offset:4352
 v_cvt_pk_bf16_f32 v105,v106,v107
 s_waitcnt lgkmcnt(2)
 v_mfma_f32_32x32x16_bf16 v[120:135],v[48:51],v[40:43],0
 v_cvt_pk_bf16_f32 v106,v108,v109
 ds_read_b64_tr_b16 v[40:41],v36 offset:8192
 v_cvt_pk_bf16_f32 v107,v110,v111
 ds_read_b64_tr_b16 v[42:43],v36 offset:8448
 v_mov_b32 v96,v32
 s_waitcnt lgkmcnt(2)
 v_mfma_f32_32x32x16_bf16 v[120:135],v[48:51],v[44:47],v[120:135]
 v_mov_b32 v97,v32
 ds_read_b64_tr_b16 v[44:45],v36 offset:12288
 v_mov_b32 v98,v32
 ds_read_b64_tr_b16 v[46:47],v36 offset:12544
 v_mov_b32 v99,v32
 s_waitcnt lgkmcnt(2)
 v_mfma_f32_32x32x16_bf16 v[120:135],v[48:51],v[40:43],v[120:135]
 v_mov_b32 v100,v32
 ds_read_b64_tr_b16 v[40:41],v36 offset:16384
 v_mov_b32 v101,v32
 ds_read_b64_tr_b16 v[42:43],v36 offset:16640
 v_mov_b32 v102,v32
 s_waitcnt lgkmcnt(2)
 v_mfma_f32_32x32x16_bf16 v[120:135],v[48:51],v[44:47],v[120:135]
 v_mov_b32 v103,v32
 ds_read_b64_tr_b16 v[44:45],v36 offset:20480
 v_permlane16_swap_b32 v104,v96
 ds_read_b64_tr_b16 v[46:47],v36 offset:20736
 v_permlane16_swap_b32 v105,v97
 s_waitcnt lgkmcnt(2)
 v_mfma_f32_32x32x16_bf16 v[120:135],v[48:51],v[40:43],v[120:135]
 v_permlane16_swap_b32 v106,v98
 ds_read_b64_tr_b16 v[40:41],v36 offset:24576
 v_permlane16_swap_b32 v107,v99
 ds_read_b64_tr_b16 v[42:43],v36 offset:24832
 v_pk_mul_f32 v[112:113],v[112:113],v[64:65]
 s_waitcnt lgkmcnt(2)
 v_mfma_f32_32x32x16_bf16 v[120:135],v[48:51],v[44:47],v[120:135]
 v_pk_mul_f32 v[114:115],v[114:115],v[66:67]
 ds_read_b64_tr_b16 v[44:45],v36 offset:28672
 v_pk_mul_f32 v[116:117],v[116:117],v[68:69]
 ds_read_b64_tr_b16 v[46:47],v36 offset:28928
 v_pk_mul_f32 v[118:119],v[118:119],v[70:71]
 s_waitcnt lgkmcnt(2)
 v_mfma_f32_32x32x16_bf16 v[120:135],v[48:51],v[40:43],v[120:135]
 v_cvt_pk_bf16_f32 v108,v112,v113
 s_waitcnt lgkmcnt(0)
 v_mfma_f32_32x32x16_bf16 v[120:135],v[48:51],v[44:47],v[120:135]
 v_cvt_pk_bf16_f32 v109,v114,v115
 v_cvt_pk_bf16_f32 v110,v116,v117
 v_cvt_pk_bf16_f32 v111,v118,v119
 v_mfma_f32_32x32x16_bf16 v[72:87],v[88:91],v[96:99],0
 v_permlane16_swap_b32 v108,v100
 v_permlane16_swap_b32 v109,v101
 v_permlane16_swap_b32 v110,v102
 v_permlane16_swap_b32 v111,v103
 v_mfma_f32_32x32x16_bf16 v[56:71],v[88:91],v[104:107],0
 s_nop 0
 v_mfma_f32_32x32x16_bf16 v[72:87],v[92:95],v[100:103],v[72:87]
 v_mfma_f32_32x32x16_bf16 v[56:71],v[92:95],v[108:111],v[56:71]
 s_lshl_b32 s53,s4,12
 s_add_u32 s53,s53,147456
 v_add_u32 v112,s53,v1
 v_bfe_u32 v118,v0,1,4
 v_lshl_add_u32 v118,v17,5,v118
 v_lshlrev_b32 v118,4,v118
 s_lshl_b32 s53,s4,11
 v_add_u32 v118,s53,v118
 v_bfe_u32 v119,v0,1,2
 v_lshlrev_b32 v119,9,v119
 v_bfe_u32 v117,v0,2,1
 v_lshl_add_u32 v119,v117,10,v119
 v_add_u32 v119,256,v119
 s_cmp_eq_u32 s4,2
 s_cselect_b64 vcc,-1,0
 v_cndmask_b32 v113,v118,v119,vcc
 v_and_b32 v118,1,v0
 v_lshl_add_u32 v113,v118,10,v113
 v_add_u32 v113,0x24000,v113
 v_add_u32 v115,s54,v1
 s_and_b32 s53,s7,0xff
 v_mov_b32 v116,s53
 v_lshrrev_b32 v118,3,v0
 v_mul_u32_u24 v118,2560,v118
 v_and_b32 v119,7,v0
 v_lshl_add_u32 v114,v119,4,v118
 v_and_b32 v117,7,v0
 v_lshlrev_b32 v117,3,v117
 v_lshl_add_u32 v117,v17,2,v117
 s_cmp_eq_u32 s4,2
 s_cselect_b32 s53,128,0
 v_and_b32 v118,4,v0
 v_mad_u32_u24 v117,v118,s53,v117
 ds_write_b128 v112,v[80:83] offset:2048
 ds_write_b128 v112,v[84:87] offset:3072
 ds_write_b128 v112,v[56:59] offset:0
 ds_write_b128 v112,v[60:63] offset:1024
 v_and_b32 v104,31,v0
 v_lshlrev_b32 v104,4,v104
 v_add_u32 v104,0x21000,v104
 s_lshl_b32 s53,s4,2
 v_add_u32 v105,s53,v104
 ds_write_b32 v105,v120 offset:0
 s_waitcnt lgkmcnt(0)
 s_barrier
 s_cmp_eq_u32 s4,3
 s_cbranch_scc1 Lw_349
 ds_read_b128 v[56:59],v113 offset:0
 ds_read_b128 v[60:63],v113 offset:4096
 ds_read_b128 v[64:67],v113 offset:8192
 ds_read_b128 v[68:71],v113 offset:12288
 s_waitcnt lgkmcnt(2)
 v_pk_add_f32 v[56:57],v[56:57],v[60:61]
 v_pk_add_f32 v[58:59],v[58:59],v[62:63]
 s_waitcnt lgkmcnt(0)
 v_pk_add_f32 v[64:65],v[64:65],v[68:69]
 v_pk_add_f32 v[66:67],v[66:67],v[70:71]
 v_pk_add_f32 v[56:57],v[56:57],v[64:65]
 v_pk_add_f32 v[58:59],v[58:59],v[66:67]
 v_cmp_gt_u32 vcc,2176,v115
 v_and_or_b32 v56,v56,s85,v116
 v_and_or_b32 v57,v57,s85,v116
 v_and_or_b32 v58,v58,s85,v116
 v_and_or_b32 v59,v59,s85,v116
 s_mul_i32 s53,s5,2560
 s_add_u32 s53,s53,s78
 s_mov_b64 exec,vcc
 s_add_u32 s52,s53,0
 buffer_store_dwordx4 v[56:59],v115,s[32:35],s52 offen sc1
 s_mov_b64 exec,-1
Lw_349:
 s_xor_b32 s48,s49,1
 s_cmp_lg_u32 s48,0
 s_cbranch_scc1 Lp_350
 v_mov_b32 v60,v56
 v_mov_b32 v64,v56
 v_mov_b32 v61,v57
 v_mov_b32 v65,v57
 v_mov_b32 v62,v58
 v_mov_b32 v66,v58
 v_mov_b32 v63,v59
 v_mov_b32 v67,v59
 s_mov_b64 exec,s[100:101]
 s_add_u32 s52,s50,0
 buffer_load_dwordx4 v[60:63],v114,s[32:35],s52 offen sc1
 s_mov_b64 exec,s[0:1]
 s_add_u32 s52,s50,20480
 buffer_load_dwordx4 v[64:67],v114,s[32:35],s52 offen sc1
 s_mov_b64 exec,-1
Lp_350:
 ds_read_b64_tr_b16 v[40:41],v5 offset:0
 ds_read_b64_tr_b16 v[42:43],v5 offset:256
 ds_read_b64_tr_b16 v[44:45],v5 offset:1024
 ds_read_b64_tr_b16 v[46:47],v5 offset:1280
 ds_read_b64_tr_b16 v[48:49],v5 offset:2048
 ds_read_b64_tr_b16 v[50:51],v5 offset:2304
 ds_read_b64_tr_b16 v[52:53],v5 offset:3072
 ds_read_b64_tr_b16 v[54:55],v5 offset:3328
 s_waitcnt lgkmcnt(6)
 v_mfma_f32_32x32x16_bf16 v[120:135],v[40:43],v[136:139],0
 ds_read_b128 v[106:109],v104 offset:0
 s_waitcnt lgkmcnt(0)
 v_add_f32 v106,v106,v107
 ds_read_b64_tr_b16 v[40:41],v5 offset:4096
 ds_read_b64_tr_b16 v[42:43],v5 offset:4352
 v_mfma_f32_32x32x16_bf16 v[120:135],v[44:47],v[140:143],v[120:135]
 v_add_f32 v108,v108,v109
 v_add_f32 v106,v106,v108
 ds_read_b64_tr_b16 v[44:45],v5 offset:5120
 ds_read_b64_tr_b16 v[46:47],v5 offset:5376
 v_mfma_f32_32x32x16_bf16 v[120:135],v[48:51],v[144:147],v[120:135]
 v_cvt_pk_bf16_f32 v107,v106,v106
 v_lshlrev_b32 v107,16,v107
 ds_read_b64_tr_b16 v[48:49],v5 offset:6144
 ds_read_b64_tr_b16 v[50:51],v5 offset:6400
 v_mfma_f32_32x32x16_bf16 v[120:135],v[52:55],v[148:151],v[120:135]
 v_sub_f32 v107,v106,v107
 v_cvt_pk_bf16_f32 v19,v106,v107
 ds_read_b64_tr_b16 v[52:53],v5 offset:7168
 ds_read_b64_tr_b16 v[54:55],v5 offset:7424
 s_waitcnt lgkmcnt(6)
 v_mfma_f32_32x32x16_bf16 v[120:135],v[40:43],v[152:155],v[120:135]
 v_lshrrev_b32 v110,2,v0
 s_lshl_b32 s53,s4,4
 v_add_u32 v110,s53,v110
 v_lshlrev_b32 v110,10,v110
 v_and_b32 v111,3,v0
 v_lshl_add_u32 v110,v111,4,v110
 buffer_load_dwordx4 a[240:243],v110,s[8:11],s80 offen
 buffer_load_dwordx4 a[244:247],v110,s[8:11],s80 offen offset:64
 s_sub_u32 s60,s63,s62
 s_add_u32 s63,s62,64
 s_cmp_lt_u32 s6,11
 s_cselect_b32 s63,s63,0x10000000
 s_lshl_b32 s53,s4,13
 s_add_u32 s53,s53,131072
 v_add_u32 v18,s53,v1
 s_lshr_b32 s52,s4,1
 s_lshl_b32 s53,s52,12
 s_and_b32 s96,s4,1
 s_lshl_b32 s96,s96,8
 s_add_u32 s53,s53,s96
 s_add_u32 s53,s53,131072
 v_lshl_add_u32 v15,v17,10,v3
 v_add_u32 v15,s53,v15
 s_add_u32 s36,s95,0
 s_and_b32 s36,s36,7
 s_and_b32 s96,s36,1
 s_lshl_b32 s36,s36,1
 s_add_u32 s36,s36,s96
 s_lshl_b32 s36,s36,11
 s_xor_b32 s8,s36,2048
 s_add_u32 s37,s95,1
 s_and_b32 s37,s37,7
 s_and_b32 s96,s37,1
 s_lshl_b32 s37,s37,1
 s_add_u32 s37,s37,s96
 s_lshl_b32 s37,s37,11
 s_xor_b32 s9,s37,2048
 s_add_u32 s38,s95,2
 s_and_b32 s38,s38,7
 s_and_b32 s96,s38,1
 s_lshl_b32 s38,s38,1
 s_add_u32 s38,s38,s96
 s_lshl_b32 s38,s38,11
 s_xor_b32 s10,s38,2048
 s_add_u32 s39,s95,3
 s_and_b32 s39,s39,7
 s_and_b32 s96,s39,1
 s_lshl_b32 s39,s39,1
 s_add_u32 s39,s39,s96
 s_lshl_b32 s39,s39,11
 s_xor_b32 s11,s39,2048
 s_add_u32 s40,s95,4
 s_and_b32 s40,s40,7
 s_and_b32 s96,s40,1
 s_lshl_b32 s40,s40,1
 s_add_u32 s40,s40,s96
 s_lshl_b32 s40,s40,11
 s_xor_b32 s57,s40,2048
 s_add_u32 s41,s95,5
 s_and_b32 s41,s41,7
 s_and_b32 s96,s41,1
 s_lshl_b32 s41,s41,1
 s_add_u32 s41,s41,s96
 s_lshl_b32 s41,s41,11
 s_xor_b32 s77,s41,2048
 s_add_u32 s42,s95,6
 s_and_b32 s42,s42,7
 s_and_b32 s96,s42,1
 s_lshl_b32 s42,s42,1
 s_add_u32 s42,s42,s96
 s_lshl_b32 s42,s42,11
 s_xor_b32 s81,s42,2048
 s_add_u32 s43,s95,7
 s_and_b32 s43,s43,7
 s_and_b32 s96,s43,1
 s_lshl_b32 s43,s43,1
 s_add_u32 s43,s43,s96
 s_lshl_b32 s43,s43,11
 s_xor_b32 s99,s43,2048
 s_mov_b32 s44,0x1ec49860
 s_cmp_eq_u32 s52,0
 s_cselect_b32 s44,s44,0x20d51c81
 s_mov_b32 s45,0x20d51c81
 s_cmp_eq_u32 s52,0
 s_cselect_b32 s45,s45,0xa2a4e51
 s_mov_b32 s46,0xa2a4e51
 s_cmp_eq_u32 s52,0
 s_cselect_b32 s46,s46,0xc303968
 s_mov_b32 s47,0xab968
 s_cmp_eq_u32 s52,0
 s_cselect_b32 s47,s47,0xabd89
 ds_read_b64_tr_b16 v[40:41],v5 offset:8192
 ds_read_b64_tr_b16 v[42:43],v5 offset:8448
 s_waitcnt lgkmcnt(6)
 v_mfma_f32_32x32x16_bf16 v[120:135],v[44:47],v[156:159],v[120:135]
 s_add_u32 s96,s59,0
 s_and_b32 s96,s96,7
 s_lshl_b32 s96,s96,16
 s_add_u32 s96,s96,s66
 s_add_u32 m0,s54,98304
 s_add_u32 s52,s96,0
 buffer_load_dwordx4 v9,s[16:19],s52 offen lds
 s_add_u32 m0,s54,102400
 s_add_u32 s52,s96,8192
 buffer_load_dwordx4 v9,s[16:19],s52 offen lds
 ds_read_b64_tr_b16 v[44:45],v5 offset:9216
 ds_read_b64_tr_b16 v[46:47],v5 offset:9472
 s_waitcnt lgkmcnt(6)
 v_mfma_f32_32x32x16_bf16 v[120:135],v[48:51],v[160:163],v[120:135]
 ds_read_b64_tr_b16 v[48:49],v5 offset:10240
 ds_read_b64_tr_b16 v[50:51],v5 offset:10496
 s_waitcnt lgkmcnt(6)
 v_mfma_f32_32x32x16_bf16 v[120:135],v[52:55],v[164:167],v[120:135]
 s_add_u32 s96,s59,1
 s_and_b32 s96,s96,7
 s_lshl_b32 s96,s96,16
 s_add_u32 s96,s96,s66
 s_add_u32 m0,s54,106496
 s_add_u32 s52,s96,0
 buffer_load_dwordx4 v9,s[16:19],s52 offen lds
 s_add_u32 m0,s54,110592
 s_add_u32 s52,s96,8192
 buffer_load_dwordx4 v9,s[16:19],s52 offen lds
 ds_read_b64_tr_b16 v[52:53],v5 offset:11264
 ds_read_b64_tr_b16 v[54:55],v5 offset:11520
 s_waitcnt lgkmcnt(6)
 v_mfma_f32_32x32x16_bf16 v[120:135],v[40:43],v[168:171],v[120:135]
 ds_read_b64_tr_b16 v[40:41],v5 offset:12288
 ds_read_b64_tr_b16 v[42:43],v5 offset:12544
 s_waitcnt lgkmcnt(6)
 v_mfma_f32_32x32x16_bf16 v[120:135],v[44:47],v[172:175],v[120:135]
 s_add_u32 s96,s59,2
 s_and_b32 s96,s96,7
 s_lshl_b32 s96,s96,16
 s_add_u32 s96,s96,s66
 s_add_u32 m0,s54,114688
 s_add_u32 s52,s96,0
 buffer_load_dwordx4 v9,s[16:19],s52 offen lds
 s_add_u32 m0,s54,118784
 s_add_u32 s52,s96,8192
 buffer_load_dwordx4 v9,s[16:19],s52 offen lds
 ds_read_b64_tr_b16 v[44:45],v5 offset:13312
 ds_read_b64_tr_b16 v[46:47],v5 offset:13568
 s_waitcnt lgkmcnt(6)
 v_mfma_f32_32x32x16_bf16 v[120:135],v[48:51],v[176:179],v[120:135]
 ds_read_b64_tr_b16 v[48:49],v5 offset:14336
 ds_read_b64_tr_b16 v[50:51],v5 offset:14592
 s_waitcnt lgkmcnt(6)
 v_mfma_f32_32x32x16_bf16 v[120:135],v[52:55],v[180:183],v[120:135]
 s_add_u32 s96,s59,3
 s_and_b32 s96,s96,7
 s_lshl_b32 s96,s96,16
 s_add_u32 s96,s96,s66
 s_add_u32 m0,s54,122880
 s_add_u32 s52,s96,0
 buffer_load_dwordx4 v9,s[16:19],s52 offen lds
 s_add_u32 m0,s54,126976
 s_add_u32 s52,s96,8192
 buffer_load_dwordx4 v9,s[16:19],s52 offen lds
 ds_read_b64_tr_b16 v[52:53],v5 offset:15360
 ds_read_b64_tr_b16 v[54:55],v5 offset:15616
 s_waitcnt lgkmcnt(6)
 v_mfma_f32_32x32x16_bf16 v[120:135],v[40:43],v[184:187],v[120:135]
 ds_read_b64_tr_b16 v[40:41],v5 offset:16384
 ds_read_b64_tr_b16 v[42:43],v5 offset:16640
 s_waitcnt lgkmcnt(6)
 v_mfma_f32_32x32x16_bf16 v[120:135],v[44:47],v[188:191],v[120:135]
 s_add_u32 s96,s59,4
 s_and_b32 s96,s96,7
 s_lshl_b32 s96,s96,16
 s_add_u32 s96,s96,s66
 s_add_u32 m0,s54,139264
 s_add_u32 s52,s96,0
 buffer_load_dwordx4 v9,s[16:19],s52 offen lds
 s_add_u32 m0,s54,143360
 s_add_u32 s52,s96,8192
 buffer_load_dwordx4 v9,s[16:19],s52 offen lds
 ds_read_b64_tr_b16 v[44:45],v5 offset:17408
 ds_read_b64_tr_b16 v[46:47],v5 offset:17664
 s_waitcnt lgkmcnt(6)
 v_mfma_f32_32x32x16_bf16 v[120:135],v[48:51],v[192:195],v[120:135]
 ds_read_b64_tr_b16 v[48:49],v5 offset:18432
 ds_read_b64_tr_b16 v[50:51],v5 offset:18688
 s_waitcnt lgkmcnt(6)
 v_mfma_f32_32x32x16_bf16 v[120:135],v[52:55],v[196:199],v[120:135]
 ds_read_b64_tr_b16 v[52:53],v5 offset:19456
 ds_read_b64_tr_b16 v[54:55],v5 offset:19712
 s_waitcnt lgkmcnt(6)
 v_mfma_f32_32x32x16_bf16 v[120:135],v[40:43],v[200:203],v[120:135]
 ds_read_b64_tr_b16 v[40:41],v5 offset:20480
 ds_read_b64_tr_b16 v[42:43],v5 offset:20736
 s_waitcnt lgkmcnt(6)
 v_mfma_f32_32x32x16_bf16 v[120:135],v[44:47],v[204:207],v[120:135]
 ds_read_b64_tr_b16 v[44:45],v5 offset:21504
 ds_read_b64_tr_b16 v[46:47],v5 offset:21760
 s_waitcnt lgkmcnt(6)
 v_mfma_f32_32x32x16_bf16 v[120:135],v[48:51],v[208:211],v[120:135]
 ds_read_b64_tr_b16 v[48:49],v5 offset:22528
 ds_read_b64_tr_b16 v[50:51],v5 offset:22784
 s_waitcnt lgkmcnt(6)
 v_mfma_f32_32x32x16_bf16 v[120:135],v[52:55],v[212:215],v[120:135]
 ds_read_b64_tr_b16 v[52:53],v5 offset:23552
 ds_read_b64_tr_b16 v[54:55],v5 offset:23808
 s_waitcnt lgkmcnt(6)
 v_mfma_f32_32x32x16_bf16 v[120:135],v[40:43],v[216:219],v[120:135]
 ds_read_b64_tr_b16 v[40:41],v5 offset:24576
 ds_read_b64_tr_b16 v[42:43],v5 offset:24832
 s_waitcnt lgkmcnt(6)
 v_mfma_f32_32x32x16_bf16 v[120:135],v[44:47],v[220:223],v[120:135]
 ds_read_b64_tr_b16 v[44:45],v5 offset:25600
 ds_read_b64_tr_b16 v[46:47],v5 offset:25856
 s_waitcnt lgkmcnt(6)
 v_mfma_f32_32x32x16_bf16 v[120:135],v[48:51],v[224:227],v[120:135]
 ds_read_b64_tr_b16 v[48:49],v5 offset:26624
 ds_read_b64_tr_b16 v[50:51],v5 offset:26880
 s_waitcnt lgkmcnt(6)
 v_mfma_f32_32x32x16_bf16 v[120:135],v[52:55],v[228:231],v[120:135]
 ds_read_b64_tr_b16 v[52:53],v5 offset:27648
 ds_read_b64_tr_b16 v[54:55],v5 offset:27904
 s_waitcnt lgkmcnt(6)
 v_mfma_f32_32x32x16_bf16 v[120:135],v[40:43],v[232:235],v[120:135]
 s_cmp_lg_u32 s48,0
 s_cbranch_scc1 Lp_351
 s_waitcnt vmcnt(12)
 v_xor_b32 v118,v60,v116
 v_bitop3_b32 v118,v63,v116,v118 bitop3:0xbe
 v_bitop3_b32 v118,v64,v116,v118 bitop3:0xbe
 v_bitop3_b32 v118,v67,v116,v118 bitop3:0xbe
 v_and_b32 v118,0xff,v118
 v_cmp_ne_u32 vcc,0,v118
 s_cbranch_vccnz La_352
 v_pk_add_f32 v[60:61],v[60:61],v[64:65]
 v_pk_add_f32 v[62:63],v[62:63],v[66:67]
 s_nop 0
 v_add_f32_dpp v60,v60,v60 row_ror:8 row_mask:0xf bank_mask:0xf
 v_add_f32_dpp v61,v61,v61 row_ror:8 row_mask:0xf bank_mask:0xf
 v_add_f32_dpp v62,v62,v62 row_ror:8 row_mask:0xf bank_mask:0xf
 v_add_f32_dpp v63,v63,v63 row_ror:8 row_mask:0xf bank_mask:0xf
 v_permlane16_swap_b32 v60,v61
 s_nop 0
 v_permlane16_swap_b32 v62,v63
 v_add_f32 v60,v60,v61
 v_add_f32 v62,v62,v63
 s_nop 1
 v_permlane32_swap_b32 v60,v62
 v_add_f32 v60,v60,v62
 v_mul_f32 v60,s3,v60
 v_mov_b32 v61,v60
 s_nop 1
 v_permlane16_swap_b32 v60,v61
 v_cvt_pk_bf16_f32 v60,v60,v61
 s_mov_b32 exec_lo,0xff
 s_mov_b32 exec_hi,0xff
 s_add_u32 s52,s51,0
 buffer_store_dword v60,v117,s[32:35],s52 offen sc1
 s_mov_b64 exec,-1
 s_mov_b32 s48,1
 s_branch Lb_353
La_352:
 s_mov_b64 exec,s[100:101]
 s_add_u32 s52,s50,0
 buffer_load_dwordx4 v[60:63],v114,s[32:35],s52 offen sc1
 s_mov_b64 exec,s[0:1]
 s_add_u32 s52,s50,20480
 buffer_load_dwordx4 v[64:67],v114,s[32:35],s52 offen sc1
 s_mov_b64 exec,-1
Lb_353:
Lp_351:
 ds_read_b64_tr_b16 v[40:41],v5 offset:28672
 ds_read_b64_tr_b16 v[42:43],v5 offset:28928
 s_waitcnt lgkmcnt(6)
 v_mfma_f32_32x32x16_bf16 v[120:135],v[44:47],v[236:239],v[120:135]
 ds_read_b64_tr_b16 v[44:45],v5 offset:29696
 ds_read_b64_tr_b16 v[46:47],v5 offset:29952
 s_waitcnt lgkmcnt(6)
 v_mfma_f32_32x32x16_bf16 v[120:135],v[48:51],v[240:243],v[120:135]
 ds_read_b64_tr_b16 v[48:49],v5 offset:30720
 ds_read_b64_tr_b16 v[50:51],v5 offset:30976
 s_waitcnt lgkmcnt(6)
 v_mfma_f32_32x32x16_bf16 v[120:135],v[52:55],v[244:247],v[120:135]
 ds_read_b64_tr_b16 v[52:53],v5 offset:31744
 ds_read_b64_tr_b16 v[54:55],v5 offset:32000
 s_waitcnt lgkmcnt(6)
 v_mfma_f32_32x32x16_bf16 v[120:135],v[40:43],v[248:251],v[120:135]
 s_waitcnt lgkmcnt(4)
 v_mfma_f32_32x32x16_bf16 v[120:135],v[44:47],v[252:255],v[120:135]
 s_waitcnt lgkmcnt(2)
 v_mfma_f32_32x32x16_bf16 v[120:135],v[48:51],a[248:251],v[120:135]
 s_waitcnt lgkmcnt(0)
 v_mfma_f32_32x32x16_bf16 v[120:135],v[52:55],a[252:255],v[120:135]
 v_mov_b32 v28,v19
 v_mov_b32 v29,v19
 s_nop 1
 v_mfma_f32_32x32x16_bf16 v[120:135],v[28:31],v[24:27],v[120:135]
 v_lshlrev_b32 v35,8,v17
 v_sub_u32 v4,v4,v35
 v_sub_u32 v5,v5,v35
 v_sub_u32 v6,v6,v35
 s_barrier
 s_cmp_lg_u32 s48,0
 s_cbranch_scc1 Lp_354
 s_waitcnt vmcnt(0)
 v_xor_b32 v118,v60,v116
 v_bitop3_b32 v118,v63,v116,v118 bitop3:0xbe
 v_bitop3_b32 v118,v64,v116,v118 bitop3:0xbe
 v_bitop3_b32 v118,v67,v116,v118 bitop3:0xbe
 v_and_b32 v118,0xff,v118
 v_cmp_ne_u32 vcc,0,v118
 s_cbranch_vccnz La_355
 v_pk_add_f32 v[60:61],v[60:61],v[64:65]
 v_pk_add_f32 v[62:63],v[62:63],v[66:67]
 s_nop 0
 v_add_f32_dpp v60,v60,v60 row_ror:8 row_mask:0xf bank_mask:0xf
 v_add_f32_dpp v61,v61,v61 row_ror:8 row_mask:0xf bank_mask:0xf
 v_add_f32_dpp v62,v62,v62 row_ror:8 row_mask:0xf bank_mask:0xf
 v_add_f32_dpp v63,v63,v63 row_ror:8 row_mask:0xf bank_mask:0xf
 v_permlane16_swap_b32 v60,v61
 s_nop 0
 v_permlane16_swap_b32 v62,v63
 v_add_f32 v60,v60,v61
 v_add_f32 v62,v62,v63
 s_nop 1
 v_permlane32_swap_b32 v60,v62
 v_add_f32 v60,v60,v62
 v_mul_f32 v60,s3,v60
 v_mov_b32 v61,v60
 s_nop 1
 v_permlane16_swap_b32 v60,v61
 v_cvt_pk_bf16_f32 v60,v60,v61
 s_mov_b32 exec_lo,0xff
 s_mov_b32 exec_hi,0xff
 s_add_u32 s52,s51,0
 buffer_store_dword v60,v117,s[32:35],s52 offen sc1
 s_mov_b64 exec,-1
 s_mov_b32 s48,1
 s_branch Lb_356
La_355:
 s_mov_b64 exec,s[100:101]
 s_add_u32 s52,s50,0
 buffer_load_dwordx4 v[60:63],v114,s[32:35],s52 offen sc1
 s_mov_b64 exec,s[0:1]
 s_add_u32 s52,s50,20480
 buffer_load_dwordx4 v[64:67],v114,s[32:35],s52 offen sc1
 s_mov_b64 exec,-1
Lb_356:
Lp_354:
 s_add_u32 s96,s59,5
 s_and_b32 s96,s96,7
 s_lshl_b32 s96,s96,16
 s_add_u32 s96,s96,s66
 s_add_u32 m0,s54,131072
 s_add_u32 s52,s96,0
 buffer_load_dwordx4 v9,s[16:19],s52 offen lds
 s_add_u32 m0,s54,135168
 s_add_u32 s52,s96,8192
 buffer_load_dwordx4 v9,s[16:19],s52 offen lds
 s_add_u32 s96,s59,6
 s_and_b32 s96,s96,7
 s_lshl_b32 s96,s96,16
 s_add_u32 s96,s96,s66
 s_add_u32 m0,s54,147456
 s_add_u32 s52,s96,0
 buffer_load_dwordx4 v9,s[16:19],s52 offen lds
 s_add_u32 m0,s54,151552
 s_add_u32 s52,s96,8192
 buffer_load_dwordx4 v9,s[16:19],s52 offen lds
 s_add_u32 s96,s59,7
 s_and_b32 s96,s96,7
 s_lshl_b32 s96,s96,16
 s_add_u32 s96,s96,s66
 s_add_u32 m0,s54,155648
 s_add_u32 s52,s96,0
 buffer_load_dwordx4 v9,s[16:19],s52 offen lds
 s_add_u32 m0,s54,159744
 s_add_u32 s52,s96,8192
 buffer_load_dwordx4 v9,s[16:19],s52 offen lds
 v_fma_f32 v120,v120,v16,s88
 v_fma_f32 v121,v121,v16,s88
 v_fma_f32 v122,v122,v16,s88
 v_fma_f32 v123,v123,v16,s88
 v_fma_f32 v124,v124,v16,s88
 v_fma_f32 v125,v125,v16,s88
 v_fma_f32 v126,v126,v16,s88
 v_fma_f32 v127,v127,v16,s88
 v_exp_f32_e64 v72,v120 clamp
 v_exp_f32_e64 v73,v121 clamp
 v_exp_f32_e64 v74,v122 clamp
 v_exp_f32_e64 v75,v123 clamp
 v_exp_f32_e64 v76,v124 clamp
 v_exp_f32_e64 v77,v125 clamp
 v_exp_f32_e64 v78,v126 clamp
 v_exp_f32_e64 v79,v127 clamp
 v_max_f32 v120,s88,v120
 v_max_f32 v121,s88,v121
 v_max_f32 v122,s88,v122
 v_max_f32 v123,s88,v123
 v_max_f32 v124,s88,v124
 v_max_f32 v125,s88,v125
 v_max_f32 v126,s88,v126
 v_max_f32 v127,s88,v127
 v_pk_fma_f32 v[120:121],v[120:121],s[90:91],v[72:73]
 v_pk_fma_f32 v[122:123],v[122:123],s[90:91],v[74:75]
 v_pk_fma_f32 v[124:125],v[124:125],s[90:91],v[76:77]
 v_pk_fma_f32 v[126:127],v[126:127],s[90:91],v[78:79]
 v_cvt_pk_bf16_f32 v120,v120,v121
 v_cvt_pk_bf16_f32 v121,v122,v123
 v_cvt_pk_bf16_f32 v122,v124,v125
 v_cvt_pk_bf16_f32 v123,v126,v127
 v_fma_f32 v128,v128,v16,s88
 v_fma_f32 v129,v129,v16,s88
 v_fma_f32 v130,v130,v16,s88
 v_fma_f32 v131,v131,v16,s88
 v_fma_f32 v132,v132,v16,s88
 v_fma_f32 v133,v133,v16,s88
 v_fma_f32 v134,v134,v16,s88
 v_fma_f32 v135,v135,v16,s88
 v_exp_f32_e64 v72,v128 clamp
 v_exp_f32_e64 v73,v129 clamp
 v_exp_f32_e64 v74,v130 clamp
 v_exp_f32_e64 v75,v131 clamp
 v_exp_f32_e64 v76,v132 clamp
 v_exp_f32_e64 v77,v133 clamp
 v_exp_f32_e64 v78,v134 clamp
 v_exp_f32_e64 v79,v135 clamp
 v_max_f32 v128,s88,v128
 v_max_f32 v129,s88,v129
 v_max_f32 v130,s88,v130
 v_max_f32 v131,s88,v131
 v_max_f32 v132,s88,v132
 v_max_f32 v133,s88,v133
 v_max_f32 v134,s88,v134
 v_max_f32 v135,s88,v135
 v_pk_fma_f32 v[128:129],v[128:129],s[90:91],v[72:73]
 v_pk_fma_f32 v[130:131],v[130:131],s[90:91],v[74:75]
 v_pk_fma_f32 v[132:133],v[132:133],s[90:91],v[76:77]
 v_pk_fma_f32 v[134:135],v[134:135],s[90:91],v[78:79]
 v_cvt_pk_bf16_f32 v124,v128,v129
 v_cvt_pk_bf16_f32 v125,v130,v131
 v_cvt_pk_bf16_f32 v126,v132,v133
 v_cvt_pk_bf16_f32 v127,v134,v135
 s_add_u32 s52,s94,0
 buffer_store_dwordx4 v[120:123],v1,s[32:35],s52 offen sc1
 s_add_u32 s52,s94,0
 buffer_store_dwordx4 v[124:127],v1,s[32:35],s52 offen offset:1024 sc1
 v_mov_b32 v96,0
 v_mov_b32 v97,0
 v_mov_b32 v98,0
 v_mov_b32 v99,0
 s_and_b32 s53,s4,1
 s_mul_i32 s53,s53,1792
 s_add_u32 s53,s53,s67
 s_add_u32 s52,s53,0
 buffer_store_dwordx4 v[96:99],v1,s[32:35],s52 offen sc1
 s_add_u32 s52,s53,0
 buffer_store_dwordx4 v[96:99],v1,s[32:35],s52 offen offset:1024 sc1
 s_add_u32 s52,s64,0
 buffer_store_dwordx4 v[96:99],v1,s[32:35],s52 offen sc1
 s_add_u32 s52,s64,0
 buffer_store_dwordx4 v[96:99],v1,s[32:35],s52 offen offset:1024 sc1
 s_add_u32 s52,s64,2048
 buffer_store_dwordx4 v[96:99],v1,s[32:35],s52 offen sc1
 s_add_u32 s52,s64,2048
 buffer_store_dwordx4 v[96:99],v1,s[32:35],s52 offen offset:1024 sc1
 s_cmp_ge_u32 s6,11
 s_cbranch_scc1 Lr3_357
 s_add_u32 s52,s64,4096
 buffer_store_dwordx4 v[96:99],v1,s[32:35],s52 offen sc1
 s_add_u32 s52,s64,4096
 buffer_store_dwordx4 v[96:99],v1,s[32:35],s52 offen offset:1024 sc1
Lr3_357:
 v_and_b32 v100,512,v3
 v_add_u32 v100,v100,v3
 s_mov_b32 exec_hi,0
 s_add_u32 s52,s79,0
 buffer_store_dword v96,v100,s[32:35],s52 offen sc1
 s_add_u32 s52,s79,131072
 buffer_store_dword v96,v100,s[32:35],s52 offen sc1
 s_add_u32 s52,s79,262144
 buffer_store_dword v96,v100,s[32:35],s52 offen sc1
 s_mov_b64 exec,-1
 v_and_b32 v36,15,v0
 v_lshlrev_b32 v36,4,v36
 v_lshl_add_u32 v36,v17,8,v36
 v_lshlrev_b32 v37,4,v17
 v_add_u32 v37,512,v37
 v_and_b32 v38,16,v0
 v_cmp_ne_u32 vcc,0,v38
 s_nop 1
 v_cndmask_b32 v36,v36,v37,vcc
 s_mul_i32 s53,s4,544
 v_add_u32 v253,s53,v36
 s_cmp_lg_u32 s48,0
 s_cbranch_scc1 Lp_358
 s_waitcnt vmcnt(17)
Lg_359:
 v_xor_b32 v118,v60,v116
 v_bitop3_b32 v118,v63,v116,v118 bitop3:0xbe
 v_bitop3_b32 v118,v64,v116,v118 bitop3:0xbe
 v_bitop3_b32 v118,v67,v116,v118 bitop3:0xbe
 v_and_b32 v118,0xff,v118
 v_cmp_ne_u32 vcc,0,v118
 s_cbranch_vccz Lgd_360
 s_mov_b64 exec,s[100:101]
 s_add_u32 s52,s50,0
 buffer_load_dwordx4 v[60:63],v114,s[32:35],s52 offen sc1
 s_mov_b64 exec,s[0:1]
 s_add_u32 s52,s50,20480
 buffer_load_dwordx4 v[64:67],v114,s[32:35],s52 offen sc1
 s_mov_b64 exec,-1
 s_waitcnt vmcnt(0)
 s_sub_u32 s55,s55,1
 s_cbranch_scc0 Lg_359
 s_mov_b32 s55,0
Lgd_360:
 v_pk_add_f32 v[60:61],v[60:61],v[64:65]
 v_pk_add_f32 v[62:63],v[62:63],v[66:67]
 s_nop 0
 v_add_f32_dpp v60,v60,v60 row_ror:8 row_mask:0xf bank_mask:0xf
 v_add_f32_dpp v61,v61,v61 row_ror:8 row_mask:0xf bank_mask:0xf
 v_add_f32_dpp v62,v62,v62 row_ror:8 row_mask:0xf bank_mask:0xf
 v_add_f32_dpp v63,v63,v63 row_ror:8 row_mask:0xf bank_mask:0xf
 v_permlane16_swap_b32 v60,v61
 s_nop 0
 v_permlane16_swap_b32 v62,v63
 v_add_f32 v60,v60,v61
 v_add_f32 v62,v62,v63
 s_nop 1
 v_permlane32_swap_b32 v60,v62
 v_add_f32 v60,v60,v62
 v_mul_f32 v60,s3,v60
 v_mov_b32 v61,v60
 s_nop 1
 v_permlane16_swap_b32 v60,v61
 v_cvt_pk_bf16_f32 v60,v60,v61
 s_mov_b32 exec_lo,0xff
 s_mov_b32 exec_hi,0xff
 s_add_u32 s52,s51,0
 buffer_store_dword v60,v117,s[32:35],s52 offen sc1
 s_mov_b64 exec,-1
 s_mov_b32 s48,1
 s_waitcnt vmcnt(1)
 s_mov_b64 exec,1
 v_mov_b32 v118,s7
 s_add_u32 s53,s97,0
 buffer_store_dword v118,off,s[32:35],s53 sc1
 s_mov_b64 exec,-1
 s_mov_b32 s48,0
Lp_358:
 s_cmp_eq_u32 s48,0
 s_cbranch_scc1 Lsk_361
 v_mov_b32 v35,s7
 s_add_u32 s53,s97,0
 s_waitcnt vmcnt(0)
 s_mov_b64 s[82:83],exec
 s_mov_b64 exec,1
 buffer_store_dword v35,off,s[32:35],s53 sc1
 s_mov_b64 exec,s[82:83]
Lsk_361:
 s_cmp_ge_u32 s65,3
 s_cbranch_scc1 Lc_362
 s_lshl_b32 s96,s65,7
 s_add_u32 s96,s96,s78
Lc_363:
 s_add_u32 s52,s96,2176
 buffer_load_dwordx4 v[60:63],v114,s[32:35],s52 offen sc1
 s_add_u32 s52,s96,22656
 buffer_load_dwordx4 v[64:67],v114,s[32:35],s52 offen sc1
 s_waitcnt vmcnt(1)
 v_xor_b32 v118,v60,v116
 v_bitop3_b32 v118,v61,v116,v118 bitop3:0xbe
 v_bitop3_b32 v118,v62,v116,v118 bitop3:0xbe
 v_bitop3_b32 v118,v63,v116,v118 bitop3:0xbe
 s_waitcnt vmcnt(0)
 v_bitop3_b32 v118,v64,v116,v118 bitop3:0xbe
 v_bitop3_b32 v118,v65,v116,v118 bitop3:0xbe
 v_bitop3_b32 v118,v66,v116,v118 bitop3:0xbe
 v_bitop3_b32 v118,v67,v116,v118 bitop3:0xbe
 v_and_b32 v118,0xff,v118
 v_cmp_ne_u32 vcc,0,v118
 s_cbranch_vccz Lc_364
 s_sub_u32 s55,s55,1
 s_cbranch_scc0 Lc_363
 s_mov_b32 s55,0
Lc_364:
 v_pk_add_f32 v[60:61],v[60:61],v[64:65]
 v_pk_add_f32 v[62:63],v[62:63],v[66:67]
 s_nop 0
 v_add_f32_dpp v60,v60,v60 row_ror:8 row_mask:0xf bank_mask:0xf
 v_add_f32_dpp v61,v61,v61 row_ror:8 row_mask:0xf bank_mask:0xf
 v_add_f32_dpp v62,v62,v62 row_ror:8 row_mask:0xf bank_mask:0xf
 v_add_f32_dpp v63,v63,v63 row_ror:8 row_mask:0xf bank_mask:0xf
 v_permlane16_swap_b32 v60,v61
 s_nop 0
 v_permlane16_swap_b32 v62,v63
 v_add_f32 v60,v60,v61
 v_add_f32 v62,v62,v63
 s_nop 1
 v_permlane32_swap_b32 v60,v62
 v_add_f32 v60,v60,v62
 v_cvt_pk_bf16_f32 v61,v60,v60
 v_lshlrev_b32 v61,16,v61
 v_sub_f32 v61,v60,v61
 v_cvt_pk_bf16_f32 v60,v60,v61
 v_and_b32 v61,7,v0
 v_lshlrev_b32 v61,4,v61
 v_lshrrev_b32 v62,4,v0
 v_lshl_add_u32 v61,v62,2,v61
 s_mul_i32 s53,s6,384
 s_lshl_b32 s96,s65,7
 s_add_u32 s53,s53,s96
 s_mov_b32 exec_lo,0x00ff00ff
 s_mov_b32 exec_hi,0x00ff00ff
 s_add_u32 s52,s53,1441792
 buffer_store_dword v60,v61,s[32:35],s52 offen sc1
 s_mov_b64 exec,-1
Lc_362:
 s_waitcnt vmcnt(11)
 v_add_u32 v12,0x10000,v10
 v_add_u32 v14,0x10000,v11
 ds_read_b64_tr_b16 a[176:177],v12 offset:32768
 ds_read_b64_tr_b16 a[180:181],v14 offset:32768
 ds_read_b64_tr_b16 a[178:179],v12 offset:36864
 ds_read_b64_tr_b16 a[182:183],v14 offset:36864
 ds_read_b64_tr_b16 a[184:185],v12 offset:40960
 ds_read_b64_tr_b16 a[188:189],v14 offset:40960
 ds_read_b64_tr_b16 a[186:187],v12 offset:45056
 ds_read_b64_tr_b16 a[190:191],v14 offset:45056
 ds_read_b64_tr_b16 a[192:193],v12 offset:49152
 ds_read_b64_tr_b16 a[196:197],v14 offset:49152
 ds_read_b64_tr_b16 a[194:195],v12 offset:53248
 ds_read_b64_tr_b16 a[198:199],v14 offset:53248
 ds_read_b64_tr_b16 a[200:201],v12 offset:57344
 ds_read_b64_tr_b16 a[204:205],v14 offset:57344
 ds_read_b64_tr_b16 a[202:203],v12 offset:61440
 ds_read_b64_tr_b16 a[206:207],v14 offset:61440
 v_add_u32 v12,0x20000,v10
 v_add_u32 v14,0x20000,v11
 ds_read_b64_tr_b16 a[208:209],v12 offset:8192
 ds_read_b64_tr_b16 a[212:213],v14 offset:8192
 ds_read_b64_tr_b16 a[210:211],v12 offset:12288
 ds_read_b64_tr_b16 a[214:215],v14 offset:12288
 ds_read_b64_tr_b16 a[216:217],v12 offset:0
 ds_read_b64_tr_b16 a[220:221],v14 offset:0
 ds_read_b64_tr_b16 a[218:219],v12 offset:4096
 ds_read_b64_tr_b16 a[222:223],v14 offset:4096
 ds_read_b64_tr_b16 a[224:225],v12 offset:16384
 ds_read_b64_tr_b16 a[228:229],v14 offset:16384
 ds_read_b64_tr_b16 a[226:227],v12 offset:20480
 ds_read_b64_tr_b16 a[230:231],v14 offset:20480
 ds_read_b64_tr_b16 a[232:233],v12 offset:24576
 ds_read_b64_tr_b16 a[236:237],v14 offset:24576
 ds_read_b64_tr_b16 a[234:235],v12 offset:28672
 ds_read_b64_tr_b16 a[238:239],v14 offset:28672
 s_waitcnt lgkmcnt(0)
 s_add_u32 s53,s54,131072
 v_add_u32 v35,s53,v1
 v_and_b32 v36,15,v0
 v_lshlrev_b32 v36,6,v36
 v_lshl_add_u32 v36,v17,5,v36
 v_bfe_u32 v37,v0,4,1
 v_lshl_add_u32 v36,v37,3,v36
 v_add_u32 v36,s53,v36
 ds_write_b128 v35,a[240:243] offset:0
 ds_write_b128 v35,a[244:247] offset:4096
 s_waitcnt lgkmcnt(0)
 ds_read_b64 a[240:241],v36 offset:0
 ds_read_b64 a[242:243],v36 offset:16
 ds_read_b64 a[244:245],v36 offset:4096
 ds_read_b64 a[246:247],v36 offset:4112
 s_waitcnt lgkmcnt(0)
 s_bfe_u32 s96,s44,0x50000
 s_lshl_b32 s96,s96,16
 s_add_u32 s96,s96,s66
 s_add_u32 m0,s54,131072
 s_add_u32 s52,s96,0
 buffer_load_dwordx4 v9,s[24:27],s52 offen lds
 s_add_u32 m0,s54,135168
 s_add_u32 s52,s96,8192
 buffer_load_dwordx4 v9,s[24:27],s52 offen lds
 s_bfe_u32 s96,s44,0x50005
 s_lshl_b32 s96,s96,16
 s_add_u32 s96,s96,s66
 s_add_u32 m0,s54,139264
 s_add_u32 s52,s96,0
 buffer_load_dwordx4 v9,s[24:27],s52 offen lds
 s_add_u32 m0,s54,143360
 s_add_u32 s52,s96,8192
 buffer_load_dwordx4 v9,s[24:27],s52 offen lds
 s_bfe_u32 s96,s44,0x5000a
 s_lshl_b32 s96,s96,16
 s_add_u32 s96,s96,s66
 s_add_u32 m0,s54,147456
 s_add_u32 s52,s96,0
 buffer_load_dwordx4 v9,s[24:27],s52 offen lds
 s_add_u32 m0,s54,151552
 s_add_u32 s52,s96,8192
 buffer_load_dwordx4 v9,s[24:27],s52 offen lds
 s_bfe_u32 s96,s44,0x5000f
 s_lshl_b32 s96,s96,16
 s_add_u32 s96,s96,s66
 s_add_u32 m0,s54,155648
 s_add_u32 s52,s96,0
 buffer_load_dwordx4 v9,s[24:27],s52 offen lds
 s_add_u32 m0,s54,159744
 s_add_u32 s52,s96,8192
 buffer_load_dwordx4 v9,s[24:27],s52 offen lds
 s_add_u32 s96,s95,0
 s_and_b32 s96,s96,7
 s_mul_i32 s96,s96,176128
 s_add_u32 s96,s96,s62
 s_add_u32 m0,s54,65536
 s_add_u32 s52,s96,0
 buffer_load_dwordx4 v8,s[20:23],s52 offen lds
 s_add_u32 s96,s96,s60
 s_add_u32 m0,s54,81920
 s_add_u32 s52,s96,0
 buffer_load_dwordx4 v8,s[20:23],s52 offen lds
 s_add_u32 s53,s98,4096
 v_lshlrev_b32 v36,2,v0
Lpoll_365:
 buffer_load_dword v35,v36,s[32:35],s53 offen sc1
 s_waitcnt vmcnt(0)
 v_cmp_ne_u32 vcc,s7,v35
 s_cbranch_vccz Lpd_366
 s_sub_u32 s55,s55,1
 s_cbranch_scc0 Lpoll_365
 s_mov_b32 s55,0
Lpd_366:
 s_add_u32 s96,s59,0
 s_and_b32 s96,s96,7
 s_mul_i32 s96,s96,2176
 s_add_u32 s52,s96,1376256
 buffer_load_dwordx4 v[136:139],v253,s[32:35],s52 offen sc1
 s_add_u32 s96,s59,1
 s_and_b32 s96,s96,7
 s_mul_i32 s96,s96,2176
 s_add_u32 s52,s96,1376256
 buffer_load_dwordx4 v[140:143],v253,s[32:35],s52 offen sc1
 s_add_u32 s96,s59,2
 s_and_b32 s96,s96,7
 s_mul_i32 s96,s96,2176
 s_add_u32 s52,s96,1376256
 buffer_load_dwordx4 v[144:147],v253,s[32:35],s52 offen sc1
 s_add_u32 s96,s59,3
 s_and_b32 s96,s96,7
 s_mul_i32 s96,s96,2176
 s_add_u32 s52,s96,1376256
 buffer_load_dwordx4 v[148:151],v253,s[32:35],s52 offen sc1
 s_add_u32 s96,s59,4
 s_and_b32 s96,s96,7
 s_mul_i32 s96,s96,2176
 s_add_u32 s52,s96,1376256
 buffer_load_dwordx4 v[152:155],v253,s[32:35],s52 offen sc1
 s_add_u32 s96,s59,5
 s_and_b32 s96,s96,7
 s_mul_i32 s96,s96,2176
 s_add_u32 s52,s96,1376256
 buffer_load_dwordx4 v[156:159],v253,s[32:35],s52 offen sc1
 s_add_u32 s96,s59,6
 s_and_b32 s96,s96,7
 s_mul_i32 s96,s96,2176
 s_add_u32 s52,s96,1376256
 buffer_load_dwordx4 v[160:163],v253,s[32:35],s52 offen sc1
 s_add_u32 s96,s59,7
 s_and_b32 s96,s96,7
 s_mul_i32 s96,s96,2176
 s_add_u32 s52,s96,1376256
 buffer_load_dwordx4 v[164:167],v253,s[32:35],s52 offen sc1
 s_add_u32 s96,s59,0
 s_and_b32 s96,s96,7
 s_mul_i32 s96,s96,4096
 s_add_u32 s96,s96,s71
 s_add_u32 s52,s96,0
 buffer_load_dwordx4 v[168:171],v1,s[32:35],s52 offen sc1
 s_add_u32 s96,s59,1
 s_and_b32 s96,s96,7
 s_mul_i32 s96,s96,4096
 s_add_u32 s96,s96,s71
 s_add_u32 s52,s96,0
 buffer_load_dwordx4 v[172:175],v1,s[32:35],s52 offen sc1
 s_add_u32 s96,s59,2
 s_and_b32 s96,s96,7
 s_mul_i32 s96,s96,4096
 s_add_u32 s96,s96,s71
 s_add_u32 s52,s96,0
 buffer_load_dwordx4 v[176:179],v1,s[32:35],s52 offen sc1
 s_add_u32 s96,s59,3
 s_and_b32 s96,s96,7
 s_mul_i32 s96,s96,4096
 s_add_u32 s96,s96,s71
 s_add_u32 s52,s96,0
 buffer_load_dwordx4 v[180:183],v1,s[32:35],s52 offen sc1
 s_add_u32 s96,s59,4
 s_and_b32 s96,s96,7
 s_mul_i32 s96,s96,4096
 s_add_u32 s96,s96,s71
 s_add_u32 s52,s96,0
 buffer_load_dwordx4 v[184:187],v1,s[32:35],s52 offen sc1
 s_add_u32 s96,s59,5
 s_and_b32 s96,s96,7
 s_mul_i32 s96,s96,4096
 s_add_u32 s96,s96,s71
 s_add_u32 s52,s96,0
 buffer_load_dwordx4 v[188:191],v1,s[32:35],s52 offen sc1
 s_add_u32 s96,s59,6
 s_and_b32 s96,s96,7
 s_mul_i32 s96,s96,4096
 s_add_u32 s96,s96,s71
 s_add_u32 s52,s96,0
 buffer_load_dwordx4 v[192:195],v1,s[32:35],s52 offen sc1
 s_add_u32 s96,s59,7
 s_and_b32 s96,s96,7
 s_mul_i32 s96,s96,4096
 s_add_u32 s96,s96,s71
 s_add_u32 s52,s96,0
 buffer_load_dwordx4 v[196:199],v1,s[32:35],s52 offen sc1
 s_add_u32 s96,s59,0
 s_and_b32 s96,s96,7
 s_mul_i32 s96,s96,4096
 s_add_u32 s96,s96,s71
 s_add_u32 s52,s96,32768
 buffer_load_dwordx4 v[200:203],v1,s[32:35],s52 offen sc1
 s_add_u32 s96,s59,1
 s_and_b32 s96,s96,7
 s_mul_i32 s96,s96,4096
 s_add_u32 s96,s96,s71
 s_add_u32 s52,s96,32768
 buffer_load_dwordx4 v[204:207],v1,s[32:35],s52 offen sc1
 s_add_u32 s96,s59,2
 s_and_b32 s96,s96,7
 s_mul_i32 s96,s96,4096
 s_add_u32 s96,s96,s71
 s_add_u32 s52,s96,32768
 buffer_load_dwordx4 v[208:211],v1,s[32:35],s52 offen sc1
 s_add_u32 s96,s59,3
 s_and_b32 s96,s96,7
 s_mul_i32 s96,s96,4096
 s_add_u32 s96,s96,s71
 s_add_u32 s52,s96,32768
 buffer_load_dwordx4 v[212:215],v1,s[32:35],s52 offen sc1
 s_add_u32 s96,s59,4
 s_and_b32 s96,s96,7
 s_mul_i32 s96,s96,4096
 s_add_u32 s96,s96,s71
 s_add_u32 s52,s96,32768
 buffer_load_dwordx4 v[216:219],v1,s[32:35],s52 offen sc1
 s_add_u32 s96,s59,5
 s_and_b32 s96,s96,7
 s_mul_i32 s96,s96,4096
 s_add_u32 s96,s96,s71
 s_add_u32 s52,s96,32768
 buffer_load_dwordx4 v[220:223],v1,s[32:35],s52 offen sc1
 s_add_u32 s96,s59,6
 s_and_b32 s96,s96,7
 s_mul_i32 s96,s96,4096
 s_add_u32 s96,s96,s71
 s_add_u32 s52,s96,32768
 buffer_load_dwordx4 v[224:227],v1,s[32:35],s52 offen sc1
 s_add_u32 s96,s59,7
 s_and_b32 s96,s96,7
 s_mul_i32 s96,s96,4096
 s_add_u32 s96,s96,s71
 s_add_u32 s52,s96,32768
 buffer_load_dwordx4 v[228:231],v1,s[32:35],s52 offen sc1
 ds_read_b64_tr_b16 a[0:1],v12 offset:0
 ds_read_b64_tr_b16 a[4:5],v14 offset:0
 ds_read_b64_tr_b16 a[2:3],v12 offset:4096
 ds_read_b64_tr_b16 a[6:7],v14 offset:4096
 ds_read_b64_tr_b16 a[8:9],v12 offset:8192
 ds_read_b64_tr_b16 a[12:13],v14 offset:8192
 ds_read_b64_tr_b16 a[10:11],v12 offset:12288
 ds_read_b64_tr_b16 a[14:15],v14 offset:12288
 ds_read_b64_tr_b16 a[16:17],v12 offset:16384
 ds_read_b64_tr_b16 a[20:21],v14 offset:16384
 ds_read_b64_tr_b16 a[18:19],v12 offset:20480
 ds_read_b64_tr_b16 a[22:23],v14 offset:20480
 ds_read_b64_tr_b16 a[24:25],v12 offset:24576
 ds_read_b64_tr_b16 a[28:29],v14 offset:24576
 ds_read_b64_tr_b16 a[26:27],v12 offset:28672
 ds_read_b64_tr_b16 a[30:31],v14 offset:28672
Lk_367:
 s_waitcnt vmcnt(23)
 v_max_u32 v37,v136,v137
 v_max3_u32 v37,v138,v139,v37
 s_waitcnt vmcnt(22)
 v_max3_u32 v37,v140,v141,v37
 v_max3_u32 v37,v142,v143,v37
 s_waitcnt vmcnt(21)
 v_max3_u32 v37,v144,v145,v37
 v_max3_u32 v37,v146,v147,v37
 s_waitcnt vmcnt(20)
 v_max3_u32 v37,v148,v149,v37
 v_max3_u32 v37,v150,v151,v37
 s_waitcnt vmcnt(19)
 v_max3_u32 v37,v152,v153,v37
 v_max3_u32 v37,v154,v155,v37
 s_waitcnt vmcnt(18)
 v_max3_u32 v37,v156,v157,v37
 v_max3_u32 v37,v158,v159,v37
 s_waitcnt vmcnt(17)
 v_max3_u32 v37,v160,v161,v37
 v_max3_u32 v37,v162,v163,v37
 s_waitcnt vmcnt(16)
 v_max3_u32 v37,v164,v165,v37
 v_max3_u32 v37,v166,v167,v37
 v_cmp_eq_u32 vcc,-1,v37
 s_cbranch_vccz Lkd_368
 s_add_u32 s96,s59,0
 s_and_b32 s96,s96,7
 s_mul_i32 s96,s96,2176
 s_add_u32 s52,s96,1376256
 buffer_load_dwordx4 v[136:139],v253,s[32:35],s52 offen sc1
 s_add_u32 s96,s59,1
 s_and_b32 s96,s96,7
 s_mul_i32 s96,s96,2176
 s_add_u32 s52,s96,1376256
 buffer_load_dwordx4 v[140:143],v253,s[32:35],s52 offen sc1
 s_add_u32 s96,s59,2
 s_and_b32 s96,s96,7
 s_mul_i32 s96,s96,2176
 s_add_u32 s52,s96,1376256
 buffer_load_dwordx4 v[144:147],v253,s[32:35],s52 offen sc1
 s_add_u32 s96,s59,3
 s_and_b32 s96,s96,7
 s_mul_i32 s96,s96,2176
 s_add_u32 s52,s96,1376256
 buffer_load_dwordx4 v[148:151],v253,s[32:35],s52 offen sc1
 s_add_u32 s96,s59,4
 s_and_b32 s96,s96,7
 s_mul_i32 s96,s96,2176
 s_add_u32 s52,s96,1376256
 buffer_load_dwordx4 v[152:155],v253,s[32:35],s52 offen sc1
 s_add_u32 s96,s59,5
 s_and_b32 s96,s96,7
 s_mul_i32 s96,s96,2176
 s_add_u32 s52,s96,1376256
 buffer_load_dwordx4 v[156:159],v253,s[32:35],s52 offen sc1
 s_add_u32 s96,s59,6
 s_and_b32 s96,s96,7
 s_mul_i32 s96,s96,2176
 s_add_u32 s52,s96,1376256
 buffer_load_dwordx4 v[160:163],v253,s[32:35],s52 offen sc1
 s_add_u32 s96,s59,7
 s_and_b32 s96,s96,7
 s_mul_i32 s96,s96,2176
 s_add_u32 s52,s96,1376256
 buffer_load_dwordx4 v[164:167],v253,s[32:35],s52 offen sc1
 s_waitcnt vmcnt(0)
 s_sub_u32 s55,s55,1
 s_cbranch_scc0 Lk_367
 s_mov_b32 s55,0
Lkd_368:
 s_waitcnt vmcnt(15)
 v_mfma_f32_32x32x16_bf16 v[56:71],v[136:139],v[168:171],0
 s_waitcnt vmcnt(14)
 v_mfma_f32_32x32x16_bf16 v[72:87],v[140:143],v[172:175],0
 s_getpc_b64 s[82:83]
Lpc_370:
 s_lshr_b32 s52,s2,3
 s_lshl_b32 s52,s52,2
 s_add_u32 s52,s52,s4
 s_lshl_b32 s52,s52,10
 s_min_u32 s52,s52,L_codeend-Lpc_370-1024
 v_add_u32 v252,s52,v1
 global_load_dwordx4 v[248:251],v252,s[82:83]
 v_and_b32 v255,31,v0
 v_lshlrev_b32 v255,2,v255
 s_mul_i32 s84,s6,384
 s_add_u32 s84,s84,1441792
 buffer_load_dword v22,v255,s[32:35],s84 offen sc1
 buffer_load_dword v23,v255,s[32:35],s84 offen offset:256 sc1
 buffer_load_dword v34,v255,s[32:35],s84 offen offset:128 sc1
 v_add_f32 v64,s76,v64
 v_rcp_f32 v64,v64
 s_nop 0
 v_mul_f32 v56,v56,v64
 v_mul_f32 v57,v57,v64
 v_mul_f32 v58,v58,v64
 v_mul_f32 v59,v59,v64
 v_mul_f32 v60,v60,v64
 v_mul_f32 v61,v61,v64
 v_mul_f32 v62,v62,v64
 v_mul_f32 v63,v63,v64
 v_cvt_pk_bf16_f32 v168,v56,v57
 v_cvt_pk_bf16_f32 v169,v58,v59
 v_cvt_pk_bf16_f32 v170,v60,v61
 v_cvt_pk_bf16_f32 v171,v62,v63
 s_waitcnt vmcnt(17)
 v_mfma_f32_32x32x16_bf16 v[40:55],v[144:147],v[176:179],0
 v_add_f32 v80,s76,v80
 v_rcp_f32 v80,v80
 s_waitcnt lgkmcnt(0)
 v_mul_f32 v72,v72,v80
 v_mul_f32 v73,v73,v80
 v_mul_f32 v74,v74,v80
 v_mul_f32 v75,v75,v80
 v_mul_f32 v76,v76,v80
 v_mul_f32 v77,v77,v80
 v_mfma_f32_32x32x16_bf16 v[88:103],a[176:179],v[168:171],0
 v_mul_f32 v78,v78,v80
 v_mul_f32 v79,v79,v80
 v_cvt_pk_bf16_f32 v172,v72,v73
 v_cvt_pk_bf16_f32 v173,v74,v75
 v_cvt_pk_bf16_f32 v174,v76,v77
 v_cvt_pk_bf16_f32 v175,v78,v79
 s_waitcnt vmcnt(16)
 v_mfma_f32_32x32x16_bf16 v[56:71],v[148:151],v[180:183],0
 v_add_f32 v48,s76,v48
 v_rcp_f32 v48,v48
 s_nop 0
 v_mul_f32 v40,v40,v48
 v_mul_f32 v41,v41,v48
 v_mul_f32 v42,v42,v48
 v_mul_f32 v43,v43,v48
 v_mul_f32 v44,v44,v48
 v_mul_f32 v45,v45,v48
 v_mfma_f32_32x32x16_bf16 v[88:103],a[184:187],v[172:175],v[88:103]
 v_mul_f32 v46,v46,v48
 v_mul_f32 v47,v47,v48
 v_cvt_pk_bf16_f32 v176,v40,v41
 v_cvt_pk_bf16_f32 v177,v42,v43
 v_cvt_pk_bf16_f32 v178,v44,v45
 v_cvt_pk_bf16_f32 v179,v46,v47
 s_waitcnt vmcnt(15)
 v_mfma_f32_32x32x16_bf16 v[72:87],v[152:155],v[184:187],0
 v_add_f32 v64,s76,v64
 v_rcp_f32 v64,v64
 s_bfe_u32 s96,s44,0x50014
 s_lshl_b32 s96,s96,16
 s_add_u32 s96,s96,s66
 s_add_u32 m0,s54,131072
 s_add_u32 s52,s96,0
 buffer_load_dwordx4 v9,s[24:27],s52 offen lds
 s_add_u32 m0,s54,135168
 s_add_u32 s52,s96,8192
 buffer_load_dwordx4 v9,s[24:27],s52 offen lds
 v_mul_f32 v56,v56,v64
 v_mul_f32 v57,v57,v64
 v_mul_f32 v58,v58,v64
 v_mul_f32 v59,v59,v64
 v_mul_f32 v60,v60,v64
 v_mul_f32 v61,v61,v64
 v_mfma_f32_32x32x16_bf16 v[88:103],a[192:195],v[176:179],v[88:103]
 v_mul_f32 v62,v62,v64
 v_mul_f32 v63,v63,v64
 v_cvt_pk_bf16_f32 v180,v56,v57
 v_cvt_pk_bf16_f32 v181,v58,v59
 v_cvt_pk_bf16_f32 v182,v60,v61
 v_cvt_pk_bf16_f32 v183,v62,v63
 s_waitcnt vmcnt(16)
 v_mfma_f32_32x32x16_bf16 v[40:55],v[156:159],v[188:191],0
 v_add_f32 v80,s76,v80
 v_rcp_f32 v80,v80
 s_nop 0
 v_mul_f32 v72,v72,v80
 v_mul_f32 v73,v73,v80
 v_mul_f32 v74,v74,v80
 v_mul_f32 v75,v75,v80
 v_mul_f32 v76,v76,v80
 v_mul_f32 v77,v77,v80
 v_mfma_f32_32x32x16_bf16 v[88:103],a[200:203],v[180:183],v[88:103]
 v_mul_f32 v78,v78,v80
 v_mul_f32 v79,v79,v80
 v_cvt_pk_bf16_f32 v184,v72,v73
 v_cvt_pk_bf16_f32 v185,v74,v75
 v_cvt_pk_bf16_f32 v186,v76,v77
 v_cvt_pk_bf16_f32 v187,v78,v79
 s_waitcnt vmcnt(15)
 v_mfma_f32_32x32x16_bf16 v[56:71],v[160:163],v[192:195],0
 v_add_f32 v48,s76,v48
 v_rcp_f32 v48,v48
 s_bfe_u32 s96,s44,0x50019
 s_lshl_b32 s96,s96,16
 s_add_u32 s96,s96,s66
 s_add_u32 m0,s54,139264
 s_add_u32 s52,s96,0
 buffer_load_dwordx4 v9,s[24:27],s52 offen lds
 s_add_u32 m0,s54,143360
 s_add_u32 s52,s96,8192
 buffer_load_dwordx4 v9,s[24:27],s52 offen lds
 v_mul_f32 v40,v40,v48
 v_mul_f32 v41,v41,v48
 v_mul_f32 v42,v42,v48
 v_mul_f32 v43,v43,v48
 v_mul_f32 v44,v44,v48
 v_mul_f32 v45,v45,v48
 v_mfma_f32_32x32x16_bf16 v[88:103],a[208:211],v[184:187],v[88:103]
 v_mul_f32 v46,v46,v48
 v_mul_f32 v47,v47,v48
 v_cvt_pk_bf16_f32 v188,v40,v41
 v_cvt_pk_bf16_f32 v189,v42,v43
 v_cvt_pk_bf16_f32 v190,v44,v45
 v_cvt_pk_bf16_f32 v191,v46,v47
 s_waitcnt vmcnt(16)
 v_mfma_f32_32x32x16_bf16 v[72:87],v[164:167],v[196:199],0
 v_add_f32 v64,s76,v64
 v_rcp_f32 v64,v64
 s_nop 0
 v_mul_f32 v56,v56,v64
 v_mul_f32 v57,v57,v64
 v_mul_f32 v58,v58,v64
 v_mul_f32 v59,v59,v64
 v_mul_f32 v60,v60,v64
 v_mul_f32 v61,v61,v64
 v_mfma_f32_32x32x16_bf16 v[88:103],a[216:219],v[188:191],v[88:103]
 v_mul_f32 v62,v62,v64
 v_mul_f32 v63,v63,v64
 v_cvt_pk_bf16_f32 v192,v56,v57
 v_cvt_pk_bf16_f32 v193,v58,v59
 v_cvt_pk_bf16_f32 v194,v60,v61
 v_cvt_pk_bf16_f32 v195,v62,v63
 s_waitcnt vmcnt(15)
 v_mfma_f32_32x32x16_bf16 v[40:55],v[136:139],v[200:203],0
 v_add_f32 v80,s76,v80
 v_rcp_f32 v80,v80
 s_bfe_u32 s96,s45,0x50000
 s_lshl_b32 s96,s96,16
 s_add_u32 s96,s96,s66
 s_add_u32 m0,s54,147456
 s_add_u32 s52,s96,0
 buffer_load_dwordx4 v9,s[24:27],s52 offen lds
 s_add_u32 m0,s54,151552
 s_add_u32 s52,s96,8192
 buffer_load_dwordx4 v9,s[24:27],s52 offen lds
 v_mul_f32 v72,v72,v80
 v_mul_f32 v73,v73,v80
 v_mul_f32 v74,v74,v80
 v_mul_f32 v75,v75,v80
 v_mul_f32 v76,v76,v80
 v_mul_f32 v77,v77,v80
 v_mfma_f32_32x32x16_bf16 v[88:103],a[224:227],v[192:195],v[88:103]
 v_mul_f32 v78,v78,v80
 v_mul_f32 v79,v79,v80
 v_cvt_pk_bf16_f32 v196,v72,v73
 v_cvt_pk_bf16_f32 v197,v74,v75
 v_cvt_pk_bf16_f32 v198,v76,v77
 v_cvt_pk_bf16_f32 v199,v78,v79
 s_waitcnt vmcnt(16)
 v_mfma_f32_32x32x16_bf16 v[56:71],v[140:143],v[204:207],0
 v_add_f32 v48,s76,v48
 v_rcp_f32 v48,v48
 s_nop 0
 v_mul_f32 v40,v40,v48
 v_mul_f32 v41,v41,v48
 v_mul_f32 v42,v42,v48
 v_mul_f32 v43,v43,v48
 v_mul_f32 v44,v44,v48
 v_mul_f32 v45,v45,v48
 v_mfma_f32_32x32x16_bf16 v[88:103],a[232:235],v[196:199],v[88:103]
 v_mul_f32 v46,v46,v48
 v_mul_f32 v47,v47,v48
 v_cvt_pk_bf16_f32 v200,v40,v41
 v_cvt_pk_bf16_f32 v201,v42,v43
 v_cvt_pk_bf16_f32 v202,v44,v45
 v_cvt_pk_bf16_f32 v203,v46,v47
 s_waitcnt vmcnt(15)
 v_mfma_f32_32x32x16_bf16 v[72:87],v[144:147],v[208:211],0
 v_add_f32 v64,s76,v64
 v_rcp_f32 v64,v64
 s_bfe_u32 s96,s45,0x50005
 s_lshl_b32 s96,s96,16
 s_add_u32 s96,s96,s66
 s_add_u32 m0,s54,155648
 s_add_u32 s52,s96,0
 buffer_load_dwordx4 v9,s[24:27],s52 offen lds
 s_add_u32 m0,s54,159744
 s_add_u32 s52,s96,8192
 buffer_load_dwordx4 v9,s[24:27],s52 offen lds
 v_mul_f32 v56,v56,v64
 v_mul_f32 v57,v57,v64
 v_mul_f32 v58,v58,v64
 v_mul_f32 v59,v59,v64
 v_mul_f32 v60,v60,v64
 v_mul_f32 v61,v61,v64
 v_mfma_f32_32x32x16_bf16 v[104:119],a[176:179],v[200:203],0
 v_mul_f32 v62,v62,v64
 v_mul_f32 v63,v63,v64
 v_cvt_pk_bf16_f32 v204,v56,v57
 v_cvt_pk_bf16_f32 v205,v58,v59
 v_cvt_pk_bf16_f32 v206,v60,v61
 v_cvt_pk_bf16_f32 v207,v62,v63
 s_waitcnt vmcnt(16)
 v_mfma_f32_32x32x16_bf16 v[40:55],v[148:151],v[212:215],0
 v_add_f32 v80,s76,v80
 v_rcp_f32 v80,v80
 s_nop 0
 v_mul_f32 v72,v72,v80
 v_mul_f32 v73,v73,v80
 v_mul_f32 v74,v74,v80
 v_mul_f32 v75,v75,v80
 v_mul_f32 v76,v76,v80
 v_mul_f32 v77,v77,v80
 v_mfma_f32_32x32x16_bf16 v[104:119],a[184:187],v[204:207],v[104:119]
 v_mul_f32 v78,v78,v80
 v_mul_f32 v79,v79,v80
 v_cvt_pk_bf16_f32 v208,v72,v73
 v_cvt_pk_bf16_f32 v209,v74,v75
 v_cvt_pk_bf16_f32 v210,v76,v77
 v_cvt_pk_bf16_f32 v211,v78,v79
 s_waitcnt vmcnt(15)
 v_mfma_f32_32x32x16_bf16 v[56:71],v[152:155],v[216:219],0
 v_add_f32 v48,s76,v48
 v_rcp_f32 v48,v48
 s_add_u32 s96,s95,1
 s_and_b32 s96,s96,7
 s_mul_i32 s96,s96,176128
 s_add_u32 s96,s96,s62
 s_add_u32 m0,s54,69632
 s_add_u32 s52,s96,0
 buffer_load_dwordx4 v8,s[20:23],s52 offen lds
 s_add_u32 s96,s96,s60
 s_add_u32 m0,s54,86016
 s_add_u32 s52,s96,0
 buffer_load_dwordx4 v8,s[20:23],s52 offen lds
 v_mul_f32 v40,v40,v48
 v_mul_f32 v41,v41,v48
 v_mul_f32 v42,v42,v48
 v_mul_f32 v43,v43,v48
 v_mul_f32 v44,v44,v48
 v_mul_f32 v45,v45,v48
 v_mfma_f32_32x32x16_bf16 v[104:119],a[192:195],v[208:211],v[104:119]
 v_mul_f32 v46,v46,v48
 v_mul_f32 v47,v47,v48
 v_cvt_pk_bf16_f32 v212,v40,v41
 v_cvt_pk_bf16_f32 v213,v42,v43
 v_cvt_pk_bf16_f32 v214,v44,v45
 v_cvt_pk_bf16_f32 v215,v46,v47
 s_waitcnt vmcnt(16)
 v_mfma_f32_32x32x16_bf16 v[72:87],v[156:159],v[220:223],0
 v_add_f32 v64,s76,v64
 v_rcp_f32 v64,v64
 s_nop 0
 v_mul_f32 v56,v56,v64
 v_mul_f32 v57,v57,v64
 v_mul_f32 v58,v58,v64
 v_mul_f32 v59,v59,v64
 v_mul_f32 v60,v60,v64
 v_mul_f32 v61,v61,v64
 v_mfma_f32_32x32x16_bf16 v[104:119],a[200:203],v[212:215],v[104:119]
 v_mul_f32 v62,v62,v64
 v_mul_f32 v63,v63,v64
 v_cvt_pk_bf16_f32 v216,v56,v57
 v_cvt_pk_bf16_f32 v217,v58,v59
 v_cvt_pk_bf16_f32 v218,v60,v61
 v_cvt_pk_bf16_f32 v219,v62,v63
 s_waitcnt vmcnt(15)
 v_mfma_f32_32x32x16_bf16 v[40:55],v[160:163],v[224:227],0
 v_add_f32 v80,s76,v80
 v_rcp_f32 v80,v80
 s_add_u32 s96,s95,2
 s_and_b32 s96,s96,7
 s_mul_i32 s96,s96,176128
 s_add_u32 s96,s96,s62
 s_add_u32 m0,s54,73728
 s_add_u32 s52,s96,0
 buffer_load_dwordx4 v8,s[20:23],s52 offen lds
 s_add_u32 s96,s96,s60
 s_add_u32 m0,s54,90112
 s_add_u32 s52,s96,0
 buffer_load_dwordx4 v8,s[20:23],s52 offen lds
 v_mul_f32 v72,v72,v80
 v_mul_f32 v73,v73,v80
 v_mul_f32 v74,v74,v80
 v_mul_f32 v75,v75,v80
 v_mul_f32 v76,v76,v80
 v_mul_f32 v77,v77,v80
 v_mfma_f32_32x32x16_bf16 v[104:119],a[208:211],v[216:219],v[104:119]
 v_mul_f32 v78,v78,v80
 v_mul_f32 v79,v79,v80
 v_cvt_pk_bf16_f32 v220,v72,v73
 v_cvt_pk_bf16_f32 v221,v74,v75
 v_cvt_pk_bf16_f32 v222,v76,v77
 v_cvt_pk_bf16_f32 v223,v78,v79
 s_waitcnt vmcnt(16)
 v_mfma_f32_32x32x16_bf16 v[56:71],v[164:167],v[228:231],0
 v_add_f32 v48,s76,v48
 v_rcp_f32 v48,v48
 s_nop 0
 v_mul_f32 v40,v40,v48
 v_mul_f32 v41,v41,v48
 v_mul_f32 v42,v42,v48
 v_mul_f32 v43,v43,v48
 v_mul_f32 v44,v44,v48
 v_mul_f32 v45,v45,v48
 v_mfma_f32_32x32x16_bf16 v[104:119],a[216:219],v[220:223],v[104:119]
 v_mul_f32 v46,v46,v48
 v_mul_f32 v47,v47,v48
 v_cvt_pk_bf16_f32 v224,v40,v41
 v_cvt_pk_bf16_f32 v225,v42,v43
 v_cvt_pk_bf16_f32 v226,v44,v45
 v_cvt_pk_bf16_f32 v227,v46,v47
 v_add_f32 v64,s76,v64
 v_rcp_f32 v64,v64
 s_add_u32 s96,s95,3
 s_and_b32 s96,s96,7
 s_mul_i32 s96,s96,176128
 s_add_u32 s96,s96,s62
 s_add_u32 m0,s54,77824
 s_add_u32 s52,s96,0
 buffer_load_dwordx4 v8,s[20:23],s52 offen lds
 s_add_u32 s96,s96,s60
 s_add_u32 m0,s54,94208
 s_add_u32 s52,s96,0
 buffer_load_dwordx4 v8,s[20:23],s52 offen lds
 v_mul_f32 v56,v56,v64
 v_mul_f32 v57,v57,v64
 v_mul_f32 v58,v58,v64
 v_mul_f32 v59,v59,v64
 v_mul_f32 v60,v60,v64
 v_mul_f32 v61,v61,v64
 v_mfma_f32_32x32x16_bf16 v[104:119],a[224:227],v[224:227],v[104:119]
 v_mul_f32 v62,v62,v64
 v_mul_f32 v63,v63,v64
 v_cvt_pk_bf16_f32 v228,v56,v57
 v_cvt_pk_bf16_f32 v229,v58,v59
 v_cvt_pk_bf16_f32 v230,v60,v61
 v_cvt_pk_bf16_f32 v231,v62,v63
 s_nop 1
 v_mfma_f32_32x32x16_bf16 v[104:119],a[232:235],v[228:231],v[104:119]
 s_add_u32 s96,s95,4
 s_and_b32 s96,s96,7
 s_mul_i32 s96,s96,176128
 s_add_u32 s96,s96,s62
 s_add_u32 m0,s54,98304
 s_add_u32 s52,s96,0
 buffer_load_dwordx4 v8,s[20:23],s52 offen lds
 s_add_u32 s96,s96,s60
 s_add_u32 m0,s54,114688
 s_add_u32 s52,s96,0
 buffer_load_dwordx4 v8,s[20:23],s52 offen lds
 s_add_u32 s96,s95,5
 s_and_b32 s96,s96,7
 s_mul_i32 s96,s96,176128
 s_add_u32 s96,s96,s62
 s_add_u32 m0,s54,102400
 s_add_u32 s52,s96,0
 buffer_load_dwordx4 v8,s[20:23],s52 offen lds
 s_add_u32 s96,s96,s60
 s_add_u32 m0,s54,118784
 s_add_u32 s52,s96,0
 buffer_load_dwordx4 v8,s[20:23],s52 offen lds
 s_waitcnt vmcnt(10)
 ds_read_b64_tr_b16 a[32:33],v12 offset:0
 ds_read_b64_tr_b16 a[36:37],v14 offset:0
 ds_read_b64_tr_b16 a[34:35],v12 offset:4096
 ds_read_b64_tr_b16 a[38:39],v14 offset:4096
 ds_read_b64_tr_b16 a[40:41],v12 offset:8192
 ds_read_b64_tr_b16 a[44:45],v14 offset:8192
 ds_read_b64_tr_b16 a[42:43],v12 offset:12288
 ds_read_b64_tr_b16 a[46:47],v14 offset:12288
 ds_read_b64_tr_b16 a[48:49],v12 offset:16384
 ds_read_b64_tr_b16 a[52:53],v14 offset:16384
 ds_read_b64_tr_b16 a[50:51],v12 offset:20480
 ds_read_b64_tr_b16 a[54:55],v14 offset:20480
 ds_read_b64_tr_b16 a[56:57],v12 offset:24576
 ds_read_b64_tr_b16 a[60:61],v14 offset:24576
 ds_read_b64_tr_b16 a[58:59],v12 offset:28672
 ds_read_b64_tr_b16 a[62:63],v14 offset:28672
 s_waitcnt lgkmcnt(0)
 s_barrier
 v_mfma_f32_32x32x16_bf16 v[120:135],a[180:183],v[168:171],0
 ds_write_b128 v18,v[88:91] offset:0
 v_accvgpr_read_b32 v41,a240
 v_accvgpr_read_b32 v43,a241
 v_accvgpr_read_b32 v45,a242
 v_mfma_f32_32x32x16_bf16 v[120:135],a[188:191],v[172:175],v[120:135]
 v_accvgpr_read_b32 v47,a243
 v_lshlrev_b32 v40,16,v41
 v_and_b32 v41,0xffff0000,v41
 v_mfma_f32_32x32x16_bf16 v[120:135],a[196:199],v[176:179],v[120:135]
 ds_write_b128 v18,v[92:95] offset:1024
 v_lshlrev_b32 v42,16,v43
 v_and_b32 v43,0xffff0000,v43
 v_lshlrev_b32 v44,16,v45
 v_mfma_f32_32x32x16_bf16 v[120:135],a[204:207],v[180:183],v[120:135]
 ds_write_b128 v18,v[96:99] offset:2048
 v_and_b32 v45,0xffff0000,v45
 v_lshlrev_b32 v46,16,v47
 v_and_b32 v47,0xffff0000,v47
 v_mfma_f32_32x32x16_bf16 v[120:135],a[212:215],v[184:187],v[120:135]
 v_accvgpr_read_b32 v49,a244
 v_accvgpr_read_b32 v51,a245
 v_accvgpr_read_b32 v53,a246
 s_add_u32 s96,s95,6
 s_and_b32 s96,s96,7
 s_mul_i32 s96,s96,176128
 s_add_u32 s96,s96,s62
 s_add_u32 m0,s54,106496
 s_add_u32 s52,s96,0
 buffer_load_dwordx4 v8,s[20:23],s52 offen lds
 s_add_u32 s96,s96,s60
 s_add_u32 m0,s54,122880
 s_add_u32 s52,s96,0
 buffer_load_dwordx4 v8,s[20:23],s52 offen lds
 v_mfma_f32_32x32x16_bf16 v[120:135],a[220:223],v[188:191],v[120:135]
 ds_write_b128 v18,v[100:103] offset:3072
 v_accvgpr_read_b32 v55,a247
 v_lshlrev_b32 v48,16,v49
 v_and_b32 v49,0xffff0000,v49
 v_mfma_f32_32x32x16_bf16 v[120:135],a[228:231],v[192:195],v[120:135]
 ds_write_b128 v18,v[104:107] offset:4096
 v_lshlrev_b32 v50,16,v51
 v_and_b32 v51,0xffff0000,v51
 v_lshlrev_b32 v52,16,v53
 v_mfma_f32_32x32x16_bf16 v[120:135],a[236:239],v[196:199],v[120:135]
 v_and_b32 v53,0xffff0000,v53
 v_lshlrev_b32 v54,16,v55
 v_and_b32 v55,0xffff0000,v55
 v_mfma_f32_32x32x16_bf16 v[232:247],a[180:183],v[200:203],0
 ds_write_b128 v18,v[108:111] offset:5120
 v_mfma_f32_32x32x16_bf16 v[232:247],a[188:191],v[204:207],v[232:247]
 s_add_u32 s96,s95,7
 s_and_b32 s96,s96,7
 s_mul_i32 s96,s96,176128
 s_add_u32 s96,s96,s62
 s_add_u32 m0,s54,110592
 s_add_u32 s52,s96,0
 buffer_load_dwordx4 v8,s[20:23],s52 offen lds
 s_add_u32 s96,s96,s60
 s_add_u32 m0,s54,126976
 s_add_u32 s52,s96,0
 buffer_load_dwordx4 v8,s[20:23],s52 offen lds
 v_mfma_f32_32x32x16_bf16 v[232:247],a[196:199],v[208:211],v[232:247]
 ds_write_b128 v18,v[112:115] offset:6144
 v_mfma_f32_32x32x16_bf16 v[232:247],a[204:207],v[212:215],v[232:247]
 ds_write_b128 v18,v[116:119] offset:7168
 v_mfma_f32_32x32x16_bf16 v[232:247],a[212:215],v[216:219],v[232:247]
 s_waitcnt lgkmcnt(0)
 s_barrier
 ds_read_b128 v[56:59],v15 offset:0
 ds_read_b128 v[60:63],v15 offset:1024
 v_mfma_f32_32x32x16_bf16 v[232:247],a[220:223],v[220:223],v[232:247]
 ds_read_b128 v[64:67],v15 offset:8192
 ds_read_b128 v[68:71],v15 offset:9216
 ds_read_b128 v[72:75],v15 offset:16384
 v_mfma_f32_32x32x16_bf16 v[232:247],a[228:231],v[224:227],v[232:247]
 ds_read_b128 v[76:79],v15 offset:17408
 ds_read_b128 v[80:83],v15 offset:24576
 ds_read_b128 v[84:87],v15 offset:25600
 v_mfma_f32_32x32x16_bf16 v[232:247],a[236:239],v[228:231],v[232:247]
 s_waitcnt lgkmcnt(7)
 v_pk_add_f32 v[56:57],v[56:57],v[40:41]
 v_pk_add_f32 v[58:59],v[58:59],v[42:43]
 s_waitcnt lgkmcnt(6)
 v_pk_add_f32 v[60:61],v[60:61],v[44:45]
 v_pk_add_f32 v[62:63],v[62:63],v[46:47]
 s_waitcnt lgkmcnt(5)
 v_pk_add_f32 v[56:57],v[56:57],v[64:65]
 v_pk_add_f32 v[58:59],v[58:59],v[66:67]
 s_waitcnt lgkmcnt(4)
 v_pk_add_f32 v[60:61],v[60:61],v[68:69]
 v_pk_add_f32 v[62:63],v[62:63],v[70:71]
 s_waitcnt lgkmcnt(1)
 v_pk_add_f32 v[72:73],v[72:73],v[80:81]
 v_pk_add_f32 v[74:75],v[74:75],v[82:83]
 s_waitcnt lgkmcnt(0)
 v_pk_add_f32 v[76:77],v[76:77],v[84:85]
 v_pk_add_f32 v[78:79],v[78:79],v[86:87]
 s_barrier
 ds_write_b128 v18,v[120:123] offset:0
 v_pk_add_f32 v[56:57],v[56:57],v[72:73]
 v_pk_add_f32 v[58:59],v[58:59],v[74:75]
 v_pk_add_f32 v[60:61],v[60:61],v[76:77]
 v_pk_add_f32 v[62:63],v[62:63],v[78:79]
 ds_write_b128 v18,v[124:127] offset:1024
 v_cvt_pk_bf16_f32 v64,v56,v57
 v_cvt_pk_bf16_f32 v65,v58,v59
 v_cvt_pk_bf16_f32 v66,v60,v61
 v_cvt_pk_bf16_f32 v67,v62,v63
 ds_write_b128 v18,v[128:131] offset:2048
 v_accvgpr_write_b32 a240,v64
 v_or_b32 v64,1,v64
 s_and_b32 s52,s6,1
 s_xor_b32 s52,s52,0
 s_lshl_b32 s52,s52,11
 s_add_u32 s52,s52,s67
 buffer_store_dwordx4 v[64:67],v3,s[32:35],s52 offen sc1
 v_pk_add_f32 v[24:25],v[56:57],v[58:59]
 ds_write_b128 v18,v[132:135] offset:3072
 v_pk_mul_f32 v[26:27],v[56:57],v[56:57]
 v_pk_fma_f32 v[26:27],v[58:59],v[58:59],v[26:27]
 v_pk_add_f32 v[24:25],v[24:25],v[60:61]
 v_pk_fma_f32 v[26:27],v[60:61],v[60:61],v[26:27]
 ds_write_b128 v18,v[232:235] offset:4096
 v_pk_add_f32 v[24:25],v[24:25],v[62:63]
 v_pk_fma_f32 v[26:27],v[62:63],v[62:63],v[26:27]
 v_accvgpr_write_b32 a241,v65
 v_accvgpr_write_b32 a242,v66
 ds_write_b128 v18,v[236:239] offset:5120
 v_accvgpr_write_b32 a243,v67
 ds_write_b128 v18,v[240:243] offset:6144
 ds_write_b128 v18,v[244:247] offset:7168
 s_waitcnt lgkmcnt(0)
 s_barrier
 ds_read_b128 v[56:59],v15 offset:0
 ds_read_b128 v[60:63],v15 offset:1024
 ds_read_b128 v[64:67],v15 offset:8192
 ds_read_b128 v[68:71],v15 offset:9216
 ds_read_b128 v[72:75],v15 offset:16384
 ds_read_b128 v[76:79],v15 offset:17408
 ds_read_b128 v[80:83],v15 offset:24576
 ds_read_b128 v[84:87],v15 offset:25600
 s_add_u32 s52,s56,0
 v_add_u32 v2,s52,v1
 s_waitcnt lgkmcnt(7)
 v_pk_add_f32 v[56:57],v[56:57],v[48:49]
 v_pk_add_f32 v[58:59],v[58:59],v[50:51]
 s_waitcnt lgkmcnt(6)
 v_pk_add_f32 v[60:61],v[60:61],v[52:53]
 v_pk_add_f32 v[62:63],v[62:63],v[54:55]
 s_waitcnt lgkmcnt(5)
 v_pk_add_f32 v[56:57],v[56:57],v[64:65]
 v_pk_add_f32 v[58:59],v[58:59],v[66:67]
 s_waitcnt lgkmcnt(4)
 v_pk_add_f32 v[60:61],v[60:61],v[68:69]
 v_pk_add_f32 v[62:63],v[62:63],v[70:71]
 s_waitcnt lgkmcnt(1)
 v_pk_add_f32 v[72:73],v[72:73],v[80:81]
 v_pk_add_f32 v[74:75],v[74:75],v[82:83]
 s_waitcnt lgkmcnt(0)
 v_pk_add_f32 v[76:77],v[76:77],v[84:85]
 v_pk_add_f32 v[78:79],v[78:79],v[86:87]
 v_pk_add_f32 v[56:57],v[56:57],v[72:73]
 v_pk_add_f32 v[58:59],v[58:59],v[74:75]
 v_pk_add_f32 v[60:61],v[60:61],v[76:77]
 v_pk_add_f32 v[62:63],v[62:63],v[78:79]
 v_cvt_pk_bf16_f32 v64,v56,v57
 v_cvt_pk_bf16_f32 v65,v58,v59
 v_cvt_pk_bf16_f32 v66,v60,v61
 v_cvt_pk_bf16_f32 v67,v62,v63
 v_accvgpr_write_b32 a244,v64
 v_or_b32 v64,1,v64
 s_and_b32 s52,s6,1
 s_xor_b32 s52,s52,1
 s_lshl_b32 s52,s52,11
 s_add_u32 s52,s52,s67
 buffer_store_dwordx4 v[64:67],v3,s[32:35],s52 offen sc1
 v_pk_add_f32 v[24:25],v[24:25],v[56:57]
 v_pk_fma_f32 v[26:27],v[56:57],v[56:57],v[26:27]
 v_pk_add_f32 v[24:25],v[24:25],v[58:59]
 buffer_load_dwordx4 v[136:139],v2,s[32:35],s36 offen sc1
 v_pk_fma_f32 v[26:27],v[58:59],v[58:59],v[26:27]
 v_pk_add_f32 v[24:25],v[24:25],v[60:61]
 v_pk_fma_f32 v[26:27],v[60:61],v[60:61],v[26:27]
 buffer_load_dwordx4 v[140:143],v2,s[32:35],s36 offen offset:1024 sc1
 v_pk_add_f32 v[24:25],v[24:25],v[62:63]
 v_pk_fma_f32 v[26:27],v[62:63],v[62:63],v[26:27]
 v_accvgpr_write_b32 a245,v65
 buffer_load_dwordx4 v[152:155],v2,s[32:35],s37 offen sc1
 v_accvgpr_write_b32 a246,v66
 v_accvgpr_write_b32 a247,v67
 v_add_f32 v24,v24,v25
 buffer_load_dwordx4 v[156:159],v2,s[32:35],s37 offen offset:1024 sc1
 v_add_f32 v26,v26,v27
 v_and_b32 v27,512,v3
 v_add_u32 v27,v27,v3
 buffer_load_dwordx4 v[168:171],v2,s[32:35],s38 offen sc1
 v_permlane16_swap_b32 v24,v26
 v_add_f32 v24,v24,v26
 v_mov_b32 v25,v24
 buffer_load_dwordx4 v[172:175],v2,s[32:35],s38 offen offset:1024 sc1
 s_nop 0
 v_permlane32_swap_b32 v24,v25
 v_add_f32 v24,v24,v25
 v_or_b32 v24,1,v24
 buffer_load_dwordx4 v[184:187],v2,s[32:35],s39 offen sc1
 s_mov_b32 exec_hi,0
 s_add_u32 s52,s79,0
 buffer_store_dword v24,v27,s[32:35],s52 offen sc1
 s_mov_b64 exec,-1
 buffer_load_dwordx4 v[188:191],v2,s[32:35],s39 offen offset:1024 sc1
 buffer_load_dwordx4 v[200:203],v2,s[32:35],s40 offen sc1
 buffer_load_dwordx4 v[204:207],v2,s[32:35],s40 offen offset:1024 sc1
 buffer_load_dwordx4 v[216:219],v2,s[32:35],s41 offen sc1
 v_max_u32 v35,v22,v23
 v_max3_u32 v35,v34,v34,v35
 v_cmp_eq_u32 s[82:83],-1,v35
 s_nop 0
 s_cmp_lg_u64 s[82:83],0
 s_cbranch_scc1 Lfix_371
Lret_372:
 s_waitcnt vmcnt(14)
 s_barrier
 ds_read_b64_tr_b16 v[40:41],v5 offset:0
 ds_read_b64_tr_b16 v[42:43],v5 offset:512
 ds_read_b64_tr_b16 v[44:45],v5 offset:16384
 ds_read_b64_tr_b16 v[46:47],v5 offset:16896
 ds_read_b64_tr_b16 v[48:49],v5 offset:1024
 ds_read_b64_tr_b16 v[50:51],v5 offset:1536
 ds_read_b64_tr_b16 v[52:53],v5 offset:17408
 ds_read_b64_tr_b16 v[54:55],v5 offset:17920
 s_waitcnt vmcnt(10)
 v_bitop3_b32 v38,v136,v140,1 bitop3:0x80
 v_cmp_eq_u32 vcc,0,v38
 s_cbranch_vccnz Lfix_374
Lret_375:
 s_waitcnt lgkmcnt(4)
 v_mfma_f32_32x32x16_bf16 v[88:103],v[40:43],v[136:139],0
 ds_read_b64_tr_b16 v[40:41],v5 offset:4096
 ds_read_b64_tr_b16 v[42:43],v5 offset:4608
 buffer_load_dwordx4 v[220:223],v2,s[32:35],s41 offen offset:1024 sc1
 v_mov_b32 v26,0
 v_mfma_f32_32x32x16_bf16 v[104:119],v[44:47],v[136:139],0
 ds_read_b64_tr_b16 v[44:45],v5 offset:20480
 ds_read_b64_tr_b16 v[46:47],v5 offset:20992
 v_mov_b32 v27,0
 s_waitcnt vmcnt(9) lgkmcnt(4)
 v_mfma_f32_32x32x16_bf16 v[88:103],v[48:51],v[140:143],v[88:103]
 ds_read_b64_tr_b16 v[48:49],v5 offset:5120
 ds_read_b64_tr_b16 v[50:51],v5 offset:5632
 buffer_load_dwordx4 v[232:235],v2,s[32:35],s42 offen sc1
 v_bitop3_b32 v38,v152,v156,1 bitop3:0x80
 v_cmp_eq_u32 vcc,0,v38
 v_mfma_f32_32x32x16_bf16 v[104:119],v[52:55],v[140:143],v[104:119]
 ds_read_b64_tr_b16 v[52:53],v5 offset:21504
 ds_read_b64_tr_b16 v[54:55],v5 offset:22016
 v_mov_b32 v30,0
 s_cbranch_vccnz Lfix_377
Lret_378:
 s_waitcnt lgkmcnt(4)
 v_mfma_f32_32x32x16_bf16 v[88:103],v[40:43],v[152:155],v[88:103]
 ds_read_b64_tr_b16 v[40:41],v5 offset:8192
 ds_read_b64_tr_b16 v[42:43],v5 offset:8704
 buffer_load_dwordx4 v[236:239],v2,s[32:35],s42 offen offset:1024 sc1
 v_mov_b32 v31,0
 v_mfma_f32_32x32x16_bf16 v[104:119],v[44:47],v[152:155],v[104:119]
 ds_read_b64_tr_b16 v[44:45],v5 offset:24576
 ds_read_b64_tr_b16 v[46:47],v5 offset:25088
 v_mov_b32 v32,0x3f803f80
 s_waitcnt vmcnt(9) lgkmcnt(4)
 v_mfma_f32_32x32x16_bf16 v[88:103],v[48:51],v[156:159],v[88:103]
 ds_read_b64_tr_b16 v[48:49],v5 offset:9216
 ds_read_b64_tr_b16 v[50:51],v5 offset:9728
 buffer_load_dwordx4 v[248:251],v2,s[32:35],s43 offen sc1
 v_bitop3_b32 v38,v168,v172,1 bitop3:0x80
 v_cmp_eq_u32 vcc,0,v38
 v_mfma_f32_32x32x16_bf16 v[104:119],v[52:55],v[156:159],v[104:119]
 ds_read_b64_tr_b16 v[52:53],v5 offset:25600
 ds_read_b64_tr_b16 v[54:55],v5 offset:26112
 v_mov_b32 v33,0x3f803f80
 s_cbranch_vccnz Lfix_380
Lret_381:
 s_waitcnt lgkmcnt(4)
 v_mfma_f32_32x32x16_bf16 v[88:103],v[40:43],v[168:171],v[88:103]
 ds_read_b64_tr_b16 v[40:41],v5 offset:12288
 ds_read_b64_tr_b16 v[42:43],v5 offset:12800
 buffer_load_dwordx4 v[252:255],v2,s[32:35],s43 offen offset:1024 sc1
 v_mfma_f32_32x32x16_bf16 v[104:119],v[44:47],v[168:171],v[104:119]
 ds_read_b64_tr_b16 v[44:45],v5 offset:28672
 ds_read_b64_tr_b16 v[46:47],v5 offset:29184
 s_waitcnt vmcnt(8) lgkmcnt(4)
 v_mfma_f32_32x32x16_bf16 v[88:103],v[48:51],v[172:175],v[88:103]
 ds_read_b64_tr_b16 v[48:49],v5 offset:13312
 ds_read_b64_tr_b16 v[50:51],v5 offset:13824
 buffer_load_dwordx4 v[144:147],v2,s[32:35],s8 offen sc1
 v_bitop3_b32 v38,v184,v188,1 bitop3:0x80
 v_cmp_eq_u32 vcc,0,v38
 v_mfma_f32_32x32x16_bf16 v[104:119],v[52:55],v[172:175],v[104:119]
 ds_read_b64_tr_b16 v[52:53],v5 offset:29696
 ds_read_b64_tr_b16 v[54:55],v5 offset:30208
 s_cbranch_vccnz Lfix_383
Lret_384:
 s_waitcnt lgkmcnt(4)
 v_mfma_f32_32x32x16_bf16 v[88:103],v[40:43],v[184:187],v[88:103]
 ds_read_b64_tr_b16 v[40:41],v5 offset:32768
 ds_read_b64_tr_b16 v[42:43],v5 offset:33280
 buffer_load_dwordx4 v[148:151],v2,s[32:35],s8 offen offset:1024 sc1
 v_mfma_f32_32x32x16_bf16 v[104:119],v[44:47],v[184:187],v[104:119]
 ds_read_b64_tr_b16 v[44:45],v5 offset:49152
 ds_read_b64_tr_b16 v[46:47],v5 offset:49664
 s_waitcnt vmcnt(8) lgkmcnt(4)
 v_mfma_f32_32x32x16_bf16 v[88:103],v[48:51],v[188:191],v[88:103]
 ds_read_b64_tr_b16 v[48:49],v5 offset:33792
 ds_read_b64_tr_b16 v[50:51],v5 offset:34304
 buffer_load_dwordx4 v[160:163],v2,s[32:35],s9 offen sc1
 v_bitop3_b32 v38,v200,v204,1 bitop3:0x80
 v_cmp_eq_u32 vcc,0,v38
 v_mfma_f32_32x32x16_bf16 v[104:119],v[52:55],v[188:191],v[104:119]
 ds_read_b64_tr_b16 v[52:53],v5 offset:50176
 ds_read_b64_tr_b16 v[54:55],v5 offset:50688
 s_cbranch_vccnz Lfix_386
Lret_387:
 s_waitcnt lgkmcnt(4)
 v_mfma_f32_32x32x16_bf16 v[88:103],v[40:43],v[200:203],v[88:103]
 ds_read_b64_tr_b16 v[40:41],v5 offset:36864
 ds_read_b64_tr_b16 v[42:43],v5 offset:37376
 buffer_load_dwordx4 v[164:167],v2,s[32:35],s9 offen offset:1024 sc1
 v_mfma_f32_32x32x16_bf16 v[104:119],v[44:47],v[200:203],v[104:119]
 ds_read_b64_tr_b16 v[44:45],v5 offset:53248
 ds_read_b64_tr_b16 v[46:47],v5 offset:53760
 s_waitcnt vmcnt(8) lgkmcnt(4)
 v_mfma_f32_32x32x16_bf16 v[88:103],v[48:51],v[204:207],v[88:103]
 ds_read_b64_tr_b16 v[48:49],v5 offset:37888
 ds_read_b64_tr_b16 v[50:51],v5 offset:38400
 s_add_u32 s84,s58,0
 buffer_load_dwordx4 v[72:75],v13,s[32:35],s84 offen sc1
 buffer_load_dwordx4 v[76:79],v13,s[32:35],s84 offen offset:512 sc1
 buffer_load_dwordx4 v[176:179],v2,s[32:35],s10 offen sc1
 v_bitop3_b32 v38,v216,v220,1 bitop3:0x80
 v_cmp_eq_u32 vcc,0,v38
 v_mfma_f32_32x32x16_bf16 v[104:119],v[52:55],v[204:207],v[104:119]
 ds_read_b64_tr_b16 v[52:53],v5 offset:54272
 ds_read_b64_tr_b16 v[54:55],v5 offset:54784
 s_cbranch_vccnz Lfix_389
Lret_390:
 s_waitcnt lgkmcnt(4)
 v_mfma_f32_32x32x16_bf16 v[88:103],v[40:43],v[216:219],v[88:103]
 ds_read_b64_tr_b16 v[40:41],v5 offset:40960
 ds_read_b64_tr_b16 v[42:43],v5 offset:41472
 buffer_load_dwordx4 v[180:183],v2,s[32:35],s10 offen offset:1024 sc1
 v_mfma_f32_32x32x16_bf16 v[104:119],v[44:47],v[216:219],v[104:119]
 ds_read_b64_tr_b16 v[44:45],v5 offset:57344
 ds_read_b64_tr_b16 v[46:47],v5 offset:57856
 s_waitcnt vmcnt(10) lgkmcnt(4)
 v_mfma_f32_32x32x16_bf16 v[88:103],v[48:51],v[220:223],v[88:103]
 ds_read_b64_tr_b16 v[48:49],v5 offset:41984
 ds_read_b64_tr_b16 v[50:51],v5 offset:42496
 buffer_load_dwordx4 v[192:195],v2,s[32:35],s11 offen sc1
 v_bitop3_b32 v38,v232,v236,1 bitop3:0x80
 v_cmp_eq_u32 vcc,0,v38
 v_mfma_f32_32x32x16_bf16 v[104:119],v[52:55],v[220:223],v[104:119]
 ds_read_b64_tr_b16 v[52:53],v5 offset:58368
 ds_read_b64_tr_b16 v[54:55],v5 offset:58880
 s_cbranch_vccnz Lfix_392
Lret_393:
 s_waitcnt lgkmcnt(4)
 v_mfma_f32_32x32x16_bf16 v[88:103],v[40:43],v[232:235],v[88:103]
 ds_read_b64_tr_b16 v[40:41],v5 offset:45056
 ds_read_b64_tr_b16 v[42:43],v5 offset:45568
 buffer_load_dwordx4 v[196:199],v2,s[32:35],s11 offen offset:1024 sc1
 v_mfma_f32_32x32x16_bf16 v[104:119],v[44:47],v[232:235],v[104:119]
 ds_read_b64_tr_b16 v[44:45],v5 offset:61440
 ds_read_b64_tr_b16 v[46:47],v5 offset:61952
 s_waitcnt vmcnt(10) lgkmcnt(4)
 v_mfma_f32_32x32x16_bf16 v[88:103],v[48:51],v[236:239],v[88:103]
 ds_read_b64_tr_b16 v[48:49],v5 offset:46080
 ds_read_b64_tr_b16 v[50:51],v5 offset:46592
 buffer_load_dwordx4 v[208:211],v2,s[32:35],s57 offen sc1
 v_bitop3_b32 v38,v248,v252,1 bitop3:0x80
 v_cmp_eq_u32 vcc,0,v38
 v_mfma_f32_32x32x16_bf16 v[104:119],v[52:55],v[236:239],v[104:119]
 ds_read_b64_tr_b16 v[52:53],v5 offset:62464
 ds_read_b64_tr_b16 v[54:55],v5 offset:62976
 s_cbranch_vccnz Lfix_395
Lret_396:
 s_waitcnt lgkmcnt(4)
 v_mfma_f32_32x32x16_bf16 v[88:103],v[40:43],v[248:251],v[88:103]
 ds_read_b64_tr_b16 v[40:41],v5 offset:2048
 ds_read_b64_tr_b16 v[42:43],v5 offset:2560
 buffer_load_dwordx4 v[212:215],v2,s[32:35],s57 offen offset:1024 sc1
 v_mfma_f32_32x32x16_bf16 v[104:119],v[44:47],v[248:251],v[104:119]
 ds_read_b64_tr_b16 v[44:45],v5 offset:18432
 ds_read_b64_tr_b16 v[46:47],v5 offset:18944
 s_waitcnt vmcnt(10) lgkmcnt(4)
 v_mfma_f32_32x32x16_bf16 v[88:103],v[48:51],v[252:255],v[88:103]
 ds_read_b64_tr_b16 v[48:49],v5 offset:3072
 ds_read_b64_tr_b16 v[50:51],v5 offset:3584
 buffer_load_dwordx4 v[224:227],v2,s[32:35],s77 offen sc1
 v_bitop3_b32 v38,v144,v148,1 bitop3:0x80
 v_cmp_eq_u32 vcc,0,v38
 v_mfma_f32_32x32x16_bf16 v[104:119],v[52:55],v[252:255],v[104:119]
 ds_read_b64_tr_b16 v[52:53],v5 offset:19456
 ds_read_b64_tr_b16 v[54:55],v5 offset:19968
 s_cbranch_vccnz Lfix_398
Lret_399:
 s_waitcnt lgkmcnt(4)
 v_mfma_f32_32x32x16_bf16 v[88:103],v[40:43],v[144:147],v[88:103]
 ds_read_b64_tr_b16 v[40:41],v5 offset:6144
 ds_read_b64_tr_b16 v[42:43],v5 offset:6656
 buffer_load_dwordx4 v[228:231],v2,s[32:35],s77 offen offset:1024 sc1
 s_add_u32 s96,s95,0
 s_and_b32 s96,s96,7
 s_mul_i32 s96,s96,176128
 s_add_u32 s96,s96,s63
 s_add_u32 m0,s54,131072
 s_add_u32 s52,s96,0
 buffer_load_dwordx4 v8,s[20:23],s52 offen lds
 v_mfma_f32_32x32x16_bf16 v[104:119],v[44:47],v[144:147],v[104:119]
 ds_read_b64_tr_b16 v[44:45],v5 offset:22528
 ds_read_b64_tr_b16 v[46:47],v5 offset:23040
 s_waitcnt vmcnt(11) lgkmcnt(4)
 v_mfma_f32_32x32x16_bf16 v[88:103],v[48:51],v[148:151],v[88:103]
 ds_read_b64_tr_b16 v[48:49],v5 offset:7168
 ds_read_b64_tr_b16 v[50:51],v5 offset:7680
 buffer_load_dwordx4 v[240:243],v2,s[32:35],s81 offen sc1
 s_add_u32 s96,s95,1
 s_and_b32 s96,s96,7
 s_mul_i32 s96,s96,176128
 s_add_u32 s96,s96,s63
 s_add_u32 m0,s54,135168
 s_add_u32 s52,s96,0
 buffer_load_dwordx4 v8,s[20:23],s52 offen lds
 v_bitop3_b32 v38,v160,v164,1 bitop3:0x80
 v_cmp_eq_u32 vcc,0,v38
 v_mfma_f32_32x32x16_bf16 v[104:119],v[52:55],v[148:151],v[104:119]
 ds_read_b64_tr_b16 v[52:53],v5 offset:23552
 ds_read_b64_tr_b16 v[54:55],v5 offset:24064
 s_cbranch_vccnz Lfix_401
Lret_402:
 s_waitcnt lgkmcnt(4)
 v_mfma_f32_32x32x16_bf16 v[88:103],v[40:43],v[160:163],v[88:103]
 ds_read_b64_tr_b16 v[40:41],v5 offset:10240
 ds_read_b64_tr_b16 v[42:43],v5 offset:10752
 buffer_load_dwordx4 v[244:247],v2,s[32:35],s81 offen offset:1024 sc1
 s_add_u32 s96,s95,2
 s_and_b32 s96,s96,7
 s_mul_i32 s96,s96,176128
 s_add_u32 s96,s96,s63
 s_add_u32 m0,s54,139264
 s_add_u32 s52,s96,0
 buffer_load_dwordx4 v8,s[20:23],s52 offen lds
 v_mfma_f32_32x32x16_bf16 v[104:119],v[44:47],v[160:163],v[104:119]
 ds_read_b64_tr_b16 v[44:45],v5 offset:26624
 ds_read_b64_tr_b16 v[46:47],v5 offset:27136
 s_waitcnt vmcnt(11) lgkmcnt(4)
 v_mfma_f32_32x32x16_bf16 v[88:103],v[48:51],v[164:167],v[88:103]
 ds_read_b64_tr_b16 v[48:49],v5 offset:11264
 ds_read_b64_tr_b16 v[50:51],v5 offset:11776
 buffer_load_dwordx4 a[248:251],v2,s[32:35],s99 offen sc1
 s_add_u32 s96,s95,3
 s_and_b32 s96,s96,7
 s_mul_i32 s96,s96,176128
 s_add_u32 s96,s96,s63
 s_add_u32 m0,s54,143360
 s_add_u32 s52,s96,0
 buffer_load_dwordx4 v8,s[20:23],s52 offen lds
 v_bitop3_b32 v38,v176,v180,1 bitop3:0x80
 v_cmp_eq_u32 vcc,0,v38
 v_mfma_f32_32x32x16_bf16 v[104:119],v[52:55],v[164:167],v[104:119]
 ds_read_b64_tr_b16 v[52:53],v5 offset:27648
 ds_read_b64_tr_b16 v[54:55],v5 offset:28160
 v_and_b32 v38,v72,v73
 v_bitop3_b32 v38,v74,v75,v38 bitop3:0x80
 v_bitop3_b32 v38,v76,v77,v38 bitop3:0x80
 v_bitop3_b32 v38,v78,v79,v38 bitop3:0x80
 v_and_b32 v38,1,v38
 v_cmp_eq_u32 s[82:83],0,v38
 s_nop 0
 s_cmp_lg_u64 s[82:83],0
 s_cbranch_scc1 Lfix_407
Lret_408:
 v_add_f32 v72,v72,v73
 s_cbranch_vccnz Lfix_404
Lret_405:
 s_waitcnt lgkmcnt(4)
 v_mfma_f32_32x32x16_bf16 v[88:103],v[40:43],v[176:179],v[88:103]
 ds_read_b64_tr_b16 v[40:41],v5 offset:14336
 ds_read_b64_tr_b16 v[42:43],v5 offset:14848
 buffer_load_dwordx4 a[252:255],v2,s[32:35],s99 offen offset:1024 sc1
 s_add_u32 s96,s95,4
 s_and_b32 s96,s96,7
 s_mul_i32 s96,s96,176128
 s_add_u32 s96,s96,s63
 s_add_u32 m0,s54,147456
 s_add_u32 s52,s96,0
 buffer_load_dwordx4 v8,s[20:23],s52 offen lds
 v_add_f32 v74,v74,v75
 v_add_f32 v76,v76,v77
 v_mfma_f32_32x32x16_bf16 v[104:119],v[44:47],v[176:179],v[104:119]
 ds_read_b64_tr_b16 v[44:45],v5 offset:30720
 ds_read_b64_tr_b16 v[46:47],v5 offset:31232
 v_add_f32 v78,v78,v79
 v_add_f32 v72,v72,v74
 s_waitcnt vmcnt(13) lgkmcnt(4)
 v_mfma_f32_32x32x16_bf16 v[88:103],v[48:51],v[180:183],v[88:103]
 ds_read_b64_tr_b16 v[48:49],v5 offset:15360
 ds_read_b64_tr_b16 v[50:51],v5 offset:15872
 s_add_u32 s96,s95,5
 s_and_b32 s96,s96,7
 s_mul_i32 s96,s96,176128
 s_add_u32 s96,s96,s63
 s_add_u32 m0,s54,151552
 s_add_u32 s52,s96,0
 buffer_load_dwordx4 v8,s[20:23],s52 offen lds
 v_bitop3_b32 v38,v192,v196,1 bitop3:0x80
 v_cmp_eq_u32 vcc,0,v38
 v_mfma_f32_32x32x16_bf16 v[104:119],v[52:55],v[180:183],v[104:119]
 ds_read_b64_tr_b16 v[52:53],v5 offset:31744
 ds_read_b64_tr_b16 v[54:55],v5 offset:32256
 v_add_f32 v76,v76,v78
 v_add_f32 v72,v72,v76
 s_cbranch_vccnz Lfix_410
Lret_411:
 s_waitcnt lgkmcnt(4)
 v_mfma_f32_32x32x16_bf16 v[88:103],v[40:43],v[192:195],v[88:103]
 ds_read_b64_tr_b16 v[40:41],v5 offset:34816
 ds_read_b64_tr_b16 v[42:43],v5 offset:35328
 s_add_u32 s96,s95,6
 s_and_b32 s96,s96,7
 s_mul_i32 s96,s96,176128
 s_add_u32 s96,s96,s63
 s_add_u32 m0,s54,155648
 s_add_u32 s52,s96,0
 buffer_load_dwordx4 v8,s[20:23],s52 offen lds
 v_mov_b32 v73,v72
 s_nop 1
 v_permlane32_swap_b32 v72,v73
 v_mfma_f32_32x32x16_bf16 v[104:119],v[44:47],v[192:195],v[104:119]
 ds_read_b64_tr_b16 v[44:45],v5 offset:51200
 ds_read_b64_tr_b16 v[46:47],v5 offset:51712
 v_mul_f32 v72,s74,v72
 v_cndmask_b32_e64 v72,0,-v72,s[92:93]
 s_waitcnt vmcnt(13) lgkmcnt(4)
 v_mfma_f32_32x32x16_bf16 v[88:103],v[48:51],v[196:199],v[88:103]
 ds_read_b64_tr_b16 v[48:49],v5 offset:35840
 ds_read_b64_tr_b16 v[50:51],v5 offset:36352
 s_add_u32 s96,s95,7
 s_and_b32 s96,s96,7
 s_mul_i32 s96,s96,176128
 s_add_u32 s96,s96,s63
 s_add_u32 m0,s54,159744
 s_add_u32 s52,s96,0
 buffer_load_dwordx4 v8,s[20:23],s52 offen lds
 v_bitop3_b32 v38,v208,v212,1 bitop3:0x80
 v_cmp_eq_u32 vcc,0,v38
 v_mfma_f32_32x32x16_bf16 v[104:119],v[52:55],v[196:199],v[104:119]
 ds_read_b64_tr_b16 v[52:53],v5 offset:52224
 ds_read_b64_tr_b16 v[54:55],v5 offset:52736
 v_cvt_pk_bf16_f32 v24,v72,v72
 v_lshlrev_b32 v74,16,v24
 s_cbranch_vccnz Lfix_413
Lret_414:
 s_waitcnt lgkmcnt(4)
 v_mfma_f32_32x32x16_bf16 v[88:103],v[40:43],v[208:211],v[88:103]
 ds_read_b64_tr_b16 v[40:41],v5 offset:38912
 ds_read_b64_tr_b16 v[42:43],v5 offset:39424
 v_sub_f32 v72,v72,v74
 v_cvt_pk_bf16_f32 v25,v72,v72
 v_mfma_f32_32x32x16_bf16 v[104:119],v[44:47],v[208:211],v[104:119]
 ds_read_b64_tr_b16 v[44:45],v5 offset:55296
 ds_read_b64_tr_b16 v[46:47],v5 offset:55808
 s_waitcnt vmcnt(12) lgkmcnt(4)
 v_mfma_f32_32x32x16_bf16 v[88:103],v[48:51],v[212:215],v[88:103]
 ds_read_b64_tr_b16 v[48:49],v5 offset:39936
 ds_read_b64_tr_b16 v[50:51],v5 offset:40448
 v_bitop3_b32 v38,v224,v228,1 bitop3:0x80
 v_cmp_eq_u32 vcc,0,v38
 v_mfma_f32_32x32x16_bf16 v[104:119],v[52:55],v[212:215],v[104:119]
 ds_read_b64_tr_b16 v[52:53],v5 offset:56320
 ds_read_b64_tr_b16 v[54:55],v5 offset:56832
 s_cbranch_vccnz Lfix_416
Lret_417:
 s_waitcnt lgkmcnt(4)
 v_mfma_f32_32x32x16_bf16 v[88:103],v[40:43],v[224:227],v[88:103]
 ds_read_b64_tr_b16 v[40:41],v5 offset:43008
 ds_read_b64_tr_b16 v[42:43],v5 offset:43520
 s_waitcnt lgkmcnt(0)
 s_barrier
 s_bfe_u32 s96,s45,0x5000a
 s_lshl_b32 s96,s96,16
 s_add_u32 s96,s96,s66
 s_add_u32 m0,s54,65536
 s_add_u32 s52,s96,0
 buffer_load_dwordx4 v9,s[24:27],s52 offen lds
 s_add_u32 m0,s54,69632
 s_add_u32 s52,s96,8192
 buffer_load_dwordx4 v9,s[24:27],s52 offen lds
 v_mfma_f32_32x32x16_bf16 v[104:119],v[44:47],v[224:227],v[104:119]
 ds_read_b64_tr_b16 v[44:45],v5 offset:59392
 ds_read_b64_tr_b16 v[46:47],v5 offset:59904
 s_bfe_u32 s96,s45,0x5000f
 s_lshl_b32 s96,s96,16
 s_add_u32 s96,s96,s66
 s_add_u32 m0,s54,73728
 s_add_u32 s52,s96,0
 buffer_load_dwordx4 v9,s[24:27],s52 offen lds
 s_add_u32 m0,s54,77824
 s_add_u32 s52,s96,8192
 buffer_load_dwordx4 v9,s[24:27],s52 offen lds
 s_bfe_u32 s96,s45,0x50014
 s_lshl_b32 s96,s96,16
 s_add_u32 s96,s96,s66
 s_add_u32 m0,s54,81920
 s_add_u32 s52,s96,0
 buffer_load_dwordx4 v9,s[24:27],s52 offen lds
 s_add_u32 m0,s54,86016
 s_add_u32 s52,s96,8192
 buffer_load_dwordx4 v9,s[24:27],s52 offen lds
 s_waitcnt vmcnt(14)
 v_mfma_f32_32x32x16_bf16 v[88:103],v[48:51],v[228:231],v[88:103]
 ds_read_b64_tr_b16 v[48:49],v5 offset:44032
 ds_read_b64_tr_b16 v[50:51],v5 offset:44544
 v_bitop3_b32 v38,v240,v244,1 bitop3:0x80
 v_cmp_eq_u32 vcc,0,v38
 v_mfma_f32_32x32x16_bf16 v[104:119],v[52:55],v[228:231],v[104:119]
 ds_read_b64_tr_b16 v[52:53],v5 offset:60416
 ds_read_b64_tr_b16 v[54:55],v5 offset:60928
 s_bfe_u32 s96,s45,0x50019
 s_lshl_b32 s96,s96,16
 s_add_u32 s96,s96,s66
 s_add_u32 m0,s54,90112
 s_add_u32 s52,s96,0
 buffer_load_dwordx4 v9,s[24:27],s52 offen lds
 s_add_u32 m0,s54,94208
 s_add_u32 s52,s96,8192
 buffer_load_dwordx4 v9,s[24:27],s52 offen lds
 s_cbranch_vccnz Lfix_419
Lret_420:
 s_waitcnt lgkmcnt(4)
 v_mfma_f32_32x32x16_bf16 v[88:103],v[40:43],v[240:243],v[88:103]
 ds_read_b64_tr_b16 v[40:41],v5 offset:47104
 ds_read_b64_tr_b16 v[42:43],v5 offset:47616
 v_mfma_f32_32x32x16_bf16 v[104:119],v[44:47],v[240:243],v[104:119]
 ds_read_b64_tr_b16 v[44:45],v5 offset:63488
 ds_read_b64_tr_b16 v[46:47],v5 offset:64000
 s_waitcnt vmcnt(12) lgkmcnt(4)
 v_mfma_f32_32x32x16_bf16 v[88:103],v[48:51],v[244:247],v[88:103]
 ds_read_b64_tr_b16 v[48:49],v5 offset:48128
 ds_read_b64_tr_b16 v[50:51],v5 offset:48640
 v_accvgpr_read_b32 v38,a248
 v_lshlrev_b32 v38,31,v38
 v_cmp_eq_u32 s[82:83],0,v38
 v_accvgpr_read_b32 v38,a252
 v_lshlrev_b32 v38,31,v38
 v_cmp_eq_u32 vcc,0,v38
 s_nop 1
 s_or_b64 vcc,vcc,s[82:83]
 v_mfma_f32_32x32x16_bf16 v[104:119],v[52:55],v[244:247],v[104:119]
 ds_read_b64_tr_b16 v[52:53],v5 offset:64512
 ds_read_b64_tr_b16 v[54:55],v5 offset:65024
 s_cbranch_vccnz Lfix_422
Lret_423:
 s_waitcnt lgkmcnt(4)
 v_mfma_f32_32x32x16_bf16 v[88:103],v[40:43],a[248:251],v[88:103]
 v_mfma_f32_32x32x16_bf16 v[104:119],v[44:47],a[248:251],v[104:119]
 s_waitcnt lgkmcnt(0)
 v_mfma_f32_32x32x16_bf16 v[88:103],v[48:51],a[252:255],v[88:103]
 v_mfma_f32_32x32x16_bf16 v[104:119],v[52:55],a[252:255],v[104:119]
 v_mov_b32 v28,v22
 v_mov_b32 v29,v22
 s_nop 1
 v_mfma_f32_32x32x16_bf16 v[88:103],v[28:31],v[24:27],v[88:103]
 v_mov_b32 v28,v23
 v_mov_b32 v29,v23
 s_nop 1
 v_mfma_f32_32x32x16_bf16 v[104:119],v[28:31],v[24:27],v[104:119]
 s_waitcnt vmcnt(8)
 s_barrier
 ds_read_b64_tr_b16 v[40:41],v6 offset:0
 ds_read_b64_tr_b16 v[42:43],v6 offset:512
 ds_read_b64_tr_b16 v[44:45],v6 offset:1024
 ds_read_b64_tr_b16 v[46:47],v6 offset:1536
 ds_read_b64_tr_b16 v[48:49],v6 offset:2048
 ds_read_b64_tr_b16 v[50:51],v6 offset:2560
 ds_read_b64_tr_b16 v[52:53],v6 offset:3072
 ds_read_b64_tr_b16 v[54:55],v6 offset:3584
 s_waitcnt lgkmcnt(6)
 v_mfma_f32_32x32x16_bf16 v[120:135],v[40:43],v[136:139],0
 ds_read_b64_tr_b16 v[40:41],v6 offset:4096
 ds_read_b64_tr_b16 v[42:43],v6 offset:4608
 s_waitcnt lgkmcnt(6)
 v_mfma_f32_32x32x16_bf16 v[120:135],v[44:47],v[140:143],v[120:135]
 ds_read_b64_tr_b16 v[44:45],v6 offset:5120
 ds_read_b64_tr_b16 v[46:47],v6 offset:5632
 s_waitcnt lgkmcnt(6)
 v_mfma_f32_32x32x16_bf16 v[120:135],v[48:51],v[144:147],v[120:135]
 v_cvt_pk_bf16_f32 v88,v88,v89
 v_cvt_pk_bf16_f32 v89,v90,v91
 v_cvt_pk_bf16_f32 v90,v92,v93
 ds_read_b64_tr_b16 v[48:49],v6 offset:6144
 ds_read_b64_tr_b16 v[50:51],v6 offset:6656
 s_waitcnt lgkmcnt(6)
 v_mfma_f32_32x32x16_bf16 v[120:135],v[52:55],v[148:151],v[120:135]
 v_cvt_pk_bf16_f32 v91,v94,v95
 v_cvt_pk_bf16_f32 v92,v96,v97
 v_cvt_pk_bf16_f32 v93,v98,v99
 ds_read_b64_tr_b16 v[52:53],v6 offset:7168
 ds_read_b64_tr_b16 v[54:55],v6 offset:7680
 s_waitcnt lgkmcnt(6)
 v_mfma_f32_32x32x16_bf16 v[120:135],v[40:43],v[152:155],v[120:135]
 v_cvt_pk_bf16_f32 v94,v100,v101
 v_cvt_pk_bf16_f32 v95,v102,v103
 v_pk_max_i16 v88,v88,0
 ds_read_b64_tr_b16 v[40:41],v6 offset:8192
 ds_read_b64_tr_b16 v[42:43],v6 offset:8704
 s_waitcnt lgkmcnt(6)
 v_mfma_f32_32x32x16_bf16 v[120:135],v[44:47],v[156:159],v[120:135]
 v_pk_max_i16 v89,v89,0
 v_pk_max_i16 v90,v90,0
 v_pk_max_i16 v91,v91,0
 ds_read_b64_tr_b16 v[44:45],v6 offset:9216
 ds_read_b64_tr_b16 v[46:47],v6 offset:9728
 s_waitcnt lgkmcnt(6)
 v_mfma_f32_32x32x16_bf16 v[120:135],v[48:51],v[160:163],v[120:135]
 v_pk_max_i16 v92,v92,0
 v_pk_max_i16 v93,v93,0
 v_pk_max_i16 v94,v94,0
 ds_read_b64_tr_b16 v[48:49],v6 offset:10240
 ds_read_b64_tr_b16 v[50:51],v6 offset:10752
 s_waitcnt lgkmcnt(6)
 v_mfma_f32_32x32x16_bf16 v[120:135],v[52:55],v[164:167],v[120:135]
 v_pk_max_i16 v95,v95,0
 v_or_b32 v88,0x80000000,v88
 v_or_b32 v92,0x80000000,v92
 ds_read_b64_tr_b16 v[52:53],v6 offset:11264
 ds_read_b64_tr_b16 v[54:55],v6 offset:11776
 s_waitcnt lgkmcnt(6)
 v_mfma_f32_32x32x16_bf16 v[120:135],v[40:43],v[168:171],v[120:135]
 s_add_u32 s52,s64,0
 buffer_store_dwordx4 v[88:91],v1,s[32:35],s52 offen sc1
 s_add_u32 s52,s64,0
 buffer_store_dwordx4 v[92:95],v1,s[32:35],s52 offen offset:1024 sc1
 v_cvt_pk_bf16_f32 v104,v104,v105
 v_cvt_pk_bf16_f32 v105,v106,v107
 ds_read_b64_tr_b16 v[40:41],v6 offset:12288
 ds_read_b64_tr_b16 v[42:43],v6 offset:12800
 s_waitcnt lgkmcnt(6)
 v_mfma_f32_32x32x16_bf16 v[120:135],v[44:47],v[172:175],v[120:135]
 v_cvt_pk_bf16_f32 v106,v108,v109
 v_cvt_pk_bf16_f32 v107,v110,v111
 v_cvt_pk_bf16_f32 v108,v112,v113
 ds_read_b64_tr_b16 v[44:45],v6 offset:13312
 ds_read_b64_tr_b16 v[46:47],v6 offset:13824
 s_waitcnt lgkmcnt(6)
 v_mfma_f32_32x32x16_bf16 v[120:135],v[48:51],v[176:179],v[120:135]
 v_cvt_pk_bf16_f32 v109,v114,v115
 v_cvt_pk_bf16_f32 v110,v116,v117
 v_cvt_pk_bf16_f32 v111,v118,v119
 ds_read_b64_tr_b16 v[48:49],v6 offset:14336
 ds_read_b64_tr_b16 v[50:51],v6 offset:14848
 s_waitcnt lgkmcnt(6)
 v_mfma_f32_32x32x16_bf16 v[120:135],v[52:55],v[180:183],v[120:135]
 v_pk_max_i16 v104,v104,0
 v_pk_max_i16 v105,v105,0
 v_pk_max_i16 v106,v106,0
 ds_read_b64_tr_b16 v[52:53],v6 offset:15360
 ds_read_b64_tr_b16 v[54:55],v6 offset:15872
 s_waitcnt lgkmcnt(6)
 v_mfma_f32_32x32x16_bf16 v[120:135],v[40:43],v[184:187],v[120:135]
 v_pk_max_i16 v107,v107,0
 v_pk_max_i16 v108,v108,0
 v_pk_max_i16 v109,v109,0
 ds_read_b64_tr_b16 v[40:41],v6 offset:16384
 ds_read_b64_tr_b16 v[42:43],v6 offset:16896
 s_waitcnt lgkmcnt(6)
 v_mfma_f32_32x32x16_bf16 v[120:135],v[44:47],v[188:191],v[120:135]
 v_pk_max_i16 v110,v110,0
 v_pk_max_i16 v111,v111,0
 v_or_b32 v104,0x80000000,v104
 ds_read_b64_tr_b16 v[44:45],v6 offset:17408
 ds_read_b64_tr_b16 v[46:47],v6 offset:17920
 s_waitcnt lgkmcnt(6)
 v_mfma_f32_32x32x16_bf16 v[120:135],v[48:51],v[192:195],v[120:135]
 v_or_b32 v108,0x80000000,v108
 s_lshl_b32 s53,s60,5
 s_add_u32 s53,s53,s64
 s_add_u32 s52,s53,0
 buffer_store_dwordx4 v[104:107],v1,s[32:35],s52 offen sc1
 s_add_u32 s52,s53,0
 buffer_store_dwordx4 v[108:111],v1,s[32:35],s52 offen offset:1024 sc1
 v_add_u32 v32,s68,v1
 ds_read_b64_tr_b16 v[48:49],v6 offset:18432
 ds_read_b64_tr_b16 v[50:51],v6 offset:18944
 s_waitcnt lgkmcnt(6)
 v_mfma_f32_32x32x16_bf16 v[120:135],v[52:55],v[196:199],v[120:135]
 v_add_u32 v33,88064,v32
 s_bfe_u32 s96,s46,0x50000
 s_lshl_b32 s96,s96,16
 s_add_u32 s96,s96,s66
 s_add_u32 m0,s54,98304
 s_add_u32 s52,s96,0
 buffer_load_dwordx4 v9,s[24:27],s52 offen lds
 s_add_u32 m0,s54,102400
 s_add_u32 s52,s96,8192
 buffer_load_dwordx4 v9,s[24:27],s52 offen lds
 s_bfe_u32 s96,s46,0x50005
 s_lshl_b32 s96,s96,16
 s_add_u32 s96,s96,s66
 s_add_u32 m0,s54,106496
 s_add_u32 s52,s96,0
 buffer_load_dwordx4 v9,s[24:27],s52 offen lds
 s_add_u32 m0,s54,110592
 s_add_u32 s52,s96,8192
 buffer_load_dwordx4 v9,s[24:27],s52 offen lds
 ds_read_b64_tr_b16 v[52:53],v6 offset:19456
 ds_read_b64_tr_b16 v[54:55],v6 offset:19968
 s_waitcnt lgkmcnt(6)
 v_mfma_f32_32x32x16_bf16 v[120:135],v[40:43],v[200:203],v[120:135]
 s_bfe_u32 s96,s46,0x5000a
 s_lshl_b32 s96,s96,16
 s_add_u32 s96,s96,s66
 s_add_u32 m0,s54,114688
 s_add_u32 s52,s96,0
 buffer_load_dwordx4 v9,s[24:27],s52 offen lds
 s_add_u32 m0,s54,118784
 s_add_u32 s52,s96,8192
 buffer_load_dwordx4 v9,s[24:27],s52 offen lds
 s_bfe_u32 s96,s46,0x5000f
 s_lshl_b32 s96,s96,16
 s_add_u32 s96,s96,s66
 s_add_u32 m0,s54,122880
 s_add_u32 s52,s96,0
 buffer_load_dwordx4 v9,s[24:27],s52 offen lds
 s_add_u32 m0,s54,126976
 s_add_u32 s52,s96,8192
 buffer_load_dwordx4 v9,s[24:27],s52 offen lds
 s_waitcnt vmcnt(12)
 ds_read_b64_tr_b16 v[40:41],v6 offset:20480
 ds_read_b64_tr_b16 v[42:43],v6 offset:20992
 s_waitcnt lgkmcnt(6)
 v_mfma_f32_32x32x16_bf16 v[120:135],v[44:47],v[204:207],v[120:135]
 v_add_u32 v12,0x10000,v10
 v_add_u32 v14,0x10000,v11
 ds_read_b64_tr_b16 a[64:65],v12 offset:0
 ds_read_b64_tr_b16 a[68:69],v14 offset:0
 ds_read_b64_tr_b16 a[66:67],v12 offset:4096
 ds_read_b64_tr_b16 a[70:71],v14 offset:4096
 ds_read_b64_tr_b16 a[72:73],v12 offset:8192
 ds_read_b64_tr_b16 a[76:77],v14 offset:8192
 ds_read_b64_tr_b16 v[44:45],v6 offset:21504
 ds_read_b64_tr_b16 v[46:47],v6 offset:22016
 s_waitcnt lgkmcnt(12)
 v_mfma_f32_32x32x16_bf16 v[120:135],v[48:51],v[208:211],v[120:135]
 ds_read_b64_tr_b16 a[74:75],v12 offset:12288
 ds_read_b64_tr_b16 a[78:79],v14 offset:12288
 ds_read_b64_tr_b16 a[80:81],v12 offset:16384
 ds_read_b64_tr_b16 a[84:85],v14 offset:16384
 ds_read_b64_tr_b16 a[82:83],v12 offset:20480
 ds_read_b64_tr_b16 a[86:87],v14 offset:20480
 ds_read_b64_tr_b16 v[48:49],v6 offset:22528
 ds_read_b64_tr_b16 v[50:51],v6 offset:23040
 s_waitcnt lgkmcnt(15)
 v_mfma_f32_32x32x16_bf16 v[120:135],v[52:55],v[212:215],v[120:135]
 ds_read_b64_tr_b16 a[88:89],v12 offset:24576
 ds_read_b64_tr_b16 a[92:93],v14 offset:24576
 ds_read_b64_tr_b16 a[90:91],v12 offset:28672
 ds_read_b64_tr_b16 a[94:95],v14 offset:28672
 s_waitcnt lgkmcnt(0)
 ds_read_b64_tr_b16 v[52:53],v6 offset:23552
 ds_read_b64_tr_b16 v[54:55],v6 offset:24064
 v_mfma_f32_32x32x16_bf16 v[120:135],v[40:43],v[216:219],v[120:135]
 s_bfe_u32 s84,s44,0x50000
 s_lshl_b32 s84,s84,12
 buffer_load_dwordx4 v[136:139],v32,s[32:35],s84 offen sc1
 ds_read_b64_tr_b16 v[40:41],v6 offset:24576
 ds_read_b64_tr_b16 v[42:43],v6 offset:25088
 v_mfma_f32_32x32x16_bf16 v[120:135],v[44:47],v[220:223],v[120:135]
 s_bfe_u32 s84,s44,0x50000
 s_lshl_b32 s84,s84,12
 buffer_load_dwordx4 v[140:143],v33,s[32:35],s84 offen sc1
 ds_read_b64_tr_b16 v[44:45],v6 offset:25600
 ds_read_b64_tr_b16 v[46:47],v6 offset:26112
 v_mfma_f32_32x32x16_bf16 v[120:135],v[48:51],v[224:227],v[120:135]
 s_bfe_u32 s84,s44,0x50005
 s_lshl_b32 s84,s84,12
 buffer_load_dwordx4 v[144:147],v32,s[32:35],s84 offen sc1
 ds_read_b64_tr_b16 v[48:49],v6 offset:26624
 ds_read_b64_tr_b16 v[50:51],v6 offset:27136
 s_waitcnt lgkmcnt(6)
 v_mfma_f32_32x32x16_bf16 v[120:135],v[52:55],v[228:231],v[120:135]
 s_bfe_u32 s84,s44,0x50005
 s_lshl_b32 s84,s84,12
 buffer_load_dwordx4 v[148:151],v33,s[32:35],s84 offen sc1
 ds_read_b64_tr_b16 v[52:53],v6 offset:27648
 ds_read_b64_tr_b16 v[54:55],v6 offset:28160
 s_waitcnt lgkmcnt(6)
 v_mfma_f32_32x32x16_bf16 v[120:135],v[40:43],v[232:235],v[120:135]
 s_bfe_u32 s84,s44,0x5000a
 s_lshl_b32 s84,s84,12
 buffer_load_dwordx4 v[152:155],v32,s[32:35],s84 offen sc1
 ds_read_b64_tr_b16 v[40:41],v6 offset:28672
 ds_read_b64_tr_b16 v[42:43],v6 offset:29184
 s_waitcnt lgkmcnt(6)
 v_mfma_f32_32x32x16_bf16 v[120:135],v[44:47],v[236:239],v[120:135]
 s_bfe_u32 s84,s44,0x5000a
 s_lshl_b32 s84,s84,12
 buffer_load_dwordx4 v[156:159],v33,s[32:35],s84 offen sc1
 ds_read_b64_tr_b16 v[44:45],v6 offset:29696
 ds_read_b64_tr_b16 v[46:47],v6 offset:30208
 s_waitcnt lgkmcnt(6)
 v_mfma_f32_32x32x16_bf16 v[120:135],v[48:51],v[240:243],v[120:135]
 s_bfe_u32 s84,s44,0x5000f
 s_lshl_b32 s84,s84,12
 buffer_load_dwordx4 v[160:163],v32,s[32:35],s84 offen sc1
 ds_read_b64_tr_b16 v[48:49],v6 offset:30720
 ds_read_b64_tr_b16 v[50:51],v6 offset:31232
 s_waitcnt lgkmcnt(6)
 v_mfma_f32_32x32x16_bf16 v[120:135],v[52:55],v[244:247],v[120:135]
 s_bfe_u32 s84,s44,0x5000f
 s_lshl_b32 s84,s84,12
 buffer_load_dwordx4 v[164:167],v33,s[32:35],s84 offen sc1
 ds_read_b64_tr_b16 v[52:53],v6 offset:31744
 ds_read_b64_tr_b16 v[54:55],v6 offset:32256
 s_waitcnt lgkmcnt(6)
 v_mfma_f32_32x32x16_bf16 v[120:135],v[40:43],v[248:251],v[120:135]
 s_bfe_u32 s84,s44,0x50014
 s_lshl_b32 s84,s84,12
 buffer_load_dwordx4 v[168:171],v32,s[32:35],s84 offen sc1
 s_waitcnt lgkmcnt(4)
 v_mfma_f32_32x32x16_bf16 v[120:135],v[44:47],v[252:255],v[120:135]
 s_bfe_u32 s84,s44,0x50014
 s_lshl_b32 s84,s84,12
 buffer_load_dwordx4 v[172:175],v33,s[32:35],s84 offen sc1
 s_waitcnt lgkmcnt(2)
 v_mfma_f32_32x32x16_bf16 v[120:135],v[48:51],a[248:251],v[120:135]
 s_waitcnt lgkmcnt(0)
 v_mfma_f32_32x32x16_bf16 v[120:135],v[52:55],a[252:255],v[120:135]
 v_mov_b32 v28,v34
 v_mov_b32 v29,v34
 s_nop 1
 v_mfma_f32_32x32x16_bf16 v[120:135],v[28:31],v[24:27],v[120:135]
 s_barrier
 s_bfe_u32 s96,s46,0x50014
 s_lshl_b32 s96,s96,16
 s_add_u32 s96,s96,s66
 s_add_u32 m0,s54,131072
 s_add_u32 s52,s96,0
 buffer_load_dwordx4 v9,s[24:27],s52 offen lds
 s_add_u32 m0,s54,135168
 s_add_u32 s52,s96,8192
 buffer_load_dwordx4 v9,s[24:27],s52 offen lds
 s_bfe_u32 s96,s46,0x50019
 s_lshl_b32 s96,s96,16
 s_add_u32 s96,s96,s66
 s_add_u32 m0,s54,139264
 s_add_u32 s52,s96,0
 buffer_load_dwordx4 v9,s[24:27],s52 offen lds
 s_add_u32 m0,s54,143360
 s_add_u32 s52,s96,8192
 buffer_load_dwordx4 v9,s[24:27],s52 offen lds
 s_bfe_u32 s96,s47,0x50000
 s_lshl_b32 s96,s96,16
 s_add_u32 s96,s96,s66
 s_add_u32 m0,s54,147456
 s_add_u32 s52,s96,0
 buffer_load_dwordx4 v9,s[24:27],s52 offen lds
 s_add_u32 m0,s54,151552
 s_add_u32 s52,s96,8192
 buffer_load_dwordx4 v9,s[24:27],s52 offen lds
 s_bfe_u32 s96,s47,0x50005
 s_lshl_b32 s96,s96,16
 s_add_u32 s96,s96,s66
 s_add_u32 m0,s54,155648
 s_add_u32 s52,s96,0
 buffer_load_dwordx4 v9,s[24:27],s52 offen lds
 s_add_u32 m0,s54,159744
 s_add_u32 s52,s96,8192
 buffer_load_dwordx4 v9,s[24:27],s52 offen lds
 v_cvt_pk_bf16_f32 v120,v120,v121
 v_cvt_pk_bf16_f32 v121,v122,v123
 v_cvt_pk_bf16_f32 v122,v124,v125
 v_cvt_pk_bf16_f32 v123,v126,v127
 v_cvt_pk_bf16_f32 v124,v128,v129
 v_cvt_pk_bf16_f32 v125,v130,v131
 v_cvt_pk_bf16_f32 v126,v132,v133
 v_cvt_pk_bf16_f32 v127,v134,v135
 v_pk_max_i16 v120,v120,0
 v_pk_max_i16 v121,v121,0
 v_pk_max_i16 v122,v122,0
 v_pk_max_i16 v123,v123,0
 v_pk_max_i16 v124,v124,0
 v_pk_max_i16 v125,v125,0
 v_pk_max_i16 v126,v126,0
 v_pk_max_i16 v127,v127,0
 v_or_b32 v120,0x80000000,v120
 v_or_b32 v124,0x80000000,v124
 s_cmp_ge_u32 s6,11
 s_cbranch_scc1 Lh3_425
 s_add_u32 s52,s64,2048
 buffer_store_dwordx4 v[120:123],v1,s[32:35],s52 offen sc1
 s_add_u32 s52,s64,2048
 buffer_store_dwordx4 v[124:127],v1,s[32:35],s52 offen offset:1024 sc1
Lh3_425:
 s_waitcnt vmcnt(18)
 ds_read_b64_tr_b16 a[96:97],v12 offset:32768
 ds_read_b64_tr_b16 a[100:101],v14 offset:32768
 ds_read_b64_tr_b16 a[98:99],v12 offset:36864
 ds_read_b64_tr_b16 a[102:103],v14 offset:36864
 ds_read_b64_tr_b16 a[104:105],v12 offset:40960
 ds_read_b64_tr_b16 a[108:109],v14 offset:40960
 ds_read_b64_tr_b16 a[106:107],v12 offset:45056
 ds_read_b64_tr_b16 a[110:111],v14 offset:45056
 ds_read_b64_tr_b16 a[112:113],v12 offset:49152
 ds_read_b64_tr_b16 a[116:117],v14 offset:49152
 ds_read_b64_tr_b16 a[114:115],v12 offset:53248
 ds_read_b64_tr_b16 a[118:119],v14 offset:53248
 ds_read_b64_tr_b16 a[120:121],v12 offset:57344
 ds_read_b64_tr_b16 a[124:125],v14 offset:57344
 ds_read_b64_tr_b16 a[122:123],v12 offset:61440
 ds_read_b64_tr_b16 a[126:127],v14 offset:61440
 s_waitcnt lgkmcnt(0)
 s_bfe_u32 s96,s47,0x5000a
 s_lshl_b32 s96,s96,16
 s_add_u32 s96,s96,s66
 s_add_u32 m0,s54,98304
 s_add_u32 s52,s96,0
 buffer_load_dwordx4 v9,s[24:27],s52 offen lds
 s_add_u32 m0,s54,102400
 s_add_u32 s52,s96,8192
 buffer_load_dwordx4 v9,s[24:27],s52 offen lds
 s_bfe_u32 s96,s47,0x5000f
 s_lshl_b32 s96,s96,16
 s_add_u32 s96,s96,s66
 s_add_u32 m0,s54,106496
 s_add_u32 s52,s96,0
 buffer_load_dwordx4 v9,s[24:27],s52 offen lds
 s_add_u32 m0,s54,110592
 s_add_u32 s52,s96,8192
 buffer_load_dwordx4 v9,s[24:27],s52 offen lds
 s_add_u32 s84,s72,0
 buffer_load_dwordx4 v[24:27],v3,s[32:35],s84 offen sc1
 s_getpc_b64 s[82:83]
Lpc_426:
 s_lshr_b32 s52,s2,3
 s_lshl_b32 s52,s52,2
 s_add_u32 s52,s52,s4
 s_lshl_b32 s52,s52,10
 s_min_u32 s52,s52,L_codeend-Lpc_426-1024
 v_add_u32 v252,s52,v1
 global_load_dwordx4 v[248:251],v252,s[82:83]
 s_waitcnt vmcnt(23)
 v_xor_b32 v136,0x80000000,v136
 s_waitcnt vmcnt(22)
 v_xor_b32 v140,0x80000000,v140
 v_or_b32 v38,v136,v140
 v_cmp_gt_i32 vcc,0,v38
 s_cbranch_vccnz Lfix_427
Lret_428:
 v_mfma_f32_32x32x16_bf16 v[88:103],a[0:3],v[136:139],0
 s_bfe_u32 s84,s44,0x50019
 s_lshl_b32 s84,s84,12
 buffer_load_dwordx4 v[176:179],v32,s[32:35],s84 offen sc1
 v_mfma_f32_32x32x16_bf16 v[120:135],a[4:7],v[136:139],0
 v_mfma_f32_32x32x16_bf16 v[104:119],a[0:3],v[140:143],0
 s_bfe_u32 s84,s44,0x50019
 s_lshl_b32 s84,s84,12
 buffer_load_dwordx4 v[180:183],v33,s[32:35],s84 offen sc1
 s_waitcnt vmcnt(23)
 v_xor_b32 v144,0x80000000,v144
 s_waitcnt vmcnt(22)
 v_xor_b32 v148,0x80000000,v148
 v_or_b32 v38,v144,v148
 v_cmp_gt_i32 vcc,0,v38
 v_mfma_f32_32x32x16_bf16 v[232:247],a[4:7],v[140:143],0
 s_cbranch_vccnz Lfix_430
Lret_431:
 v_mfma_f32_32x32x16_bf16 v[88:103],a[8:11],v[144:147],v[88:103]
 s_bfe_u32 s84,s45,0x50000
 s_lshl_b32 s84,s84,12
 buffer_load_dwordx4 v[184:187],v32,s[32:35],s84 offen sc1
 v_mfma_f32_32x32x16_bf16 v[120:135],a[12:15],v[144:147],v[120:135]
 v_mfma_f32_32x32x16_bf16 v[104:119],a[8:11],v[148:151],v[104:119]
 s_bfe_u32 s84,s45,0x50000
 s_lshl_b32 s84,s84,12
 buffer_load_dwordx4 v[188:191],v33,s[32:35],s84 offen sc1
 s_waitcnt vmcnt(23)
 v_xor_b32 v152,0x80000000,v152
 s_waitcnt vmcnt(22)
 v_xor_b32 v156,0x80000000,v156
 v_or_b32 v38,v152,v156
 v_cmp_gt_i32 vcc,0,v38
 v_mfma_f32_32x32x16_bf16 v[232:247],a[12:15],v[148:151],v[232:247]
 s_cbranch_vccnz Lfix_433
Lret_434:
 v_mfma_f32_32x32x16_bf16 v[88:103],a[16:19],v[152:155],v[88:103]
 s_bfe_u32 s84,s45,0x50005
 s_lshl_b32 s84,s84,12
 buffer_load_dwordx4 v[192:195],v32,s[32:35],s84 offen sc1
 s_waitcnt vmcnt(7)
 v_mfma_f32_32x32x16_bf16 v[120:135],a[20:23],v[152:155],v[120:135]
 v_mfma_f32_32x32x16_bf16 v[104:119],a[16:19],v[156:159],v[104:119]
 s_bfe_u32 s84,s45,0x50005
 s_lshl_b32 s84,s84,12
 buffer_load_dwordx4 v[196:199],v33,s[32:35],s84 offen sc1
 v_xor_b32 v160,0x80000000,v160
 v_xor_b32 v164,0x80000000,v164
 v_or_b32 v38,v160,v164
 v_cmp_gt_i32 vcc,0,v38
 v_add_u32 v12,0x20000,v10
 v_add_u32 v14,0x20000,v11
 ds_read_b64_tr_b16 a[128:129],v12 offset:0
 ds_read_b64_tr_b16 a[132:133],v14 offset:0
 v_mfma_f32_32x32x16_bf16 v[232:247],a[20:23],v[156:159],v[232:247]
 s_cbranch_vccnz Lfix_436
Lret_437:
 v_mfma_f32_32x32x16_bf16 v[88:103],a[24:27],v[160:163],v[88:103]
 s_bfe_u32 s84,s45,0x5000a
 s_lshl_b32 s84,s84,12
 buffer_load_dwordx4 v[200:203],v32,s[32:35],s84 offen sc1
 ds_read_b64_tr_b16 a[130:131],v12 offset:4096
 ds_read_b64_tr_b16 a[134:135],v14 offset:4096
 v_mfma_f32_32x32x16_bf16 v[120:135],a[28:31],v[160:163],v[120:135]
 v_mfma_f32_32x32x16_bf16 v[104:119],a[24:27],v[164:167],v[104:119]
 s_bfe_u32 s84,s45,0x5000a
 s_lshl_b32 s84,s84,12
 buffer_load_dwordx4 v[204:207],v33,s[32:35],s84 offen sc1
 v_xor_b32 v168,0x80000000,v168
 v_xor_b32 v172,0x80000000,v172
 v_or_b32 v38,v168,v172
 v_cmp_gt_i32 vcc,0,v38
 ds_read_b64_tr_b16 a[136:137],v12 offset:8192
 ds_read_b64_tr_b16 a[140:141],v14 offset:8192
 v_mfma_f32_32x32x16_bf16 v[232:247],a[28:31],v[164:167],v[232:247]
 s_cbranch_vccnz Lfix_439
Lret_440:
 v_mfma_f32_32x32x16_bf16 v[88:103],a[32:35],v[168:171],v[88:103]
 s_bfe_u32 s84,s45,0x5000f
 s_lshl_b32 s84,s84,12
 buffer_load_dwordx4 v[208:211],v32,s[32:35],s84 offen sc1
 ds_read_b64_tr_b16 a[138:139],v12 offset:12288
 ds_read_b64_tr_b16 a[142:143],v14 offset:12288
 v_mfma_f32_32x32x16_bf16 v[120:135],a[36:39],v[168:171],v[120:135]
 v_mfma_f32_32x32x16_bf16 v[104:119],a[32:35],v[172:175],v[104:119]
 s_bfe_u32 s84,s45,0x5000f
 s_lshl_b32 s84,s84,12
 buffer_load_dwordx4 v[212:215],v33,s[32:35],s84 offen sc1
 s_waitcnt vmcnt(9)
 v_xor_b32 v176,0x80000000,v176
 s_waitcnt vmcnt(8)
 v_xor_b32 v180,0x80000000,v180
 v_or_b32 v38,v176,v180
 v_cmp_gt_i32 vcc,0,v38
 ds_read_b64_tr_b16 a[144:145],v12 offset:16384
 ds_read_b64_tr_b16 a[148:149],v14 offset:16384
 v_mfma_f32_32x32x16_bf16 v[232:247],a[36:39],v[172:175],v[232:247]
 s_cbranch_vccnz Lfix_442
Lret_443:
 v_mfma_f32_32x32x16_bf16 v[88:103],a[40:43],v[176:179],v[88:103]
 s_bfe_u32 s84,s45,0x50014
 s_lshl_b32 s84,s84,12
 buffer_load_dwordx4 v[216:219],v32,s[32:35],s84 offen sc1
 ds_read_b64_tr_b16 a[146:147],v12 offset:20480
 ds_read_b64_tr_b16 a[150:151],v14 offset:20480
 v_mfma_f32_32x32x16_bf16 v[120:135],a[44:47],v[176:179],v[120:135]
 v_mfma_f32_32x32x16_bf16 v[104:119],a[40:43],v[180:183],v[104:119]
 s_bfe_u32 s84,s45,0x50014
 s_lshl_b32 s84,s84,12
 buffer_load_dwordx4 v[220:223],v33,s[32:35],s84 offen sc1
 s_waitcnt vmcnt(9)
 v_xor_b32 v184,0x80000000,v184
 s_waitcnt vmcnt(8)
 v_xor_b32 v188,0x80000000,v188
 v_or_b32 v38,v184,v188
 v_cmp_gt_i32 vcc,0,v38
 ds_read_b64_tr_b16 a[152:153],v12 offset:24576
 ds_read_b64_tr_b16 a[156:157],v14 offset:24576
 v_mfma_f32_32x32x16_bf16 v[232:247],a[44:47],v[180:183],v[232:247]
 s_cbranch_vccnz Lfix_445
Lret_446:
 v_mfma_f32_32x32x16_bf16 v[88:103],a[48:51],v[184:187],v[88:103]
 s_bfe_u32 s84,s45,0x50019
 s_lshl_b32 s84,s84,12
 buffer_load_dwordx4 v[224:227],v32,s[32:35],s84 offen sc1
 ds_read_b64_tr_b16 a[154:155],v12 offset:28672
 ds_read_b64_tr_b16 a[158:159],v14 offset:28672
 v_mfma_f32_32x32x16_bf16 v[120:135],a[52:55],v[184:187],v[120:135]
 v_mfma_f32_32x32x16_bf16 v[104:119],a[48:51],v[188:191],v[104:119]
 s_bfe_u32 s84,s45,0x50019
 s_lshl_b32 s84,s84,12
 buffer_load_dwordx4 v[228:231],v33,s[32:35],s84 offen sc1
 s_waitcnt vmcnt(9)
 v_xor_b32 v192,0x80000000,v192
 s_waitcnt vmcnt(8)
 v_xor_b32 v196,0x80000000,v196
 v_or_b32 v38,v192,v196
 v_cmp_gt_i32 vcc,0,v38
 v_add_u32 v12,0x10000,v10
 v_add_u32 v14,0x10000,v11
 ds_read_b64_tr_b16 a[160:161],v12 offset:32768
 ds_read_b64_tr_b16 a[164:165],v14 offset:32768
 v_mfma_f32_32x32x16_bf16 v[232:247],a[52:55],v[188:191],v[232:247]
 s_cbranch_vccnz Lfix_448
Lret_449:
 v_mfma_f32_32x32x16_bf16 v[88:103],a[56:59],v[192:195],v[88:103]
 s_bfe_u32 s84,s46,0x50000
 s_lshl_b32 s84,s84,12
 buffer_load_dwordx4 v[136:139],v32,s[32:35],s84 offen sc1
 ds_read_b64_tr_b16 a[162:163],v12 offset:36864
 ds_read_b64_tr_b16 a[166:167],v14 offset:36864
 v_mfma_f32_32x32x16_bf16 v[120:135],a[60:63],v[192:195],v[120:135]
 v_mfma_f32_32x32x16_bf16 v[104:119],a[56:59],v[196:199],v[104:119]
 s_bfe_u32 s84,s46,0x50000
 s_lshl_b32 s84,s84,12
 buffer_load_dwordx4 v[140:143],v33,s[32:35],s84 offen sc1
 s_waitcnt vmcnt(9)
 v_xor_b32 v200,0x80000000,v200
 s_waitcnt vmcnt(8)
 v_xor_b32 v204,0x80000000,v204
 v_or_b32 v38,v200,v204
 v_cmp_gt_i32 vcc,0,v38
 ds_read_b64_tr_b16 a[168:169],v12 offset:40960
 ds_read_b64_tr_b16 a[172:173],v14 offset:40960
 v_mfma_f32_32x32x16_bf16 v[232:247],a[60:63],v[196:199],v[232:247]
 s_cbranch_vccnz Lfix_451
Lret_452:
 v_mfma_f32_32x32x16_bf16 v[88:103],a[64:67],v[200:203],v[88:103]
 s_bfe_u32 s84,s46,0x50005
 s_lshl_b32 s84,s84,12
 buffer_load_dwordx4 v[144:147],v32,s[32:35],s84 offen sc1
 ds_read_b64_tr_b16 a[170:171],v12 offset:45056
 ds_read_b64_tr_b16 a[174:175],v14 offset:45056
 v_mfma_f32_32x32x16_bf16 v[120:135],a[68:71],v[200:203],v[120:135]
 v_and_b32 v30,v24,v25
 v_bitop3_b32 v30,v26,v27,v30 bitop3:0x80
 v_and_b32 v30,1,v30
 v_cmp_eq_u32 s[82:83],0,v30
 s_nop 0
 s_cmp_lg_u64 s[82:83],0
 s_cbranch_scc1 Lfix_454
Lret_455:
 v_mfma_f32_32x32x16_bf16 v[104:119],a[64:67],v[204:207],v[104:119]
 s_bfe_u32 s84,s46,0x50005
 s_lshl_b32 s84,s84,12
 buffer_load_dwordx4 v[148:151],v33,s[32:35],s84 offen sc1
 s_waitcnt vmcnt(9)
 v_xor_b32 v208,0x80000000,v208
 s_waitcnt vmcnt(8)
 v_xor_b32 v212,0x80000000,v212
 v_or_b32 v38,v208,v212
 v_cmp_gt_i32 vcc,0,v38
 v_add_f32 v24,v24,v25
 v_mfma_f32_32x32x16_bf16 v[232:247],a[68:71],v[204:207],v[232:247]
 v_add_f32 v26,v26,v27
 v_add_f32 v24,v24,v26
 v_mov_b32 v25,v24
 s_nop 1
 v_permlane16_swap_b32 v24,v25
 v_add_f32 v24,v24,v25
 v_mov_b32 v25,v24
 s_cbranch_vccnz Lfix_457
Lret_458:
 v_mfma_f32_32x32x16_bf16 v[88:103],a[72:75],v[208:211],v[88:103]
 s_bfe_u32 s84,s46,0x5000a
 s_lshl_b32 s84,s84,12
 buffer_load_dwordx4 v[152:155],v32,s[32:35],s84 offen sc1
 v_permlane32_swap_b32 v24,v25
 v_mfma_f32_32x32x16_bf16 v[120:135],a[76:79],v[208:211],v[120:135]
 v_mul_f32 v24,s74,v24
 v_mul_f32 v25,s74,v25
 v_fma_f32 v25,-v24,v24,v25
 v_max_f32 v25,0,v25
 v_add_f32 v25,s75,v25
 v_rsq_f32 v28,v25
 v_mfma_f32_32x32x16_bf16 v[104:119],a[72:75],v[212:215],v[104:119]
 s_bfe_u32 s84,s46,0x5000a
 s_lshl_b32 s84,s84,12
 buffer_load_dwordx4 v[156:159],v33,s[32:35],s84 offen sc1
 s_waitcnt vmcnt(9)
 v_xor_b32 v216,0x80000000,v216
 s_waitcnt vmcnt(8)
 v_xor_b32 v220,0x80000000,v220
 v_or_b32 v38,v216,v220
 v_cmp_gt_i32 vcc,0,v38
 v_mfma_f32_32x32x16_bf16 v[232:247],a[76:79],v[212:215],v[232:247]
 s_waitcnt lgkmcnt(0)
 s_barrier
 s_cbranch_vccnz Lfix_460
Lret_461:
 v_mfma_f32_32x32x16_bf16 v[88:103],a[80:83],v[216:219],v[88:103]
 s_bfe_u32 s84,s46,0x5000f
 s_lshl_b32 s84,s84,12
 buffer_load_dwordx4 v[160:163],v32,s[32:35],s84 offen sc1
 v_mfma_f32_32x32x16_bf16 v[120:135],a[84:87],v[216:219],v[120:135]
 v_mfma_f32_32x32x16_bf16 v[104:119],a[80:83],v[220:223],v[104:119]
 s_bfe_u32 s84,s46,0x5000f
 s_lshl_b32 s84,s84,12
 buffer_load_dwordx4 v[164:167],v33,s[32:35],s84 offen sc1
 s_waitcnt vmcnt(9)
 v_xor_b32 v224,0x80000000,v224
 s_waitcnt vmcnt(8)
 v_xor_b32 v228,0x80000000,v228
 v_or_b32 v38,v224,v228
 v_cmp_gt_i32 vcc,0,v38
 v_mfma_f32_32x32x16_bf16 v[232:247],a[84:87],v[220:223],v[232:247]
 s_cbranch_vccnz Lfix_463
Lret_464:
 v_mfma_f32_32x32x16_bf16 v[88:103],a[88:91],v[224:227],v[88:103]
 s_bfe_u32 s84,s46,0x50014
 s_lshl_b32 s84,s84,12
 buffer_load_dwordx4 v[168:171],v32,s[32:35],s84 offen sc1
 v_mfma_f32_32x32x16_bf16 v[120:135],a[92:95],v[224:227],v[120:135]
 v_mfma_f32_32x32x16_bf16 v[104:119],a[88:91],v[228:231],v[104:119]
 s_bfe_u32 s84,s46,0x50014
 s_lshl_b32 s84,s84,12
 buffer_load_dwordx4 v[172:175],v33,s[32:35],s84 offen sc1
 s_waitcnt vmcnt(9)
 v_xor_b32 v136,0x80000000,v136
 s_waitcnt vmcnt(8)
 v_xor_b32 v140,0x80000000,v140
 v_or_b32 v38,v136,v140
 v_cmp_gt_i32 vcc,0,v38
 v_mfma_f32_32x32x16_bf16 v[232:247],a[92:95],v[228:231],v[232:247]
 s_cbranch_vccnz Lfix_466
Lret_467:
 v_mfma_f32_32x32x16_bf16 v[88:103],a[96:99],v[136:139],v[88:103]
 s_bfe_u32 s84,s46,0x50019
 s_lshl_b32 s84,s84,12
 buffer_load_dwordx4 v[176:179],v32,s[32:35],s84 offen sc1
 v_mfma_f32_32x32x16_bf16 v[120:135],a[100:103],v[136:139],v[120:135]
 v_mfma_f32_32x32x16_bf16 v[104:119],a[96:99],v[140:143],v[104:119]
 s_bfe_u32 s84,s46,0x50019
 s_lshl_b32 s84,s84,12
 buffer_load_dwordx4 v[180:183],v33,s[32:35],s84 offen sc1
 s_waitcnt vmcnt(9)
 v_xor_b32 v144,0x80000000,v144
 s_waitcnt vmcnt(8)
 v_xor_b32 v148,0x80000000,v148
 v_or_b32 v38,v144,v148
 v_cmp_gt_i32 vcc,0,v38
 v_mfma_f32_32x32x16_bf16 v[232:247],a[100:103],v[140:143],v[232:247]
 s_cbranch_vccnz Lfix_469
Lret_470:
 v_mfma_f32_32x32x16_bf16 v[88:103],a[104:107],v[144:147],v[88:103]
 s_bfe_u32 s84,s47,0x50000
 s_lshl_b32 s84,s84,12
 buffer_load_dwordx4 v[184:187],v32,s[32:35],s84 offen sc1
 v_mfma_f32_32x32x16_bf16 v[120:135],a[108:111],v[144:147],v[120:135]
 v_mfma_f32_32x32x16_bf16 v[104:119],a[104:107],v[148:151],v[104:119]
 s_bfe_u32 s84,s47,0x50000
 s_lshl_b32 s84,s84,12
 buffer_load_dwordx4 v[188:191],v33,s[32:35],s84 offen sc1
 s_waitcnt vmcnt(9)
 v_xor_b32 v152,0x80000000,v152
 s_waitcnt vmcnt(8)
 v_xor_b32 v156,0x80000000,v156
 v_or_b32 v38,v152,v156
 v_cmp_gt_i32 vcc,0,v38
 v_mfma_f32_32x32x16_bf16 v[232:247],a[108:111],v[148:151],v[232:247]
 s_cbranch_vccnz Lfix_472
Lret_473:
 v_mfma_f32_32x32x16_bf16 v[88:103],a[112:115],v[152:155],v[88:103]
 s_bfe_u32 s84,s47,0x50005
 s_lshl_b32 s84,s84,12
 buffer_load_dwordx4 v[192:195],v32,s[32:35],s84 offen sc1
 v_mfma_f32_32x32x16_bf16 v[104:119],a[112:115],v[156:159],v[104:119]
 s_bfe_u32 s84,s47,0x50005
 s_lshl_b32 s84,s84,12
 buffer_load_dwordx4 v[196:199],v33,s[32:35],s84 offen sc1
 s_waitcnt vmcnt(9)
 v_xor_b32 v160,0x80000000,v160
 s_waitcnt vmcnt(8)
 v_xor_b32 v164,0x80000000,v164
 v_or_b32 v38,v160,v164
 v_cmp_gt_i32 vcc,0,v38
 s_cbranch_vccnz Lfix_475
Lret_476:
 v_mfma_f32_32x32x16_bf16 v[88:103],a[120:123],v[160:163],v[88:103]
 s_bfe_u32 s84,s47,0x5000a
 s_lshl_b32 s84,s84,12
 buffer_load_dwordx4 v[200:203],v32,s[32:35],s84 offen sc1
 v_mfma_f32_32x32x16_bf16 v[104:119],a[120:123],v[164:167],v[104:119]
 s_bfe_u32 s84,s47,0x5000a
 s_lshl_b32 s84,s84,12
 buffer_load_dwordx4 v[204:207],v33,s[32:35],s84 offen sc1
 s_waitcnt vmcnt(9)
 v_xor_b32 v168,0x80000000,v168
 s_waitcnt vmcnt(8)
 v_xor_b32 v172,0x80000000,v172
 v_or_b32 v38,v168,v172
 v_cmp_gt_i32 vcc,0,v38
 s_cbranch_vccnz Lfix_478
Lret_479:
 v_mfma_f32_32x32x16_bf16 v[88:103],a[128:131],v[168:171],v[88:103]
 buffer_load_dwordx4 v[208:211],v32,s[32:35],s70 offen sc1
 v_mfma_f32_32x32x16_bf16 v[104:119],a[128:131],v[172:175],v[104:119]
 buffer_load_dwordx4 v[212:215],v33,s[32:35],s70 offen sc1
 s_waitcnt vmcnt(9)
 v_xor_b32 v176,0x80000000,v176
 s_waitcnt vmcnt(8)
 v_xor_b32 v180,0x80000000,v180
 v_or_b32 v38,v176,v180
 v_cmp_gt_i32 vcc,0,v38
 s_cbranch_vccnz Lfix_481
Lret_482:
 v_mfma_f32_32x32x16_bf16 v[88:103],a[136:139],v[176:179],v[88:103]
 v_mfma_f32_32x32x16_bf16 v[104:119],a[136:139],v[180:183],v[104:119]
 s_waitcnt vmcnt(7)
 v_xor_b32 v184,0x80000000,v184
 s_waitcnt vmcnt(6)
 v_xor_b32 v188,0x80000000,v188
 v_or_b32 v38,v184,v188
 v_cmp_gt_i32 vcc,0,v38
 s_cbranch_vccnz Lfix_484
Lret_485:
 v_mfma_f32_32x32x16_bf16 v[88:103],a[144:147],v[184:187],v[88:103]
 v_mfma_f32_32x32x16_bf16 v[104:119],a[144:147],v[188:191],v[104:119]
 s_waitcnt vmcnt(5)
 v_xor_b32 v192,0x80000000,v192
 s_waitcnt vmcnt(4)
 v_xor_b32 v196,0x80000000,v196
 v_or_b32 v38,v192,v196
 v_cmp_gt_i32 vcc,0,v38
 s_cbranch_vccnz Lfix_487
Lret_488:
 v_mfma_f32_32x32x16_bf16 v[88:103],a[152:155],v[192:195],v[88:103]
 v_mfma_f32_32x32x16_bf16 v[104:119],a[152:155],v[196:199],v[104:119]
 s_waitcnt vmcnt(3)
 v_xor_b32 v200,0x80000000,v200
 s_waitcnt vmcnt(2)
 v_xor_b32 v204,0x80000000,v204
 v_or_b32 v38,v200,v204
 v_cmp_gt_i32 vcc,0,v38
 s_cbranch_vccnz Lfix_490
Lret_491:
 v_mfma_f32_32x32x16_bf16 v[88:103],a[160:163],v[200:203],v[88:103]
 v_mfma_f32_32x32x16_bf16 v[104:119],a[160:163],v[204:207],v[104:119]
 s_waitcnt vmcnt(1)
 v_xor_b32 v208,0x80000000,v208
 s_waitcnt vmcnt(0)
 v_xor_b32 v212,0x80000000,v212
 v_or_b32 v38,v208,v212
 v_cmp_gt_i32 vcc,0,v38
 s_cbranch_vccnz Lfix_493
Lret_494:
 v_mfma_f32_32x32x16_bf16 v[88:103],a[168:171],v[208:211],v[88:103]
 v_mfma_f32_32x32x16_bf16 v[104:119],a[168:171],v[212:215],v[104:119]
 v_mfma_f32_32x32x16_bf16 v[120:135],a[116:119],v[152:155],v[120:135]
 s_nop 9
 ds_write_b128 v18,v[88:91] offset:0
 v_accvgpr_read_b32 v41,a240
 v_accvgpr_read_b32 v43,a241
 v_accvgpr_read_b32 v45,a242
 v_mfma_f32_32x32x16_bf16 v[232:247],a[116:119],v[156:159],v[232:247]
 v_accvgpr_read_b32 v47,a243
 v_lshlrev_b32 v40,16,v41
 v_and_b32 v41,0xffff0000,v41
 v_mfma_f32_32x32x16_bf16 v[120:135],a[124:127],v[160:163],v[120:135]
 ds_write_b128 v18,v[92:95] offset:1024
 v_lshlrev_b32 v42,16,v43
 v_and_b32 v43,0xffff0000,v43
 v_lshlrev_b32 v44,16,v45
 v_mfma_f32_32x32x16_bf16 v[232:247],a[124:127],v[164:167],v[232:247]
 ds_write_b128 v18,v[96:99] offset:2048
 v_and_b32 v45,0xffff0000,v45
 v_lshlrev_b32 v46,16,v47
 v_and_b32 v47,0xffff0000,v47
 v_mfma_f32_32x32x16_bf16 v[120:135],a[132:135],v[168:171],v[120:135]
 v_accvgpr_read_b32 v49,a244
 v_accvgpr_read_b32 v51,a245
 v_accvgpr_read_b32 v53,a246
 s_add_u32 s96,s95,4
 s_and_b32 s96,s96,7
 s_mul_i32 s96,s96,176128
 s_add_u32 s96,s96,s62
 s_add_u32 m0,s54,98304
 s_add_u32 s52,s96,0
 buffer_load_dwordx4 v8,s[20:23],s52 offen lds
 s_add_u32 s96,s96,s60
 s_add_u32 m0,s54,114688
 s_add_u32 s52,s96,0
 buffer_load_dwordx4 v8,s[20:23],s52 offen lds
 v_mfma_f32_32x32x16_bf16 v[232:247],a[132:135],v[172:175],v[232:247]
 ds_write_b128 v18,v[100:103] offset:3072
 v_accvgpr_read_b32 v55,a247
 v_lshlrev_b32 v48,16,v49
 v_and_b32 v49,0xffff0000,v49
 v_mfma_f32_32x32x16_bf16 v[120:135],a[140:143],v[176:179],v[120:135]
 ds_write_b128 v18,v[104:107] offset:4096
 v_lshlrev_b32 v50,16,v51
 v_and_b32 v51,0xffff0000,v51
 v_lshlrev_b32 v52,16,v53
 v_mfma_f32_32x32x16_bf16 v[232:247],a[140:143],v[180:183],v[232:247]
 v_and_b32 v53,0xffff0000,v53
 v_lshlrev_b32 v54,16,v55
 v_and_b32 v55,0xffff0000,v55
 v_mfma_f32_32x32x16_bf16 v[120:135],a[148:151],v[184:187],v[120:135]
 ds_write_b128 v18,v[108:111] offset:5120
 v_mfma_f32_32x32x16_bf16 v[232:247],a[148:151],v[188:191],v[232:247]
 s_add_u32 s96,s95,5
 s_and_b32 s96,s96,7
 s_mul_i32 s96,s96,176128
 s_add_u32 s96,s96,s62
 s_add_u32 m0,s54,102400
 s_add_u32 s52,s96,0
 buffer_load_dwordx4 v8,s[20:23],s52 offen lds
 s_add_u32 s96,s96,s60
 s_add_u32 m0,s54,118784
 s_add_u32 s52,s96,0
 buffer_load_dwordx4 v8,s[20:23],s52 offen lds
 v_mfma_f32_32x32x16_bf16 v[120:135],a[156:159],v[192:195],v[120:135]
 ds_write_b128 v18,v[112:115] offset:6144
 v_mfma_f32_32x32x16_bf16 v[232:247],a[156:159],v[196:199],v[232:247]
 ds_write_b128 v18,v[116:119] offset:7168
 v_mfma_f32_32x32x16_bf16 v[120:135],a[164:167],v[200:203],v[120:135]
 s_waitcnt lgkmcnt(0)
 s_barrier
 ds_read_b128 v[56:59],v15 offset:0
 ds_read_b128 v[60:63],v15 offset:1024
 v_mfma_f32_32x32x16_bf16 v[232:247],a[164:167],v[204:207],v[232:247]
 ds_read_b128 v[64:67],v15 offset:8192
 ds_read_b128 v[68:71],v15 offset:9216
 ds_read_b128 v[72:75],v15 offset:16384
 v_mfma_f32_32x32x16_bf16 v[120:135],a[172:175],v[208:211],v[120:135]
 ds_read_b128 v[76:79],v15 offset:17408
 ds_read_b128 v[80:83],v15 offset:24576
 ds_read_b128 v[84:87],v15 offset:25600
 v_mfma_f32_32x32x16_bf16 v[232:247],a[172:175],v[212:215],v[232:247]
 s_waitcnt lgkmcnt(5)
 v_pk_add_f32 v[56:57],v[56:57],v[64:65]
 v_pk_add_f32 v[58:59],v[58:59],v[66:67]
 s_waitcnt lgkmcnt(4)
 v_pk_add_f32 v[60:61],v[60:61],v[68:69]
 v_pk_add_f32 v[62:63],v[62:63],v[70:71]
 s_waitcnt lgkmcnt(1)
 v_pk_add_f32 v[72:73],v[72:73],v[80:81]
 v_pk_add_f32 v[74:75],v[74:75],v[82:83]
 s_waitcnt lgkmcnt(0)
 v_pk_add_f32 v[76:77],v[76:77],v[84:85]
 v_pk_add_f32 v[78:79],v[78:79],v[86:87]
 s_barrier
 ds_write_b128 v18,v[120:123] offset:0
 v_pk_add_f32 v[56:57],v[56:57],v[72:73]
 v_pk_add_f32 v[58:59],v[58:59],v[74:75]
 v_pk_add_f32 v[60:61],v[60:61],v[76:77]
 v_pk_add_f32 v[62:63],v[62:63],v[78:79]
 s_add_u32 s96,s95,6
 s_and_b32 s96,s96,7
 s_mul_i32 s96,s96,176128
 s_add_u32 s96,s96,s62
 s_add_u32 m0,s54,106496
 s_add_u32 s52,s96,0
 buffer_load_dwordx4 v8,s[20:23],s52 offen lds
 s_add_u32 s96,s96,s60
 s_add_u32 m0,s54,122880
 s_add_u32 s52,s96,0
 buffer_load_dwordx4 v8,s[20:23],s52 offen lds
 ds_write_b128 v18,v[124:127] offset:1024
 v_pk_fma_f32 v[56:57],v[56:57],v[28:29],v[40:41] op_sel_hi:[1,0,1]
 v_pk_fma_f32 v[58:59],v[58:59],v[28:29],v[42:43] op_sel_hi:[1,0,1]
 v_pk_fma_f32 v[60:61],v[60:61],v[28:29],v[44:45] op_sel_hi:[1,0,1]
 v_pk_fma_f32 v[62:63],v[62:63],v[28:29],v[46:47] op_sel_hi:[1,0,1]
 ds_write_b128 v18,v[128:131] offset:2048
 v_cvt_pk_bf16_f32 v64,v56,v57
 v_cvt_pk_bf16_f32 v65,v58,v59
 v_cvt_pk_bf16_f32 v66,v60,v61
 v_cvt_pk_bf16_f32 v67,v62,v63
 ds_write_b128 v18,v[132:135] offset:3072
 v_accvgpr_write_b32 a240,v64
 v_and_b32 v64,-2,v64
 s_and_b32 s52,s6,1
 s_xor_b32 s52,s52,0
 s_lshl_b32 s52,s52,11
 s_add_u32 s52,s52,s67
 buffer_store_dwordx4 v[64:67],v3,s[32:35],s52 offen sc1
 v_pk_add_f32 v[24:25],v[56:57],v[58:59]
 s_add_u32 s96,s95,7
 s_and_b32 s96,s96,7
 s_mul_i32 s96,s96,176128
 s_add_u32 s96,s96,s62
 s_add_u32 m0,s54,110592
 s_add_u32 s52,s96,0
 buffer_load_dwordx4 v8,s[20:23],s52 offen lds
 s_add_u32 s96,s96,s60
 s_add_u32 m0,s54,126976
 s_add_u32 s52,s96,0
 buffer_load_dwordx4 v8,s[20:23],s52 offen lds
 ds_write_b128 v18,v[232:235] offset:4096
 v_pk_mul_f32 v[26:27],v[56:57],v[56:57]
 v_pk_fma_f32 v[26:27],v[58:59],v[58:59],v[26:27]
 v_pk_add_f32 v[24:25],v[24:25],v[60:61]
 v_pk_fma_f32 v[26:27],v[60:61],v[60:61],v[26:27]
 ds_write_b128 v18,v[236:239] offset:5120
 v_pk_add_f32 v[24:25],v[24:25],v[62:63]
 v_pk_fma_f32 v[26:27],v[62:63],v[62:63],v[26:27]
 v_accvgpr_write_b32 a241,v65
 v_accvgpr_write_b32 a242,v66
 ds_write_b128 v18,v[240:243] offset:6144
 v_accvgpr_write_b32 a243,v67
 ds_write_b128 v18,v[244:247] offset:7168
 s_waitcnt lgkmcnt(0)
 s_barrier
 ds_read_b128 v[56:59],v15 offset:0
 ds_read_b128 v[60:63],v15 offset:1024
 ds_read_b128 v[64:67],v15 offset:8192
 ds_read_b128 v[68:71],v15 offset:9216
 ds_read_b128 v[72:75],v15 offset:16384
 ds_read_b128 v[76:79],v15 offset:17408
 ds_read_b128 v[80:83],v15 offset:24576
 ds_read_b128 v[84:87],v15 offset:25600
 s_add_u32 s52,s56,0
 v_add_u32 v2,s52,v1
 s_waitcnt lgkmcnt(5)
 v_pk_add_f32 v[56:57],v[56:57],v[64:65]
 v_pk_add_f32 v[58:59],v[58:59],v[66:67]
 s_waitcnt lgkmcnt(4)
 v_pk_add_f32 v[60:61],v[60:61],v[68:69]
 v_pk_add_f32 v[62:63],v[62:63],v[70:71]
 s_waitcnt lgkmcnt(1)
 v_pk_add_f32 v[72:73],v[72:73],v[80:81]
 v_pk_add_f32 v[74:75],v[74:75],v[82:83]
 s_waitcnt lgkmcnt(0)
 v_pk_add_f32 v[76:77],v[76:77],v[84:85]
 v_pk_add_f32 v[78:79],v[78:79],v[86:87]
 v_pk_add_f32 v[56:57],v[56:57],v[72:73]
 v_pk_add_f32 v[58:59],v[58:59],v[74:75]
 v_pk_add_f32 v[60:61],v[60:61],v[76:77]
 v_pk_add_f32 v[62:63],v[62:63],v[78:79]
 v_pk_fma_f32 v[56:57],v[56:57],v[28:29],v[48:49] op_sel_hi:[1,0,1]
 v_pk_fma_f32 v[58:59],v[58:59],v[28:29],v[50:51] op_sel_hi:[1,0,1]
 v_pk_fma_f32 v[60:61],v[60:61],v[28:29],v[52:53] op_sel_hi:[1,0,1]
 v_pk_fma_f32 v[62:63],v[62:63],v[28:29],v[54:55] op_sel_hi:[1,0,1]
 v_cvt_pk_bf16_f32 v64,v56,v57
 v_cvt_pk_bf16_f32 v65,v58,v59
 v_cvt_pk_bf16_f32 v66,v60,v61
 v_cvt_pk_bf16_f32 v67,v62,v63
 v_accvgpr_write_b32 a244,v64
 v_and_b32 v64,-2,v64
 s_and_b32 s52,s6,1
 s_xor_b32 s52,s52,1
 s_lshl_b32 s52,s52,11
 s_add_u32 s52,s52,s67
 buffer_store_dwordx4 v[64:67],v3,s[32:35],s52 offen sc1
 v_pk_add_f32 v[24:25],v[24:25],v[56:57]
 v_pk_fma_f32 v[26:27],v[56:57],v[56:57],v[26:27]
 v_pk_add_f32 v[24:25],v[24:25],v[58:59]
 buffer_load_dwordx4 v[136:139],v2,s[32:35],s36 offen sc1
 v_pk_fma_f32 v[26:27],v[58:59],v[58:59],v[26:27]
 v_pk_add_f32 v[24:25],v[24:25],v[60:61]
 v_pk_fma_f32 v[26:27],v[60:61],v[60:61],v[26:27]
 buffer_load_dwordx4 v[140:143],v2,s[32:35],s36 offen offset:1024 sc1
 v_pk_add_f32 v[24:25],v[24:25],v[62:63]
 v_pk_fma_f32 v[26:27],v[62:63],v[62:63],v[26:27]
 v_accvgpr_write_b32 a245,v65
 buffer_load_dwordx4 v[152:155],v2,s[32:35],s37 offen sc1
 v_accvgpr_write_b32 a246,v66
 v_accvgpr_write_b32 a247,v67
 v_add_f32 v24,v24,v25
 buffer_load_dwordx4 v[156:159],v2,s[32:35],s37 offen offset:1024 sc1
 v_add_f32 v26,v26,v27
 v_and_b32 v27,512,v3
 v_add_u32 v27,v27,v3
 buffer_load_dwordx4 v[168:171],v2,s[32:35],s38 offen sc1
 v_permlane16_swap_b32 v24,v26
 v_add_f32 v24,v24,v26
 v_mov_b32 v25,v24
 buffer_load_dwordx4 v[172:175],v2,s[32:35],s38 offen offset:1024 sc1
 s_nop 0
 v_permlane32_swap_b32 v24,v25
 v_add_f32 v24,v24,v25
 v_or_b32 v24,1,v24
 buffer_load_dwordx4 v[184:187],v2,s[32:35],s39 offen sc1
 s_mov_b32 exec_hi,0
 s_add_u32 s52,s79,131072
 buffer_store_dword v24,v27,s[32:35],s52 offen sc1
 s_mov_b64 exec,-1
 buffer_load_dwordx4 v[188:191],v2,s[32:35],s39 offen offset:1024 sc1
 buffer_load_dwordx4 v[200:203],v2,s[32:35],s40 offen sc1
 buffer_load_dwordx4 v[204:207],v2,s[32:35],s40 offen offset:1024 sc1
 buffer_load_dwordx4 v[216:219],v2,s[32:35],s41 offen sc1
 ds_read_b64_tr_b16 v[40:41],v4 offset:0
 ds_read_b64_tr_b16 v[42:43],v4 offset:512
 ds_read_b64_tr_b16 v[44:45],v4 offset:32768
 ds_read_b64_tr_b16 v[46:47],v4 offset:33280
 ds_read_b64_tr_b16 v[48:49],v4 offset:1024
 ds_read_b64_tr_b16 v[50:51],v4 offset:1536
 ds_read_b64_tr_b16 v[52:53],v4 offset:33792
 ds_read_b64_tr_b16 v[54:55],v4 offset:34304
 s_waitcnt vmcnt(10)
 v_bitop3_b32 v38,v136,v140,1 bitop3:0xa8
 v_cmp_ne_u32 vcc,0,v38
 s_cbranch_vccnz Lfix_496
Lret_497:
 s_waitcnt lgkmcnt(4)
 v_mfma_f32_32x32x16_bf16 v[88:103],v[136:139],v[40:43],0
 ds_read_b64_tr_b16 v[40:41],v4 offset:4096
 ds_read_b64_tr_b16 v[42:43],v4 offset:4608
 buffer_load_dwordx4 v[220:223],v2,s[32:35],s41 offen offset:1024 sc1
 v_mov_b32 v26,0
 v_mfma_f32_32x32x16_bf16 v[104:119],v[136:139],v[44:47],0
 ds_read_b64_tr_b16 v[44:45],v4 offset:36864
 ds_read_b64_tr_b16 v[46:47],v4 offset:37376
 v_mov_b32 v27,0
 s_waitcnt vmcnt(9) lgkmcnt(4)
 v_mfma_f32_32x32x16_bf16 v[88:103],v[140:143],v[48:51],v[88:103]
 ds_read_b64_tr_b16 v[48:49],v4 offset:5120
 ds_read_b64_tr_b16 v[50:51],v4 offset:5632
 buffer_load_dwordx4 v[232:235],v2,s[32:35],s42 offen sc1
 v_bitop3_b32 v38,v152,v156,1 bitop3:0xa8
 v_cmp_ne_u32 vcc,0,v38
 v_mfma_f32_32x32x16_bf16 v[104:119],v[140:143],v[52:55],v[104:119]
 ds_read_b64_tr_b16 v[52:53],v4 offset:37888
 ds_read_b64_tr_b16 v[54:55],v4 offset:38400
 v_mov_b32 v30,0
 s_cbranch_vccnz Lfix_499
Lret_500:
 s_waitcnt lgkmcnt(4)
 v_mfma_f32_32x32x16_bf16 v[88:103],v[152:155],v[40:43],v[88:103]
 ds_read_b64_tr_b16 v[40:41],v4 offset:8192
 ds_read_b64_tr_b16 v[42:43],v4 offset:8704
 buffer_load_dwordx4 v[236:239],v2,s[32:35],s42 offen offset:1024 sc1
 v_mov_b32 v31,0
 v_mfma_f32_32x32x16_bf16 v[104:119],v[152:155],v[44:47],v[104:119]
 ds_read_b64_tr_b16 v[44:45],v4 offset:40960
 ds_read_b64_tr_b16 v[46:47],v4 offset:41472
 v_mov_b32 v32,0x3f803f80
 s_waitcnt vmcnt(9) lgkmcnt(4)
 v_mfma_f32_32x32x16_bf16 v[88:103],v[156:159],v[48:51],v[88:103]
 ds_read_b64_tr_b16 v[48:49],v4 offset:9216
 ds_read_b64_tr_b16 v[50:51],v4 offset:9728
 buffer_load_dwordx4 v[248:251],v2,s[32:35],s43 offen sc1
 v_bitop3_b32 v38,v168,v172,1 bitop3:0xa8
 v_cmp_ne_u32 vcc,0,v38
 v_mfma_f32_32x32x16_bf16 v[104:119],v[156:159],v[52:55],v[104:119]
 ds_read_b64_tr_b16 v[52:53],v4 offset:41984
 ds_read_b64_tr_b16 v[54:55],v4 offset:42496
 v_mov_b32 v33,0x3f803f80
 s_cbranch_vccnz Lfix_502
Lret_503:
 s_waitcnt lgkmcnt(4)
 v_mfma_f32_32x32x16_bf16 v[88:103],v[168:171],v[40:43],v[88:103]
 ds_read_b64_tr_b16 v[40:41],v4 offset:12288
 ds_read_b64_tr_b16 v[42:43],v4 offset:12800
 buffer_load_dwordx4 v[252:255],v2,s[32:35],s43 offen offset:1024 sc1
 v_subrev_u32 v18,0x20000,v18
 v_mfma_f32_32x32x16_bf16 v[104:119],v[168:171],v[44:47],v[104:119]
 ds_read_b64_tr_b16 v[44:45],v4 offset:45056
 ds_read_b64_tr_b16 v[46:47],v4 offset:45568
 v_subrev_u32 v15,0x20000,v15
 s_waitcnt vmcnt(8) lgkmcnt(4)
 v_mfma_f32_32x32x16_bf16 v[88:103],v[172:175],v[48:51],v[88:103]
 ds_read_b64_tr_b16 v[48:49],v4 offset:13312
 ds_read_b64_tr_b16 v[50:51],v4 offset:13824
 buffer_load_dwordx4 v[144:147],v2,s[32:35],s8 offen sc1
 v_bitop3_b32 v38,v184,v188,1 bitop3:0xa8
 v_cmp_ne_u32 vcc,0,v38
 v_mfma_f32_32x32x16_bf16 v[104:119],v[172:175],v[52:55],v[104:119]
 ds_read_b64_tr_b16 v[52:53],v4 offset:46080
 ds_read_b64_tr_b16 v[54:55],v4 offset:46592
 s_cbranch_vccnz Lfix_505
Lret_506:
 s_waitcnt lgkmcnt(4)
 v_mfma_f32_32x32x16_bf16 v[88:103],v[184:187],v[40:43],v[88:103]
 ds_read_b64_tr_b16 v[40:41],v4 offset:16384
 ds_read_b64_tr_b16 v[42:43],v4 offset:16896
 buffer_load_dwordx4 v[148:151],v2,s[32:35],s8 offen offset:1024 sc1
 v_mfma_f32_32x32x16_bf16 v[104:119],v[184:187],v[44:47],v[104:119]
 ds_read_b64_tr_b16 v[44:45],v4 offset:49152
 ds_read_b64_tr_b16 v[46:47],v4 offset:49664
 s_waitcnt vmcnt(8) lgkmcnt(4)
 v_mfma_f32_32x32x16_bf16 v[88:103],v[188:191],v[48:51],v[88:103]
 ds_read_b64_tr_b16 v[48:49],v4 offset:17408
 ds_read_b64_tr_b16 v[50:51],v4 offset:17920
 buffer_load_dwordx4 v[160:163],v2,s[32:35],s9 offen sc1
 v_bitop3_b32 v38,v200,v204,1 bitop3:0xa8
 v_cmp_ne_u32 vcc,0,v38
 v_mfma_f32_32x32x16_bf16 v[104:119],v[188:191],v[52:55],v[104:119]
 ds_read_b64_tr_b16 v[52:53],v4 offset:50176
 ds_read_b64_tr_b16 v[54:55],v4 offset:50688
 s_cbranch_vccnz Lfix_508
Lret_509:
 s_waitcnt lgkmcnt(4)
 v_mfma_f32_32x32x16_bf16 v[88:103],v[200:203],v[40:43],v[88:103]
 ds_read_b64_tr_b16 v[40:41],v4 offset:20480
 ds_read_b64_tr_b16 v[42:43],v4 offset:20992
 buffer_load_dwordx4 v[164:167],v2,s[32:35],s9 offen offset:1024 sc1
 v_mfma_f32_32x32x16_bf16 v[104:119],v[200:203],v[44:47],v[104:119]
 ds_read_b64_tr_b16 v[44:45],v4 offset:53248
 ds_read_b64_tr_b16 v[46:47],v4 offset:53760
 s_waitcnt vmcnt(8) lgkmcnt(4)
 v_mfma_f32_32x32x16_bf16 v[88:103],v[204:207],v[48:51],v[88:103]
 ds_read_b64_tr_b16 v[48:49],v4 offset:21504
 ds_read_b64_tr_b16 v[50:51],v4 offset:22016
 s_add_u32 s84,s58,131072
 buffer_load_dwordx4 v[72:75],v13,s[32:35],s84 offen sc1
 buffer_load_dwordx4 v[76:79],v13,s[32:35],s84 offen offset:512 sc1
 buffer_load_dwordx4 v[176:179],v2,s[32:35],s10 offen sc1
 v_bitop3_b32 v38,v216,v220,1 bitop3:0xa8
 v_cmp_ne_u32 vcc,0,v38
 v_mfma_f32_32x32x16_bf16 v[104:119],v[204:207],v[52:55],v[104:119]
 ds_read_b64_tr_b16 v[52:53],v4 offset:54272
 ds_read_b64_tr_b16 v[54:55],v4 offset:54784
 s_cbranch_vccnz Lfix_511
Lret_512:
 s_waitcnt lgkmcnt(4)
 v_mfma_f32_32x32x16_bf16 v[88:103],v[216:219],v[40:43],v[88:103]
 ds_read_b64_tr_b16 v[40:41],v4 offset:24576
 ds_read_b64_tr_b16 v[42:43],v4 offset:25088
 buffer_load_dwordx4 v[180:183],v2,s[32:35],s10 offen offset:1024 sc1
 v_mfma_f32_32x32x16_bf16 v[104:119],v[216:219],v[44:47],v[104:119]
 ds_read_b64_tr_b16 v[44:45],v4 offset:57344
 ds_read_b64_tr_b16 v[46:47],v4 offset:57856
 s_waitcnt vmcnt(10) lgkmcnt(4)
 v_mfma_f32_32x32x16_bf16 v[88:103],v[220:223],v[48:51],v[88:103]
 ds_read_b64_tr_b16 v[48:49],v4 offset:25600
 ds_read_b64_tr_b16 v[50:51],v4 offset:26112
 buffer_load_dwordx4 v[192:195],v2,s[32:35],s11 offen sc1
 v_bitop3_b32 v38,v232,v236,1 bitop3:0xa8
 v_cmp_ne_u32 vcc,0,v38
 v_mfma_f32_32x32x16_bf16 v[104:119],v[220:223],v[52:55],v[104:119]
 ds_read_b64_tr_b16 v[52:53],v4 offset:58368
 ds_read_b64_tr_b16 v[54:55],v4 offset:58880
 s_cbranch_vccnz Lfix_514
Lret_515:
 s_waitcnt lgkmcnt(4)
 v_mfma_f32_32x32x16_bf16 v[88:103],v[232:235],v[40:43],v[88:103]
 ds_read_b64_tr_b16 v[40:41],v4 offset:28672
 ds_read_b64_tr_b16 v[42:43],v4 offset:29184
 buffer_load_dwordx4 v[196:199],v2,s[32:35],s11 offen offset:1024 sc1
 s_waitcnt lgkmcnt(0)
 s_barrier
 v_mfma_f32_32x32x16_bf16 v[104:119],v[232:235],v[44:47],v[104:119]
 ds_read_b64_tr_b16 v[44:45],v4 offset:61440
 ds_read_b64_tr_b16 v[46:47],v4 offset:61952
 s_waitcnt vmcnt(10)
 v_mfma_f32_32x32x16_bf16 v[88:103],v[236:239],v[48:51],v[88:103]
 ds_read_b64_tr_b16 v[48:49],v4 offset:29696
 ds_read_b64_tr_b16 v[50:51],v4 offset:30208
 buffer_load_dwordx4 v[208:211],v2,s[32:35],s57 offen sc1
 v_bitop3_b32 v38,v248,v252,1 bitop3:0xa8
 v_cmp_ne_u32 vcc,0,v38
 v_mfma_f32_32x32x16_bf16 v[104:119],v[236:239],v[52:55],v[104:119]
 ds_read_b64_tr_b16 v[52:53],v4 offset:62464
 ds_read_b64_tr_b16 v[54:55],v4 offset:62976
 s_cbranch_vccnz Lfix_517
Lret_518:
 s_waitcnt lgkmcnt(4)
 v_mfma_f32_32x32x16_bf16 v[88:103],v[248:251],v[40:43],v[88:103]
 ds_read_b64_tr_b16 v[40:41],v4 offset:2048
 ds_read_b64_tr_b16 v[42:43],v4 offset:2560
 buffer_load_dwordx4 v[212:215],v2,s[32:35],s57 offen offset:1024 sc1
 v_mfma_f32_32x32x16_bf16 v[104:119],v[248:251],v[44:47],v[104:119]
 ds_read_b64_tr_b16 v[44:45],v4 offset:34816
 ds_read_b64_tr_b16 v[46:47],v4 offset:35328
 s_waitcnt vmcnt(10) lgkmcnt(4)
 v_mfma_f32_32x32x16_bf16 v[88:103],v[252:255],v[48:51],v[88:103]
 ds_read_b64_tr_b16 v[48:49],v4 offset:3072
 ds_read_b64_tr_b16 v[50:51],v4 offset:3584
 buffer_load_dwordx4 v[224:227],v2,s[32:35],s77 offen sc1
 v_bitop3_b32 v38,v144,v148,1 bitop3:0xa8
 v_cmp_ne_u32 vcc,0,v38
 v_mfma_f32_32x32x16_bf16 v[104:119],v[252:255],v[52:55],v[104:119]
 ds_read_b64_tr_b16 v[52:53],v4 offset:35840
 ds_read_b64_tr_b16 v[54:55],v4 offset:36352
 s_cbranch_vccnz Lfix_520
Lret_521:
 s_waitcnt lgkmcnt(4)
 v_mfma_f32_32x32x16_bf16 v[88:103],v[144:147],v[40:43],v[88:103]
 ds_read_b64_tr_b16 v[40:41],v4 offset:6144
 ds_read_b64_tr_b16 v[42:43],v4 offset:6656
 buffer_load_dwordx4 v[228:231],v2,s[32:35],s77 offen offset:1024 sc1
 v_mfma_f32_32x32x16_bf16 v[104:119],v[144:147],v[44:47],v[104:119]
 ds_read_b64_tr_b16 v[44:45],v4 offset:38912
 ds_read_b64_tr_b16 v[46:47],v4 offset:39424
 s_waitcnt vmcnt(10) lgkmcnt(4)
 v_mfma_f32_32x32x16_bf16 v[88:103],v[148:151],v[48:51],v[88:103]
 ds_read_b64_tr_b16 v[48:49],v4 offset:7168
 ds_read_b64_tr_b16 v[50:51],v4 offset:7680
 buffer_load_dwordx4 v[240:243],v2,s[32:35],s81 offen sc1
 v_bitop3_b32 v38,v160,v164,1 bitop3:0xa8
 v_cmp_ne_u32 vcc,0,v38
 v_mfma_f32_32x32x16_bf16 v[104:119],v[148:151],v[52:55],v[104:119]
 ds_read_b64_tr_b16 v[52:53],v4 offset:39936
 ds_read_b64_tr_b16 v[54:55],v4 offset:40448
 s_cbranch_vccnz Lfix_523
Lret_524:
 s_waitcnt lgkmcnt(4)
 v_mfma_f32_32x32x16_bf16 v[88:103],v[160:163],v[40:43],v[88:103]
 ds_read_b64_tr_b16 v[40:41],v4 offset:10240
 ds_read_b64_tr_b16 v[42:43],v4 offset:10752
 buffer_load_dwordx4 v[244:247],v2,s[32:35],s81 offen offset:1024 sc1
 v_mfma_f32_32x32x16_bf16 v[104:119],v[160:163],v[44:47],v[104:119]
 ds_read_b64_tr_b16 v[44:45],v4 offset:43008
 ds_read_b64_tr_b16 v[46:47],v4 offset:43520
 s_waitcnt vmcnt(8) lgkmcnt(4)
 v_mfma_f32_32x32x16_bf16 v[88:103],v[164:167],v[48:51],v[88:103]
 ds_read_b64_tr_b16 v[48:49],v4 offset:11264
 ds_read_b64_tr_b16 v[50:51],v4 offset:11776
 buffer_load_dwordx4 a[248:251],v2,s[32:35],s99 offen sc1
 v_bitop3_b32 v38,v176,v180,1 bitop3:0xa8
 v_cmp_ne_u32 vcc,0,v38
 v_mfma_f32_32x32x16_bf16 v[104:119],v[164:167],v[52:55],v[104:119]
 ds_read_b64_tr_b16 v[52:53],v4 offset:44032
 ds_read_b64_tr_b16 v[54:55],v4 offset:44544
 v_and_b32 v38,v72,v73
 v_bitop3_b32 v38,v74,v75,v38 bitop3:0x80
 v_bitop3_b32 v38,v76,v77,v38 bitop3:0x80
 v_bitop3_b32 v38,v78,v79,v38 bitop3:0x80
 v_and_b32 v38,1,v38
 v_cmp_eq_u32 s[82:83],0,v38
 s_nop 0
 s_cmp_lg_u64 s[82:83],0
 s_cbranch_scc1 Lfix_529
Lret_530:
 v_add_f32 v72,v72,v73
 s_cbranch_vccnz Lfix_526
Lret_527:
 s_waitcnt lgkmcnt(4)
 v_mfma_f32_32x32x16_bf16 v[88:103],v[176:179],v[40:43],v[88:103]
 ds_read_b64_tr_b16 v[40:41],v4 offset:14336
 ds_read_b64_tr_b16 v[42:43],v4 offset:14848
 buffer_load_dwordx4 a[252:255],v2,s[32:35],s99 offen offset:1024 sc1
 v_add_f32 v74,v74,v75
 v_add_f32 v76,v76,v77
 v_mfma_f32_32x32x16_bf16 v[104:119],v[176:179],v[44:47],v[104:119]
 ds_read_b64_tr_b16 v[44:45],v4 offset:47104
 ds_read_b64_tr_b16 v[46:47],v4 offset:47616
 v_add_f32 v78,v78,v79
 v_add_f32 v72,v72,v74
 s_waitcnt vmcnt(8) lgkmcnt(4)
 v_mfma_f32_32x32x16_bf16 v[88:103],v[180:183],v[48:51],v[88:103]
 ds_read_b64_tr_b16 v[48:49],v4 offset:15360
 ds_read_b64_tr_b16 v[50:51],v4 offset:15872
 s_add_u32 s96,s95,0
 s_and_b32 s96,s96,7
 s_mul_i32 s96,s96,196608
 s_add_u32 s96,s96,s61
 s_add_u32 m0,s54,65536
 s_add_u32 s52,s96,0
 buffer_load_dwordx4 v7,s[12:15],s52 offen lds
 v_bitop3_b32 v38,v192,v196,1 bitop3:0xa8
 v_cmp_ne_u32 vcc,0,v38
 v_mfma_f32_32x32x16_bf16 v[104:119],v[180:183],v[52:55],v[104:119]
 ds_read_b64_tr_b16 v[52:53],v4 offset:48128
 ds_read_b64_tr_b16 v[54:55],v4 offset:48640
 v_add_f32 v76,v76,v78
 v_add_f32 v72,v72,v76
 s_cbranch_vccnz Lfix_532
Lret_533:
 s_waitcnt lgkmcnt(4)
 v_mfma_f32_32x32x16_bf16 v[88:103],v[192:195],v[40:43],v[88:103]
 ds_read_b64_tr_b16 v[40:41],v4 offset:18432
 ds_read_b64_tr_b16 v[42:43],v4 offset:18944
 s_add_u32 s96,s95,1
 s_and_b32 s96,s96,7
 s_mul_i32 s96,s96,196608
 s_add_u32 s96,s96,s61
 s_add_u32 m0,s54,69632
 s_add_u32 s52,s96,0
 buffer_load_dwordx4 v7,s[12:15],s52 offen lds
 v_mov_b32 v73,v72
 s_nop 1
 v_permlane32_swap_b32 v72,v73
 v_mfma_f32_32x32x16_bf16 v[104:119],v[192:195],v[44:47],v[104:119]
 ds_read_b64_tr_b16 v[44:45],v4 offset:51200
 ds_read_b64_tr_b16 v[46:47],v4 offset:51712
 v_mul_f32 v72,s74,v72
 v_mul_f32 v73,s74,v73
 s_waitcnt vmcnt(8) lgkmcnt(4)
 v_mfma_f32_32x32x16_bf16 v[88:103],v[196:199],v[48:51],v[88:103]
 ds_read_b64_tr_b16 v[48:49],v4 offset:19456
 ds_read_b64_tr_b16 v[50:51],v4 offset:19968
 s_add_u32 s96,s95,2
 s_and_b32 s96,s96,7
 s_mul_i32 s96,s96,196608
 s_add_u32 s96,s96,s61
 s_add_u32 m0,s54,73728
 s_add_u32 s52,s96,0
 buffer_load_dwordx4 v7,s[12:15],s52 offen lds
 v_bitop3_b32 v38,v208,v212,1 bitop3:0xa8
 v_cmp_ne_u32 vcc,0,v38
 v_mfma_f32_32x32x16_bf16 v[104:119],v[196:199],v[52:55],v[104:119]
 ds_read_b64_tr_b16 v[52:53],v4 offset:52224
 ds_read_b64_tr_b16 v[54:55],v4 offset:52736
 v_fma_f32 v73,-v72,v72,v73
 v_max_f32 v73,0,v73
 s_cbranch_vccnz Lfix_535
Lret_536:
 s_waitcnt lgkmcnt(4)
 v_mfma_f32_32x32x16_bf16 v[88:103],v[208:211],v[40:43],v[88:103]
 ds_read_b64_tr_b16 v[40:41],v4 offset:22528
 ds_read_b64_tr_b16 v[42:43],v4 offset:23040
 s_add_u32 s96,s95,3
 s_and_b32 s96,s96,7
 s_mul_i32 s96,s96,196608
 s_add_u32 s96,s96,s61
 s_add_u32 m0,s54,77824
 s_add_u32 s52,s96,0
 buffer_load_dwordx4 v7,s[12:15],s52 offen lds
 v_add_f32 v73,s75,v73
 v_rsq_f32 v73,v73
 v_mfma_f32_32x32x16_bf16 v[104:119],v[208:211],v[44:47],v[104:119]
 ds_read_b64_tr_b16 v[44:45],v4 offset:55296
 ds_read_b64_tr_b16 v[46:47],v4 offset:55808
 v_mul_f32 v16,s73,v73
 v_cndmask_b32_e64 v72,0,-v72,s[92:93]
 s_waitcnt vmcnt(8) lgkmcnt(4)
 v_mfma_f32_32x32x16_bf16 v[88:103],v[212:215],v[48:51],v[88:103]
 ds_read_b64_tr_b16 v[48:49],v4 offset:23552
 ds_read_b64_tr_b16 v[50:51],v4 offset:24064
 s_add_u32 s96,s95,4
 s_and_b32 s96,s96,7
 s_mul_i32 s96,s96,196608
 s_add_u32 s96,s96,s61
 s_add_u32 m0,s54,81920
 s_add_u32 s52,s96,0
 buffer_load_dwordx4 v7,s[12:15],s52 offen lds
 v_bitop3_b32 v38,v224,v228,1 bitop3:0xa8
 v_cmp_ne_u32 vcc,0,v38
 v_mfma_f32_32x32x16_bf16 v[104:119],v[212:215],v[52:55],v[104:119]
 ds_read_b64_tr_b16 v[52:53],v4 offset:56320
 ds_read_b64_tr_b16 v[54:55],v4 offset:56832
 v_cvt_pk_bf16_f32 v24,v72,v72
 v_lshlrev_b32 v74,16,v24
 s_cbranch_vccnz Lfix_538
Lret_539:
 s_waitcnt lgkmcnt(4)
 v_mfma_f32_32x32x16_bf16 v[88:103],v[224:227],v[40:43],v[88:103]
 ds_read_b64_tr_b16 v[40:41],v4 offset:26624
 ds_read_b64_tr_b16 v[42:43],v4 offset:27136
 s_add_u32 s96,s95,5
 s_and_b32 s96,s96,7
 s_mul_i32 s96,s96,196608
 s_add_u32 s96,s96,s61
 s_add_u32 m0,s54,86016
 s_add_u32 s52,s96,0
 buffer_load_dwordx4 v7,s[12:15],s52 offen lds
 v_sub_f32 v72,v72,v74
 v_cvt_pk_bf16_f32 v25,v72,v72
 v_mfma_f32_32x32x16_bf16 v[104:119],v[224:227],v[44:47],v[104:119]
 ds_read_b64_tr_b16 v[44:45],v4 offset:59392
 ds_read_b64_tr_b16 v[46:47],v4 offset:59904
 v_cndmask_b32 v73,0,v16,s[92:93]
 v_cvt_pk_bf16_f32 v74,v73,v73
 s_waitcnt vmcnt(8) lgkmcnt(4)
 v_mfma_f32_32x32x16_bf16 v[88:103],v[228:231],v[48:51],v[88:103]
 ds_read_b64_tr_b16 v[48:49],v4 offset:27648
 ds_read_b64_tr_b16 v[50:51],v4 offset:28160
 s_add_u32 s96,s95,6
 s_and_b32 s96,s96,7
 s_mul_i32 s96,s96,196608
 s_add_u32 s96,s96,s61
 s_add_u32 m0,s54,90112
 s_add_u32 s52,s96,0
 buffer_load_dwordx4 v7,s[12:15],s52 offen lds
 v_bitop3_b32 v38,v240,v244,1 bitop3:0xa8
 v_cmp_ne_u32 vcc,0,v38
 v_mfma_f32_32x32x16_bf16 v[104:119],v[228:231],v[52:55],v[104:119]
 ds_read_b64_tr_b16 v[52:53],v4 offset:60416
 ds_read_b64_tr_b16 v[54:55],v4 offset:60928
 v_lshlrev_b32 v74,16,v74
 v_sub_f32 v74,v73,v74
 s_cbranch_vccnz Lfix_541
Lret_542:
 s_waitcnt lgkmcnt(4)
 v_mfma_f32_32x32x16_bf16 v[88:103],v[240:243],v[40:43],v[88:103]
 ds_read_b64_tr_b16 v[40:41],v4 offset:30720
 ds_read_b64_tr_b16 v[42:43],v4 offset:31232
 s_add_u32 s96,s95,7
 s_and_b32 s96,s96,7
 s_mul_i32 s96,s96,196608
 s_add_u32 s96,s96,s61
 s_add_u32 m0,s54,94208
 s_add_u32 s52,s96,0
 buffer_load_dwordx4 v7,s[12:15],s52 offen lds
 v_cvt_pk_bf16_f32 v26,v73,v74
 s_nop 1
 v_mfma_f32_32x32x16_bf16 v[56:71],v[24:27],v[30:33],0
 v_mfma_f32_32x32x16_bf16 v[104:119],v[240:243],v[44:47],v[104:119]
 ds_read_b64_tr_b16 v[44:45],v4 offset:63488
 ds_read_b64_tr_b16 v[46:47],v4 offset:64000
 s_waitcnt vmcnt(8) lgkmcnt(4)
 v_mfma_f32_32x32x16_bf16 v[88:103],v[244:247],v[48:51],v[88:103]
 ds_read_b64_tr_b16 v[48:49],v4 offset:31744
 ds_read_b64_tr_b16 v[50:51],v4 offset:32256
 v_accvgpr_read_b32 v38,a248
 v_lshlrev_b32 v38,31,v38
 v_cmp_ne_u32 s[82:83],0,v38
 v_accvgpr_read_b32 v38,a252
 v_lshlrev_b32 v38,31,v38
 v_cmp_ne_u32 vcc,0,v38
 s_nop 1
 s_or_b64 vcc,vcc,s[82:83]
 v_mfma_f32_32x32x16_bf16 v[104:119],v[244:247],v[52:55],v[104:119]
 ds_read_b64_tr_b16 v[52:53],v4 offset:64512
 ds_read_b64_tr_b16 v[54:55],v4 offset:65024
 s_cbranch_vccnz Lfix_544
Lret_545:
 s_waitcnt lgkmcnt(4)
 v_mfma_f32_32x32x16_bf16 v[88:103],a[248:251],v[40:43],v[88:103]
 v_mfma_f32_32x32x16_bf16 v[104:119],a[248:251],v[44:47],v[104:119]
 s_waitcnt lgkmcnt(0)
 v_mfma_f32_32x32x16_bf16 v[88:103],a[252:255],v[48:51],v[88:103]
 v_mfma_f32_32x32x16_bf16 v[104:119],a[252:255],v[52:55],v[104:119]
 v_mov_b32 v28,v20
 v_mov_b32 v29,v20
 s_nop 1
 v_mfma_f32_32x32x16_bf16 v[88:103],v[24:27],v[28:31],v[88:103]
 v_mov_b32 v28,v21
 v_mov_b32 v29,v21
 s_nop 1
 v_mfma_f32_32x32x16_bf16 v[104:119],v[24:27],v[28:31],v[104:119]
 s_nop 6
 v_pk_fma_f32 v[88:89],v[88:89],v[56:57],s[88:89]
 v_pk_fma_f32 v[90:91],v[90:91],v[58:59],s[88:89]
 v_pk_fma_f32 v[92:93],v[92:93],v[60:61],s[88:89]
 v_pk_fma_f32 v[94:95],v[94:95],v[62:63],s[88:89]
 v_exp_f32_e64 v72,v88 clamp
 v_exp_f32_e64 v73,v89 clamp
 v_exp_f32_e64 v74,v90 clamp
 v_exp_f32_e64 v75,v91 clamp
 v_exp_f32_e64 v76,v92 clamp
 v_exp_f32_e64 v77,v93 clamp
 v_exp_f32_e64 v78,v94 clamp
 v_exp_f32_e64 v79,v95 clamp
 v_max_f32 v88,s88,v88
 v_max_f32 v89,s88,v89
 v_max_f32 v90,s88,v90
 v_max_f32 v91,s88,v91
 v_max_f32 v92,s88,v92
 v_max_f32 v93,s88,v93
 v_max_f32 v94,s88,v94
 v_max_f32 v95,s88,v95
 v_pk_fma_f32 v[88:89],v[88:89],s[90:91],v[72:73]
 v_pk_fma_f32 v[90:91],v[90:91],s[90:91],v[74:75]
 v_pk_fma_f32 v[92:93],v[92:93],s[90:91],v[76:77]
 v_pk_fma_f32 v[94:95],v[94:95],s[90:91],v[78:79]
 v_cvt_pk_bf16_f32 v88,v88,v89
 v_cvt_pk_bf16_f32 v89,v90,v91
 v_cvt_pk_bf16_f32 v90,v92,v93
 v_cvt_pk_bf16_f32 v91,v94,v95
 v_pk_fma_f32 v[96:97],v[96:97],v[64:65],s[88:89]
 v_pk_fma_f32 v[98:99],v[98:99],v[66:67],s[88:89]
 v_pk_fma_f32 v[100:101],v[100:101],v[68:69],s[88:89]
 v_pk_fma_f32 v[102:103],v[102:103],v[70:71],s[88:89]
 v_exp_f32_e64 v72,v96 clamp
 v_exp_f32_e64 v73,v97 clamp
 v_exp_f32_e64 v74,v98 clamp
 v_exp_f32_e64 v75,v99 clamp
 v_exp_f32_e64 v76,v100 clamp
 v_exp_f32_e64 v77,v101 clamp
 v_exp_f32_e64 v78,v102 clamp
 v_exp_f32_e64 v79,v103 clamp
 v_max_f32 v96,s88,v96
 v_max_f32 v97,s88,v97
 v_max_f32 v98,s88,v98
 v_max_f32 v99,s88,v99
 v_max_f32 v100,s88,v100
 v_max_f32 v101,s88,v101
 v_max_f32 v102,s88,v102
 v_max_f32 v103,s88,v103
 v_pk_fma_f32 v[96:97],v[96:97],s[90:91],v[72:73]
 v_pk_fma_f32 v[98:99],v[98:99],s[90:91],v[74:75]
 v_pk_fma_f32 v[100:101],v[100:101],s[90:91],v[76:77]
 v_pk_fma_f32 v[102:103],v[102:103],s[90:91],v[78:79]
 v_cvt_pk_bf16_f32 v92,v96,v97
 v_cvt_pk_bf16_f32 v93,v98,v99
 v_cvt_pk_bf16_f32 v94,v100,v101
 v_cvt_pk_bf16_f32 v95,v102,v103
 v_pk_mul_f32 v[104:105],v[104:105],v[56:57]
 v_pk_mul_f32 v[106:107],v[106:107],v[58:59]
 v_pk_mul_f32 v[108:109],v[108:109],v[60:61]
 v_pk_mul_f32 v[110:111],v[110:111],v[62:63]
 v_cvt_pk_bf16_f32 v104,v104,v105
 v_cvt_pk_bf16_f32 v105,v106,v107
 v_cvt_pk_bf16_f32 v106,v108,v109
 v_cvt_pk_bf16_f32 v107,v110,v111
 v_mov_b32 v96,v32
 v_mov_b32 v97,v32
 v_mov_b32 v98,v32
 v_mov_b32 v99,v32
 v_mov_b32 v100,v32
 v_mov_b32 v101,v32
 v_mov_b32 v102,v32
 v_mov_b32 v103,v32
 v_permlane16_swap_b32 v104,v96
 v_permlane16_swap_b32 v105,v97
 v_permlane16_swap_b32 v106,v98
 v_permlane16_swap_b32 v107,v99
 v_pk_mul_f32 v[112:113],v[112:113],v[64:65]
 v_pk_mul_f32 v[114:115],v[114:115],v[66:67]
 v_pk_mul_f32 v[116:117],v[116:117],v[68:69]
 v_pk_mul_f32 v[118:119],v[118:119],v[70:71]
 v_cvt_pk_bf16_f32 v108,v112,v113
 v_cvt_pk_bf16_f32 v109,v114,v115
 v_cvt_pk_bf16_f32 v110,v116,v117
 v_cvt_pk_bf16_f32 v111,v118,v119
 v_mfma_f32_32x32x16_bf16 v[72:87],v[88:91],v[96:99],0
 v_permlane16_swap_b32 v108,v100
 v_permlane16_swap_b32 v109,v101
 v_permlane16_swap_b32 v110,v102
 v_permlane16_swap_b32 v111,v103
 v_mfma_f32_32x32x16_bf16 v[56:71],v[88:91],v[104:107],0
 s_nop 0
 v_mfma_f32_32x32x16_bf16 v[72:87],v[92:95],v[100:103],v[72:87]
 v_mfma_f32_32x32x16_bf16 v[56:71],v[92:95],v[108:111],v[56:71]
 s_lshl_b32 s53,s4,12
 s_add_u32 s53,s53,147456
 v_add_u32 v112,s53,v1
 v_bfe_u32 v118,v0,1,4
 v_lshl_add_u32 v118,v17,5,v118
 v_lshlrev_b32 v118,4,v118
 s_lshl_b32 s53,s4,11
 v_add_u32 v118,s53,v118
 v_bfe_u32 v119,v0,1,2
 v_lshlrev_b32 v119,9,v119
 v_bfe_u32 v117,v0,2,1
 v_lshl_add_u32 v119,v117,10,v119
 v_add_u32 v119,256,v119
 s_cmp_eq_u32 s4,2
 s_cselect_b64 vcc,-1,0
 v_cndmask_b32 v113,v118,v119,vcc
 v_and_b32 v118,1,v0
 v_lshl_add_u32 v113,v118,10,v113
 v_add_u32 v113,0x24000,v113
 v_add_u32 v115,s54,v1
 s_and_b32 s53,s7,0xff
 v_mov_b32 v116,s53
 v_lshrrev_b32 v118,3,v0
 v_mul_u32_u24 v118,2560,v118
 v_and_b32 v119,7,v0
 v_lshl_add_u32 v114,v119,4,v118
 v_and_b32 v117,7,v0
 v_lshlrev_b32 v117,3,v117
 v_lshl_add_u32 v117,v17,2,v117
 s_cmp_eq_u32 s4,2
 s_cselect_b32 s53,128,0
 v_and_b32 v118,4,v0
 v_mad_u32_u24 v117,v118,s53,v117
 ds_write_b128 v112,v[80:83] offset:2048
 ds_write_b128 v112,v[84:87] offset:3072
 ds_write_b128 v112,v[56:59] offset:0
 ds_write_b128 v112,v[60:63] offset:1024
 s_waitcnt vmcnt(0)
 s_waitcnt lgkmcnt(0)
 s_barrier
 s_cmp_eq_u32 s4,3
 s_cbranch_scc1 Lw_547
 ds_read_b128 v[56:59],v113 offset:0
 ds_read_b128 v[60:63],v113 offset:4096
 ds_read_b128 v[64:67],v113 offset:8192
 ds_read_b128 v[68:71],v113 offset:12288
 s_waitcnt lgkmcnt(2)
 v_pk_add_f32 v[56:57],v[56:57],v[60:61]
 v_pk_add_f32 v[58:59],v[58:59],v[62:63]
 s_waitcnt lgkmcnt(0)
 v_pk_add_f32 v[64:65],v[64:65],v[68:69]
 v_pk_add_f32 v[66:67],v[66:67],v[70:71]
 v_pk_add_f32 v[56:57],v[56:57],v[64:65]
 v_pk_add_f32 v[58:59],v[58:59],v[66:67]
 v_cmp_gt_u32 vcc,2176,v115
 v_and_or_b32 v56,v56,s85,v116
 v_and_or_b32 v57,v57,s85,v116
 v_and_or_b32 v58,v58,s85,v116
 v_and_or_b32 v59,v59,s85,v116
 s_mul_i32 s53,s5,2560
 s_add_u32 s53,s53,s78
 s_mov_b64 exec,vcc
 s_add_u32 s52,s53,655360
 buffer_store_dwordx4 v[56:59],v115,s[32:35],s52 offen sc1
 s_mov_b64 exec,-1
Lw_547:
 s_xor_b32 s48,s49,1
 s_cmp_lg_u32 s48,0
 s_cbranch_scc1 Lp_548
 v_mov_b32 v60,v56
 v_mov_b32 v64,v56
 v_mov_b32 v61,v57
 v_mov_b32 v65,v57
 v_mov_b32 v62,v58
 v_mov_b32 v66,v58
 v_mov_b32 v63,v59
 v_mov_b32 v67,v59
 s_mov_b64 exec,s[100:101]
 s_add_u32 s52,s50,655360
 buffer_load_dwordx4 v[60:63],v114,s[32:35],s52 offen sc1
 s_mov_b64 exec,s[0:1]
 s_add_u32 s52,s50,675840
 buffer_load_dwordx4 v[64:67],v114,s[32:35],s52 offen sc1
 s_mov_b64 exec,-1
Lp_548:
 ds_read_b64_tr_b16 v[40:41],v5 offset:0
 ds_read_b64_tr_b16 v[42:43],v5 offset:512
 ds_read_b64_tr_b16 v[44:45],v5 offset:1024
 ds_read_b64_tr_b16 v[46:47],v5 offset:1536
 ds_read_b64_tr_b16 v[48:49],v5 offset:2048
 ds_read_b64_tr_b16 v[50:51],v5 offset:2560
 ds_read_b64_tr_b16 v[52:53],v5 offset:3072
 ds_read_b64_tr_b16 v[54:55],v5 offset:3584
 s_waitcnt lgkmcnt(6)
 v_mfma_f32_32x32x16_bf16 v[120:135],v[40:43],v[136:139],0
 ds_read_b64_tr_b16 v[40:41],v5 offset:4096
 ds_read_b64_tr_b16 v[42:43],v5 offset:4608
 s_waitcnt lgkmcnt(6)
 v_mfma_f32_32x32x16_bf16 v[120:135],v[44:47],v[140:143],v[120:135]
 ds_read_b64_tr_b16 v[44:45],v5 offset:5120
 ds_read_b64_tr_b16 v[46:47],v5 offset:5632
 s_waitcnt lgkmcnt(6)
 v_mfma_f32_32x32x16_bf16 v[120:135],v[48:51],v[144:147],v[120:135]
 ds_read_b64_tr_b16 v[48:49],v5 offset:6144
 ds_read_b64_tr_b16 v[50:51],v5 offset:6656
 s_waitcnt lgkmcnt(6)
 v_mfma_f32_32x32x16_bf16 v[120:135],v[52:55],v[148:151],v[120:135]
 ds_read_b64_tr_b16 v[52:53],v5 offset:7168
 ds_read_b64_tr_b16 v[54:55],v5 offset:7680
 s_waitcnt lgkmcnt(6)
 v_mfma_f32_32x32x16_bf16 v[120:135],v[40:43],v[152:155],v[120:135]
 ds_read_b64_tr_b16 v[40:41],v5 offset:8192
 ds_read_b64_tr_b16 v[42:43],v5 offset:8704
 s_waitcnt lgkmcnt(6)
 v_mfma_f32_32x32x16_bf16 v[120:135],v[44:47],v[156:159],v[120:135]
 ds_read_b64_tr_b16 v[44:45],v5 offset:9216
 ds_read_b64_tr_b16 v[46:47],v5 offset:9728
 s_waitcnt lgkmcnt(6)
 v_mfma_f32_32x32x16_bf16 v[120:135],v[48:51],v[160:163],v[120:135]
 ds_read_b64_tr_b16 v[48:49],v5 offset:10240
 ds_read_b64_tr_b16 v[50:51],v5 offset:10752
 s_waitcnt lgkmcnt(6)
 v_mfma_f32_32x32x16_bf16 v[120:135],v[52:55],v[164:167],v[120:135]
 ds_read_b64_tr_b16 v[52:53],v5 offset:11264
 ds_read_b64_tr_b16 v[54:55],v5 offset:11776
 s_waitcnt lgkmcnt(6)
 v_mfma_f32_32x32x16_bf16 v[120:135],v[40:43],v[168:171],v[120:135]
 ds_read_b64_tr_b16 v[40:41],v5 offset:12288
 ds_read_b64_tr_b16 v[42:43],v5 offset:12800
 s_waitcnt lgkmcnt(6)
 v_mfma_f32_32x32x16_bf16 v[120:135],v[44:47],v[172:175],v[120:135]
 ds_read_b64_tr_b16 v[44:45],v5 offset:13312
 ds_read_b64_tr_b16 v[46:47],v5 offset:13824
 s_waitcnt lgkmcnt(6)
 v_mfma_f32_32x32x16_bf16 v[120:135],v[48:51],v[176:179],v[120:135]
 ds_read_b64_tr_b16 v[48:49],v5 offset:14336
 ds_read_b64_tr_b16 v[50:51],v5 offset:14848
 s_waitcnt lgkmcnt(6)
 v_mfma_f32_32x32x16_bf16 v[120:135],v[52:55],v[180:183],v[120:135]
 ds_read_b64_tr_b16 v[52:53],v5 offset:15360
 ds_read_b64_tr_b16 v[54:55],v5 offset:15872
 s_waitcnt lgkmcnt(6)
 v_mfma_f32_32x32x16_bf16 v[120:135],v[40:43],v[184:187],v[120:135]
 ds_read_b64_tr_b16 v[40:41],v5 offset:16384
 ds_read_b64_tr_b16 v[42:43],v5 offset:16896
 s_waitcnt lgkmcnt(6)
 v_mfma_f32_32x32x16_bf16 v[120:135],v[44:47],v[188:191],v[120:135]
 ds_read_b64_tr_b16 v[44:45],v5 offset:17408
 ds_read_b64_tr_b16 v[46:47],v5 offset:17920
 s_waitcnt lgkmcnt(6)
 v_mfma_f32_32x32x16_bf16 v[120:135],v[48:51],v[192:195],v[120:135]
 ds_read_b64_tr_b16 v[48:49],v5 offset:18432
 ds_read_b64_tr_b16 v[50:51],v5 offset:18944
 s_waitcnt lgkmcnt(6)
 v_mfma_f32_32x32x16_bf16 v[120:135],v[52:55],v[196:199],v[120:135]
 ds_read_b64_tr_b16 v[52:53],v5 offset:19456
 ds_read_b64_tr_b16 v[54:55],v5 offset:19968
 s_waitcnt lgkmcnt(6)
 v_mfma_f32_32x32x16_bf16 v[120:135],v[40:43],v[200:203],v[120:135]
 ds_read_b64_tr_b16 v[40:41],v5 offset:20480
 ds_read_b64_tr_b16 v[42:43],v5 offset:20992
 s_waitcnt lgkmcnt(6)
 v_mfma_f32_32x32x16_bf16 v[120:135],v[44:47],v[204:207],v[120:135]
 ds_read_b64_tr_b16 v[44:45],v5 offset:21504
 ds_read_b64_tr_b16 v[46:47],v5 offset:22016
 s_waitcnt lgkmcnt(6)
 v_mfma_f32_32x32x16_bf16 v[120:135],v[48:51],v[208:211],v[120:135]
 ds_read_b64_tr_b16 v[48:49],v5 offset:22528
 ds_read_b64_tr_b16 v[50:51],v5 offset:23040
 s_waitcnt lgkmcnt(6)
 v_mfma_f32_32x32x16_bf16 v[120:135],v[52:55],v[212:215],v[120:135]
 ds_read_b64_tr_b16 v[52:53],v5 offset:23552
 ds_read_b64_tr_b16 v[54:55],v5 offset:24064
 s_waitcnt lgkmcnt(6)
 v_mfma_f32_32x32x16_bf16 v[120:135],v[40:43],v[216:219],v[120:135]
 ds_read_b64_tr_b16 v[40:41],v5 offset:24576
 ds_read_b64_tr_b16 v[42:43],v5 offset:25088
 s_waitcnt lgkmcnt(6)
 v_mfma_f32_32x32x16_bf16 v[120:135],v[44:47],v[220:223],v[120:135]
 ds_read_b64_tr_b16 v[44:45],v5 offset:25600
 ds_read_b64_tr_b16 v[46:47],v5 offset:26112
 s_waitcnt lgkmcnt(6)
 v_mfma_f32_32x32x16_bf16 v[120:135],v[48:51],v[224:227],v[120:135]
 ds_read_b64_tr_b16 v[48:49],v5 offset:26624
 ds_read_b64_tr_b16 v[50:51],v5 offset:27136
 s_waitcnt lgkmcnt(6)
 v_mfma_f32_32x32x16_bf16 v[120:135],v[52:55],v[228:231],v[120:135]
 ds_read_b64_tr_b16 v[52:53],v5 offset:27648
 ds_read_b64_tr_b16 v[54:55],v5 offset:28160
 s_waitcnt lgkmcnt(6)
 v_mfma_f32_32x32x16_bf16 v[120:135],v[40:43],v[232:235],v[120:135]
 s_cmp_lg_u32 s48,0
 s_cbranch_scc1 Lp_549
 s_waitcnt vmcnt(0)
 v_xor_b32 v118,v60,v116
 v_bitop3_b32 v118,v63,v116,v118 bitop3:0xbe
 v_bitop3_b32 v118,v64,v116,v118 bitop3:0xbe
 v_bitop3_b32 v118,v67,v116,v118 bitop3:0xbe
 v_and_b32 v118,0xff,v118
 v_cmp_ne_u32 vcc,0,v118
 s_cbranch_vccnz La_550
 v_pk_add_f32 v[60:61],v[60:61],v[64:65]
 v_pk_add_f32 v[62:63],v[62:63],v[66:67]
 s_nop 0
 v_add_f32_dpp v60,v60,v60 row_ror:8 row_mask:0xf bank_mask:0xf
 v_add_f32_dpp v61,v61,v61 row_ror:8 row_mask:0xf bank_mask:0xf
 v_add_f32_dpp v62,v62,v62 row_ror:8 row_mask:0xf bank_mask:0xf
 v_add_f32_dpp v63,v63,v63 row_ror:8 row_mask:0xf bank_mask:0xf
 v_permlane16_swap_b32 v60,v61
 s_nop 0
 v_permlane16_swap_b32 v62,v63
 v_add_f32 v60,v60,v61
 v_add_f32 v62,v62,v63
 s_nop 1
 v_permlane32_swap_b32 v60,v62
 v_add_f32 v60,v60,v62
 v_mul_f32 v60,s3,v60
 v_mov_b32 v61,v60
 s_nop 1
 v_permlane16_swap_b32 v60,v61
 v_cvt_pk_bf16_f32 v60,v60,v61
 s_mov_b32 exec_lo,0xff
 s_mov_b32 exec_hi,0xff
 s_add_u32 s52,s51,32768
 buffer_store_dword v60,v117,s[32:35],s52 offen sc1
 s_mov_b64 exec,-1
 s_mov_b32 s48,1
 s_branch Lb_551
La_550:
 s_mov_b64 exec,s[100:101]
 s_add_u32 s52,s50,655360
 buffer_load_dwordx4 v[60:63],v114,s[32:35],s52 offen sc1
 s_mov_b64 exec,s[0:1]
 s_add_u32 s52,s50,675840
 buffer_load_dwordx4 v[64:67],v114,s[32:35],s52 offen sc1
 s_mov_b64 exec,-1
Lb_551:
Lp_549:
 ds_read_b64_tr_b16 v[40:41],v5 offset:28672
 ds_read_b64_tr_b16 v[42:43],v5 offset:29184
 s_waitcnt lgkmcnt(6)
 v_mfma_f32_32x32x16_bf16 v[120:135],v[44:47],v[236:239],v[120:135]
 ds_read_b64_tr_b16 v[44:45],v5 offset:29696
 ds_read_b64_tr_b16 v[46:47],v5 offset:30208
 s_waitcnt lgkmcnt(6)
 v_mfma_f32_32x32x16_bf16 v[120:135],v[48:51],v[240:243],v[120:135]
 ds_read_b64_tr_b16 v[48:49],v5 offset:30720
 ds_read_b64_tr_b16 v[50:51],v5 offset:31232
 s_waitcnt lgkmcnt(6)
 v_mfma_f32_32x32x16_bf16 v[120:135],v[52:55],v[244:247],v[120:135]
 ds_read_b64_tr_b16 v[52:53],v5 offset:31744
 ds_read_b64_tr_b16 v[54:55],v5 offset:32256
 s_waitcnt lgkmcnt(6)
 v_mfma_f32_32x32x16_bf16 v[120:135],v[40:43],v[248:251],v[120:135]
 s_waitcnt lgkmcnt(4)
 v_mfma_f32_32x32x16_bf16 v[120:135],v[44:47],v[252:255],v[120:135]
 s_waitcnt lgkmcnt(2)
 v_mfma_f32_32x32x16_bf16 v[120:135],v[48:51],a[248:251],v[120:135]
 s_waitcnt lgkmcnt(0)
 v_mfma_f32_32x32x16_bf16 v[120:135],v[52:55],a[252:255],v[120:135]
 v_mov_b32 v28,v19
 v_mov_b32 v29,v19
 s_nop 1
 v_mfma_f32_32x32x16_bf16 v[120:135],v[28:31],v[24:27],v[120:135]
 s_barrier
 s_cmp_lg_u32 s48,0
 s_cbranch_scc1 Lp_552
 s_waitcnt vmcnt(0)
 v_xor_b32 v118,v60,v116
 v_bitop3_b32 v118,v63,v116,v118 bitop3:0xbe
 v_bitop3_b32 v118,v64,v116,v118 bitop3:0xbe
 v_bitop3_b32 v118,v67,v116,v118 bitop3:0xbe
 v_and_b32 v118,0xff,v118
 v_cmp_ne_u32 vcc,0,v118
 s_cbranch_vccnz La_553
 v_pk_add_f32 v[60:61],v[60:61],v[64:65]
 v_pk_add_f32 v[62:63],v[62:63],v[66:67]
 s_nop 0
 v_add_f32_dpp v60,v60,v60 row_ror:8 row_mask:0xf bank_mask:0xf
 v_add_f32_dpp v61,v61,v61 row_ror:8 row_mask:0xf bank_mask:0xf
 v_add_f32_dpp v62,v62,v62 row_ror:8 row_mask:0xf bank_mask:0xf
 v_add_f32_dpp v63,v63,v63 row_ror:8 row_mask:0xf bank_mask:0xf
 v_permlane16_swap_b32 v60,v61
 s_nop 0
 v_permlane16_swap_b32 v62,v63
 v_add_f32 v60,v60,v61
 v_add_f32 v62,v62,v63
 s_nop 1
 v_permlane32_swap_b32 v60,v62
 v_add_f32 v60,v60,v62
 v_mul_f32 v60,s3,v60
 v_mov_b32 v61,v60
 s_nop 1
 v_permlane16_swap_b32 v60,v61
 v_cvt_pk_bf16_f32 v60,v60,v61
 s_mov_b32 exec_lo,0xff
 s_mov_b32 exec_hi,0xff
 s_add_u32 s52,s51,32768
 buffer_store_dword v60,v117,s[32:35],s52 offen sc1
 s_mov_b64 exec,-1
 s_mov_b32 s48,1
 s_branch Lb_554
La_553:
 s_mov_b64 exec,s[100:101]
 s_add_u32 s52,s50,655360
 buffer_load_dwordx4 v[60:63],v114,s[32:35],s52 offen sc1
 s_mov_b64 exec,s[0:1]
 s_add_u32 s52,s50,675840
 buffer_load_dwordx4 v[64:67],v114,s[32:35],s52 offen sc1
 s_mov_b64 exec,-1
Lb_554:
Lp_552:
 v_fma_f32 v120,v120,v16,s88
 v_fma_f32 v121,v121,v16,s88
 v_fma_f32 v122,v122,v16,s88
 v_fma_f32 v123,v123,v16,s88
 v_fma_f32 v124,v124,v16,s88
 v_fma_f32 v125,v125,v16,s88
 v_fma_f32 v126,v126,v16,s88
 v_fma_f32 v127,v127,v16,s88
 v_exp_f32_e64 v72,v120 clamp
 v_exp_f32_e64 v73,v121 clamp
 v_exp_f32_e64 v74,v122 clamp
 v_exp_f32_e64 v75,v123 clamp
 v_exp_f32_e64 v76,v124 clamp
 v_exp_f32_e64 v77,v125 clamp
 v_exp_f32_e64 v78,v126 clamp
 v_exp_f32_e64 v79,v127 clamp
 v_max_f32 v120,s88,v120
 v_max_f32 v121,s88,v121
 v_max_f32 v122,s88,v122
 v_max_f32 v123,s88,v123
 v_max_f32 v124,s88,v124
 v_max_f32 v125,s88,v125
 v_max_f32 v126,s88,v126
 v_max_f32 v127,s88,v127
 v_pk_fma_f32 v[120:121],v[120:121],s[90:91],v[72:73]
 v_pk_fma_f32 v[122:123],v[122:123],s[90:91],v[74:75]
 v_pk_fma_f32 v[124:125],v[124:125],s[90:91],v[76:77]
 v_pk_fma_f32 v[126:127],v[126:127],s[90:91],v[78:79]
 v_cvt_pk_bf16_f32 v120,v120,v121
 v_cvt_pk_bf16_f32 v121,v122,v123
 v_cvt_pk_bf16_f32 v122,v124,v125
 v_cvt_pk_bf16_f32 v123,v126,v127
 v_fma_f32 v128,v128,v16,s88
 v_fma_f32 v129,v129,v16,s88
 v_fma_f32 v130,v130,v16,s88
 v_fma_f32 v131,v131,v16,s88
 v_fma_f32 v132,v132,v16,s88
 v_fma_f32 v133,v133,v16,s88
 v_fma_f32 v134,v134,v16,s88
 v_fma_f32 v135,v135,v16,s88
 v_exp_f32_e64 v72,v128 clamp
 v_exp_f32_e64 v73,v129 clamp
 v_exp_f32_e64 v74,v130 clamp
 v_exp_f32_e64 v75,v131 clamp
 v_exp_f32_e64 v76,v132 clamp
 v_exp_f32_e64 v77,v133 clamp
 v_exp_f32_e64 v78,v134 clamp
 v_exp_f32_e64 v79,v135 clamp
 v_max_f32 v128,s88,v128
 v_max_f32 v129,s88,v129
 v_max_f32 v130,s88,v130
 v_max_f32 v131,s88,v131
 v_max_f32 v132,s88,v132
 v_max_f32 v133,s88,v133
 v_max_f32 v134,s88,v134
 v_max_f32 v135,s88,v135
 v_pk_fma_f32 v[128:129],v[128:129],s[90:91],v[72:73]
 v_pk_fma_f32 v[130:131],v[130:131],s[90:91],v[74:75]
 v_pk_fma_f32 v[132:133],v[132:133],s[90:91],v[76:77]
 v_pk_fma_f32 v[134:135],v[134:135],s[90:91],v[78:79]
 v_cvt_pk_bf16_f32 v124,v128,v129
 v_cvt_pk_bf16_f32 v125,v130,v131
 v_cvt_pk_bf16_f32 v126,v132,v133
 v_cvt_pk_bf16_f32 v127,v134,v135
 s_add_u32 s52,s94,0
 buffer_store_dwordx4 v[120:123],v1,s[32:35],s52 offen sc1
 s_add_u32 s52,s94,0
 buffer_store_dwordx4 v[124:127],v1,s[32:35],s52 offen offset:1024 sc1
 v_and_b32 v36,15,v0
 v_lshlrev_b32 v36,4,v36
 v_lshl_add_u32 v36,v17,8,v36
 v_lshlrev_b32 v37,4,v17
 v_add_u32 v37,512,v37
 v_and_b32 v38,16,v0
 v_cmp_ne_u32 vcc,0,v38
 s_nop 1
 v_cndmask_b32 v36,v36,v37,vcc
 s_mul_i32 s53,s4,544
 v_add_u32 v253,s53,v36
 s_cmp_lg_u32 s48,0
 s_cbranch_scc1 Lp_555
 s_waitcnt vmcnt(2)
Lg_556:
 v_xor_b32 v118,v60,v116
 v_bitop3_b32 v118,v63,v116,v118 bitop3:0xbe
 v_bitop3_b32 v118,v64,v116,v118 bitop3:0xbe
 v_bitop3_b32 v118,v67,v116,v118 bitop3:0xbe
 v_and_b32 v118,0xff,v118
 v_cmp_ne_u32 vcc,0,v118
 s_cbranch_vccz Lgd_557
 s_mov_b64 exec,s[100:101]
 s_add_u32 s52,s50,655360
 buffer_load_dwordx4 v[60:63],v114,s[32:35],s52 offen sc1
 s_mov_b64 exec,s[0:1]
 s_add_u32 s52,s50,675840
 buffer_load_dwordx4 v[64:67],v114,s[32:35],s52 offen sc1
 s_mov_b64 exec,-1
 s_waitcnt vmcnt(0)
 s_sub_u32 s55,s55,1
 s_cbranch_scc0 Lg_556
 s_mov_b32 s55,0
Lgd_557:
 v_pk_add_f32 v[60:61],v[60:61],v[64:65]
 v_pk_add_f32 v[62:63],v[62:63],v[66:67]
 s_nop 0
 v_add_f32_dpp v60,v60,v60 row_ror:8 row_mask:0xf bank_mask:0xf
 v_add_f32_dpp v61,v61,v61 row_ror:8 row_mask:0xf bank_mask:0xf
 v_add_f32_dpp v62,v62,v62 row_ror:8 row_mask:0xf bank_mask:0xf
 v_add_f32_dpp v63,v63,v63 row_ror:8 row_mask:0xf bank_mask:0xf
 v_permlane16_swap_b32 v60,v61
 s_nop 0
 v_permlane16_swap_b32 v62,v63
 v_add_f32 v60,v60,v61
 v_add_f32 v62,v62,v63
 s_nop 1
 v_permlane32_swap_b32 v60,v62
 v_add_f32 v60,v60,v62
 v_mul_f32 v60,s3,v60
 v_mov_b32 v61,v60
 s_nop 1
 v_permlane16_swap_b32 v60,v61
 v_cvt_pk_bf16_f32 v60,v60,v61
 s_mov_b32 exec_lo,0xff
 s_mov_b32 exec_hi,0xff
 s_add_u32 s52,s51,32768
 buffer_store_dword v60,v117,s[32:35],s52 offen sc1
 s_mov_b64 exec,-1
 s_mov_b32 s48,1
 s_waitcnt vmcnt(1)
 s_mov_b64 exec,1
 v_mov_b32 v118,s7
 s_add_u32 s53,s97,16384
 buffer_store_dword v118,off,s[32:35],s53 sc1
 s_mov_b64 exec,-1
 s_mov_b32 s48,0
Lp_555:
 s_cmp_eq_u32 s48,0
 s_cbranch_scc1 Lsk_558
 v_mov_b32 v35,s7
 s_add_u32 s53,s97,16384
 s_waitcnt vmcnt(0)
 s_mov_b64 s[82:83],exec
 s_mov_b64 exec,1
 buffer_store_dword v35,off,s[32:35],s53 sc1
 s_mov_b64 exec,s[82:83]
Lsk_558:
 s_add_u32 s96,s95,0
 s_and_b32 s96,s96,7
 s_mul_i32 s96,s96,176128
 s_add_u32 s96,s96,s62
 s_add_u32 m0,s54,65536
 s_add_u32 s52,s96,0
 buffer_load_dwordx4 v8,s[20:23],s52 offen lds
 s_add_u32 s96,s96,s60
 s_add_u32 m0,s54,81920
 s_add_u32 s52,s96,0
 buffer_load_dwordx4 v8,s[20:23],s52 offen lds
 s_add_u32 s96,s95,1
 s_and_b32 s96,s96,7
 s_mul_i32 s96,s96,176128
 s_add_u32 s96,s96,s62
 s_add_u32 m0,s54,69632
 s_add_u32 s52,s96,0
 buffer_load_dwordx4 v8,s[20:23],s52 offen lds
 s_add_u32 s96,s96,s60
 s_add_u32 m0,s54,86016
 s_add_u32 s52,s96,0
 buffer_load_dwordx4 v8,s[20:23],s52 offen lds
 s_add_u32 s53,s98,20480
 v_lshlrev_b32 v36,2,v0
Lpoll_559:
 buffer_load_dword v35,v36,s[32:35],s53 offen sc1
 s_waitcnt vmcnt(0)
 v_cmp_ne_u32 vcc,s7,v35
 s_cbranch_vccz Lpd_560
 s_sub_u32 s55,s55,1
 s_cbranch_scc0 Lpoll_559
 s_mov_b32 s55,0
Lpd_560:
 s_add_u32 s96,s59,0
 s_and_b32 s96,s96,7
 s_mul_i32 s96,s96,2176
 s_add_u32 s52,s96,1409024
 buffer_load_dwordx4 v[136:139],v253,s[32:35],s52 offen sc1
 s_add_u32 s96,s59,1
 s_and_b32 s96,s96,7
 s_mul_i32 s96,s96,2176
 s_add_u32 s52,s96,1409024
 buffer_load_dwordx4 v[140:143],v253,s[32:35],s52 offen sc1
 s_add_u32 s96,s59,2
 s_and_b32 s96,s96,7
 s_mul_i32 s96,s96,2176
 s_add_u32 s52,s96,1409024
 buffer_load_dwordx4 v[144:147],v253,s[32:35],s52 offen sc1
 s_add_u32 s96,s59,3
 s_and_b32 s96,s96,7
 s_mul_i32 s96,s96,2176
 s_add_u32 s52,s96,1409024
 buffer_load_dwordx4 v[148:151],v253,s[32:35],s52 offen sc1
 s_add_u32 s96,s59,4
 s_and_b32 s96,s96,7
 s_mul_i32 s96,s96,2176
 s_add_u32 s52,s96,1409024
 buffer_load_dwordx4 v[152:155],v253,s[32:35],s52 offen sc1
 s_add_u32 s96,s59,5
 s_and_b32 s96,s96,7
 s_mul_i32 s96,s96,2176
 s_add_u32 s52,s96,1409024
 buffer_load_dwordx4 v[156:159],v253,s[32:35],s52 offen sc1
 s_add_u32 s96,s59,6
 s_and_b32 s96,s96,7
 s_mul_i32 s96,s96,2176
 s_add_u32 s52,s96,1409024
 buffer_load_dwordx4 v[160:163],v253,s[32:35],s52 offen sc1
 s_add_u32 s96,s59,7
 s_and_b32 s96,s96,7
 s_mul_i32 s96,s96,2176
 s_add_u32 s52,s96,1409024
 buffer_load_dwordx4 v[164:167],v253,s[32:35],s52 offen sc1
 s_add_u32 s96,s59,0
 s_and_b32 s96,s96,7
 s_mul_i32 s96,s96,4096
 s_add_u32 s96,s96,s71
 s_add_u32 s52,s96,0
 buffer_load_dwordx4 v[168:171],v1,s[32:35],s52 offen sc1
 s_add_u32 s96,s59,1
 s_and_b32 s96,s96,7
 s_mul_i32 s96,s96,4096
 s_add_u32 s96,s96,s71
 s_add_u32 s52,s96,0
 buffer_load_dwordx4 v[172:175],v1,s[32:35],s52 offen sc1
 s_add_u32 s96,s59,2
 s_and_b32 s96,s96,7
 s_mul_i32 s96,s96,4096
 s_add_u32 s96,s96,s71
 s_add_u32 s52,s96,0
 buffer_load_dwordx4 v[176:179],v1,s[32:35],s52 offen sc1
 s_add_u32 s96,s59,3
 s_and_b32 s96,s96,7
 s_mul_i32 s96,s96,4096
 s_add_u32 s96,s96,s71
 s_add_u32 s52,s96,0
 buffer_load_dwordx4 v[180:183],v1,s[32:35],s52 offen sc1
 s_add_u32 s96,s59,4
 s_and_b32 s96,s96,7
 s_mul_i32 s96,s96,4096
 s_add_u32 s96,s96,s71
 s_add_u32 s52,s96,0
 buffer_load_dwordx4 v[184:187],v1,s[32:35],s52 offen sc1
 s_add_u32 s96,s59,5
 s_and_b32 s96,s96,7
 s_mul_i32 s96,s96,4096
 s_add_u32 s96,s96,s71
 s_add_u32 s52,s96,0
 buffer_load_dwordx4 v[188:191],v1,s[32:35],s52 offen sc1
 s_add_u32 s96,s59,6
 s_and_b32 s96,s96,7
 s_mul_i32 s96,s96,4096
 s_add_u32 s96,s96,s71
 s_add_u32 s52,s96,0
 buffer_load_dwordx4 v[192:195],v1,s[32:35],s52 offen sc1
 s_add_u32 s96,s59,7
 s_and_b32 s96,s96,7
 s_mul_i32 s96,s96,4096
 s_add_u32 s96,s96,s71
 s_add_u32 s52,s96,0
 buffer_load_dwordx4 v[196:199],v1,s[32:35],s52 offen sc1
 s_add_u32 s96,s59,0
 s_and_b32 s96,s96,7
 s_mul_i32 s96,s96,4096
 s_add_u32 s96,s96,s71
 s_add_u32 s52,s96,32768
 buffer_load_dwordx4 v[200:203],v1,s[32:35],s52 offen sc1
 s_add_u32 s96,s59,1
 s_and_b32 s96,s96,7
 s_mul_i32 s96,s96,4096
 s_add_u32 s96,s96,s71
 s_add_u32 s52,s96,32768
 buffer_load_dwordx4 v[204:207],v1,s[32:35],s52 offen sc1
 s_add_u32 s96,s59,2
 s_and_b32 s96,s96,7
 s_mul_i32 s96,s96,4096
 s_add_u32 s96,s96,s71
 s_add_u32 s52,s96,32768
 buffer_load_dwordx4 v[208:211],v1,s[32:35],s52 offen sc1
 s_add_u32 s96,s59,3
 s_and_b32 s96,s96,7
 s_mul_i32 s96,s96,4096
 s_add_u32 s96,s96,s71
 s_add_u32 s52,s96,32768
 buffer_load_dwordx4 v[212:215],v1,s[32:35],s52 offen sc1
 s_add_u32 s96,s59,4
 s_and_b32 s96,s96,7
 s_mul_i32 s96,s96,4096
 s_add_u32 s96,s96,s71
 s_add_u32 s52,s96,32768
 buffer_load_dwordx4 v[216:219],v1,s[32:35],s52 offen sc1
 s_add_u32 s96,s59,5
 s_and_b32 s96,s96,7
 s_mul_i32 s96,s96,4096
 s_add_u32 s96,s96,s71
 s_add_u32 s52,s96,32768
 buffer_load_dwordx4 v[220:223],v1,s[32:35],s52 offen sc1
 s_add_u32 s96,s59,6
 s_and_b32 s96,s96,7
 s_mul_i32 s96,s96,4096
 s_add_u32 s96,s96,s71
 s_add_u32 s52,s96,32768
 buffer_load_dwordx4 v[224:227],v1,s[32:35],s52 offen sc1
 s_add_u32 s96,s59,7
 s_and_b32 s96,s96,7
 s_mul_i32 s96,s96,4096
 s_add_u32 s96,s96,s71
 s_add_u32 s52,s96,32768
 buffer_load_dwordx4 v[228:231],v1,s[32:35],s52 offen sc1
Lk_561:
 s_waitcnt vmcnt(23)
 v_max_u32 v37,v136,v137
 v_max3_u32 v37,v138,v139,v37
 s_waitcnt vmcnt(22)
 v_max3_u32 v37,v140,v141,v37
 v_max3_u32 v37,v142,v143,v37
 s_waitcnt vmcnt(21)
 v_max3_u32 v37,v144,v145,v37
 v_max3_u32 v37,v146,v147,v37
 s_waitcnt vmcnt(20)
 v_max3_u32 v37,v148,v149,v37
 v_max3_u32 v37,v150,v151,v37
 s_waitcnt vmcnt(19)
 v_max3_u32 v37,v152,v153,v37
 v_max3_u32 v37,v154,v155,v37
 s_waitcnt vmcnt(18)
 v_max3_u32 v37,v156,v157,v37
 v_max3_u32 v37,v158,v159,v37
 s_waitcnt vmcnt(17)
 v_max3_u32 v37,v160,v161,v37
 v_max3_u32 v37,v162,v163,v37
 s_waitcnt vmcnt(16)
 v_max3_u32 v37,v164,v165,v37
 v_max3_u32 v37,v166,v167,v37
 v_cmp_eq_u32 vcc,-1,v37
 s_cbranch_vccz Lkd_562
 s_add_u32 s96,s59,0
 s_and_b32 s96,s96,7
 s_mul_i32 s96,s96,2176
 s_add_u32 s52,s96,1409024
 buffer_load_dwordx4 v[136:139],v253,s[32:35],s52 offen sc1
 s_add_u32 s96,s59,1
 s_and_b32 s96,s96,7
 s_mul_i32 s96,s96,2176
 s_add_u32 s52,s96,1409024
 buffer_load_dwordx4 v[140:143],v253,s[32:35],s52 offen sc1
 s_add_u32 s96,s59,2
 s_and_b32 s96,s96,7
 s_mul_i32 s96,s96,2176
 s_add_u32 s52,s96,1409024
 buffer_load_dwordx4 v[144:147],v253,s[32:35],s52 offen sc1
 s_add_u32 s96,s59,3
 s_and_b32 s96,s96,7
 s_mul_i32 s96,s96,2176
 s_add_u32 s52,s96,1409024
 buffer_load_dwordx4 v[148:151],v253,s[32:35],s52 offen sc1
 s_add_u32 s96,s59,4
 s_and_b32 s96,s96,7
 s_mul_i32 s96,s96,2176
 s_add_u32 s52,s96,1409024
 buffer_load_dwordx4 v[152:155],v253,s[32:35],s52 offen sc1
 s_add_u32 s96,s59,5
 s_and_b32 s96,s96,7
 s_mul_i32 s96,s96,2176
 s_add_u32 s52,s96,1409024
 buffer_load_dwordx4 v[156:159],v253,s[32:35],s52 offen sc1
 s_add_u32 s96,s59,6
 s_and_b32 s96,s96,7
 s_mul_i32 s96,s96,2176
 s_add_u32 s52,s96,1409024
 buffer_load_dwordx4 v[160:163],v253,s[32:35],s52 offen sc1
 s_add_u32 s96,s59,7
 s_and_b32 s96,s96,7
 s_mul_i32 s96,s96,2176
 s_add_u32 s52,s96,1409024
 buffer_load_dwordx4 v[164:167],v253,s[32:35],s52 offen sc1
 s_waitcnt vmcnt(0)
 s_sub_u32 s55,s55,1
 s_cbranch_scc0 Lk_561
 s_mov_b32 s55,0
Lkd_562:
 s_waitcnt vmcnt(15)
 v_mfma_f32_32x32x16_bf16 v[56:71],v[136:139],v[168:171],0
 s_waitcnt vmcnt(14)
 v_mfma_f32_32x32x16_bf16 v[72:87],v[140:143],v[172:175],0
 s_add_u32 s96,s95,2
 s_and_b32 s96,s96,7
 s_mul_i32 s96,s96,176128
 s_add_u32 s96,s96,s62
 s_add_u32 m0,s54,73728
 s_add_u32 s52,s96,0
 buffer_load_dwordx4 v8,s[20:23],s52 offen lds
 s_add_u32 s96,s96,s60
 s_add_u32 m0,s54,90112
 s_add_u32 s52,s96,0
 buffer_load_dwordx4 v8,s[20:23],s52 offen lds
 s_add_u32 s96,s95,3
 s_and_b32 s96,s96,7
 s_mul_i32 s96,s96,176128
 s_add_u32 s96,s96,s62
 s_add_u32 m0,s54,77824
 s_add_u32 s52,s96,0
 buffer_load_dwordx4 v8,s[20:23],s52 offen lds
 s_add_u32 s96,s96,s60
 s_add_u32 m0,s54,94208
 s_add_u32 s52,s96,0
 buffer_load_dwordx4 v8,s[20:23],s52 offen lds
 v_add_f32 v64,s76,v64
 v_rcp_f32 v64,v64
 s_nop 0
 v_mul_f32 v56,v56,v64
 v_mul_f32 v57,v57,v64
 v_mul_f32 v58,v58,v64
 v_mul_f32 v59,v59,v64
 v_mul_f32 v60,v60,v64
 v_mul_f32 v61,v61,v64
 v_mul_f32 v62,v62,v64
 v_mul_f32 v63,v63,v64
 v_cvt_pk_bf16_f32 v168,v56,v57
 v_cvt_pk_bf16_f32 v169,v58,v59
 v_cvt_pk_bf16_f32 v170,v60,v61
 v_cvt_pk_bf16_f32 v171,v62,v63
 s_waitcnt vmcnt(17)
 v_mfma_f32_32x32x16_bf16 v[40:55],v[144:147],v[176:179],0
 v_add_f32 v80,s76,v80
 v_rcp_f32 v80,v80
 s_add_u32 s96,s95,0
 s_and_b32 s96,s96,7
 s_mul_i32 s96,s96,176128
 s_add_u32 s96,s96,s63
 s_add_u32 m0,s54,131072
 s_add_u32 s52,s96,0
 buffer_load_dwordx4 v8,s[20:23],s52 offen lds
 v_mul_f32 v72,v72,v80
 v_mul_f32 v73,v73,v80
 v_mul_f32 v74,v74,v80
 v_mul_f32 v75,v75,v80
 v_mul_f32 v76,v76,v80
 v_mul_f32 v77,v77,v80
 v_mfma_f32_32x32x16_bf16 v[88:103],a[176:179],v[168:171],0
 v_mul_f32 v78,v78,v80
 v_mul_f32 v79,v79,v80
 v_cvt_pk_bf16_f32 v172,v72,v73
 v_cvt_pk_bf16_f32 v173,v74,v75
 v_cvt_pk_bf16_f32 v174,v76,v77
 v_cvt_pk_bf16_f32 v175,v78,v79
 s_waitcnt vmcnt(17)
 v_mfma_f32_32x32x16_bf16 v[56:71],v[148:151],v[180:183],0
 v_add_f32 v48,s76,v48
 v_rcp_f32 v48,v48
 s_nop 0
 v_mul_f32 v40,v40,v48
 v_mul_f32 v41,v41,v48
 v_mul_f32 v42,v42,v48
 v_mul_f32 v43,v43,v48
 v_mul_f32 v44,v44,v48
 v_mul_f32 v45,v45,v48
 v_mfma_f32_32x32x16_bf16 v[88:103],a[184:187],v[172:175],v[88:103]
 v_mul_f32 v46,v46,v48
 v_mul_f32 v47,v47,v48
 v_cvt_pk_bf16_f32 v176,v40,v41
 v_cvt_pk_bf16_f32 v177,v42,v43
 v_cvt_pk_bf16_f32 v178,v44,v45
 v_cvt_pk_bf16_f32 v179,v46,v47
 s_waitcnt vmcnt(16)
 v_mfma_f32_32x32x16_bf16 v[72:87],v[152:155],v[184:187],0
 v_add_f32 v64,s76,v64
 v_rcp_f32 v64,v64
 s_add_u32 s96,s95,1
 s_and_b32 s96,s96,7
 s_mul_i32 s96,s96,176128
 s_add_u32 s96,s96,s63
 s_add_u32 m0,s54,135168
 s_add_u32 s52,s96,0
 buffer_load_dwordx4 v8,s[20:23],s52 offen lds
 v_mul_f32 v56,v56,v64
 v_mul_f32 v57,v57,v64
 v_mul_f32 v58,v58,v64
 v_mul_f32 v59,v59,v64
 v_mul_f32 v60,v60,v64
 v_mul_f32 v61,v61,v64
 v_mfma_f32_32x32x16_bf16 v[88:103],a[192:195],v[176:179],v[88:103]
 v_mul_f32 v62,v62,v64
 v_mul_f32 v63,v63,v64
 v_cvt_pk_bf16_f32 v180,v56,v57
 v_cvt_pk_bf16_f32 v181,v58,v59
 v_cvt_pk_bf16_f32 v182,v60,v61
 v_cvt_pk_bf16_f32 v183,v62,v63
 s_waitcnt vmcnt(16)
 v_mfma_f32_32x32x16_bf16 v[40:55],v[156:159],v[188:191],0
 v_add_f32 v80,s76,v80
 v_rcp_f32 v80,v80
 s_nop 0
 v_mul_f32 v72,v72,v80
 v_mul_f32 v73,v73,v80
 v_mul_f32 v74,v74,v80
 v_mul_f32 v75,v75,v80
 v_mul_f32 v76,v76,v80
 v_mul_f32 v77,v77,v80
 v_mfma_f32_32x32x16_bf16 v[88:103],a[200:203],v[180:183],v[88:103]
 v_mul_f32 v78,v78,v80
 v_mul_f32 v79,v79,v80
 v_cvt_pk_bf16_f32 v184,v72,v73
 v_cvt_pk_bf16_f32 v185,v74,v75
 v_cvt_pk_bf16_f32 v186,v76,v77
 v_cvt_pk_bf16_f32 v187,v78,v79
 s_waitcnt vmcnt(15)
 v_mfma_f32_32x32x16_bf16 v[56:71],v[160:163],v[192:195],0
 v_add_f32 v48,s76,v48
 v_rcp_f32 v48,v48
 s_add_u32 s96,s95,2
 s_and_b32 s96,s96,7
 s_mul_i32 s96,s96,176128
 s_add_u32 s96,s96,s63
 s_add_u32 m0,s54,139264
 s_add_u32 s52,s96,0
 buffer_load_dwordx4 v8,s[20:23],s52 offen lds
 v_mul_f32 v40,v40,v48
 v_mul_f32 v41,v41,v48
 v_mul_f32 v42,v42,v48
 v_mul_f32 v43,v43,v48
 v_mul_f32 v44,v44,v48
 v_mul_f32 v45,v45,v48
 v_mfma_f32_32x32x16_bf16 v[88:103],a[208:211],v[184:187],v[88:103]
 v_mul_f32 v46,v46,v48
 v_mul_f32 v47,v47,v48
 v_cvt_pk_bf16_f32 v188,v40,v41
 v_cvt_pk_bf16_f32 v189,v42,v43
 v_cvt_pk_bf16_f32 v190,v44,v45
 v_cvt_pk_bf16_f32 v191,v46,v47
 s_waitcnt vmcnt(15)
 v_mfma_f32_32x32x16_bf16 v[72:87],v[164:167],v[196:199],0
 v_add_f32 v64,s76,v64
 v_rcp_f32 v64,v64
 s_nop 0
 v_mul_f32 v56,v56,v64
 v_mul_f32 v57,v57,v64
 v_mul_f32 v58,v58,v64
 v_mul_f32 v59,v59,v64
 v_mul_f32 v60,v60,v64
 v_mul_f32 v61,v61,v64
 v_mfma_f32_32x32x16_bf16 v[88:103],a[216:219],v[188:191],v[88:103]
 v_mul_f32 v62,v62,v64
 v_mul_f32 v63,v63,v64
 v_cvt_pk_bf16_f32 v192,v56,v57
 v_cvt_pk_bf16_f32 v193,v58,v59
 v_cvt_pk_bf16_f32 v194,v60,v61
 v_cvt_pk_bf16_f32 v195,v62,v63
 s_waitcnt vmcnt(14)
 v_mfma_f32_32x32x16_bf16 v[40:55],v[136:139],v[200:203],0
 v_add_f32 v80,s76,v80
 v_rcp_f32 v80,v80
 s_add_u32 s96,s95,3
 s_and_b32 s96,s96,7
 s_mul_i32 s96,s96,176128
 s_add_u32 s96,s96,s63
 s_add_u32 m0,s54,143360
 s_add_u32 s52,s96,0
 buffer_load_dwordx4 v8,s[20:23],s52 offen lds
 v_mul_f32 v72,v72,v80
 v_mul_f32 v73,v73,v80
 v_mul_f32 v74,v74,v80
 v_mul_f32 v75,v75,v80
 v_mul_f32 v76,v76,v80
 v_mul_f32 v77,v77,v80
 v_mfma_f32_32x32x16_bf16 v[88:103],a[224:227],v[192:195],v[88:103]
 v_mul_f32 v78,v78,v80
 v_mul_f32 v79,v79,v80
 v_cvt_pk_bf16_f32 v196,v72,v73
 v_cvt_pk_bf16_f32 v197,v74,v75
 v_cvt_pk_bf16_f32 v198,v76,v77
 v_cvt_pk_bf16_f32 v199,v78,v79
 s_waitcnt vmcnt(14)
 v_mfma_f32_32x32x16_bf16 v[56:71],v[140:143],v[204:207],0
 v_add_f32 v48,s76,v48
 v_rcp_f32 v48,v48
 s_nop 0
 v_mul_f32 v40,v40,v48
 v_mul_f32 v41,v41,v48
 v_mul_f32 v42,v42,v48
 v_mul_f32 v43,v43,v48
 v_mul_f32 v44,v44,v48
 v_mul_f32 v45,v45,v48
 v_mfma_f32_32x32x16_bf16 v[88:103],a[232:235],v[196:199],v[88:103]
 v_mul_f32 v46,v46,v48
 v_mul_f32 v47,v47,v48
 v_cvt_pk_bf16_f32 v200,v40,v41
 v_cvt_pk_bf16_f32 v201,v42,v43
 v_cvt_pk_bf16_f32 v202,v44,v45
 v_cvt_pk_bf16_f32 v203,v46,v47
 s_waitcnt vmcnt(13)
 v_mfma_f32_32x32x16_bf16 v[72:87],v[144:147],v[208:211],0
 v_add_f32 v64,s76,v64
 v_rcp_f32 v64,v64
 s_add_u32 s96,s95,4
 s_and_b32 s96,s96,7
 s_mul_i32 s96,s96,176128
 s_add_u32 s96,s96,s63
 s_add_u32 m0,s54,147456
 s_add_u32 s52,s96,0
 buffer_load_dwordx4 v8,s[20:23],s52 offen lds
 v_mul_f32 v56,v56,v64
 v_mul_f32 v57,v57,v64
 v_mul_f32 v58,v58,v64
 v_mul_f32 v59,v59,v64
 v_mul_f32 v60,v60,v64
 v_mul_f32 v61,v61,v64
 v_mfma_f32_32x32x16_bf16 v[104:119],a[176:179],v[200:203],0
 v_mul_f32 v62,v62,v64
 v_mul_f32 v63,v63,v64
 v_cvt_pk_bf16_f32 v204,v56,v57
 v_cvt_pk_bf16_f32 v205,v58,v59
 v_cvt_pk_bf16_f32 v206,v60,v61
 v_cvt_pk_bf16_f32 v207,v62,v63
 s_waitcnt vmcnt(13)
 v_mfma_f32_32x32x16_bf16 v[40:55],v[148:151],v[212:215],0
 v_add_f32 v80,s76,v80
 v_rcp_f32 v80,v80
 s_nop 0
 v_mul_f32 v72,v72,v80
 v_mul_f32 v73,v73,v80
 v_mul_f32 v74,v74,v80
 v_mul_f32 v75,v75,v80
 v_mul_f32 v76,v76,v80
 v_mul_f32 v77,v77,v80
 v_mfma_f32_32x32x16_bf16 v[104:119],a[184:187],v[204:207],v[104:119]
 v_mul_f32 v78,v78,v80
 v_mul_f32 v79,v79,v80
 v_cvt_pk_bf16_f32 v208,v72,v73
 v_cvt_pk_bf16_f32 v209,v74,v75
 v_cvt_pk_bf16_f32 v210,v76,v77
 v_cvt_pk_bf16_f32 v211,v78,v79
 s_waitcnt vmcnt(12)
 v_mfma_f32_32x32x16_bf16 v[56:71],v[152:155],v[216:219],0
 v_add_f32 v48,s76,v48
 v_rcp_f32 v48,v48
 s_add_u32 s96,s95,5
 s_and_b32 s96,s96,7
 s_mul_i32 s96,s96,176128
 s_add_u32 s96,s96,s63
 s_add_u32 m0,s54,151552
 s_add_u32 s52,s96,0
 buffer_load_dwordx4 v8,s[20:23],s52 offen lds
 v_mul_f32 v40,v40,v48
 v_mul_f32 v41,v41,v48
 v_mul_f32 v42,v42,v48
 v_mul_f32 v43,v43,v48
 v_mul_f32 v44,v44,v48
 v_mul_f32 v45,v45,v48
 v_mfma_f32_32x32x16_bf16 v[104:119],a[192:195],v[208:211],v[104:119]
 v_mul_f32 v46,v46,v48
 v_mul_f32 v47,v47,v48
 v_cvt_pk_bf16_f32 v212,v40,v41
 v_cvt_pk_bf16_f32 v213,v42,v43
 v_cvt_pk_bf16_f32 v214,v44,v45
 v_cvt_pk_bf16_f32 v215,v46,v47
 s_waitcnt vmcnt(12)
 v_mfma_f32_32x32x16_bf16 v[72:87],v[156:159],v[220:223],0
 v_add_f32 v64,s76,v64
 v_rcp_f32 v64,v64
 s_nop 0
 v_mul_f32 v56,v56,v64
 v_mul_f32 v57,v57,v64
 v_mul_f32 v58,v58,v64
 v_mul_f32 v59,v59,v64
 v_mul_f32 v60,v60,v64
 v_mul_f32 v61,v61,v64
 v_mfma_f32_32x32x16_bf16 v[104:119],a[200:203],v[212:215],v[104:119]
 v_mul_f32 v62,v62,v64
 v_mul_f32 v63,v63,v64
 v_cvt_pk_bf16_f32 v216,v56,v57
 v_cvt_pk_bf16_f32 v217,v58,v59
 v_cvt_pk_bf16_f32 v218,v60,v61
 v_cvt_pk_bf16_f32 v219,v62,v63
 s_waitcnt vmcnt(11)
 v_mfma_f32_32x32x16_bf16 v[40:55],v[160:163],v[224:227],0
 v_add_f32 v80,s76,v80
 v_rcp_f32 v80,v80
 s_add_u32 s96,s95,6
 s_and_b32 s96,s96,7
 s_mul_i32 s96,s96,176128
 s_add_u32 s96,s96,s63
 s_add_u32 m0,s54,155648
 s_add_u32 s52,s96,0
 buffer_load_dwordx4 v8,s[20:23],s52 offen lds
 v_mul_f32 v72,v72,v80
 v_mul_f32 v73,v73,v80
 v_mul_f32 v74,v74,v80
 v_mul_f32 v75,v75,v80
 v_mul_f32 v76,v76,v80
 v_mul_f32 v77,v77,v80
 v_mfma_f32_32x32x16_bf16 v[104:119],a[208:211],v[216:219],v[104:119]
 v_mul_f32 v78,v78,v80
 v_mul_f32 v79,v79,v80
 v_cvt_pk_bf16_f32 v220,v72,v73
 v_cvt_pk_bf16_f32 v221,v74,v75
 v_cvt_pk_bf16_f32 v222,v76,v77
 v_cvt_pk_bf16_f32 v223,v78,v79
 s_waitcnt vmcnt(11)
 v_mfma_f32_32x32x16_bf16 v[56:71],v[164:167],v[228:231],0
 v_add_f32 v48,s76,v48
 v_rcp_f32 v48,v48
 s_nop 0
 v_mul_f32 v40,v40,v48
 v_mul_f32 v41,v41,v48
 v_mul_f32 v42,v42,v48
 v_mul_f32 v43,v43,v48
 v_mul_f32 v44,v44,v48
 v_mul_f32 v45,v45,v48
 v_mfma_f32_32x32x16_bf16 v[104:119],a[216:219],v[220:223],v[104:119]
 v_mul_f32 v46,v46,v48
 v_mul_f32 v47,v47,v48
 v_cvt_pk_bf16_f32 v224,v40,v41
 v_cvt_pk_bf16_f32 v225,v42,v43
 v_cvt_pk_bf16_f32 v226,v44,v45
 v_cvt_pk_bf16_f32 v227,v46,v47
 v_add_f32 v64,s76,v64
 v_rcp_f32 v64,v64
 s_add_u32 s96,s95,7
 s_and_b32 s96,s96,7
 s_mul_i32 s96,s96,176128
 s_add_u32 s96,s96,s63
 s_add_u32 m0,s54,159744
 s_add_u32 s52,s96,0
 buffer_load_dwordx4 v8,s[20:23],s52 offen lds
 v_mul_f32 v56,v56,v64
 v_mul_f32 v57,v57,v64
 v_mul_f32 v58,v58,v64
 v_mul_f32 v59,v59,v64
 v_mul_f32 v60,v60,v64
 v_mul_f32 v61,v61,v64
 v_mfma_f32_32x32x16_bf16 v[104:119],a[224:227],v[224:227],v[104:119]
 v_mul_f32 v62,v62,v64
 v_mul_f32 v63,v63,v64
 v_cvt_pk_bf16_f32 v228,v56,v57
 v_cvt_pk_bf16_f32 v229,v58,v59
 v_cvt_pk_bf16_f32 v230,v60,v61
 v_cvt_pk_bf16_f32 v231,v62,v63
 s_nop 1
 v_mfma_f32_32x32x16_bf16 v[104:119],a[232:235],v[228:231],v[104:119]
 v_mfma_f32_32x32x16_bf16 v[120:135],a[180:183],v[168:171],0
 ds_write_b128 v18,v[88:91] offset:0
 v_accvgpr_read_b32 v41,a240
 v_accvgpr_read_b32 v43,a241
 v_accvgpr_read_b32 v45,a242
 v_mfma_f32_32x32x16_bf16 v[120:135],a[188:191],v[172:175],v[120:135]
 v_accvgpr_read_b32 v47,a243
 v_lshlrev_b32 v40,16,v41
 v_and_b32 v41,0xffff0000,v41
 v_mfma_f32_32x32x16_bf16 v[120:135],a[196:199],v[176:179],v[120:135]
 ds_write_b128 v18,v[92:95] offset:1024
 v_lshlrev_b32 v42,16,v43
 v_and_b32 v43,0xffff0000,v43
 v_lshlrev_b32 v44,16,v45
 v_mfma_f32_32x32x16_bf16 v[120:135],a[204:207],v[180:183],v[120:135]
 ds_write_b128 v18,v[96:99] offset:2048
 v_and_b32 v45,0xffff0000,v45
 v_lshlrev_b32 v46,16,v47
 v_and_b32 v47,0xffff0000,v47
 v_mfma_f32_32x32x16_bf16 v[120:135],a[212:215],v[184:187],v[120:135]
 v_accvgpr_read_b32 v49,a244
 v_accvgpr_read_b32 v51,a245
 v_accvgpr_read_b32 v53,a246
 v_mfma_f32_32x32x16_bf16 v[120:135],a[220:223],v[188:191],v[120:135]
 ds_write_b128 v18,v[100:103] offset:3072
 v_accvgpr_read_b32 v55,a247
 v_lshlrev_b32 v48,16,v49
 v_and_b32 v49,0xffff0000,v49
 v_mfma_f32_32x32x16_bf16 v[120:135],a[228:231],v[192:195],v[120:135]
 ds_write_b128 v18,v[104:107] offset:4096
 v_lshlrev_b32 v50,16,v51
 v_and_b32 v51,0xffff0000,v51
 v_lshlrev_b32 v52,16,v53
 v_mfma_f32_32x32x16_bf16 v[120:135],a[236:239],v[196:199],v[120:135]
 v_and_b32 v53,0xffff0000,v53
 v_lshlrev_b32 v54,16,v55
 v_and_b32 v55,0xffff0000,v55
 v_mfma_f32_32x32x16_bf16 v[232:247],a[180:183],v[200:203],0
 ds_write_b128 v18,v[108:111] offset:5120
 v_mfma_f32_32x32x16_bf16 v[232:247],a[188:191],v[204:207],v[232:247]
 v_mfma_f32_32x32x16_bf16 v[232:247],a[196:199],v[208:211],v[232:247]
 ds_write_b128 v18,v[112:115] offset:6144
 v_mfma_f32_32x32x16_bf16 v[232:247],a[204:207],v[212:215],v[232:247]
 ds_write_b128 v18,v[116:119] offset:7168
 v_mfma_f32_32x32x16_bf16 v[232:247],a[212:215],v[216:219],v[232:247]
 s_waitcnt lgkmcnt(0)
 s_barrier
 ds_read_b128 v[56:59],v15 offset:0
 ds_read_b128 v[60:63],v15 offset:1024
 v_mfma_f32_32x32x16_bf16 v[232:247],a[220:223],v[220:223],v[232:247]
 ds_read_b128 v[64:67],v15 offset:8192
 ds_read_b128 v[68:71],v15 offset:9216
 ds_read_b128 v[72:75],v15 offset:16384
 v_mfma_f32_32x32x16_bf16 v[232:247],a[228:231],v[224:227],v[232:247]
 ds_read_b128 v[76:79],v15 offset:17408
 ds_read_b128 v[80:83],v15 offset:24576
 ds_read_b128 v[84:87],v15 offset:25600
 v_mfma_f32_32x32x16_bf16 v[232:247],a[236:239],v[228:231],v[232:247]
 s_waitcnt lgkmcnt(7)
 v_pk_add_f32 v[56:57],v[56:57],v[40:41]
 v_pk_add_f32 v[58:59],v[58:59],v[42:43]
 s_waitcnt lgkmcnt(6)
 v_pk_add_f32 v[60:61],v[60:61],v[44:45]
 v_pk_add_f32 v[62:63],v[62:63],v[46:47]
 s_waitcnt lgkmcnt(5)
 v_pk_add_f32 v[56:57],v[56:57],v[64:65]
 v_pk_add_f32 v[58:59],v[58:59],v[66:67]
 s_waitcnt lgkmcnt(4)
 v_pk_add_f32 v[60:61],v[60:61],v[68:69]
 v_pk_add_f32 v[62:63],v[62:63],v[70:71]
 s_waitcnt lgkmcnt(1)
 v_pk_add_f32 v[72:73],v[72:73],v[80:81]
 v_pk_add_f32 v[74:75],v[74:75],v[82:83]
 s_waitcnt lgkmcnt(0)
 v_pk_add_f32 v[76:77],v[76:77],v[84:85]
 v_pk_add_f32 v[78:79],v[78:79],v[86:87]
 s_barrier
 ds_write_b128 v18,v[120:123] offset:0
 v_pk_add_f32 v[56:57],v[56:57],v[72:73]
 v_pk_add_f32 v[58:59],v[58:59],v[74:75]
 v_pk_add_f32 v[60:61],v[60:61],v[76:77]
 v_pk_add_f32 v[62:63],v[62:63],v[78:79]
 ds_write_b128 v18,v[124:127] offset:1024
 v_cvt_pk_bf16_f32 v64,v56,v57
 v_cvt_pk_bf16_f32 v65,v58,v59
 v_cvt_pk_bf16_f32 v66,v60,v61
 v_cvt_pk_bf16_f32 v67,v62,v63
 ds_write_b128 v18,v[128:131] offset:2048
 v_accvgpr_write_b32 a240,v64
 v_or_b32 v64,1,v64
 s_and_b32 s52,s6,1
 s_xor_b32 s52,s52,0
 s_lshl_b32 s52,s52,11
 s_add_u32 s52,s52,s67
 buffer_store_dwordx4 v[64:67],v3,s[32:35],s52 offen sc1
 v_pk_add_f32 v[24:25],v[56:57],v[58:59]
 ds_write_b128 v18,v[132:135] offset:3072
 v_pk_mul_f32 v[26:27],v[56:57],v[56:57]
 v_pk_fma_f32 v[26:27],v[58:59],v[58:59],v[26:27]
 v_pk_add_f32 v[24:25],v[24:25],v[60:61]
 v_pk_fma_f32 v[26:27],v[60:61],v[60:61],v[26:27]
 ds_write_b128 v18,v[232:235] offset:4096
 v_pk_add_f32 v[24:25],v[24:25],v[62:63]
 v_pk_fma_f32 v[26:27],v[62:63],v[62:63],v[26:27]
 v_accvgpr_write_b32 a241,v65
 v_accvgpr_write_b32 a242,v66
 ds_write_b128 v18,v[236:239] offset:5120
 v_accvgpr_write_b32 a243,v67
 ds_write_b128 v18,v[240:243] offset:6144
 ds_write_b128 v18,v[244:247] offset:7168
 s_waitcnt lgkmcnt(0)
 s_barrier
 ds_read_b128 v[56:59],v15 offset:0
 ds_read_b128 v[60:63],v15 offset:1024
 ds_read_b128 v[64:67],v15 offset:8192
 ds_read_b128 v[68:71],v15 offset:9216
 ds_read_b128 v[72:75],v15 offset:16384
 ds_read_b128 v[76:79],v15 offset:17408
 ds_read_b128 v[80:83],v15 offset:24576
 ds_read_b128 v[84:87],v15 offset:25600
 s_add_u32 s52,s56,0
 v_add_u32 v2,s52,v1
 s_waitcnt lgkmcnt(7)
 v_pk_add_f32 v[56:57],v[56:57],v[48:49]
 v_pk_add_f32 v[58:59],v[58:59],v[50:51]
 s_waitcnt lgkmcnt(6)
 v_pk_add_f32 v[60:61],v[60:61],v[52:53]
 v_pk_add_f32 v[62:63],v[62:63],v[54:55]
 s_waitcnt lgkmcnt(5)
 v_pk_add_f32 v[56:57],v[56:57],v[64:65]
 v_pk_add_f32 v[58:59],v[58:59],v[66:67]
 s_waitcnt lgkmcnt(4)
 v_pk_add_f32 v[60:61],v[60:61],v[68:69]
 v_pk_add_f32 v[62:63],v[62:63],v[70:71]
 s_waitcnt lgkmcnt(1)
 v_pk_add_f32 v[72:73],v[72:73],v[80:81]
 v_pk_add_f32 v[74:75],v[74:75],v[82:83]
 s_waitcnt lgkmcnt(0)
 v_pk_add_f32 v[76:77],v[76:77],v[84:85]
 v_pk_add_f32 v[78:79],v[78:79],v[86:87]
 v_pk_add_f32 v[56:57],v[56:57],v[72:73]
 v_pk_add_f32 v[58:59],v[58:59],v[74:75]
 v_pk_add_f32 v[60:61],v[60:61],v[76:77]
 v_pk_add_f32 v[62:63],v[62:63],v[78:79]
 v_cvt_pk_bf16_f32 v64,v56,v57
 v_cvt_pk_bf16_f32 v65,v58,v59
 v_cvt_pk_bf16_f32 v66,v60,v61
 v_cvt_pk_bf16_f32 v67,v62,v63
 v_accvgpr_write_b32 a244,v64
 v_or_b32 v64,1,v64
 s_and_b32 s52,s6,1
 s_xor_b32 s52,s52,1
 s_lshl_b32 s52,s52,11
 s_add_u32 s52,s52,s67
 buffer_store_dwordx4 v[64:67],v3,s[32:35],s52 offen sc1
 v_pk_add_f32 v[24:25],v[24:25],v[56:57]
 v_pk_fma_f32 v[26:27],v[56:57],v[56:57],v[26:27]
 v_pk_add_f32 v[24:25],v[24:25],v[58:59]
 buffer_load_dwordx4 v[136:139],v2,s[32:35],s36 offen sc1
 v_pk_fma_f32 v[26:27],v[58:59],v[58:59],v[26:27]
 v_pk_add_f32 v[24:25],v[24:25],v[60:61]
 v_pk_fma_f32 v[26:27],v[60:61],v[60:61],v[26:27]
 buffer_load_dwordx4 v[140:143],v2,s[32:35],s36 offen offset:1024 sc1
 v_pk_add_f32 v[24:25],v[24:25],v[62:63]
 v_pk_fma_f32 v[26:27],v[62:63],v[62:63],v[26:27]
 v_accvgpr_write_b32 a245,v65
 buffer_load_dwordx4 v[152:155],v2,s[32:35],s37 offen sc1
 v_accvgpr_write_b32 a246,v66
 v_accvgpr_write_b32 a247,v67
 v_add_f32 v24,v24,v25
 buffer_load_dwordx4 v[156:159],v2,s[32:35],s37 offen offset:1024 sc1
 v_add_f32 v26,v26,v27
 v_and_b32 v27,512,v3
 v_add_u32 v27,v27,v3
 buffer_load_dwordx4 v[168:171],v2,s[32:35],s38 offen sc1
 v_permlane16_swap_b32 v24,v26
 v_add_f32 v24,v24,v26
 v_mov_b32 v25,v24
 buffer_load_dwordx4 v[172:175],v2,s[32:35],s38 offen offset:1024 sc1
 s_nop 0
 v_permlane32_swap_b32 v24,v25
 v_add_f32 v24,v24,v25
 v_or_b32 v24,1,v24
 buffer_load_dwordx4 v[184:187],v2,s[32:35],s39 offen sc1
 s_mov_b32 exec_hi,0
 s_add_u32 s52,s79,262144
 buffer_store_dword v24,v27,s[32:35],s52 offen sc1
 s_mov_b64 exec,-1
 buffer_load_dwordx4 v[188:191],v2,s[32:35],s39 offen offset:1024 sc1
 buffer_load_dwordx4 v[200:203],v2,s[32:35],s40 offen sc1
 buffer_load_dwordx4 v[204:207],v2,s[32:35],s40 offen offset:1024 sc1
 buffer_load_dwordx4 v[216:219],v2,s[32:35],s41 offen sc1
 s_waitcnt vmcnt(14)
 s_barrier
 ds_read_b64_tr_b16 v[40:41],v5 offset:0
 ds_read_b64_tr_b16 v[42:43],v5 offset:512
 ds_read_b64_tr_b16 v[44:45],v5 offset:16384
 ds_read_b64_tr_b16 v[46:47],v5 offset:16896
 ds_read_b64_tr_b16 v[48:49],v5 offset:1024
 ds_read_b64_tr_b16 v[50:51],v5 offset:1536
 ds_read_b64_tr_b16 v[52:53],v5 offset:17408
 ds_read_b64_tr_b16 v[54:55],v5 offset:17920
 s_waitcnt vmcnt(10)
 v_bitop3_b32 v38,v136,v140,1 bitop3:0x80
 v_cmp_eq_u32 vcc,0,v38
 s_cbranch_vccnz Lfix_564
Lret_565:
 s_waitcnt lgkmcnt(4)
 v_mfma_f32_32x32x16_bf16 v[88:103],v[40:43],v[136:139],0
 ds_read_b64_tr_b16 v[40:41],v5 offset:4096
 ds_read_b64_tr_b16 v[42:43],v5 offset:4608
 buffer_load_dwordx4 v[220:223],v2,s[32:35],s41 offen offset:1024 sc1
 v_mov_b32 v26,0
 v_mfma_f32_32x32x16_bf16 v[104:119],v[44:47],v[136:139],0
 ds_read_b64_tr_b16 v[44:45],v5 offset:20480
 ds_read_b64_tr_b16 v[46:47],v5 offset:20992
 v_mov_b32 v27,0
 s_waitcnt vmcnt(9) lgkmcnt(4)
 v_mfma_f32_32x32x16_bf16 v[88:103],v[48:51],v[140:143],v[88:103]
 ds_read_b64_tr_b16 v[48:49],v5 offset:5120
 ds_read_b64_tr_b16 v[50:51],v5 offset:5632
 buffer_load_dwordx4 v[232:235],v2,s[32:35],s42 offen sc1
 v_bitop3_b32 v38,v152,v156,1 bitop3:0x80
 v_cmp_eq_u32 vcc,0,v38
 v_mfma_f32_32x32x16_bf16 v[104:119],v[52:55],v[140:143],v[104:119]
 ds_read_b64_tr_b16 v[52:53],v5 offset:21504
 ds_read_b64_tr_b16 v[54:55],v5 offset:22016
 v_mov_b32 v30,0
 s_cbranch_vccnz Lfix_567
Lret_568:
 s_waitcnt lgkmcnt(4)
 v_mfma_f32_32x32x16_bf16 v[88:103],v[40:43],v[152:155],v[88:103]
 ds_read_b64_tr_b16 v[40:41],v5 offset:8192
 ds_read_b64_tr_b16 v[42:43],v5 offset:8704
 buffer_load_dwordx4 v[236:239],v2,s[32:35],s42 offen offset:1024 sc1
 v_mov_b32 v31,0
 v_mfma_f32_32x32x16_bf16 v[104:119],v[44:47],v[152:155],v[104:119]
 ds_read_b64_tr_b16 v[44:45],v5 offset:24576
 ds_read_b64_tr_b16 v[46:47],v5 offset:25088
 v_mov_b32 v32,0x3f803f80
 s_waitcnt vmcnt(9) lgkmcnt(4)
 v_mfma_f32_32x32x16_bf16 v[88:103],v[48:51],v[156:159],v[88:103]
 ds_read_b64_tr_b16 v[48:49],v5 offset:9216
 ds_read_b64_tr_b16 v[50:51],v5 offset:9728
 buffer_load_dwordx4 v[248:251],v2,s[32:35],s43 offen sc1
 v_bitop3_b32 v38,v168,v172,1 bitop3:0x80
 v_cmp_eq_u32 vcc,0,v38
 v_mfma_f32_32x32x16_bf16 v[104:119],v[52:55],v[156:159],v[104:119]
 ds_read_b64_tr_b16 v[52:53],v5 offset:25600
 ds_read_b64_tr_b16 v[54:55],v5 offset:26112
 v_mov_b32 v33,0x3f803f80
 s_cbranch_vccnz Lfix_570
Lret_571:
 s_waitcnt lgkmcnt(4)
 v_mfma_f32_32x32x16_bf16 v[88:103],v[40:43],v[168:171],v[88:103]
 ds_read_b64_tr_b16 v[40:41],v5 offset:12288
 ds_read_b64_tr_b16 v[42:43],v5 offset:12800
 buffer_load_dwordx4 v[252:255],v2,s[32:35],s43 offen offset:1024 sc1
 v_and_b32 v35,15,v0
 v_mfma_f32_32x32x16_bf16 v[104:119],v[44:47],v[168:171],v[104:119]
 ds_read_b64_tr_b16 v[44:45],v5 offset:28672
 ds_read_b64_tr_b16 v[46:47],v5 offset:29184
 v_mul_u32_u24 v35,144,v35
 s_waitcnt vmcnt(8) lgkmcnt(4)
 v_mfma_f32_32x32x16_bf16 v[88:103],v[48:51],v[172:175],v[88:103]
 ds_read_b64_tr_b16 v[48:49],v5 offset:13312
 ds_read_b64_tr_b16 v[50:51],v5 offset:13824
 buffer_load_dwordx4 v[144:147],v2,s[32:35],s8 offen sc1
 v_bitop3_b32 v38,v184,v188,1 bitop3:0x80
 v_cmp_eq_u32 vcc,0,v38
 v_mfma_f32_32x32x16_bf16 v[104:119],v[52:55],v[172:175],v[104:119]
 ds_read_b64_tr_b16 v[52:53],v5 offset:29696
 ds_read_b64_tr_b16 v[54:55],v5 offset:30208
 v_lshl_add_u32 v35,v17,5,v35
 s_cbranch_vccnz Lfix_573
Lret_574:
 s_waitcnt lgkmcnt(4)
 v_mfma_f32_32x32x16_bf16 v[88:103],v[40:43],v[184:187],v[88:103]
 ds_read_b64_tr_b16 v[40:41],v5 offset:32768
 ds_read_b64_tr_b16 v[42:43],v5 offset:33280
 buffer_load_dwordx4 v[148:151],v2,s[32:35],s8 offen offset:1024 sc1
 v_bfe_u32 v36,v0,4,1
 v_mfma_f32_32x32x16_bf16 v[104:119],v[44:47],v[184:187],v[104:119]
 ds_read_b64_tr_b16 v[44:45],v5 offset:49152
 ds_read_b64_tr_b16 v[46:47],v5 offset:49664
 v_lshl_add_u32 v35,v36,3,v35
 s_waitcnt vmcnt(8) lgkmcnt(4)
 v_mfma_f32_32x32x16_bf16 v[88:103],v[48:51],v[188:191],v[88:103]
 ds_read_b64_tr_b16 v[48:49],v5 offset:33792
 ds_read_b64_tr_b16 v[50:51],v5 offset:34304
 buffer_load_dwordx4 v[160:163],v2,s[32:35],s9 offen sc1
 v_bitop3_b32 v38,v200,v204,1 bitop3:0x80
 v_cmp_eq_u32 vcc,0,v38
 v_mfma_f32_32x32x16_bf16 v[104:119],v[52:55],v[188:191],v[104:119]
 ds_read_b64_tr_b16 v[52:53],v5 offset:50176
 ds_read_b64_tr_b16 v[54:55],v5 offset:50688
 s_mul_i32 s53,s4,2304
 s_cbranch_vccnz Lfix_576
Lret_577:
 s_waitcnt lgkmcnt(4)
 v_mfma_f32_32x32x16_bf16 v[88:103],v[40:43],v[200:203],v[88:103]
 ds_read_b64_tr_b16 v[40:41],v5 offset:36864
 ds_read_b64_tr_b16 v[42:43],v5 offset:37376
 buffer_load_dwordx4 v[164:167],v2,s[32:35],s9 offen offset:1024 sc1
 s_add_u32 s53,s53,32768
 v_mfma_f32_32x32x16_bf16 v[104:119],v[44:47],v[200:203],v[104:119]
 ds_read_b64_tr_b16 v[44:45],v5 offset:53248
 ds_read_b64_tr_b16 v[46:47],v5 offset:53760
 v_add_u32 v35,s53,v35
 s_waitcnt vmcnt(8) lgkmcnt(4)
 v_mfma_f32_32x32x16_bf16 v[88:103],v[48:51],v[204:207],v[88:103]
 ds_read_b64_tr_b16 v[48:49],v5 offset:37888
 ds_read_b64_tr_b16 v[50:51],v5 offset:38400
 s_add_u32 s84,s58,262144
 buffer_load_dwordx4 v[72:75],v13,s[32:35],s84 offen sc1
 buffer_load_dwordx4 v[76:79],v13,s[32:35],s84 offen offset:512 sc1
 buffer_load_dwordx4 v[176:179],v2,s[32:35],s10 offen sc1
 v_bitop3_b32 v38,v216,v220,1 bitop3:0x80
 v_cmp_eq_u32 vcc,0,v38
 v_mfma_f32_32x32x16_bf16 v[104:119],v[52:55],v[204:207],v[104:119]
 ds_read_b64_tr_b16 v[52:53],v5 offset:54272
 ds_read_b64_tr_b16 v[54:55],v5 offset:54784
 v_lshrrev_b32 v36,3,v0
 s_cbranch_vccnz Lfix_579
Lret_580:
 s_waitcnt lgkmcnt(4)
 v_mfma_f32_32x32x16_bf16 v[88:103],v[40:43],v[216:219],v[88:103]
 ds_read_b64_tr_b16 v[40:41],v5 offset:40960
 ds_read_b64_tr_b16 v[42:43],v5 offset:41472
 buffer_load_dwordx4 v[180:183],v2,s[32:35],s10 offen offset:1024 sc1
 v_mul_u32_u24 v36,144,v36
 v_mfma_f32_32x32x16_bf16 v[104:119],v[44:47],v[216:219],v[104:119]
 ds_read_b64_tr_b16 v[44:45],v5 offset:57344
 ds_read_b64_tr_b16 v[46:47],v5 offset:57856
 v_and_b32 v37,7,v0
 s_waitcnt vmcnt(10) lgkmcnt(4)
 v_mfma_f32_32x32x16_bf16 v[88:103],v[48:51],v[220:223],v[88:103]
 ds_read_b64_tr_b16 v[48:49],v5 offset:41984
 ds_read_b64_tr_b16 v[50:51],v5 offset:42496
 buffer_load_dwordx4 v[192:195],v2,s[32:35],s11 offen sc1
 v_bitop3_b32 v38,v232,v236,1 bitop3:0x80
 v_cmp_eq_u32 vcc,0,v38
 v_mfma_f32_32x32x16_bf16 v[104:119],v[52:55],v[220:223],v[104:119]
 ds_read_b64_tr_b16 v[52:53],v5 offset:58368
 ds_read_b64_tr_b16 v[54:55],v5 offset:58880
 v_lshl_add_u32 v36,v37,4,v36
 s_cbranch_vccnz Lfix_582
Lret_583:
 s_waitcnt lgkmcnt(4)
 v_mfma_f32_32x32x16_bf16 v[88:103],v[40:43],v[232:235],v[88:103]
 ds_read_b64_tr_b16 v[40:41],v5 offset:45056
 ds_read_b64_tr_b16 v[42:43],v5 offset:45568
 buffer_load_dwordx4 v[196:199],v2,s[32:35],s11 offen offset:1024 sc1
 s_mul_i32 s53,s4,1152
 v_mfma_f32_32x32x16_bf16 v[104:119],v[44:47],v[232:235],v[104:119]
 ds_read_b64_tr_b16 v[44:45],v5 offset:61440
 ds_read_b64_tr_b16 v[46:47],v5 offset:61952
 s_add_u32 s53,s53,32768
 s_waitcnt vmcnt(10) lgkmcnt(4)
 v_mfma_f32_32x32x16_bf16 v[88:103],v[48:51],v[236:239],v[88:103]
 ds_read_b64_tr_b16 v[48:49],v5 offset:46080
 ds_read_b64_tr_b16 v[50:51],v5 offset:46592
 buffer_load_dwordx4 v[208:211],v2,s[32:35],s57 offen sc1
 v_bitop3_b32 v38,v248,v252,1 bitop3:0x80
 v_cmp_eq_u32 vcc,0,v38
 v_mfma_f32_32x32x16_bf16 v[104:119],v[52:55],v[236:239],v[104:119]
 ds_read_b64_tr_b16 v[52:53],v5 offset:62464
 ds_read_b64_tr_b16 v[54:55],v5 offset:62976
 v_add_u32 v36,s53,v36
 s_cbranch_vccnz Lfix_585
Lret_586:
 s_waitcnt lgkmcnt(4)
 v_mfma_f32_32x32x16_bf16 v[88:103],v[40:43],v[248:251],v[88:103]
 ds_read_b64_tr_b16 v[40:41],v5 offset:2048
 ds_read_b64_tr_b16 v[42:43],v5 offset:2560
 buffer_load_dwordx4 v[212:215],v2,s[32:35],s57 offen offset:1024 sc1
 ds_write_b64 v35,a[240:241] offset:0
 v_mfma_f32_32x32x16_bf16 v[104:119],v[44:47],v[248:251],v[104:119]
 ds_read_b64_tr_b16 v[44:45],v5 offset:18432
 ds_read_b64_tr_b16 v[46:47],v5 offset:18944
 ds_write_b64 v35,a[242:243] offset:16
 s_waitcnt vmcnt(10) lgkmcnt(6)
 v_mfma_f32_32x32x16_bf16 v[88:103],v[48:51],v[252:255],v[88:103]
 ds_read_b64_tr_b16 v[48:49],v5 offset:3072
 ds_read_b64_tr_b16 v[50:51],v5 offset:3584
 buffer_load_dwordx4 v[224:227],v2,s[32:35],s77 offen sc1
 v_bitop3_b32 v38,v144,v148,1 bitop3:0x80
 v_cmp_eq_u32 vcc,0,v38
 v_mfma_f32_32x32x16_bf16 v[104:119],v[52:55],v[252:255],v[104:119]
 ds_read_b64_tr_b16 v[52:53],v5 offset:19456
 ds_read_b64_tr_b16 v[54:55],v5 offset:19968
 ds_write_b64 v35,a[244:245] offset:64
 s_cbranch_vccnz Lfix_588
Lret_589:
 s_waitcnt lgkmcnt(6)
 v_mfma_f32_32x32x16_bf16 v[88:103],v[40:43],v[144:147],v[88:103]
 ds_read_b64_tr_b16 v[40:41],v5 offset:6144
 ds_read_b64_tr_b16 v[42:43],v5 offset:6656
 buffer_load_dwordx4 v[228:231],v2,s[32:35],s77 offen offset:1024 sc1
 ds_write_b64 v35,a[246:247] offset:80
 v_mfma_f32_32x32x16_bf16 v[104:119],v[44:47],v[144:147],v[104:119]
 ds_read_b64_tr_b16 v[44:45],v5 offset:22528
 ds_read_b64_tr_b16 v[46:47],v5 offset:23040
 s_waitcnt vmcnt(10) lgkmcnt(6)
 v_mfma_f32_32x32x16_bf16 v[88:103],v[48:51],v[148:151],v[88:103]
 ds_read_b64_tr_b16 v[48:49],v5 offset:7168
 ds_read_b64_tr_b16 v[50:51],v5 offset:7680
 buffer_load_dwordx4 v[240:243],v2,s[32:35],s81 offen sc1
 v_bitop3_b32 v38,v160,v164,1 bitop3:0x80
 v_cmp_eq_u32 vcc,0,v38
 v_mfma_f32_32x32x16_bf16 v[104:119],v[52:55],v[148:151],v[104:119]
 ds_read_b64_tr_b16 v[52:53],v5 offset:23552
 ds_read_b64_tr_b16 v[54:55],v5 offset:24064
 s_cbranch_vccnz Lfix_591
Lret_592:
 s_waitcnt lgkmcnt(4)
 v_mfma_f32_32x32x16_bf16 v[88:103],v[40:43],v[160:163],v[88:103]
 ds_read_b64_tr_b16 v[40:41],v5 offset:10240
 ds_read_b64_tr_b16 v[42:43],v5 offset:10752
 buffer_load_dwordx4 v[244:247],v2,s[32:35],s81 offen offset:1024 sc1
 v_mfma_f32_32x32x16_bf16 v[104:119],v[44:47],v[160:163],v[104:119]
 ds_read_b64_tr_b16 v[44:45],v5 offset:26624
 ds_read_b64_tr_b16 v[46:47],v5 offset:27136
 s_waitcnt vmcnt(8) lgkmcnt(4)
 v_mfma_f32_32x32x16_bf16 v[88:103],v[48:51],v[164:167],v[88:103]
 ds_read_b64_tr_b16 v[48:49],v5 offset:11264
 ds_read_b64_tr_b16 v[50:51],v5 offset:11776
 buffer_load_dwordx4 a[248:251],v2,s[32:35],s99 offen sc1
 v_bitop3_b32 v38,v176,v180,1 bitop3:0x80
 v_cmp_eq_u32 vcc,0,v38
 v_mfma_f32_32x32x16_bf16 v[104:119],v[52:55],v[164:167],v[104:119]
 ds_read_b64_tr_b16 v[52:53],v5 offset:27648
 ds_read_b64_tr_b16 v[54:55],v5 offset:28160
 v_and_b32 v38,v72,v73
 v_bitop3_b32 v38,v74,v75,v38 bitop3:0x80
 v_bitop3_b32 v38,v76,v77,v38 bitop3:0x80
 v_bitop3_b32 v38,v78,v79,v38 bitop3:0x80
 v_and_b32 v38,1,v38
 v_cmp_eq_u32 s[82:83],0,v38
 s_nop 0
 s_cmp_lg_u64 s[82:83],0
 s_cbranch_scc1 Lfix_597
Lret_598:
 v_add_f32 v72,v72,v73
 s_cbranch_vccnz Lfix_594
Lret_595:
 s_waitcnt lgkmcnt(4)
 v_mfma_f32_32x32x16_bf16 v[88:103],v[40:43],v[176:179],v[88:103]
 ds_read_b64_tr_b16 v[40:41],v5 offset:14336
 ds_read_b64_tr_b16 v[42:43],v5 offset:14848
 buffer_load_dwordx4 a[252:255],v2,s[32:35],s99 offen offset:1024 sc1
 v_add_f32 v74,v74,v75
 v_add_f32 v76,v76,v77
 v_mfma_f32_32x32x16_bf16 v[104:119],v[44:47],v[176:179],v[104:119]
 ds_read_b64_tr_b16 v[44:45],v5 offset:30720
 ds_read_b64_tr_b16 v[46:47],v5 offset:31232
 v_add_f32 v78,v78,v79
 v_add_f32 v72,v72,v74
 s_waitcnt vmcnt(8) lgkmcnt(4)
 v_mfma_f32_32x32x16_bf16 v[88:103],v[48:51],v[180:183],v[88:103]
 ds_read_b64_tr_b16 v[48:49],v5 offset:15360
 ds_read_b64_tr_b16 v[50:51],v5 offset:15872
 v_bitop3_b32 v38,v192,v196,1 bitop3:0x80
 v_cmp_eq_u32 vcc,0,v38
 v_mfma_f32_32x32x16_bf16 v[104:119],v[52:55],v[180:183],v[104:119]
 ds_read_b64_tr_b16 v[52:53],v5 offset:31744
 ds_read_b64_tr_b16 v[54:55],v5 offset:32256
 v_add_f32 v76,v76,v78
 v_add_f32 v72,v72,v76
 s_cbranch_vccnz Lfix_600
Lret_601:
 s_waitcnt lgkmcnt(4)
 v_mfma_f32_32x32x16_bf16 v[88:103],v[40:43],v[192:195],v[88:103]
 ds_read_b64_tr_b16 v[40:41],v5 offset:34816
 ds_read_b64_tr_b16 v[42:43],v5 offset:35328
 v_mov_b32 v73,v72
 s_nop 1
 v_permlane32_swap_b32 v72,v73
 v_mfma_f32_32x32x16_bf16 v[104:119],v[44:47],v[192:195],v[104:119]
 ds_read_b64_tr_b16 v[44:45],v5 offset:51200
 ds_read_b64_tr_b16 v[46:47],v5 offset:51712
 v_mul_f32 v72,s74,v72
 v_cndmask_b32_e64 v72,0,-v72,s[92:93]
 s_waitcnt vmcnt(6) lgkmcnt(4)
 v_mfma_f32_32x32x16_bf16 v[88:103],v[48:51],v[196:199],v[88:103]
 ds_read_b64_tr_b16 v[48:49],v5 offset:35840
 ds_read_b64_tr_b16 v[50:51],v5 offset:36352
 v_bitop3_b32 v38,v208,v212,1 bitop3:0x80
 v_cmp_eq_u32 vcc,0,v38
 v_mfma_f32_32x32x16_bf16 v[104:119],v[52:55],v[196:199],v[104:119]
 ds_read_b64_tr_b16 v[52:53],v5 offset:52224
 ds_read_b64_tr_b16 v[54:55],v5 offset:52736
 v_cvt_pk_bf16_f32 v24,v72,v72
 v_lshlrev_b32 v74,16,v24
 s_cbranch_vccnz Lfix_603
Lret_604:
 s_waitcnt lgkmcnt(4)
 v_mfma_f32_32x32x16_bf16 v[88:103],v[40:43],v[208:211],v[88:103]
 ds_read_b64_tr_b16 v[40:41],v5 offset:38912
 ds_read_b64_tr_b16 v[42:43],v5 offset:39424
 v_sub_f32 v72,v72,v74
 v_cvt_pk_bf16_f32 v25,v72,v72
 v_mfma_f32_32x32x16_bf16 v[104:119],v[44:47],v[208:211],v[104:119]
 ds_read_b64_tr_b16 v[44:45],v5 offset:55296
 ds_read_b64_tr_b16 v[46:47],v5 offset:55808
 s_waitcnt vmcnt(4) lgkmcnt(4)
 v_mfma_f32_32x32x16_bf16 v[88:103],v[48:51],v[212:215],v[88:103]
 ds_read_b64_tr_b16 v[48:49],v5 offset:39936
 ds_read_b64_tr_b16 v[50:51],v5 offset:40448
 v_bitop3_b32 v38,v224,v228,1 bitop3:0x80
 v_cmp_eq_u32 vcc,0,v38
 v_mfma_f32_32x32x16_bf16 v[104:119],v[52:55],v[212:215],v[104:119]
 ds_read_b64_tr_b16 v[52:53],v5 offset:56320
 ds_read_b64_tr_b16 v[54:55],v5 offset:56832
 s_cbranch_vccnz Lfix_606
Lret_607:
 s_waitcnt lgkmcnt(4)
 v_mfma_f32_32x32x16_bf16 v[88:103],v[40:43],v[224:227],v[88:103]
 ds_read_b64_tr_b16 v[40:41],v5 offset:43008
 ds_read_b64_tr_b16 v[42:43],v5 offset:43520
 v_mfma_f32_32x32x16_bf16 v[104:119],v[44:47],v[224:227],v[104:119]
 ds_read_b64_tr_b16 v[44:45],v5 offset:59392
 ds_read_b64_tr_b16 v[46:47],v5 offset:59904
 s_waitcnt vmcnt(2) lgkmcnt(4)
 v_mfma_f32_32x32x16_bf16 v[88:103],v[48:51],v[228:231],v[88:103]
 ds_read_b64_tr_b16 v[48:49],v5 offset:44032
 ds_read_b64_tr_b16 v[50:51],v5 offset:44544
 v_bitop3_b32 v38,v240,v244,1 bitop3:0x80
 v_cmp_eq_u32 vcc,0,v38
 v_mfma_f32_32x32x16_bf16 v[104:119],v[52:55],v[228:231],v[104:119]
 ds_read_b64_tr_b16 v[52:53],v5 offset:60416
 ds_read_b64_tr_b16 v[54:55],v5 offset:60928
 s_cbranch_vccnz Lfix_609
Lret_610:
 s_waitcnt lgkmcnt(4)
 v_mfma_f32_32x32x16_bf16 v[88:103],v[40:43],v[240:243],v[88:103]
 ds_read_b64_tr_b16 v[40:41],v5 offset:47104
 ds_read_b64_tr_b16 v[42:43],v5 offset:47616
 v_mfma_f32_32x32x16_bf16 v[104:119],v[44:47],v[240:243],v[104:119]
 ds_read_b64_tr_b16 v[44:45],v5 offset:63488
 ds_read_b64_tr_b16 v[46:47],v5 offset:64000
 s_waitcnt vmcnt(0) lgkmcnt(4)
 v_mfma_f32_32x32x16_bf16 v[88:103],v[48:51],v[244:247],v[88:103]
 ds_read_b64_tr_b16 v[48:49],v5 offset:48128
 ds_read_b64_tr_b16 v[50:51],v5 offset:48640
 v_accvgpr_read_b32 v38,a248
 v_lshlrev_b32 v38,31,v38
 v_cmp_eq_u32 s[82:83],0,v38
 v_accvgpr_read_b32 v38,a252
 v_lshlrev_b32 v38,31,v38
 v_cmp_eq_u32 vcc,0,v38
 s_nop 1
 s_or_b64 vcc,vcc,s[82:83]
 v_mfma_f32_32x32x16_bf16 v[104:119],v[52:55],v[244:247],v[104:119]
 ds_read_b64_tr_b16 v[52:53],v5 offset:64512
 ds_read_b64_tr_b16 v[54:55],v5 offset:65024
 s_cbranch_vccnz Lfix_612
Lret_613:
 s_waitcnt lgkmcnt(4)
 v_mfma_f32_32x32x16_bf16 v[88:103],v[40:43],a[248:251],v[88:103]
 v_mfma_f32_32x32x16_bf16 v[104:119],v[44:47],a[248:251],v[104:119]
 s_waitcnt lgkmcnt(0)
 v_mfma_f32_32x32x16_bf16 v[88:103],v[48:51],a[252:255],v[88:103]
 v_mfma_f32_32x32x16_bf16 v[104:119],v[52:55],a[252:255],v[104:119]
 v_mov_b32 v28,v22
 v_mov_b32 v29,v22
 s_nop 1
 v_mfma_f32_32x32x16_bf16 v[88:103],v[28:31],v[24:27],v[88:103]
 v_mov_b32 v28,v23
 v_mov_b32 v29,v23
 s_nop 1
 v_mfma_f32_32x32x16_bf16 v[104:119],v[28:31],v[24:27],v[104:119]
 s_barrier
 ds_read_b128 a[240:243],v36 offset:0
 ds_read_b128 a[244:247],v36 offset:4608
 ds_read_b64_tr_b16 v[40:41],v6 offset:0
 ds_read_b64_tr_b16 v[42:43],v6 offset:512
 ds_read_b64_tr_b16 v[44:45],v6 offset:1024
 ds_read_b64_tr_b16 v[46:47],v6 offset:1536
 ds_read_b64_tr_b16 v[48:49],v6 offset:2048
 ds_read_b64_tr_b16 v[50:51],v6 offset:2560
 ds_read_b64_tr_b16 v[52:53],v6 offset:3072
 ds_read_b64_tr_b16 v[54:55],v6 offset:3584
 s_waitcnt lgkmcnt(6)
 v_mfma_f32_32x32x16_bf16 v[120:135],v[40:43],v[136:139],0
 ds_read_b64_tr_b16 v[40:41],v6 offset:4096
 ds_read_b64_tr_b16 v[42:43],v6 offset:4608
 s_waitcnt lgkmcnt(6)
 v_mfma_f32_32x32x16_bf16 v[120:135],v[44:47],v[140:143],v[120:135]
 ds_read_b64_tr_b16 v[44:45],v6 offset:5120
 ds_read_b64_tr_b16 v[46:47],v6 offset:5632
 s_waitcnt lgkmcnt(6)
 v_mfma_f32_32x32x16_bf16 v[120:135],v[48:51],v[144:147],v[120:135]
 v_cvt_pk_bf16_f32 v88,v88,v89
 v_cvt_pk_bf16_f32 v89,v90,v91
 v_cvt_pk_bf16_f32 v90,v92,v93
 ds_read_b64_tr_b16 v[48:49],v6 offset:6144
 ds_read_b64_tr_b16 v[50:51],v6 offset:6656
 s_waitcnt lgkmcnt(6)
 v_mfma_f32_32x32x16_bf16 v[120:135],v[52:55],v[148:151],v[120:135]
 v_cvt_pk_bf16_f32 v91,v94,v95
 v_cvt_pk_bf16_f32 v92,v96,v97
 v_cvt_pk_bf16_f32 v93,v98,v99
 ds_read_b64_tr_b16 v[52:53],v6 offset:7168
 ds_read_b64_tr_b16 v[54:55],v6 offset:7680
 s_waitcnt lgkmcnt(6)
 v_mfma_f32_32x32x16_bf16 v[120:135],v[40:43],v[152:155],v[120:135]
 v_cvt_pk_bf16_f32 v94,v100,v101
 v_cvt_pk_bf16_f32 v95,v102,v103
 v_pk_max_i16 v88,v88,0
 ds_read_b64_tr_b16 v[40:41],v6 offset:8192
 ds_read_b64_tr_b16 v[42:43],v6 offset:8704
 s_waitcnt lgkmcnt(6)
 v_mfma_f32_32x32x16_bf16 v[120:135],v[44:47],v[156:159],v[120:135]
 v_pk_max_i16 v89,v89,0
 v_pk_max_i16 v90,v90,0
 v_pk_max_i16 v91,v91,0
 ds_read_b64_tr_b16 v[44:45],v6 offset:9216
 ds_read_b64_tr_b16 v[46:47],v6 offset:9728
 s_waitcnt lgkmcnt(6)
 v_mfma_f32_32x32x16_bf16 v[120:135],v[48:51],v[160:163],v[120:135]
 v_pk_max_i16 v92,v92,0
 v_pk_max_i16 v93,v93,0
 v_pk_max_i16 v94,v94,0
 ds_read_b64_tr_b16 v[48:49],v6 offset:10240
 ds_read_b64_tr_b16 v[50:51],v6 offset:10752
 s_waitcnt lgkmcnt(6)
 v_mfma_f32_32x32x16_bf16 v[120:135],v[52:55],v[164:167],v[120:135]
 v_pk_max_i16 v95,v95,0
 s_add_u32 s52,s64,0
 buffer_store_dwordx4 v[88:91],v1,s[32:35],s52 offen sc1
 s_add_u32 s52,s64,0
 buffer_store_dwordx4 v[92:95],v1,s[32:35],s52 offen offset:1024 sc1
 v_cvt_pk_bf16_f32 v104,v104,v105
 ds_read_b64_tr_b16 v[52:53],v6 offset:11264
 ds_read_b64_tr_b16 v[54:55],v6 offset:11776
 s_waitcnt lgkmcnt(6)
 v_mfma_f32_32x32x16_bf16 v[120:135],v[40:43],v[168:171],v[120:135]
 v_cvt_pk_bf16_f32 v105,v106,v107
 v_cvt_pk_bf16_f32 v106,v108,v109
 v_cvt_pk_bf16_f32 v107,v110,v111
 ds_read_b64_tr_b16 v[40:41],v6 offset:12288
 ds_read_b64_tr_b16 v[42:43],v6 offset:12800
 s_waitcnt lgkmcnt(6)
 v_mfma_f32_32x32x16_bf16 v[120:135],v[44:47],v[172:175],v[120:135]
 v_cvt_pk_bf16_f32 v108,v112,v113
 v_cvt_pk_bf16_f32 v109,v114,v115
 v_cvt_pk_bf16_f32 v110,v116,v117
 ds_read_b64_tr_b16 v[44:45],v6 offset:13312
 ds_read_b64_tr_b16 v[46:47],v6 offset:13824
 s_waitcnt lgkmcnt(6)
 v_mfma_f32_32x32x16_bf16 v[120:135],v[48:51],v[176:179],v[120:135]
 v_cvt_pk_bf16_f32 v111,v118,v119
 v_pk_max_i16 v104,v104,0
 v_pk_max_i16 v105,v105,0
 ds_read_b64_tr_b16 v[48:49],v6 offset:14336
 ds_read_b64_tr_b16 v[50:51],v6 offset:14848
 s_waitcnt lgkmcnt(6)
 v_mfma_f32_32x32x16_bf16 v[120:135],v[52:55],v[180:183],v[120:135]
 v_pk_max_i16 v106,v106,0
 v_pk_max_i16 v107,v107,0
 v_pk_max_i16 v108,v108,0
 ds_read_b64_tr_b16 v[52:53],v6 offset:15360
 ds_read_b64_tr_b16 v[54:55],v6 offset:15872
 s_waitcnt lgkmcnt(6)
 v_mfma_f32_32x32x16_bf16 v[120:135],v[40:43],v[184:187],v[120:135]
 v_pk_max_i16 v109,v109,0
 v_pk_max_i16 v110,v110,0
 v_pk_max_i16 v111,v111,0
 ds_read_b64_tr_b16 v[40:41],v6 offset:16384
 ds_read_b64_tr_b16 v[42:43],v6 offset:16896
 s_waitcnt lgkmcnt(6)
 v_mfma_f32_32x32x16_bf16 v[120:135],v[44:47],v[188:191],v[120:135]
 s_lshl_b32 s53,s60,5
 s_add_u32 s53,s53,s64
 s_add_u32 s52,s53,0
 buffer_store_dwordx4 v[104:107],v1,s[32:35],s52 offen sc1
 s_add_u32 s52,s53,0
 buffer_store_dwordx4 v[108:111],v1,s[32:35],s52 offen offset:1024 sc1
 v_add_u32 v32,s68,v1
 v_add_u32 v33,88064,v32
 ds_read_b64_tr_b16 v[44:45],v6 offset:17408
 ds_read_b64_tr_b16 v[46:47],v6 offset:17920
 s_waitcnt lgkmcnt(6)
 v_mfma_f32_32x32x16_bf16 v[120:135],v[48:51],v[192:195],v[120:135]
 s_lshl_b32 s53,s4,13
 s_add_u32 s53,s53,0
 v_add_u32 v7,s53,v1
 ds_read_b64_tr_b16 v[48:49],v6 offset:18432
 ds_read_b64_tr_b16 v[50:51],v6 offset:18944
 s_waitcnt lgkmcnt(6)
 v_mfma_f32_32x32x16_bf16 v[120:135],v[52:55],v[196:199],v[120:135]
 v_xor_b32 v8,64,v7
 v_xor_b32 v9,128,v7
 v_xor_b32 v10,192,v7
 ds_read_b64_tr_b16 v[52:53],v6 offset:19456
 ds_read_b64_tr_b16 v[54:55],v6 offset:19968
 s_waitcnt lgkmcnt(6)
 v_mfma_f32_32x32x16_bf16 v[120:135],v[40:43],v[200:203],v[120:135]
 v_and_b32 v21,7,v0
 s_lshl_b32 s53,s4,3
 v_add_u32 v20,s53,v21
 ds_read_b64_tr_b16 v[40:41],v6 offset:20480
 ds_read_b64_tr_b16 v[42:43],v6 offset:20992
 s_waitcnt lgkmcnt(6)
 v_mfma_f32_32x32x16_bf16 v[120:135],v[44:47],v[204:207],v[120:135]
 v_lshrrev_b32 v56,3,v0
 v_lshlrev_b32 v19,2,v56
 v_lshlrev_b32 v14,9,v56
 ds_read_b64_tr_b16 v[44:45],v6 offset:21504
 ds_read_b64_tr_b16 v[46:47],v6 offset:22016
 s_waitcnt lgkmcnt(6)
 v_mfma_f32_32x32x16_bf16 v[120:135],v[48:51],v[208:211],v[120:135]
 v_lshl_add_u32 v14,v20,4,v14
 s_lshl_b32 s53,s4,3
 v_add_u32 v20,s53,v56
 ds_read_b64_tr_b16 v[48:49],v6 offset:22528
 ds_read_b64_tr_b16 v[50:51],v6 offset:23040
 s_waitcnt lgkmcnt(6)
 v_mfma_f32_32x32x16_bf16 v[120:135],v[52:55],v[212:215],v[120:135]
 v_lshlrev_b32 v12,10,v20
 v_lshl_add_u32 v12,v21,4,v12
 v_and_b32 v56,3,v0
 ds_read_b64_tr_b16 v[52:53],v6 offset:23552
 ds_read_b64_tr_b16 v[54:55],v6 offset:24064
 s_waitcnt lgkmcnt(6)
 v_mfma_f32_32x32x16_bf16 v[120:135],v[40:43],v[216:219],v[120:135]
 v_lshlrev_b32 v56,2,v56
 v_xor_b32 v56,v56,v20
 v_lshlrev_b32 v56,4,v56
 v_lshl_add_u32 v11,v21,10,v56
 v_add_u32 v11,0x0,v11
 s_bfe_u32 s84,s44,0x50000
 s_lshl_b32 s84,s84,12
 buffer_load_dwordx4 v[136:139],v32,s[32:35],s84 offen sc1
 ds_read_b64_tr_b16 v[40:41],v6 offset:24576
 ds_read_b64_tr_b16 v[42:43],v6 offset:25088
 s_waitcnt lgkmcnt(6)
 v_mfma_f32_32x32x16_bf16 v[120:135],v[44:47],v[220:223],v[120:135]
 s_bfe_u32 s84,s44,0x50005
 s_lshl_b32 s84,s84,12
 buffer_load_dwordx4 v[140:143],v32,s[32:35],s84 offen sc1
 ds_read_b64_tr_b16 v[44:45],v6 offset:25600
 ds_read_b64_tr_b16 v[46:47],v6 offset:26112
 s_waitcnt lgkmcnt(6)
 v_mfma_f32_32x32x16_bf16 v[120:135],v[48:51],v[224:227],v[120:135]
 s_bfe_u32 s84,s44,0x5000a
 s_lshl_b32 s84,s84,12
 buffer_load_dwordx4 v[144:147],v32,s[32:35],s84 offen sc1
 ds_read_b64_tr_b16 v[48:49],v6 offset:26624
 ds_read_b64_tr_b16 v[50:51],v6 offset:27136
 s_waitcnt lgkmcnt(6)
 v_mfma_f32_32x32x16_bf16 v[120:135],v[52:55],v[228:231],v[120:135]
 s_bfe_u32 s84,s44,0x5000f
 s_lshl_b32 s84,s84,12
 buffer_load_dwordx4 v[148:151],v32,s[32:35],s84 offen sc1
 ds_read_b64_tr_b16 v[52:53],v6 offset:27648
 ds_read_b64_tr_b16 v[54:55],v6 offset:28160
 s_waitcnt lgkmcnt(6)
 v_mfma_f32_32x32x16_bf16 v[120:135],v[40:43],v[232:235],v[120:135]
 s_bfe_u32 s84,s44,0x50014
 s_lshl_b32 s84,s84,12
 buffer_load_dwordx4 v[152:155],v32,s[32:35],s84 offen sc1
 ds_read_b64_tr_b16 v[40:41],v6 offset:28672
 ds_read_b64_tr_b16 v[42:43],v6 offset:29184
 s_waitcnt lgkmcnt(6)
 v_mfma_f32_32x32x16_bf16 v[120:135],v[44:47],v[236:239],v[120:135]
 s_bfe_u32 s84,s44,0x50019
 s_lshl_b32 s84,s84,12
 buffer_load_dwordx4 v[156:159],v32,s[32:35],s84 offen sc1
 ds_read_b64_tr_b16 v[44:45],v6 offset:29696
 ds_read_b64_tr_b16 v[46:47],v6 offset:30208
 s_waitcnt lgkmcnt(6)
 v_mfma_f32_32x32x16_bf16 v[120:135],v[48:51],v[240:243],v[120:135]
 s_bfe_u32 s84,s45,0x50000
 s_lshl_b32 s84,s84,12
 buffer_load_dwordx4 v[160:163],v32,s[32:35],s84 offen sc1
 ds_read_b64_tr_b16 v[48:49],v6 offset:30720
 ds_read_b64_tr_b16 v[50:51],v6 offset:31232
 s_waitcnt lgkmcnt(6)
 v_mfma_f32_32x32x16_bf16 v[120:135],v[52:55],v[244:247],v[120:135]
 s_bfe_u32 s84,s45,0x50005
 s_lshl_b32 s84,s84,12
 buffer_load_dwordx4 v[164:167],v32,s[32:35],s84 offen sc1
 ds_read_b64_tr_b16 v[52:53],v6 offset:31744
 ds_read_b64_tr_b16 v[54:55],v6 offset:32256
 s_waitcnt lgkmcnt(6)
 v_mfma_f32_32x32x16_bf16 v[120:135],v[40:43],v[248:251],v[120:135]
 s_bfe_u32 s84,s45,0x5000a
 s_lshl_b32 s84,s84,12
 buffer_load_dwordx4 v[168:171],v32,s[32:35],s84 offen sc1
 s_waitcnt lgkmcnt(4)
 v_mfma_f32_32x32x16_bf16 v[120:135],v[44:47],v[252:255],v[120:135]
 s_bfe_u32 s84,s45,0x5000f
 s_lshl_b32 s84,s84,12
 buffer_load_dwordx4 v[172:175],v32,s[32:35],s84 offen sc1
 s_waitcnt lgkmcnt(2)
 v_mfma_f32_32x32x16_bf16 v[120:135],v[48:51],a[248:251],v[120:135]
 s_waitcnt lgkmcnt(0)
 v_mfma_f32_32x32x16_bf16 v[120:135],v[52:55],a[252:255],v[120:135]
 v_mov_b32 v28,v34
 v_mov_b32 v29,v34
 s_nop 1
 v_mfma_f32_32x32x16_bf16 v[120:135],v[28:31],v[24:27],v[120:135]
 s_nop 11
 v_cvt_pk_bf16_f32 v120,v120,v121
 v_cvt_pk_bf16_f32 v121,v122,v123
 v_cvt_pk_bf16_f32 v122,v124,v125
 v_cvt_pk_bf16_f32 v123,v126,v127
 v_cvt_pk_bf16_f32 v124,v128,v129
 v_cvt_pk_bf16_f32 v125,v130,v131
 v_cvt_pk_bf16_f32 v126,v132,v133
 v_cvt_pk_bf16_f32 v127,v134,v135
 v_pk_max_i16 v120,v120,0
 v_pk_max_i16 v121,v121,0
 v_pk_max_i16 v122,v122,0
 v_pk_max_i16 v123,v123,0
 v_pk_max_i16 v124,v124,0
 v_pk_max_i16 v125,v125,0
 v_pk_max_i16 v126,v126,0
 v_pk_max_i16 v127,v127,0
 s_cmp_ge_u32 s6,11
 s_cbranch_scc1 Lh3_615
 s_add_u32 s52,s64,2048
 buffer_store_dwordx4 v[120:123],v1,s[32:35],s52 offen sc1
 s_add_u32 s52,s64,2048
 buffer_store_dwordx4 v[124:127],v1,s[32:35],s52 offen offset:1024 sc1
Lh3_615:
 s_add_u32 s84,s69,262144
 buffer_load_dwordx4 v[24:27],v14,s[32:35],s84 offen sc1
 s_waitcnt vmcnt(9)
 v_or_b32 v38,v136,v140
 v_cmp_gt_i32 vcc,0,v38
 s_cbranch_vccnz Lfix_616
Lret_617:
 v_mfma_f32_32x32x16_bf16 v[88:103],a[0:3],v[136:139],0
 s_bfe_u32 s84,s45,0x50014
 s_lshl_b32 s84,s84,12
 buffer_load_dwordx4 v[176:179],v32,s[32:35],s84 offen sc1
 v_mfma_f32_32x32x16_bf16 v[104:119],a[4:7],v[136:139],0
 v_mfma_f32_32x32x16_bf16 v[88:103],a[8:11],v[140:143],v[88:103]
 s_bfe_u32 s84,s45,0x50019
 s_lshl_b32 s84,s84,12
 buffer_load_dwordx4 v[180:183],v32,s[32:35],s84 offen sc1
 s_waitcnt vmcnt(9)
 v_or_b32 v38,v144,v148
 v_cmp_gt_i32 vcc,0,v38
 v_mfma_f32_32x32x16_bf16 v[104:119],a[12:15],v[140:143],v[104:119]
 s_cbranch_vccnz Lfix_619
Lret_620:
 v_mfma_f32_32x32x16_bf16 v[88:103],a[16:19],v[144:147],v[88:103]
 s_bfe_u32 s84,s46,0x50000
 s_lshl_b32 s84,s84,12
 buffer_load_dwordx4 v[184:187],v32,s[32:35],s84 offen sc1
 v_mfma_f32_32x32x16_bf16 v[104:119],a[20:23],v[144:147],v[104:119]
 v_mfma_f32_32x32x16_bf16 v[88:103],a[24:27],v[148:151],v[88:103]
 s_bfe_u32 s84,s46,0x50005
 s_lshl_b32 s84,s84,12
 buffer_load_dwordx4 v[188:191],v32,s[32:35],s84 offen sc1
 s_waitcnt vmcnt(9)
 v_or_b32 v38,v152,v156
 v_cmp_gt_i32 vcc,0,v38
 v_mfma_f32_32x32x16_bf16 v[104:119],a[28:31],v[148:151],v[104:119]
 s_cbranch_vccnz Lfix_622
Lret_623:
 v_mfma_f32_32x32x16_bf16 v[88:103],a[32:35],v[152:155],v[88:103]
 s_bfe_u32 s84,s46,0x5000a
 s_lshl_b32 s84,s84,12
 buffer_load_dwordx4 v[192:195],v32,s[32:35],s84 offen sc1
 v_mfma_f32_32x32x16_bf16 v[104:119],a[36:39],v[152:155],v[104:119]
 v_mfma_f32_32x32x16_bf16 v[88:103],a[40:43],v[156:159],v[88:103]
 s_bfe_u32 s84,s46,0x5000f
 s_lshl_b32 s84,s84,12
 buffer_load_dwordx4 v[196:199],v32,s[32:35],s84 offen sc1
 s_waitcnt vmcnt(9)
 v_or_b32 v38,v160,v164
 v_cmp_gt_i32 vcc,0,v38
 v_mfma_f32_32x32x16_bf16 v[104:119],a[44:47],v[156:159],v[104:119]
 s_cbranch_vccnz Lfix_625
Lret_626:
 v_mfma_f32_32x32x16_bf16 v[88:103],a[48:51],v[160:163],v[88:103]
 s_bfe_u32 s84,s46,0x50014
 s_lshl_b32 s84,s84,12
 buffer_load_dwordx4 v[200:203],v32,s[32:35],s84 offen sc1
 v_mfma_f32_32x32x16_bf16 v[104:119],a[52:55],v[160:163],v[104:119]
 v_mfma_f32_32x32x16_bf16 v[88:103],a[56:59],v[164:167],v[88:103]
 s_bfe_u32 s84,s46,0x50019
 s_lshl_b32 s84,s84,12
 buffer_load_dwordx4 v[204:207],v32,s[32:35],s84 offen sc1
 s_waitcnt vmcnt(9)
 v_or_b32 v38,v168,v172
 v_cmp_gt_i32 vcc,0,v38
 v_mfma_f32_32x32x16_bf16 v[104:119],a[60:63],v[164:167],v[104:119]
 s_cbranch_vccnz Lfix_628
Lret_629:
 v_mfma_f32_32x32x16_bf16 v[88:103],a[64:67],v[168:171],v[88:103]
 s_bfe_u32 s84,s47,0x50000
 s_lshl_b32 s84,s84,12
 buffer_load_dwordx4 v[208:211],v32,s[32:35],s84 offen sc1
 s_waitcnt vmcnt(9)
 v_and_b32 v30,v24,v25
 v_bitop3_b32 v30,v26,v27,v30 bitop3:0x80
 v_and_b32 v30,1,v30
 v_cmp_eq_u32 s[82:83],0,v30
 s_nop 0
 s_cmp_lg_u64 s[82:83],0
 s_cbranch_scc1 Lfix_631
Lret_632:
 v_mfma_f32_32x32x16_bf16 v[104:119],a[68:71],v[168:171],v[104:119]
 v_add_f32 v24,v24,v25
 v_mfma_f32_32x32x16_bf16 v[88:103],a[72:75],v[172:175],v[88:103]
 s_bfe_u32 s84,s47,0x50005
 s_lshl_b32 s84,s84,12
 buffer_load_dwordx4 v[212:215],v32,s[32:35],s84 offen sc1
 s_waitcnt vmcnt(8)
 v_or_b32 v38,v176,v180
 v_cmp_gt_i32 vcc,0,v38
 v_add_f32 v26,v26,v27
 v_mfma_f32_32x32x16_bf16 v[104:119],a[76:79],v[172:175],v[104:119]
 v_add_f32 v24,v24,v26
 s_nop 1
 v_add_f32_dpp v24,v24,v24 row_ror:8 row_mask:0xf bank_mask:0xf
 v_mov_b32 v25,v24
 s_nop 1
 v_permlane16_swap_b32 v24,v25
 v_mul_f32 v24,s74,v24
 v_mul_f32 v25,s74,v25
 s_cbranch_vccnz Lfix_634
Lret_635:
 v_mfma_f32_32x32x16_bf16 v[88:103],a[80:83],v[176:179],v[88:103]
 s_bfe_u32 s84,s47,0x5000a
 s_lshl_b32 s84,s84,12
 buffer_load_dwordx4 v[216:219],v32,s[32:35],s84 offen sc1
 v_fma_f32 v25,-v24,v24,v25
 v_mfma_f32_32x32x16_bf16 v[104:119],a[84:87],v[176:179],v[104:119]
 v_max_f32 v25,0,v25
 v_add_f32 v25,s75,v25
 v_rsq_f32 v28,v25
 s_nop 0
 v_mov_b32 v30,v28
 s_nop 1
 v_permlane32_swap_b32 v30,v28
 v_mfma_f32_32x32x16_bf16 v[88:103],a[88:91],v[180:183],v[88:103]
 buffer_load_dwordx4 v[220:223],v32,s[32:35],s70 offen sc1
 s_waitcnt vmcnt(8)
 v_or_b32 v38,v184,v188
 v_cmp_gt_i32 vcc,0,v38
 ds_bpermute_b32 v30,v19,v30
 v_mfma_f32_32x32x16_bf16 v[104:119],a[92:95],v[180:183],v[104:119]
 ds_bpermute_b32 v28,v19,v28
 s_cbranch_vccnz Lfix_637
Lret_638:
 v_mfma_f32_32x32x16_bf16 v[88:103],a[96:99],v[184:187],v[88:103]
 s_bfe_u32 s84,s44,0x50000
 s_lshl_b32 s84,s84,12
 buffer_load_dwordx4 v[224:227],v33,s[32:35],s84 offen sc1
 v_mfma_f32_32x32x16_bf16 v[104:119],a[100:103],v[184:187],v[104:119]
 v_mfma_f32_32x32x16_bf16 v[88:103],a[104:107],v[188:191],v[88:103]
 s_bfe_u32 s84,s44,0x50005
 s_lshl_b32 s84,s84,12
 buffer_load_dwordx4 v[228:231],v33,s[32:35],s84 offen sc1
 s_waitcnt vmcnt(8)
 v_or_b32 v38,v192,v196
 v_cmp_gt_i32 vcc,0,v38
 v_mfma_f32_32x32x16_bf16 v[104:119],a[108:111],v[188:191],v[104:119]
 s_cbranch_vccnz Lfix_640
Lret_641:
 v_mfma_f32_32x32x16_bf16 v[88:103],a[112:115],v[192:195],v[88:103]
 s_bfe_u32 s84,s44,0x5000a
 s_lshl_b32 s84,s84,12
 buffer_load_dwordx4 v[136:139],v33,s[32:35],s84 offen sc1
 v_mfma_f32_32x32x16_bf16 v[104:119],a[116:119],v[192:195],v[104:119]
 v_mfma_f32_32x32x16_bf16 v[88:103],a[120:123],v[196:199],v[88:103]
 s_bfe_u32 s84,s44,0x5000f
 s_lshl_b32 s84,s84,12
 buffer_load_dwordx4 v[140:143],v33,s[32:35],s84 offen sc1
 s_waitcnt vmcnt(8)
 v_or_b32 v38,v200,v204
 v_cmp_gt_i32 vcc,0,v38
 v_mfma_f32_32x32x16_bf16 v[104:119],a[124:127],v[196:199],v[104:119]
 s_cbranch_vccnz Lfix_643
Lret_644:
 v_mfma_f32_32x32x16_bf16 v[88:103],a[128:131],v[200:203],v[88:103]
 s_bfe_u32 s84,s44,0x50014
 s_lshl_b32 s84,s84,12
 buffer_load_dwordx4 v[144:147],v33,s[32:35],s84 offen sc1
 v_mfma_f32_32x32x16_bf16 v[104:119],a[132:135],v[200:203],v[104:119]
 v_mfma_f32_32x32x16_bf16 v[88:103],a[136:139],v[204:207],v[88:103]
 s_bfe_u32 s84,s44,0x50019
 s_lshl_b32 s84,s84,12
 buffer_load_dwordx4 v[148:151],v33,s[32:35],s84 offen sc1
 s_waitcnt vmcnt(8)
 v_or_b32 v38,v208,v212
 v_cmp_gt_i32 vcc,0,v38
 v_mfma_f32_32x32x16_bf16 v[104:119],a[140:143],v[204:207],v[104:119]
 s_cbranch_vccnz Lfix_646
Lret_647:
 v_mfma_f32_32x32x16_bf16 v[88:103],a[144:147],v[208:211],v[88:103]
 s_bfe_u32 s84,s45,0x50000
 s_lshl_b32 s84,s84,12
 buffer_load_dwordx4 v[152:155],v33,s[32:35],s84 offen sc1
 v_mfma_f32_32x32x16_bf16 v[104:119],a[148:151],v[208:211],v[104:119]
 v_mfma_f32_32x32x16_bf16 v[88:103],a[152:155],v[212:215],v[88:103]
 s_bfe_u32 s84,s45,0x50005
 s_lshl_b32 s84,s84,12
 buffer_load_dwordx4 v[156:159],v33,s[32:35],s84 offen sc1
 s_waitcnt vmcnt(8)
 v_or_b32 v38,v216,v220
 v_cmp_gt_i32 vcc,0,v38
 v_mfma_f32_32x32x16_bf16 v[104:119],a[156:159],v[212:215],v[104:119]
 s_cbranch_vccnz Lfix_649
Lret_650:
 v_mfma_f32_32x32x16_bf16 v[88:103],a[160:163],v[216:219],v[88:103]
 s_bfe_u32 s84,s45,0x5000a
 s_lshl_b32 s84,s84,12
 buffer_load_dwordx4 v[160:163],v33,s[32:35],s84 offen sc1
 v_mfma_f32_32x32x16_bf16 v[104:119],a[164:167],v[216:219],v[104:119]
 v_mfma_f32_32x32x16_bf16 v[88:103],a[168:171],v[220:223],v[88:103]
 s_bfe_u32 s84,s45,0x5000f
 s_lshl_b32 s84,s84,12
 buffer_load_dwordx4 v[164:167],v33,s[32:35],s84 offen sc1
 s_waitcnt vmcnt(8)
 v_or_b32 v38,v224,v228
 v_cmp_gt_i32 vcc,0,v38
 v_mfma_f32_32x32x16_bf16 v[104:119],a[172:175],v[220:223],v[104:119]
 s_cbranch_vccnz Lfix_652
Lret_653:
 v_mfma_f32_32x32x16_bf16 v[120:135],a[0:3],v[224:227],0
 s_bfe_u32 s84,s45,0x50014
 s_lshl_b32 s84,s84,12
 buffer_load_dwordx4 v[168:171],v33,s[32:35],s84 offen sc1
 v_mfma_f32_32x32x16_bf16 v[232:247],a[4:7],v[224:227],0
 v_mfma_f32_32x32x16_bf16 v[120:135],a[8:11],v[228:231],v[120:135]
 s_bfe_u32 s84,s45,0x50019
 s_lshl_b32 s84,s84,12
 buffer_load_dwordx4 v[172:175],v33,s[32:35],s84 offen sc1
 s_waitcnt vmcnt(8)
 v_or_b32 v38,v136,v140
 v_cmp_gt_i32 vcc,0,v38
 ds_write_b128 v7,v[88:91] offset:0
 v_mfma_f32_32x32x16_bf16 v[232:247],a[12:15],v[228:231],v[232:247]
 s_cbranch_vccnz Lfix_655
Lret_656:
 v_mfma_f32_32x32x16_bf16 v[120:135],a[16:19],v[136:139],v[120:135]
 s_bfe_u32 s84,s46,0x50000
 s_lshl_b32 s84,s84,12
 buffer_load_dwordx4 v[176:179],v33,s[32:35],s84 offen sc1
 v_mfma_f32_32x32x16_bf16 v[232:247],a[20:23],v[136:139],v[232:247]
 v_mfma_f32_32x32x16_bf16 v[120:135],a[24:27],v[140:143],v[120:135]
 s_bfe_u32 s84,s46,0x50005
 s_lshl_b32 s84,s84,12
 buffer_load_dwordx4 v[180:183],v33,s[32:35],s84 offen sc1
 s_waitcnt vmcnt(8)
 v_or_b32 v38,v144,v148
 v_cmp_gt_i32 vcc,0,v38
 ds_write_b128 v8,v[92:95] offset:1024
 v_mfma_f32_32x32x16_bf16 v[232:247],a[28:31],v[140:143],v[232:247]
 s_cbranch_vccnz Lfix_658
Lret_659:
 v_mfma_f32_32x32x16_bf16 v[120:135],a[32:35],v[144:147],v[120:135]
 s_bfe_u32 s84,s46,0x5000a
 s_lshl_b32 s84,s84,12
 buffer_load_dwordx4 v[184:187],v33,s[32:35],s84 offen sc1
 v_mfma_f32_32x32x16_bf16 v[232:247],a[36:39],v[144:147],v[232:247]
 v_mfma_f32_32x32x16_bf16 v[120:135],a[40:43],v[148:151],v[120:135]
 s_bfe_u32 s84,s46,0x5000f
 s_lshl_b32 s84,s84,12
 buffer_load_dwordx4 v[188:191],v33,s[32:35],s84 offen sc1
 s_waitcnt vmcnt(8)
 v_or_b32 v38,v152,v156
 v_cmp_gt_i32 vcc,0,v38
 ds_write_b128 v9,v[96:99] offset:2048
 v_mfma_f32_32x32x16_bf16 v[232:247],a[44:47],v[148:151],v[232:247]
 s_cbranch_vccnz Lfix_661
Lret_662:
 v_mfma_f32_32x32x16_bf16 v[120:135],a[48:51],v[152:155],v[120:135]
 s_bfe_u32 s84,s46,0x50014
 s_lshl_b32 s84,s84,12
 buffer_load_dwordx4 v[192:195],v33,s[32:35],s84 offen sc1
 v_mfma_f32_32x32x16_bf16 v[232:247],a[52:55],v[152:155],v[232:247]
 v_mfma_f32_32x32x16_bf16 v[120:135],a[56:59],v[156:159],v[120:135]
 s_bfe_u32 s84,s46,0x50019
 s_lshl_b32 s84,s84,12
 buffer_load_dwordx4 v[196:199],v33,s[32:35],s84 offen sc1
 s_waitcnt vmcnt(8)
 v_or_b32 v38,v160,v164
 v_cmp_gt_i32 vcc,0,v38
 ds_write_b128 v10,v[100:103] offset:3072
 v_mfma_f32_32x32x16_bf16 v[232:247],a[60:63],v[156:159],v[232:247]
 s_cbranch_vccnz Lfix_664
Lret_665:
 v_mfma_f32_32x32x16_bf16 v[120:135],a[64:67],v[160:163],v[120:135]
 s_bfe_u32 s84,s47,0x50000
 s_lshl_b32 s84,s84,12
 buffer_load_dwordx4 v[200:203],v33,s[32:35],s84 offen sc1
 v_mfma_f32_32x32x16_bf16 v[232:247],a[68:71],v[160:163],v[232:247]
 v_mfma_f32_32x32x16_bf16 v[120:135],a[72:75],v[164:167],v[120:135]
 s_bfe_u32 s84,s47,0x50005
 s_lshl_b32 s84,s84,12
 buffer_load_dwordx4 v[204:207],v33,s[32:35],s84 offen sc1
 s_waitcnt vmcnt(8)
 v_or_b32 v38,v168,v172
 v_cmp_gt_i32 vcc,0,v38
 ds_write_b128 v7,v[104:107] offset:4096
 v_mfma_f32_32x32x16_bf16 v[232:247],a[76:79],v[164:167],v[232:247]
 s_cbranch_vccnz Lfix_667
Lret_668:
 v_mfma_f32_32x32x16_bf16 v[120:135],a[80:83],v[168:171],v[120:135]
 s_bfe_u32 s84,s47,0x5000a
 s_lshl_b32 s84,s84,12
 buffer_load_dwordx4 v[208:211],v33,s[32:35],s84 offen sc1
 v_mfma_f32_32x32x16_bf16 v[232:247],a[84:87],v[168:171],v[232:247]
 v_mfma_f32_32x32x16_bf16 v[120:135],a[88:91],v[172:175],v[120:135]
 buffer_load_dwordx4 v[212:215],v33,s[32:35],s70 offen sc1
 s_waitcnt vmcnt(8)
 v_or_b32 v38,v176,v180
 v_cmp_gt_i32 vcc,0,v38
 ds_write_b128 v8,v[108:111] offset:5120
 v_mfma_f32_32x32x16_bf16 v[232:247],a[92:95],v[172:175],v[232:247]
 s_cbranch_vccnz Lfix_670
Lret_671:
 v_mfma_f32_32x32x16_bf16 v[120:135],a[96:99],v[176:179],v[120:135]
 v_mfma_f32_32x32x16_bf16 v[232:247],a[100:103],v[176:179],v[232:247]
 v_mfma_f32_32x32x16_bf16 v[120:135],a[104:107],v[180:183],v[120:135]
 s_waitcnt vmcnt(6)
 v_or_b32 v38,v184,v188
 v_cmp_gt_i32 vcc,0,v38
 ds_write_b128 v9,v[112:115] offset:6144
 v_mfma_f32_32x32x16_bf16 v[232:247],a[108:111],v[180:183],v[232:247]
 s_cbranch_vccnz Lfix_673
Lret_674:
 v_mfma_f32_32x32x16_bf16 v[120:135],a[112:115],v[184:187],v[120:135]
 v_mfma_f32_32x32x16_bf16 v[232:247],a[116:119],v[184:187],v[232:247]
 s_lshr_b32 s52,s2,3
 s_or_b32 s52,s52,s4
 s_cmp_lg_u32 s52,0
 s_cbranch_scc1 Lwb_676
 buffer_wbl2 sc1
Lwb_676:
 v_mfma_f32_32x32x16_bf16 v[120:135],a[120:123],v[188:191],v[120:135]
 s_waitcnt vmcnt(4)
 v_or_b32 v38,v192,v196
 v_cmp_gt_i32 vcc,0,v38
 ds_write_b128 v10,v[116:119] offset:7168
 v_mfma_f32_32x32x16_bf16 v[232:247],a[124:127],v[188:191],v[232:247]
 s_cbranch_vccnz Lfix_677
Lret_678:
 v_mfma_f32_32x32x16_bf16 v[120:135],a[128:131],v[192:195],v[120:135]
 v_mfma_f32_32x32x16_bf16 v[232:247],a[132:135],v[192:195],v[232:247]
 v_mfma_f32_32x32x16_bf16 v[120:135],a[136:139],v[196:199],v[120:135]
 s_waitcnt vmcnt(2)
 v_or_b32 v38,v200,v204
 v_cmp_gt_i32 vcc,0,v38
 s_waitcnt lgkmcnt(0)
 s_barrier
 v_mfma_f32_32x32x16_bf16 v[232:247],a[140:143],v[196:199],v[232:247]
 ds_read_b128 v[56:59],v11 offset:0
 s_cbranch_vccnz Lfix_680
Lret_681:
 v_mfma_f32_32x32x16_bf16 v[120:135],a[144:147],v[200:203],v[120:135]
 ds_read_b128 v[60:63],v11 offset:512
 ds_read_b128 v[64:67],v11 offset:8192
 ds_read_b128 v[68:71],v11 offset:8704
 ds_read_b128 v[72:75],v11 offset:16384
 ds_read_b128 v[76:79],v11 offset:16896
 ds_read_b128 v[80:83],v11 offset:24576
 v_mfma_f32_32x32x16_bf16 v[120:135],a[152:155],v[204:207],v[120:135]
 s_waitcnt vmcnt(0)
 v_or_b32 v38,v208,v212
 v_cmp_gt_i32 vcc,0,v38
 ds_read_b128 v[84:87],v11 offset:25088
 v_accvgpr_read_b32 v89,a240
 v_accvgpr_read_b32 v91,a241
 v_accvgpr_read_b32 v93,a242
 v_accvgpr_read_b32 v95,a243
 v_lshlrev_b32 v88,16,v89
 s_cbranch_vccnz Lfix_683
Lret_684:
 v_mfma_f32_32x32x16_bf16 v[120:135],a[160:163],v[208:211],v[120:135]
 v_and_b32 v89,0xffff0000,v89
 v_lshlrev_b32 v90,16,v91
 v_and_b32 v91,0xffff0000,v91
 v_lshlrev_b32 v92,16,v93
 v_and_b32 v93,0xffff0000,v93
 v_lshlrev_b32 v94,16,v95
 v_mfma_f32_32x32x16_bf16 v[120:135],a[168:171],v[212:215],v[120:135]
 v_and_b32 v95,0xffff0000,v95
 s_waitcnt lgkmcnt(5)
 v_pk_add_f32 v[56:57],v[56:57],v[64:65]
 v_pk_add_f32 v[58:59],v[58:59],v[66:67]
 s_waitcnt lgkmcnt(4)
 v_pk_add_f32 v[60:61],v[60:61],v[68:69]
 v_pk_add_f32 v[62:63],v[62:63],v[70:71]
 s_waitcnt lgkmcnt(1)
 v_pk_add_f32 v[72:73],v[72:73],v[80:81]
 v_pk_add_f32 v[74:75],v[74:75],v[82:83]
 s_waitcnt lgkmcnt(0)
 v_pk_add_f32 v[76:77],v[76:77],v[84:85]
 v_pk_add_f32 v[78:79],v[78:79],v[86:87]
 v_pk_add_f32 v[56:57],v[56:57],v[72:73]
 v_pk_add_f32 v[58:59],v[58:59],v[74:75]
 v_pk_add_f32 v[60:61],v[60:61],v[76:77]
 v_pk_add_f32 v[62:63],v[62:63],v[78:79]
 v_pk_fma_f32 v[56:57],v[56:57],v[30:31],v[88:89] op_sel_hi:[1,0,1]
 v_pk_fma_f32 v[58:59],v[58:59],v[30:31],v[90:91] op_sel_hi:[1,0,1]
 v_pk_fma_f32 v[60:61],v[60:61],v[30:31],v[92:93] op_sel_hi:[1,0,1]
 v_pk_fma_f32 v[62:63],v[62:63],v[30:31],v[94:95] op_sel_hi:[1,0,1]
 v_cvt_pk_bf16_f32 v64,v56,v57
 v_cvt_pk_bf16_f32 v65,v58,v59
 v_cvt_pk_bf16_f32 v66,v60,v61
 v_cvt_pk_bf16_f32 v67,v62,v63
 s_add_u32 s52,s80,0
 buffer_store_dwordx4 v[64:67],v12,s[28:31],s52 offen sc1
 v_accvgpr_read_b32 v105,a244
 v_accvgpr_read_b32 v107,a245
 v_accvgpr_read_b32 v109,a246
 v_accvgpr_read_b32 v111,a247
 v_lshlrev_b32 v104,16,v105
 v_and_b32 v105,0xffff0000,v105
 v_lshlrev_b32 v106,16,v107
 v_and_b32 v107,0xffff0000,v107
 v_lshlrev_b32 v108,16,v109
 v_and_b32 v109,0xffff0000,v109
 v_lshlrev_b32 v110,16,v111
 v_and_b32 v111,0xffff0000,v111
 s_barrier
 v_mfma_f32_32x32x16_bf16 v[232:247],a[148:151],v[200:203],v[232:247]
 v_mfma_f32_32x32x16_bf16 v[232:247],a[156:159],v[204:207],v[232:247]
 ds_write_b128 v7,v[120:123] offset:0
 v_mfma_f32_32x32x16_bf16 v[232:247],a[164:167],v[208:211],v[232:247]
 ds_write_b128 v8,v[124:127] offset:1024
 v_mfma_f32_32x32x16_bf16 v[232:247],a[172:175],v[212:215],v[232:247]
 ds_write_b128 v9,v[128:131] offset:2048
 ds_write_b128 v10,v[132:135] offset:3072
 s_nop 9
 ds_write_b128 v7,v[232:235] offset:4096
 ds_write_b128 v8,v[236:239] offset:5120
 ds_write_b128 v9,v[240:243] offset:6144
 ds_write_b128 v10,v[244:247] offset:7168
 s_waitcnt lgkmcnt(0)
 s_barrier
 ds_read_b128 v[56:59],v11 offset:0
 ds_read_b128 v[60:63],v11 offset:512
 ds_read_b128 v[64:67],v11 offset:8192
 ds_read_b128 v[68:71],v11 offset:8704
 ds_read_b128 v[72:75],v11 offset:16384
 ds_read_b128 v[76:79],v11 offset:16896
 ds_read_b128 v[80:83],v11 offset:24576
 ds_read_b128 v[84:87],v11 offset:25088
 s_waitcnt lgkmcnt(5)
 v_pk_add_f32 v[56:57],v[56:57],v[64:65]
 v_pk_add_f32 v[58:59],v[58:59],v[66:67]
 s_waitcnt lgkmcnt(4)
 v_pk_add_f32 v[60:61],v[60:61],v[68:69]
 v_pk_add_f32 v[62:63],v[62:63],v[70:71]
 s_waitcnt lgkmcnt(1)
 v_pk_add_f32 v[72:73],v[72:73],v[80:81]
 v_pk_add_f32 v[74:75],v[74:75],v[82:83]
 s_waitcnt lgkmcnt(0)
 v_pk_add_f32 v[76:77],v[76:77],v[84:85]
 v_pk_add_f32 v[78:79],v[78:79],v[86:87]
 v_pk_add_f32 v[56:57],v[56:57],v[72:73]
 v_pk_add_f32 v[58:59],v[58:59],v[74:75]
 v_pk_add_f32 v[60:61],v[60:61],v[76:77]
 v_pk_add_f32 v[62:63],v[62:63],v[78:79]
 v_pk_fma_f32 v[56:57],v[56:57],v[28:29],v[104:105] op_sel_hi:[1,0,1]
 v_pk_fma_f32 v[58:59],v[58:59],v[28:29],v[106:107] op_sel_hi:[1,0,1]
 v_pk_fma_f32 v[60:61],v[60:61],v[28:29],v[108:109] op_sel_hi:[1,0,1]
 v_pk_fma_f32 v[62:63],v[62:63],v[28:29],v[110:111] op_sel_hi:[1,0,1]
 v_cvt_pk_bf16_f32 v64,v56,v57
 v_cvt_pk_bf16_f32 v65,v58,v59
 v_cvt_pk_bf16_f32 v66,v60,v61
 v_cvt_pk_bf16_f32 v67,v62,v63
 s_add_u32 s52,s80,32768
 buffer_store_dwordx4 v[64:67],v12,s[28:31],s52 offen sc1
 s_or_b32 s52,s2,s4
 s_cmp_lg_u32 s52,0
 s_cbranch_scc1 Le_686
 s_mov_b64 exec,1
 v_mov_b32 v24,s7
 buffer_store_dword v24,off,s[32:35],0 sc1
 s_mov_b64 exec,-1
Le_686:
 s_endpgm
Lfix_371:
 v_and_b32 v255,31,v0
 v_lshlrev_b32 v255,2,v255
 s_mul_i32 s84,s6,384
 s_add_u32 s84,s84,1441792
 buffer_load_dword v22,v255,s[32:35],s84 offen sc1
 buffer_load_dword v23,v255,s[32:35],s84 offen offset:256 sc1
 buffer_load_dword v34,v255,s[32:35],s84 offen offset:128 sc1
 s_waitcnt vmcnt(0)
 v_max_u32 v35,v22,v23
 v_max3_u32 v35,v34,v34,v35
 v_cmp_eq_u32 s[82:83],-1,v35
 s_nop 0
 s_cmp_eq_u64 s[82:83],0
 s_cbranch_scc1 Lok_373
 s_sub_u32 s55,s55,1
 s_cbranch_scc0 Lfix_371
 s_mov_b32 s55,0
Lok_373:
 s_branch Lret_372
Lfix_374:
 buffer_load_dwordx4 v[136:139],v2,s[32:35],s36 offen sc1
 buffer_load_dwordx4 v[140:143],v2,s[32:35],s36 offen offset:1024 sc1
 buffer_load_dwordx4 v[152:155],v2,s[32:35],s37 offen sc1
 buffer_load_dwordx4 v[156:159],v2,s[32:35],s37 offen offset:1024 sc1
 buffer_load_dwordx4 v[168:171],v2,s[32:35],s38 offen sc1
 buffer_load_dwordx4 v[172:175],v2,s[32:35],s38 offen offset:1024 sc1
 buffer_load_dwordx4 v[184:187],v2,s[32:35],s39 offen sc1
 s_add_u32 s84,s97,32768
 buffer_store_dword v38,off,s[32:35],s84
 buffer_load_dwordx4 v[188:191],v2,s[32:35],s39 offen offset:1024 sc1
 buffer_load_dwordx4 v[200:203],v2,s[32:35],s40 offen sc1
 buffer_load_dwordx4 v[204:207],v2,s[32:35],s40 offen offset:1024 sc1
 buffer_load_dwordx4 v[216:219],v2,s[32:35],s41 offen sc1
 s_waitcnt vmcnt(10)
 v_bitop3_b32 v38,v136,v140,1 bitop3:0x80
 v_cmp_eq_u32 vcc,0,v38
 s_cbranch_vccz Lok_376
 s_sub_u32 s55,s55,1
 s_cbranch_scc0 Lfix_374
 s_mov_b32 s55,0
Lok_376:
 s_branch Lret_375
Lfix_377:
 buffer_load_dwordx4 v[152:155],v2,s[32:35],s37 offen sc1
 buffer_load_dwordx4 v[156:159],v2,s[32:35],s37 offen offset:1024 sc1
 buffer_load_dwordx4 v[168:171],v2,s[32:35],s38 offen sc1
 buffer_load_dwordx4 v[172:175],v2,s[32:35],s38 offen offset:1024 sc1
 buffer_load_dwordx4 v[184:187],v2,s[32:35],s39 offen sc1
 s_add_u32 s84,s97,32768
 buffer_store_dword v38,off,s[32:35],s84
 buffer_load_dwordx4 v[188:191],v2,s[32:35],s39 offen offset:1024 sc1
 buffer_load_dwordx4 v[200:203],v2,s[32:35],s40 offen sc1
 buffer_load_dwordx4 v[204:207],v2,s[32:35],s40 offen offset:1024 sc1
 buffer_load_dwordx4 v[216:219],v2,s[32:35],s41 offen sc1
 buffer_load_dwordx4 v[220:223],v2,s[32:35],s41 offen offset:1024 sc1
 buffer_load_dwordx4 v[232:235],v2,s[32:35],s42 offen sc1
 s_waitcnt vmcnt(10)
 v_bitop3_b32 v38,v152,v156,1 bitop3:0x80
 v_cmp_eq_u32 vcc,0,v38
 s_cbranch_vccz Lok_379
 s_sub_u32 s55,s55,1
 s_cbranch_scc0 Lfix_377
 s_mov_b32 s55,0
Lok_379:
 s_branch Lret_378
Lfix_380:
 buffer_load_dwordx4 v[168:171],v2,s[32:35],s38 offen sc1
 buffer_load_dwordx4 v[172:175],v2,s[32:35],s38 offen offset:1024 sc1
 buffer_load_dwordx4 v[184:187],v2,s[32:35],s39 offen sc1
 s_add_u32 s84,s97,32768
 buffer_store_dword v38,off,s[32:35],s84
 buffer_load_dwordx4 v[188:191],v2,s[32:35],s39 offen offset:1024 sc1
 buffer_load_dwordx4 v[200:203],v2,s[32:35],s40 offen sc1
 buffer_load_dwordx4 v[204:207],v2,s[32:35],s40 offen offset:1024 sc1
 buffer_load_dwordx4 v[216:219],v2,s[32:35],s41 offen sc1
 buffer_load_dwordx4 v[220:223],v2,s[32:35],s41 offen offset:1024 sc1
 buffer_load_dwordx4 v[232:235],v2,s[32:35],s42 offen sc1
 buffer_load_dwordx4 v[236:239],v2,s[32:35],s42 offen offset:1024 sc1
 buffer_load_dwordx4 v[248:251],v2,s[32:35],s43 offen sc1
 s_waitcnt vmcnt(10)
 v_bitop3_b32 v38,v168,v172,1 bitop3:0x80
 v_cmp_eq_u32 vcc,0,v38
 s_cbranch_vccz Lok_382
 s_sub_u32 s55,s55,1
 s_cbranch_scc0 Lfix_380
 s_mov_b32 s55,0
Lok_382:
 s_branch Lret_381
Lfix_383:
 buffer_load_dwordx4 v[184:187],v2,s[32:35],s39 offen sc1
 buffer_load_dwordx4 v[188:191],v2,s[32:35],s39 offen offset:1024 sc1
 buffer_load_dwordx4 v[200:203],v2,s[32:35],s40 offen sc1
 buffer_load_dwordx4 v[204:207],v2,s[32:35],s40 offen offset:1024 sc1
 buffer_load_dwordx4 v[216:219],v2,s[32:35],s41 offen sc1
 buffer_load_dwordx4 v[220:223],v2,s[32:35],s41 offen offset:1024 sc1
 buffer_load_dwordx4 v[232:235],v2,s[32:35],s42 offen sc1
 buffer_load_dwordx4 v[236:239],v2,s[32:35],s42 offen offset:1024 sc1
 buffer_load_dwordx4 v[248:251],v2,s[32:35],s43 offen sc1
 buffer_load_dwordx4 v[252:255],v2,s[32:35],s43 offen offset:1024 sc1
 buffer_load_dwordx4 v[144:147],v2,s[32:35],s8 offen sc1
 s_waitcnt vmcnt(9)
 v_bitop3_b32 v38,v184,v188,1 bitop3:0x80
 v_cmp_eq_u32 vcc,0,v38
 s_cbranch_vccz Lok_385
 s_sub_u32 s55,s55,1
 s_cbranch_scc0 Lfix_383
 s_mov_b32 s55,0
Lok_385:
 s_branch Lret_384
Lfix_386:
 buffer_load_dwordx4 v[200:203],v2,s[32:35],s40 offen sc1
 buffer_load_dwordx4 v[204:207],v2,s[32:35],s40 offen offset:1024 sc1
 buffer_load_dwordx4 v[216:219],v2,s[32:35],s41 offen sc1
 buffer_load_dwordx4 v[220:223],v2,s[32:35],s41 offen offset:1024 sc1
 buffer_load_dwordx4 v[232:235],v2,s[32:35],s42 offen sc1
 buffer_load_dwordx4 v[236:239],v2,s[32:35],s42 offen offset:1024 sc1
 buffer_load_dwordx4 v[248:251],v2,s[32:35],s43 offen sc1
 buffer_load_dwordx4 v[252:255],v2,s[32:35],s43 offen offset:1024 sc1
 buffer_load_dwordx4 v[144:147],v2,s[32:35],s8 offen sc1
 buffer_load_dwordx4 v[148:151],v2,s[32:35],s8 offen offset:1024 sc1
 buffer_load_dwordx4 v[160:163],v2,s[32:35],s9 offen sc1
 s_waitcnt vmcnt(9)
 v_bitop3_b32 v38,v200,v204,1 bitop3:0x80
 v_cmp_eq_u32 vcc,0,v38
 s_cbranch_vccz Lok_388
 s_sub_u32 s55,s55,1
 s_cbranch_scc0 Lfix_386
 s_mov_b32 s55,0
Lok_388:
 s_branch Lret_387
Lfix_389:
 buffer_load_dwordx4 v[216:219],v2,s[32:35],s41 offen sc1
 buffer_load_dwordx4 v[220:223],v2,s[32:35],s41 offen offset:1024 sc1
 buffer_load_dwordx4 v[232:235],v2,s[32:35],s42 offen sc1
 buffer_load_dwordx4 v[236:239],v2,s[32:35],s42 offen offset:1024 sc1
 buffer_load_dwordx4 v[248:251],v2,s[32:35],s43 offen sc1
 buffer_load_dwordx4 v[252:255],v2,s[32:35],s43 offen offset:1024 sc1
 buffer_load_dwordx4 v[144:147],v2,s[32:35],s8 offen sc1
 buffer_load_dwordx4 v[148:151],v2,s[32:35],s8 offen offset:1024 sc1
 buffer_load_dwordx4 v[160:163],v2,s[32:35],s9 offen sc1
 buffer_load_dwordx4 v[164:167],v2,s[32:35],s9 offen offset:1024 sc1
 s_add_u32 s84,s97,32768
 buffer_store_dword v38,off,s[32:35],s84
 s_add_u32 s84,s97,32768
 buffer_store_dword v38,off,s[32:35],s84
 buffer_load_dwordx4 v[176:179],v2,s[32:35],s10 offen sc1
 s_waitcnt vmcnt(11)
 v_bitop3_b32 v38,v216,v220,1 bitop3:0x80
 v_cmp_eq_u32 vcc,0,v38
 s_cbranch_vccz Lok_391
 s_sub_u32 s55,s55,1
 s_cbranch_scc0 Lfix_389
 s_mov_b32 s55,0
Lok_391:
 s_branch Lret_390
Lfix_392:
 buffer_load_dwordx4 v[232:235],v2,s[32:35],s42 offen sc1
 buffer_load_dwordx4 v[236:239],v2,s[32:35],s42 offen offset:1024 sc1
 buffer_load_dwordx4 v[248:251],v2,s[32:35],s43 offen sc1
 buffer_load_dwordx4 v[252:255],v2,s[32:35],s43 offen offset:1024 sc1
 buffer_load_dwordx4 v[144:147],v2,s[32:35],s8 offen sc1
 buffer_load_dwordx4 v[148:151],v2,s[32:35],s8 offen offset:1024 sc1
 buffer_load_dwordx4 v[160:163],v2,s[32:35],s9 offen sc1
 buffer_load_dwordx4 v[164:167],v2,s[32:35],s9 offen offset:1024 sc1
 s_add_u32 s84,s97,32768
 buffer_store_dword v38,off,s[32:35],s84
 s_add_u32 s84,s97,32768
 buffer_store_dword v38,off,s[32:35],s84
 buffer_load_dwordx4 v[176:179],v2,s[32:35],s10 offen sc1
 buffer_load_dwordx4 v[180:183],v2,s[32:35],s10 offen offset:1024 sc1
 buffer_load_dwordx4 v[192:195],v2,s[32:35],s11 offen sc1
 s_waitcnt vmcnt(11)
 v_bitop3_b32 v38,v232,v236,1 bitop3:0x80
 v_cmp_eq_u32 vcc,0,v38
 s_cbranch_vccz Lok_394
 s_sub_u32 s55,s55,1
 s_cbranch_scc0 Lfix_392
 s_mov_b32 s55,0
Lok_394:
 s_branch Lret_393
Lfix_395:
 buffer_load_dwordx4 v[248:251],v2,s[32:35],s43 offen sc1
 buffer_load_dwordx4 v[252:255],v2,s[32:35],s43 offen offset:1024 sc1
 buffer_load_dwordx4 v[144:147],v2,s[32:35],s8 offen sc1
 buffer_load_dwordx4 v[148:151],v2,s[32:35],s8 offen offset:1024 sc1
 buffer_load_dwordx4 v[160:163],v2,s[32:35],s9 offen sc1
 buffer_load_dwordx4 v[164:167],v2,s[32:35],s9 offen offset:1024 sc1
 s_add_u32 s84,s97,32768
 buffer_store_dword v38,off,s[32:35],s84
 s_add_u32 s84,s97,32768
 buffer_store_dword v38,off,s[32:35],s84
 buffer_load_dwordx4 v[176:179],v2,s[32:35],s10 offen sc1
 buffer_load_dwordx4 v[180:183],v2,s[32:35],s10 offen offset:1024 sc1
 buffer_load_dwordx4 v[192:195],v2,s[32:35],s11 offen sc1
 buffer_load_dwordx4 v[196:199],v2,s[32:35],s11 offen offset:1024 sc1
 buffer_load_dwordx4 v[208:211],v2,s[32:35],s57 offen sc1
 s_waitcnt vmcnt(11)
 v_bitop3_b32 v38,v248,v252,1 bitop3:0x80
 v_cmp_eq_u32 vcc,0,v38
 s_cbranch_vccz Lok_397
 s_sub_u32 s55,s55,1
 s_cbranch_scc0 Lfix_395
 s_mov_b32 s55,0
Lok_397:
 s_branch Lret_396
Lfix_398:
 buffer_load_dwordx4 v[144:147],v2,s[32:35],s8 offen sc1
 buffer_load_dwordx4 v[148:151],v2,s[32:35],s8 offen offset:1024 sc1
 buffer_load_dwordx4 v[160:163],v2,s[32:35],s9 offen sc1
 buffer_load_dwordx4 v[164:167],v2,s[32:35],s9 offen offset:1024 sc1
 s_add_u32 s84,s97,32768
 buffer_store_dword v38,off,s[32:35],s84
 s_add_u32 s84,s97,32768
 buffer_store_dword v38,off,s[32:35],s84
 buffer_load_dwordx4 v[176:179],v2,s[32:35],s10 offen sc1
 buffer_load_dwordx4 v[180:183],v2,s[32:35],s10 offen offset:1024 sc1
 buffer_load_dwordx4 v[192:195],v2,s[32:35],s11 offen sc1
 buffer_load_dwordx4 v[196:199],v2,s[32:35],s11 offen offset:1024 sc1
 buffer_load_dwordx4 v[208:211],v2,s[32:35],s57 offen sc1
 buffer_load_dwordx4 v[212:215],v2,s[32:35],s57 offen offset:1024 sc1
 buffer_load_dwordx4 v[224:227],v2,s[32:35],s77 offen sc1
 s_waitcnt vmcnt(11)
 v_bitop3_b32 v38,v144,v148,1 bitop3:0x80
 v_cmp_eq_u32 vcc,0,v38
 s_cbranch_vccz Lok_400
 s_sub_u32 s55,s55,1
 s_cbranch_scc0 Lfix_398
 s_mov_b32 s55,0
Lok_400:
 s_branch Lret_399
Lfix_401:
 buffer_load_dwordx4 v[160:163],v2,s[32:35],s9 offen sc1
 buffer_load_dwordx4 v[164:167],v2,s[32:35],s9 offen offset:1024 sc1
 s_add_u32 s84,s97,32768
 buffer_store_dword v38,off,s[32:35],s84
 s_add_u32 s84,s97,32768
 buffer_store_dword v38,off,s[32:35],s84
 buffer_load_dwordx4 v[176:179],v2,s[32:35],s10 offen sc1
 buffer_load_dwordx4 v[180:183],v2,s[32:35],s10 offen offset:1024 sc1
 buffer_load_dwordx4 v[192:195],v2,s[32:35],s11 offen sc1
 buffer_load_dwordx4 v[196:199],v2,s[32:35],s11 offen offset:1024 sc1
 buffer_load_dwordx4 v[208:211],v2,s[32:35],s57 offen sc1
 buffer_load_dwordx4 v[212:215],v2,s[32:35],s57 offen offset:1024 sc1
 buffer_load_dwordx4 v[224:227],v2,s[32:35],s77 offen sc1
 buffer_load_dwordx4 v[228:231],v2,s[32:35],s77 offen offset:1024 sc1
 s_add_u32 s84,s97,32768
 buffer_store_dword v38,off,s[32:35],s84
 buffer_load_dwordx4 v[240:243],v2,s[32:35],s81 offen sc1
 s_add_u32 s84,s97,32768
 buffer_store_dword v38,off,s[32:35],s84
 s_waitcnt vmcnt(13)
 v_bitop3_b32 v38,v160,v164,1 bitop3:0x80
 v_cmp_eq_u32 vcc,0,v38
 s_cbranch_vccz Lok_403
 s_sub_u32 s55,s55,1
 s_cbranch_scc0 Lfix_401
 s_mov_b32 s55,0
Lok_403:
 s_branch Lret_402
Lfix_407:
 s_add_u32 s84,s58,0
 buffer_load_dwordx4 v[72:75],v13,s[32:35],s84 offen sc1
 buffer_load_dwordx4 v[76:79],v13,s[32:35],s84 offen offset:512 sc1
 s_waitcnt vmcnt(0)
 v_and_b32 v38,v72,v73
 v_bitop3_b32 v38,v74,v75,v38 bitop3:0x80
 v_bitop3_b32 v38,v76,v77,v38 bitop3:0x80
 v_bitop3_b32 v38,v78,v79,v38 bitop3:0x80
 v_and_b32 v38,1,v38
 v_cmp_eq_u32 s[82:83],0,v38
 s_nop 0
 s_cmp_eq_u64 s[82:83],0
 s_cbranch_scc1 Lok_409
 s_sub_u32 s55,s55,1
 s_cbranch_scc0 Lfix_407
 s_mov_b32 s55,0
Lok_409:
 s_branch Lret_408
Lfix_404:
 buffer_load_dwordx4 v[176:179],v2,s[32:35],s10 offen sc1
 buffer_load_dwordx4 v[180:183],v2,s[32:35],s10 offen offset:1024 sc1
 buffer_load_dwordx4 v[192:195],v2,s[32:35],s11 offen sc1
 buffer_load_dwordx4 v[196:199],v2,s[32:35],s11 offen offset:1024 sc1
 buffer_load_dwordx4 v[208:211],v2,s[32:35],s57 offen sc1
 buffer_load_dwordx4 v[212:215],v2,s[32:35],s57 offen offset:1024 sc1
 buffer_load_dwordx4 v[224:227],v2,s[32:35],s77 offen sc1
 buffer_load_dwordx4 v[228:231],v2,s[32:35],s77 offen offset:1024 sc1
 s_add_u32 s84,s97,32768
 buffer_store_dword v38,off,s[32:35],s84
 buffer_load_dwordx4 v[240:243],v2,s[32:35],s81 offen sc1
 s_add_u32 s84,s97,32768
 buffer_store_dword v38,off,s[32:35],s84
 buffer_load_dwordx4 v[244:247],v2,s[32:35],s81 offen offset:1024 sc1
 s_add_u32 s84,s97,32768
 buffer_store_dword v38,off,s[32:35],s84
 buffer_load_dwordx4 a[248:251],v2,s[32:35],s99 offen sc1
 s_add_u32 s84,s97,32768
 buffer_store_dword v38,off,s[32:35],s84
 s_waitcnt vmcnt(13)
 v_bitop3_b32 v38,v176,v180,1 bitop3:0x80
 v_cmp_eq_u32 vcc,0,v38
 s_cbranch_vccz Lok_406
 s_sub_u32 s55,s55,1
 s_cbranch_scc0 Lfix_404
 s_mov_b32 s55,0
Lok_406:
 s_branch Lret_405
Lfix_410:
 buffer_load_dwordx4 v[192:195],v2,s[32:35],s11 offen sc1
 buffer_load_dwordx4 v[196:199],v2,s[32:35],s11 offen offset:1024 sc1
 buffer_load_dwordx4 v[208:211],v2,s[32:35],s57 offen sc1
 buffer_load_dwordx4 v[212:215],v2,s[32:35],s57 offen offset:1024 sc1
 buffer_load_dwordx4 v[224:227],v2,s[32:35],s77 offen sc1
 buffer_load_dwordx4 v[228:231],v2,s[32:35],s77 offen offset:1024 sc1
 s_add_u32 s84,s97,32768
 buffer_store_dword v38,off,s[32:35],s84
 buffer_load_dwordx4 v[240:243],v2,s[32:35],s81 offen sc1
 s_add_u32 s84,s97,32768
 buffer_store_dword v38,off,s[32:35],s84
 buffer_load_dwordx4 v[244:247],v2,s[32:35],s81 offen offset:1024 sc1
 s_add_u32 s84,s97,32768
 buffer_store_dword v38,off,s[32:35],s84
 buffer_load_dwordx4 a[248:251],v2,s[32:35],s99 offen sc1
 s_add_u32 s84,s97,32768
 buffer_store_dword v38,off,s[32:35],s84
 buffer_load_dwordx4 a[252:255],v2,s[32:35],s99 offen offset:1024 sc1
 s_add_u32 s84,s97,32768
 buffer_store_dword v38,off,s[32:35],s84
 s_add_u32 s84,s97,32768
 buffer_store_dword v38,off,s[32:35],s84
 s_waitcnt vmcnt(14)
 v_bitop3_b32 v38,v192,v196,1 bitop3:0x80
 v_cmp_eq_u32 vcc,0,v38
 s_cbranch_vccz Lok_412
 s_sub_u32 s55,s55,1
 s_cbranch_scc0 Lfix_410
 s_mov_b32 s55,0
Lok_412:
 s_branch Lret_411
Lfix_413:
 buffer_load_dwordx4 v[208:211],v2,s[32:35],s57 offen sc1
 buffer_load_dwordx4 v[212:215],v2,s[32:35],s57 offen offset:1024 sc1
 buffer_load_dwordx4 v[224:227],v2,s[32:35],s77 offen sc1
 buffer_load_dwordx4 v[228:231],v2,s[32:35],s77 offen offset:1024 sc1
 s_add_u32 s84,s97,32768
 buffer_store_dword v38,off,s[32:35],s84
 buffer_load_dwordx4 v[240:243],v2,s[32:35],s81 offen sc1
 s_add_u32 s84,s97,32768
 buffer_store_dword v38,off,s[32:35],s84
 buffer_load_dwordx4 v[244:247],v2,s[32:35],s81 offen offset:1024 sc1
 s_add_u32 s84,s97,32768
 buffer_store_dword v38,off,s[32:35],s84
 buffer_load_dwordx4 a[248:251],v2,s[32:35],s99 offen sc1
 s_add_u32 s84,s97,32768
 buffer_store_dword v38,off,s[32:35],s84
 buffer_load_dwordx4 a[252:255],v2,s[32:35],s99 offen offset:1024 sc1
 s_add_u32 s84,s97,32768
 buffer_store_dword v38,off,s[32:35],s84
 s_add_u32 s84,s97,32768
 buffer_store_dword v38,off,s[32:35],s84
 s_add_u32 s84,s97,32768
 buffer_store_dword v38,off,s[32:35],s84
 s_add_u32 s84,s97,32768
 buffer_store_dword v38,off,s[32:35],s84
 s_waitcnt vmcnt(14)
 v_bitop3_b32 v38,v208,v212,1 bitop3:0x80
 v_cmp_eq_u32 vcc,0,v38
 s_cbranch_vccz Lok_415
 s_sub_u32 s55,s55,1
 s_cbranch_scc0 Lfix_413
 s_mov_b32 s55,0
Lok_415:
 s_branch Lret_414
Lfix_416:
 buffer_load_dwordx4 v[224:227],v2,s[32:35],s77 offen sc1
 buffer_load_dwordx4 v[228:231],v2,s[32:35],s77 offen offset:1024 sc1
 s_add_u32 s84,s97,32768
 buffer_store_dword v38,off,s[32:35],s84
 buffer_load_dwordx4 v[240:243],v2,s[32:35],s81 offen sc1
 s_add_u32 s84,s97,32768
 buffer_store_dword v38,off,s[32:35],s84
 buffer_load_dwordx4 v[244:247],v2,s[32:35],s81 offen offset:1024 sc1
 s_add_u32 s84,s97,32768
 buffer_store_dword v38,off,s[32:35],s84
 buffer_load_dwordx4 a[248:251],v2,s[32:35],s99 offen sc1
 s_add_u32 s84,s97,32768
 buffer_store_dword v38,off,s[32:35],s84
 buffer_load_dwordx4 a[252:255],v2,s[32:35],s99 offen offset:1024 sc1
 s_add_u32 s84,s97,32768
 buffer_store_dword v38,off,s[32:35],s84
 s_add_u32 s84,s97,32768
 buffer_store_dword v38,off,s[32:35],s84
 s_add_u32 s84,s97,32768
 buffer_store_dword v38,off,s[32:35],s84
 s_add_u32 s84,s97,32768
 buffer_store_dword v38,off,s[32:35],s84
 s_waitcnt vmcnt(12)
 v_bitop3_b32 v38,v224,v228,1 bitop3:0x80
 v_cmp_eq_u32 vcc,0,v38
 s_cbranch_vccz Lok_418
 s_sub_u32 s55,s55,1
 s_cbranch_scc0 Lfix_416
 s_mov_b32 s55,0
Lok_418:
 s_branch Lret_417
Lfix_419:
 buffer_load_dwordx4 v[240:243],v2,s[32:35],s81 offen sc1
 buffer_load_dwordx4 v[244:247],v2,s[32:35],s81 offen offset:1024 sc1
 s_add_u32 s84,s97,32768
 buffer_store_dword v38,off,s[32:35],s84
 buffer_load_dwordx4 a[248:251],v2,s[32:35],s99 offen sc1
 s_add_u32 s84,s97,32768
 buffer_store_dword v38,off,s[32:35],s84
 buffer_load_dwordx4 a[252:255],v2,s[32:35],s99 offen offset:1024 sc1
 s_add_u32 s84,s97,32768
 buffer_store_dword v38,off,s[32:35],s84
 s_add_u32 s84,s97,32768
 buffer_store_dword v38,off,s[32:35],s84
 s_add_u32 s84,s97,32768
 buffer_store_dword v38,off,s[32:35],s84
 s_add_u32 s84,s97,32768
 buffer_store_dword v38,off,s[32:35],s84
 s_add_u32 s84,s97,32768
 buffer_store_dword v38,off,s[32:35],s84
 s_add_u32 s84,s97,32768
 buffer_store_dword v38,off,s[32:35],s84
 s_add_u32 s84,s97,32768
 buffer_store_dword v38,off,s[32:35],s84
 s_add_u32 s84,s97,32768
 buffer_store_dword v38,off,s[32:35],s84
 s_add_u32 s84,s97,32768
 buffer_store_dword v38,off,s[32:35],s84
 s_add_u32 s84,s97,32768
 buffer_store_dword v38,off,s[32:35],s84
 s_add_u32 s84,s97,32768
 buffer_store_dword v38,off,s[32:35],s84
 s_add_u32 s84,s97,32768
 buffer_store_dword v38,off,s[32:35],s84
 s_waitcnt vmcnt(16)
 v_bitop3_b32 v38,v240,v244,1 bitop3:0x80
 v_cmp_eq_u32 vcc,0,v38
 s_cbranch_vccz Lok_421
 s_sub_u32 s55,s55,1
 s_cbranch_scc0 Lfix_419
 s_mov_b32 s55,0
Lok_421:
 s_branch Lret_420
Lfix_422:
 buffer_load_dwordx4 a[248:251],v2,s[32:35],s99 offen sc1
 buffer_load_dwordx4 a[252:255],v2,s[32:35],s99 offen offset:1024 sc1
 s_add_u32 s84,s97,32768
 buffer_store_dword v38,off,s[32:35],s84
 s_add_u32 s84,s97,32768
 buffer_store_dword v38,off,s[32:35],s84
 s_add_u32 s84,s97,32768
 buffer_store_dword v38,off,s[32:35],s84
 s_add_u32 s84,s97,32768
 buffer_store_dword v38,off,s[32:35],s84
 s_add_u32 s84,s97,32768
 buffer_store_dword v38,off,s[32:35],s84
 s_add_u32 s84,s97,32768
 buffer_store_dword v38,off,s[32:35],s84
 s_add_u32 s84,s97,32768
 buffer_store_dword v38,off,s[32:35],s84
 s_add_u32 s84,s97,32768
 buffer_store_dword v38,off,s[32:35],s84
 s_add_u32 s84,s97,32768
 buffer_store_dword v38,off,s[32:35],s84
 s_add_u32 s84,s97,32768
 buffer_store_dword v38,off,s[32:35],s84
 s_add_u32 s84,s97,32768
 buffer_store_dword v38,off,s[32:35],s84
 s_add_u32 s84,s97,32768
 buffer_store_dword v38,off,s[32:35],s84
 s_waitcnt vmcnt(12)
 v_accvgpr_read_b32 v38,a248
 v_lshlrev_b32 v38,31,v38
 v_cmp_eq_u32 s[82:83],0,v38
 v_accvgpr_read_b32 v38,a252
 v_lshlrev_b32 v38,31,v38
 v_cmp_eq_u32 vcc,0,v38
 s_nop 1
 s_or_b64 vcc,vcc,s[82:83]
 s_cbranch_vccz Lok_424
 s_sub_u32 s55,s55,1
 s_cbranch_scc0 Lfix_422
 s_mov_b32 s55,0
Lok_424:
 s_branch Lret_423
Lfix_427:
 s_bfe_u32 s84,s44,0x50000
 s_lshl_b32 s84,s84,12
 buffer_load_dwordx4 v[136:139],v32,s[32:35],s84 offen sc1
 s_bfe_u32 s84,s44,0x50000
 s_lshl_b32 s84,s84,12
 buffer_load_dwordx4 v[140:143],v33,s[32:35],s84 offen sc1
 s_bfe_u32 s84,s44,0x50005
 s_lshl_b32 s84,s84,12
 buffer_load_dwordx4 v[144:147],v32,s[32:35],s84 offen sc1
 s_bfe_u32 s84,s44,0x50005
 s_lshl_b32 s84,s84,12
 buffer_load_dwordx4 v[148:151],v33,s[32:35],s84 offen sc1
 s_bfe_u32 s84,s44,0x5000a
 s_lshl_b32 s84,s84,12
 buffer_load_dwordx4 v[152:155],v32,s[32:35],s84 offen sc1
 s_bfe_u32 s84,s44,0x5000a
 s_lshl_b32 s84,s84,12
 buffer_load_dwordx4 v[156:159],v33,s[32:35],s84 offen sc1
 s_bfe_u32 s84,s44,0x5000f
 s_lshl_b32 s84,s84,12
 buffer_load_dwordx4 v[160:163],v32,s[32:35],s84 offen sc1
 s_bfe_u32 s84,s44,0x5000f
 s_lshl_b32 s84,s84,12
 buffer_load_dwordx4 v[164:167],v33,s[32:35],s84 offen sc1
 s_bfe_u32 s84,s44,0x50014
 s_lshl_b32 s84,s84,12
 buffer_load_dwordx4 v[168:171],v32,s[32:35],s84 offen sc1
 s_bfe_u32 s84,s44,0x50014
 s_lshl_b32 s84,s84,12
 buffer_load_dwordx4 v[172:175],v33,s[32:35],s84 offen sc1
 s_add_u32 s84,s97,32768
 buffer_store_dword v38,off,s[32:35],s84
 s_add_u32 s84,s97,32768
 buffer_store_dword v38,off,s[32:35],s84
 s_add_u32 s84,s97,32768
 buffer_store_dword v38,off,s[32:35],s84
 s_add_u32 s84,s97,32768
 buffer_store_dword v38,off,s[32:35],s84
 s_add_u32 s84,s97,32768
 buffer_store_dword v38,off,s[32:35],s84
 s_add_u32 s84,s97,32768
 buffer_store_dword v38,off,s[32:35],s84
 s_add_u32 s84,s97,32768
 buffer_store_dword v38,off,s[32:35],s84
 s_add_u32 s84,s97,32768
 buffer_store_dword v38,off,s[32:35],s84
 s_add_u32 s84,s97,32768
 buffer_store_dword v38,off,s[32:35],s84
 s_add_u32 s84,s97,32768
 buffer_store_dword v38,off,s[32:35],s84
 s_add_u32 s84,s97,32768
 buffer_store_dword v38,off,s[32:35],s84
 s_add_u32 s84,s97,32768
 buffer_store_dword v38,off,s[32:35],s84
 s_add_u32 s84,s97,32768
 buffer_store_dword v38,off,s[32:35],s84
 s_add_u32 s84,s97,32768
 buffer_store_dword v38,off,s[32:35],s84
 s_waitcnt vmcnt(22)
 v_xor_b32 v136,0x80000000,v136
 v_xor_b32 v140,0x80000000,v140
 v_or_b32 v38,v136,v140
 v_cmp_gt_i32 vcc,0,v38
 s_cbranch_vccz Lok_429
 s_sub_u32 s55,s55,1
 s_cbranch_scc0 Lfix_427
 s_mov_b32 s55,0
Lok_429:
 s_branch Lret_428
Lfix_430:
 s_bfe_u32 s84,s44,0x50005
 s_lshl_b32 s84,s84,12
 buffer_load_dwordx4 v[144:147],v32,s[32:35],s84 offen sc1
 s_bfe_u32 s84,s44,0x50005
 s_lshl_b32 s84,s84,12
 buffer_load_dwordx4 v[148:151],v33,s[32:35],s84 offen sc1
 s_bfe_u32 s84,s44,0x5000a
 s_lshl_b32 s84,s84,12
 buffer_load_dwordx4 v[152:155],v32,s[32:35],s84 offen sc1
 s_bfe_u32 s84,s44,0x5000a
 s_lshl_b32 s84,s84,12
 buffer_load_dwordx4 v[156:159],v33,s[32:35],s84 offen sc1
 s_bfe_u32 s84,s44,0x5000f
 s_lshl_b32 s84,s84,12
 buffer_load_dwordx4 v[160:163],v32,s[32:35],s84 offen sc1
 s_bfe_u32 s84,s44,0x5000f
 s_lshl_b32 s84,s84,12
 buffer_load_dwordx4 v[164:167],v33,s[32:35],s84 offen sc1
 s_bfe_u32 s84,s44,0x50014
 s_lshl_b32 s84,s84,12
 buffer_load_dwordx4 v[168:171],v32,s[32:35],s84 offen sc1
 s_bfe_u32 s84,s44,0x50014
 s_lshl_b32 s84,s84,12
 buffer_load_dwordx4 v[172:175],v33,s[32:35],s84 offen sc1
 s_add_u32 s84,s97,32768
 buffer_store_dword v38,off,s[32:35],s84
 s_add_u32 s84,s97,32768
 buffer_store_dword v38,off,s[32:35],s84
 s_add_u32 s84,s97,32768
 buffer_store_dword v38,off,s[32:35],s84
 s_add_u32 s84,s97,32768
 buffer_store_dword v38,off,s[32:35],s84
 s_add_u32 s84,s97,32768
 buffer_store_dword v38,off,s[32:35],s84
 s_add_u32 s84,s97,32768
 buffer_store_dword v38,off,s[32:35],s84
 s_add_u32 s84,s97,32768
 buffer_store_dword v38,off,s[32:35],s84
 s_add_u32 s84,s97,32768
 buffer_store_dword v38,off,s[32:35],s84
 s_add_u32 s84,s97,32768
 buffer_store_dword v38,off,s[32:35],s84
 s_add_u32 s84,s97,32768
 buffer_store_dword v38,off,s[32:35],s84
 s_add_u32 s84,s97,32768
 buffer_store_dword v38,off,s[32:35],s84
 s_add_u32 s84,s97,32768
 buffer_store_dword v38,off,s[32:35],s84
 s_add_u32 s84,s97,32768
 buffer_store_dword v38,off,s[32:35],s84
 s_add_u32 s84,s97,32768
 buffer_store_dword v38,off,s[32:35],s84
 s_bfe_u32 s84,s44,0x50019
 s_lshl_b32 s84,s84,12
 buffer_load_dwordx4 v[176:179],v32,s[32:35],s84 offen sc1
 s_bfe_u32 s84,s44,0x50019
 s_lshl_b32 s84,s84,12
 buffer_load_dwordx4 v[180:183],v33,s[32:35],s84 offen sc1
 s_waitcnt vmcnt(22)
 v_xor_b32 v144,0x80000000,v144
 v_xor_b32 v148,0x80000000,v148
 v_or_b32 v38,v144,v148
 v_cmp_gt_i32 vcc,0,v38
 s_cbranch_vccz Lok_432
 s_sub_u32 s55,s55,1
 s_cbranch_scc0 Lfix_430
 s_mov_b32 s55,0
Lok_432:
 s_branch Lret_431
Lfix_433:
 s_bfe_u32 s84,s44,0x5000a
 s_lshl_b32 s84,s84,12
 buffer_load_dwordx4 v[152:155],v32,s[32:35],s84 offen sc1
 s_bfe_u32 s84,s44,0x5000a
 s_lshl_b32 s84,s84,12
 buffer_load_dwordx4 v[156:159],v33,s[32:35],s84 offen sc1
 s_bfe_u32 s84,s44,0x5000f
 s_lshl_b32 s84,s84,12
 buffer_load_dwordx4 v[160:163],v32,s[32:35],s84 offen sc1
 s_bfe_u32 s84,s44,0x5000f
 s_lshl_b32 s84,s84,12
 buffer_load_dwordx4 v[164:167],v33,s[32:35],s84 offen sc1
 s_bfe_u32 s84,s44,0x50014
 s_lshl_b32 s84,s84,12
 buffer_load_dwordx4 v[168:171],v32,s[32:35],s84 offen sc1
 s_bfe_u32 s84,s44,0x50014
 s_lshl_b32 s84,s84,12
 buffer_load_dwordx4 v[172:175],v33,s[32:35],s84 offen sc1
 s_add_u32 s84,s97,32768
 buffer_store_dword v38,off,s[32:35],s84
 s_add_u32 s84,s97,32768
 buffer_store_dword v38,off,s[32:35],s84
 s_add_u32 s84,s97,32768
 buffer_store_dword v38,off,s[32:35],s84
 s_add_u32 s84,s97,32768
 buffer_store_dword v38,off,s[32:35],s84
 s_add_u32 s84,s97,32768
 buffer_store_dword v38,off,s[32:35],s84
 s_add_u32 s84,s97,32768
 buffer_store_dword v38,off,s[32:35],s84
 s_add_u32 s84,s97,32768
 buffer_store_dword v38,off,s[32:35],s84
 s_add_u32 s84,s97,32768
 buffer_store_dword v38,off,s[32:35],s84
 s_add_u32 s84,s97,32768
 buffer_store_dword v38,off,s[32:35],s84
 s_add_u32 s84,s97,32768
 buffer_store_dword v38,off,s[32:35],s84
 s_add_u32 s84,s97,32768
 buffer_store_dword v38,off,s[32:35],s84
 s_add_u32 s84,s97,32768
 buffer_store_dword v38,off,s[32:35],s84
 s_add_u32 s84,s97,32768
 buffer_store_dword v38,off,s[32:35],s84
 s_add_u32 s84,s97,32768
 buffer_store_dword v38,off,s[32:35],s84
 s_bfe_u32 s84,s44,0x50019
 s_lshl_b32 s84,s84,12
 buffer_load_dwordx4 v[176:179],v32,s[32:35],s84 offen sc1
 s_bfe_u32 s84,s44,0x50019
 s_lshl_b32 s84,s84,12
 buffer_load_dwordx4 v[180:183],v33,s[32:35],s84 offen sc1
 s_bfe_u32 s84,s45,0x50000
 s_lshl_b32 s84,s84,12
 buffer_load_dwordx4 v[184:187],v32,s[32:35],s84 offen sc1
 s_bfe_u32 s84,s45,0x50000
 s_lshl_b32 s84,s84,12
 buffer_load_dwordx4 v[188:191],v33,s[32:35],s84 offen sc1
 s_waitcnt vmcnt(22)
 v_xor_b32 v152,0x80000000,v152
 v_xor_b32 v156,0x80000000,v156
 v_or_b32 v38,v152,v156
 v_cmp_gt_i32 vcc,0,v38
 s_cbranch_vccz Lok_435
 s_sub_u32 s55,s55,1
 s_cbranch_scc0 Lfix_433
 s_mov_b32 s55,0
Lok_435:
 s_branch Lret_434
Lfix_436:
 s_bfe_u32 s84,s44,0x5000f
 s_lshl_b32 s84,s84,12
 buffer_load_dwordx4 v[160:163],v32,s[32:35],s84 offen sc1
 s_bfe_u32 s84,s44,0x5000f
 s_lshl_b32 s84,s84,12
 buffer_load_dwordx4 v[164:167],v33,s[32:35],s84 offen sc1
 s_add_u32 s84,s97,32768
 buffer_store_dword v38,off,s[32:35],s84
 s_add_u32 s84,s97,32768
 buffer_store_dword v38,off,s[32:35],s84
 s_bfe_u32 s84,s44,0x50019
 s_lshl_b32 s84,s84,12
 buffer_load_dwordx4 v[176:179],v32,s[32:35],s84 offen sc1
 s_bfe_u32 s84,s44,0x50019
 s_lshl_b32 s84,s84,12
 buffer_load_dwordx4 v[180:183],v33,s[32:35],s84 offen sc1
 s_bfe_u32 s84,s45,0x50000
 s_lshl_b32 s84,s84,12
 buffer_load_dwordx4 v[184:187],v32,s[32:35],s84 offen sc1
 s_bfe_u32 s84,s45,0x50000
 s_lshl_b32 s84,s84,12
 buffer_load_dwordx4 v[188:191],v33,s[32:35],s84 offen sc1
 s_bfe_u32 s84,s45,0x50005
 s_lshl_b32 s84,s84,12
 buffer_load_dwordx4 v[192:195],v32,s[32:35],s84 offen sc1
 s_bfe_u32 s84,s45,0x50005
 s_lshl_b32 s84,s84,12
 buffer_load_dwordx4 v[196:199],v33,s[32:35],s84 offen sc1
 s_waitcnt vmcnt(8)
 v_xor_b32 v160,0x80000000,v160
 v_xor_b32 v164,0x80000000,v164
 v_or_b32 v38,v160,v164
 v_cmp_gt_i32 vcc,0,v38
 s_cbranch_vccz Lok_438
 s_sub_u32 s55,s55,1
 s_cbranch_scc0 Lfix_436
 s_mov_b32 s55,0
Lok_438:
 s_branch Lret_437
Lfix_439:
 s_bfe_u32 s84,s44,0x50014
 s_lshl_b32 s84,s84,12
 buffer_load_dwordx4 v[168:171],v32,s[32:35],s84 offen sc1
 s_bfe_u32 s84,s44,0x50014
 s_lshl_b32 s84,s84,12
 buffer_load_dwordx4 v[172:175],v33,s[32:35],s84 offen sc1
 s_add_u32 s84,s97,32768
 buffer_store_dword v38,off,s[32:35],s84
 s_add_u32 s84,s97,32768
 buffer_store_dword v38,off,s[32:35],s84
 s_bfe_u32 s84,s44,0x50019
 s_lshl_b32 s84,s84,12
 buffer_load_dwordx4 v[176:179],v32,s[32:35],s84 offen sc1
 s_bfe_u32 s84,s44,0x50019
 s_lshl_b32 s84,s84,12
 buffer_load_dwordx4 v[180:183],v33,s[32:35],s84 offen sc1
 s_bfe_u32 s84,s45,0x50000
 s_lshl_b32 s84,s84,12
 buffer_load_dwordx4 v[184:187],v32,s[32:35],s84 offen sc1
 s_bfe_u32 s84,s45,0x50000
 s_lshl_b32 s84,s84,12
 buffer_load_dwordx4 v[188:191],v33,s[32:35],s84 offen sc1
 s_bfe_u32 s84,s45,0x50005
 s_lshl_b32 s84,s84,12
 buffer_load_dwordx4 v[192:195],v32,s[32:35],s84 offen sc1
 s_bfe_u32 s84,s45,0x50005
 s_lshl_b32 s84,s84,12
 buffer_load_dwordx4 v[196:199],v33,s[32:35],s84 offen sc1
 s_bfe_u32 s84,s45,0x5000a
 s_lshl_b32 s84,s84,12
 buffer_load_dwordx4 v[200:203],v32,s[32:35],s84 offen sc1
 s_bfe_u32 s84,s45,0x5000a
 s_lshl_b32 s84,s84,12
 buffer_load_dwordx4 v[204:207],v33,s[32:35],s84 offen sc1
 s_waitcnt vmcnt(10)
 v_xor_b32 v168,0x80000000,v168
 v_xor_b32 v172,0x80000000,v172
 v_or_b32 v38,v168,v172
 v_cmp_gt_i32 vcc,0,v38
 s_cbranch_vccz Lok_441
 s_sub_u32 s55,s55,1
 s_cbranch_scc0 Lfix_439
 s_mov_b32 s55,0
Lok_441:
 s_branch Lret_440
Lfix_442:
 s_bfe_u32 s84,s44,0x50019
 s_lshl_b32 s84,s84,12
 buffer_load_dwordx4 v[176:179],v32,s[32:35],s84 offen sc1
 s_bfe_u32 s84,s44,0x50019
 s_lshl_b32 s84,s84,12
 buffer_load_dwordx4 v[180:183],v33,s[32:35],s84 offen sc1
 s_bfe_u32 s84,s45,0x50000
 s_lshl_b32 s84,s84,12
 buffer_load_dwordx4 v[184:187],v32,s[32:35],s84 offen sc1
 s_bfe_u32 s84,s45,0x50000
 s_lshl_b32 s84,s84,12
 buffer_load_dwordx4 v[188:191],v33,s[32:35],s84 offen sc1
 s_bfe_u32 s84,s45,0x50005
 s_lshl_b32 s84,s84,12
 buffer_load_dwordx4 v[192:195],v32,s[32:35],s84 offen sc1
 s_bfe_u32 s84,s45,0x50005
 s_lshl_b32 s84,s84,12
 buffer_load_dwordx4 v[196:199],v33,s[32:35],s84 offen sc1
 s_bfe_u32 s84,s45,0x5000a
 s_lshl_b32 s84,s84,12
 buffer_load_dwordx4 v[200:203],v32,s[32:35],s84 offen sc1
 s_bfe_u32 s84,s45,0x5000a
 s_lshl_b32 s84,s84,12
 buffer_load_dwordx4 v[204:207],v33,s[32:35],s84 offen sc1
 s_bfe_u32 s84,s45,0x5000f
 s_lshl_b32 s84,s84,12
 buffer_load_dwordx4 v[208:211],v32,s[32:35],s84 offen sc1
 s_bfe_u32 s84,s45,0x5000f
 s_lshl_b32 s84,s84,12
 buffer_load_dwordx4 v[212:215],v33,s[32:35],s84 offen sc1
 s_waitcnt vmcnt(8)
 v_xor_b32 v176,0x80000000,v176
 v_xor_b32 v180,0x80000000,v180
 v_or_b32 v38,v176,v180
 v_cmp_gt_i32 vcc,0,v38
 s_cbranch_vccz Lok_444
 s_sub_u32 s55,s55,1
 s_cbranch_scc0 Lfix_442
 s_mov_b32 s55,0
Lok_444:
 s_branch Lret_443
Lfix_445:
 s_bfe_u32 s84,s45,0x50000
 s_lshl_b32 s84,s84,12
 buffer_load_dwordx4 v[184:187],v32,s[32:35],s84 offen sc1
 s_bfe_u32 s84,s45,0x50000
 s_lshl_b32 s84,s84,12
 buffer_load_dwordx4 v[188:191],v33,s[32:35],s84 offen sc1
 s_bfe_u32 s84,s45,0x50005
 s_lshl_b32 s84,s84,12
 buffer_load_dwordx4 v[192:195],v32,s[32:35],s84 offen sc1
 s_bfe_u32 s84,s45,0x50005
 s_lshl_b32 s84,s84,12
 buffer_load_dwordx4 v[196:199],v33,s[32:35],s84 offen sc1
 s_bfe_u32 s84,s45,0x5000a
 s_lshl_b32 s84,s84,12
 buffer_load_dwordx4 v[200:203],v32,s[32:35],s84 offen sc1
 s_bfe_u32 s84,s45,0x5000a
 s_lshl_b32 s84,s84,12
 buffer_load_dwordx4 v[204:207],v33,s[32:35],s84 offen sc1
 s_bfe_u32 s84,s45,0x5000f
 s_lshl_b32 s84,s84,12
 buffer_load_dwordx4 v[208:211],v32,s[32:35],s84 offen sc1
 s_bfe_u32 s84,s45,0x5000f
 s_lshl_b32 s84,s84,12
 buffer_load_dwordx4 v[212:215],v33,s[32:35],s84 offen sc1
 s_bfe_u32 s84,s45,0x50014
 s_lshl_b32 s84,s84,12
 buffer_load_dwordx4 v[216:219],v32,s[32:35],s84 offen sc1
 s_bfe_u32 s84,s45,0x50014
 s_lshl_b32 s84,s84,12
 buffer_load_dwordx4 v[220:223],v33,s[32:35],s84 offen sc1
 s_waitcnt vmcnt(8)
 v_xor_b32 v184,0x80000000,v184
 v_xor_b32 v188,0x80000000,v188
 v_or_b32 v38,v184,v188
 v_cmp_gt_i32 vcc,0,v38
 s_cbranch_vccz Lok_447
 s_sub_u32 s55,s55,1
 s_cbranch_scc0 Lfix_445
 s_mov_b32 s55,0
Lok_447:
 s_branch Lret_446
Lfix_448:
 s_bfe_u32 s84,s45,0x50005
 s_lshl_b32 s84,s84,12
 buffer_load_dwordx4 v[192:195],v32,s[32:35],s84 offen sc1
 s_bfe_u32 s84,s45,0x50005
 s_lshl_b32 s84,s84,12
 buffer_load_dwordx4 v[196:199],v33,s[32:35],s84 offen sc1
 s_bfe_u32 s84,s45,0x5000a
 s_lshl_b32 s84,s84,12
 buffer_load_dwordx4 v[200:203],v32,s[32:35],s84 offen sc1
 s_bfe_u32 s84,s45,0x5000a
 s_lshl_b32 s84,s84,12
 buffer_load_dwordx4 v[204:207],v33,s[32:35],s84 offen sc1
 s_bfe_u32 s84,s45,0x5000f
 s_lshl_b32 s84,s84,12
 buffer_load_dwordx4 v[208:211],v32,s[32:35],s84 offen sc1
 s_bfe_u32 s84,s45,0x5000f
 s_lshl_b32 s84,s84,12
 buffer_load_dwordx4 v[212:215],v33,s[32:35],s84 offen sc1
 s_bfe_u32 s84,s45,0x50014
 s_lshl_b32 s84,s84,12
 buffer_load_dwordx4 v[216:219],v32,s[32:35],s84 offen sc1
 s_bfe_u32 s84,s45,0x50014
 s_lshl_b32 s84,s84,12
 buffer_load_dwordx4 v[220:223],v33,s[32:35],s84 offen sc1
 s_bfe_u32 s84,s45,0x50019
 s_lshl_b32 s84,s84,12
 buffer_load_dwordx4 v[224:227],v32,s[32:35],s84 offen sc1
 s_bfe_u32 s84,s45,0x50019
 s_lshl_b32 s84,s84,12
 buffer_load_dwordx4 v[228:231],v33,s[32:35],s84 offen sc1
 s_waitcnt vmcnt(8)
 v_xor_b32 v192,0x80000000,v192
 v_xor_b32 v196,0x80000000,v196
 v_or_b32 v38,v192,v196
 v_cmp_gt_i32 vcc,0,v38
 s_cbranch_vccz Lok_450
 s_sub_u32 s55,s55,1
 s_cbranch_scc0 Lfix_448
 s_mov_b32 s55,0
Lok_450:
 s_branch Lret_449
Lfix_451:
 s_bfe_u32 s84,s45,0x5000a
 s_lshl_b32 s84,s84,12
 buffer_load_dwordx4 v[200:203],v32,s[32:35],s84 offen sc1
 s_bfe_u32 s84,s45,0x5000a
 s_lshl_b32 s84,s84,12
 buffer_load_dwordx4 v[204:207],v33,s[32:35],s84 offen sc1
 s_bfe_u32 s84,s45,0x5000f
 s_lshl_b32 s84,s84,12
 buffer_load_dwordx4 v[208:211],v32,s[32:35],s84 offen sc1
 s_bfe_u32 s84,s45,0x5000f
 s_lshl_b32 s84,s84,12
 buffer_load_dwordx4 v[212:215],v33,s[32:35],s84 offen sc1
 s_bfe_u32 s84,s45,0x50014
 s_lshl_b32 s84,s84,12
 buffer_load_dwordx4 v[216:219],v32,s[32:35],s84 offen sc1
 s_bfe_u32 s84,s45,0x50014
 s_lshl_b32 s84,s84,12
 buffer_load_dwordx4 v[220:223],v33,s[32:35],s84 offen sc1
 s_bfe_u32 s84,s45,0x50019
 s_lshl_b32 s84,s84,12
 buffer_load_dwordx4 v[224:227],v32,s[32:35],s84 offen sc1
 s_bfe_u32 s84,s45,0x50019
 s_lshl_b32 s84,s84,12
 buffer_load_dwordx4 v[228:231],v33,s[32:35],s84 offen sc1
 s_bfe_u32 s84,s46,0x50000
 s_lshl_b32 s84,s84,12
 buffer_load_dwordx4 v[136:139],v32,s[32:35],s84 offen sc1
 s_bfe_u32 s84,s46,0x50000
 s_lshl_b32 s84,s84,12
 buffer_load_dwordx4 v[140:143],v33,s[32:35],s84 offen sc1
 s_waitcnt vmcnt(8)
 v_xor_b32 v200,0x80000000,v200
 v_xor_b32 v204,0x80000000,v204
 v_or_b32 v38,v200,v204
 v_cmp_gt_i32 vcc,0,v38
 s_cbranch_vccz Lok_453
 s_sub_u32 s55,s55,1
 s_cbranch_scc0 Lfix_451
 s_mov_b32 s55,0
Lok_453:
 s_branch Lret_452
Lfix_454:
 s_add_u32 s84,s72,0
 buffer_load_dwordx4 v[24:27],v3,s[32:35],s84 offen sc1
 s_waitcnt vmcnt(0)
 v_and_b32 v30,v24,v25
 v_bitop3_b32 v30,v26,v27,v30 bitop3:0x80
 v_and_b32 v30,1,v30
 v_cmp_eq_u32 s[82:83],0,v30
 s_nop 0
 s_cmp_eq_u64 s[82:83],0
 s_cbranch_scc1 Lok_456
 s_sub_u32 s55,s55,1
 s_cbranch_scc0 Lfix_454
 s_mov_b32 s55,0
Lok_456:
 s_branch Lret_455
Lfix_457:
 s_bfe_u32 s84,s45,0x5000f
 s_lshl_b32 s84,s84,12
 buffer_load_dwordx4 v[208:211],v32,s[32:35],s84 offen sc1
 s_bfe_u32 s84,s45,0x5000f
 s_lshl_b32 s84,s84,12
 buffer_load_dwordx4 v[212:215],v33,s[32:35],s84 offen sc1
 s_bfe_u32 s84,s45,0x50014
 s_lshl_b32 s84,s84,12
 buffer_load_dwordx4 v[216:219],v32,s[32:35],s84 offen sc1
 s_bfe_u32 s84,s45,0x50014
 s_lshl_b32 s84,s84,12
 buffer_load_dwordx4 v[220:223],v33,s[32:35],s84 offen sc1
 s_bfe_u32 s84,s45,0x50019
 s_lshl_b32 s84,s84,12
 buffer_load_dwordx4 v[224:227],v32,s[32:35],s84 offen sc1
 s_bfe_u32 s84,s45,0x50019
 s_lshl_b32 s84,s84,12
 buffer_load_dwordx4 v[228:231],v33,s[32:35],s84 offen sc1
 s_bfe_u32 s84,s46,0x50000
 s_lshl_b32 s84,s84,12
 buffer_load_dwordx4 v[136:139],v32,s[32:35],s84 offen sc1
 s_bfe_u32 s84,s46,0x50000
 s_lshl_b32 s84,s84,12
 buffer_load_dwordx4 v[140:143],v33,s[32:35],s84 offen sc1
 s_bfe_u32 s84,s46,0x50005
 s_lshl_b32 s84,s84,12
 buffer_load_dwordx4 v[144:147],v32,s[32:35],s84 offen sc1
 s_bfe_u32 s84,s46,0x50005
 s_lshl_b32 s84,s84,12
 buffer_load_dwordx4 v[148:151],v33,s[32:35],s84 offen sc1
 s_waitcnt vmcnt(8)
 v_xor_b32 v208,0x80000000,v208
 v_xor_b32 v212,0x80000000,v212
 v_or_b32 v38,v208,v212
 v_cmp_gt_i32 vcc,0,v38
 s_cbranch_vccz Lok_459
 s_sub_u32 s55,s55,1
 s_cbranch_scc0 Lfix_457
 s_mov_b32 s55,0
Lok_459:
 s_branch Lret_458
Lfix_460:
 s_bfe_u32 s84,s45,0x50014
 s_lshl_b32 s84,s84,12
 buffer_load_dwordx4 v[216:219],v32,s[32:35],s84 offen sc1
 s_bfe_u32 s84,s45,0x50014
 s_lshl_b32 s84,s84,12
 buffer_load_dwordx4 v[220:223],v33,s[32:35],s84 offen sc1
 s_bfe_u32 s84,s45,0x50019
 s_lshl_b32 s84,s84,12
 buffer_load_dwordx4 v[224:227],v32,s[32:35],s84 offen sc1
 s_bfe_u32 s84,s45,0x50019
 s_lshl_b32 s84,s84,12
 buffer_load_dwordx4 v[228:231],v33,s[32:35],s84 offen sc1
 s_bfe_u32 s84,s46,0x50000
 s_lshl_b32 s84,s84,12
 buffer_load_dwordx4 v[136:139],v32,s[32:35],s84 offen sc1
 s_bfe_u32 s84,s46,0x50000
 s_lshl_b32 s84,s84,12
 buffer_load_dwordx4 v[140:143],v33,s[32:35],s84 offen sc1
 s_bfe_u32 s84,s46,0x50005
 s_lshl_b32 s84,s84,12
 buffer_load_dwordx4 v[144:147],v32,s[32:35],s84 offen sc1
 s_bfe_u32 s84,s46,0x50005
 s_lshl_b32 s84,s84,12
 buffer_load_dwordx4 v[148:151],v33,s[32:35],s84 offen sc1
 s_bfe_u32 s84,s46,0x5000a
 s_lshl_b32 s84,s84,12
 buffer_load_dwordx4 v[152:155],v32,s[32:35],s84 offen sc1
 s_bfe_u32 s84,s46,0x5000a
 s_lshl_b32 s84,s84,12
 buffer_load_dwordx4 v[156:159],v33,s[32:35],s84 offen sc1
 s_waitcnt vmcnt(8)
 v_xor_b32 v216,0x80000000,v216
 v_xor_b32 v220,0x80000000,v220
 v_or_b32 v38,v216,v220
 v_cmp_gt_i32 vcc,0,v38
 s_cbranch_vccz Lok_462
 s_sub_u32 s55,s55,1
 s_cbranch_scc0 Lfix_460
 s_mov_b32 s55,0
Lok_462:
 s_branch Lret_461
Lfix_463:
 s_bfe_u32 s84,s45,0x50019
 s_lshl_b32 s84,s84,12
 buffer_load_dwordx4 v[224:227],v32,s[32:35],s84 offen sc1
 s_bfe_u32 s84,s45,0x50019
 s_lshl_b32 s84,s84,12
 buffer_load_dwordx4 v[228:231],v33,s[32:35],s84 offen sc1
 s_bfe_u32 s84,s46,0x50000
 s_lshl_b32 s84,s84,12
 buffer_load_dwordx4 v[136:139],v32,s[32:35],s84 offen sc1
 s_bfe_u32 s84,s46,0x50000
 s_lshl_b32 s84,s84,12
 buffer_load_dwordx4 v[140:143],v33,s[32:35],s84 offen sc1
 s_bfe_u32 s84,s46,0x50005
 s_lshl_b32 s84,s84,12
 buffer_load_dwordx4 v[144:147],v32,s[32:35],s84 offen sc1
 s_bfe_u32 s84,s46,0x50005
 s_lshl_b32 s84,s84,12
 buffer_load_dwordx4 v[148:151],v33,s[32:35],s84 offen sc1
 s_bfe_u32 s84,s46,0x5000a
 s_lshl_b32 s84,s84,12
 buffer_load_dwordx4 v[152:155],v32,s[32:35],s84 offen sc1
 s_bfe_u32 s84,s46,0x5000a
 s_lshl_b32 s84,s84,12
 buffer_load_dwordx4 v[156:159],v33,s[32:35],s84 offen sc1
 s_bfe_u32 s84,s46,0x5000f
 s_lshl_b32 s84,s84,12
 buffer_load_dwordx4 v[160:163],v32,s[32:35],s84 offen sc1
 s_bfe_u32 s84,s46,0x5000f
 s_lshl_b32 s84,s84,12
 buffer_load_dwordx4 v[164:167],v33,s[32:35],s84 offen sc1
 s_waitcnt vmcnt(8)
 v_xor_b32 v224,0x80000000,v224
 v_xor_b32 v228,0x80000000,v228
 v_or_b32 v38,v224,v228
 v_cmp_gt_i32 vcc,0,v38
 s_cbranch_vccz Lok_465
 s_sub_u32 s55,s55,1
 s_cbranch_scc0 Lfix_463
 s_mov_b32 s55,0
Lok_465:
 s_branch Lret_464
Lfix_466:
 s_bfe_u32 s84,s46,0x50000
 s_lshl_b32 s84,s84,12
 buffer_load_dwordx4 v[136:139],v32,s[32:35],s84 offen sc1
 s_bfe_u32 s84,s46,0x50000
 s_lshl_b32 s84,s84,12
 buffer_load_dwordx4 v[140:143],v33,s[32:35],s84 offen sc1
 s_bfe_u32 s84,s46,0x50005
 s_lshl_b32 s84,s84,12
 buffer_load_dwordx4 v[144:147],v32,s[32:35],s84 offen sc1
 s_bfe_u32 s84,s46,0x50005
 s_lshl_b32 s84,s84,12
 buffer_load_dwordx4 v[148:151],v33,s[32:35],s84 offen sc1
 s_bfe_u32 s84,s46,0x5000a
 s_lshl_b32 s84,s84,12
 buffer_load_dwordx4 v[152:155],v32,s[32:35],s84 offen sc1
 s_bfe_u32 s84,s46,0x5000a
 s_lshl_b32 s84,s84,12
 buffer_load_dwordx4 v[156:159],v33,s[32:35],s84 offen sc1
 s_bfe_u32 s84,s46,0x5000f
 s_lshl_b32 s84,s84,12
 buffer_load_dwordx4 v[160:163],v32,s[32:35],s84 offen sc1
 s_bfe_u32 s84,s46,0x5000f
 s_lshl_b32 s84,s84,12
 buffer_load_dwordx4 v[164:167],v33,s[32:35],s84 offen sc1
 s_bfe_u32 s84,s46,0x50014
 s_lshl_b32 s84,s84,12
 buffer_load_dwordx4 v[168:171],v32,s[32:35],s84 offen sc1
 s_bfe_u32 s84,s46,0x50014
 s_lshl_b32 s84,s84,12
 buffer_load_dwordx4 v[172:175],v33,s[32:35],s84 offen sc1
 s_waitcnt vmcnt(8)
 v_xor_b32 v136,0x80000000,v136
 v_xor_b32 v140,0x80000000,v140
 v_or_b32 v38,v136,v140
 v_cmp_gt_i32 vcc,0,v38
 s_cbranch_vccz Lok_468
 s_sub_u32 s55,s55,1
 s_cbranch_scc0 Lfix_466
 s_mov_b32 s55,0
Lok_468:
 s_branch Lret_467
Lfix_469:
 s_bfe_u32 s84,s46,0x50005
 s_lshl_b32 s84,s84,12
 buffer_load_dwordx4 v[144:147],v32,s[32:35],s84 offen sc1
 s_bfe_u32 s84,s46,0x50005
 s_lshl_b32 s84,s84,12
 buffer_load_dwordx4 v[148:151],v33,s[32:35],s84 offen sc1
 s_bfe_u32 s84,s46,0x5000a
 s_lshl_b32 s84,s84,12
 buffer_load_dwordx4 v[152:155],v32,s[32:35],s84 offen sc1
 s_bfe_u32 s84,s46,0x5000a
 s_lshl_b32 s84,s84,12
 buffer_load_dwordx4 v[156:159],v33,s[32:35],s84 offen sc1
 s_bfe_u32 s84,s46,0x5000f
 s_lshl_b32 s84,s84,12
 buffer_load_dwordx4 v[160:163],v32,s[32:35],s84 offen sc1
 s_bfe_u32 s84,s46,0x5000f
 s_lshl_b32 s84,s84,12
 buffer_load_dwordx4 v[164:167],v33,s[32:35],s84 offen sc1
 s_bfe_u32 s84,s46,0x50014
 s_lshl_b32 s84,s84,12
 buffer_load_dwordx4 v[168:171],v32,s[32:35],s84 offen sc1
 s_bfe_u32 s84,s46,0x50014
 s_lshl_b32 s84,s84,12
 buffer_load_dwordx4 v[172:175],v33,s[32:35],s84 offen sc1
 s_bfe_u32 s84,s46,0x50019
 s_lshl_b32 s84,s84,12
 buffer_load_dwordx4 v[176:179],v32,s[32:35],s84 offen sc1
 s_bfe_u32 s84,s46,0x50019
 s_lshl_b32 s84,s84,12
 buffer_load_dwordx4 v[180:183],v33,s[32:35],s84 offen sc1
 s_waitcnt vmcnt(8)
 v_xor_b32 v144,0x80000000,v144
 v_xor_b32 v148,0x80000000,v148
 v_or_b32 v38,v144,v148
 v_cmp_gt_i32 vcc,0,v38
 s_cbranch_vccz Lok_471
 s_sub_u32 s55,s55,1
 s_cbranch_scc0 Lfix_469
 s_mov_b32 s55,0
Lok_471:
 s_branch Lret_470
Lfix_472:
 s_bfe_u32 s84,s46,0x5000a
 s_lshl_b32 s84,s84,12
 buffer_load_dwordx4 v[152:155],v32,s[32:35],s84 offen sc1
 s_bfe_u32 s84,s46,0x5000a
 s_lshl_b32 s84,s84,12
 buffer_load_dwordx4 v[156:159],v33,s[32:35],s84 offen sc1
 s_bfe_u32 s84,s46,0x5000f
 s_lshl_b32 s84,s84,12
 buffer_load_dwordx4 v[160:163],v32,s[32:35],s84 offen sc1
 s_bfe_u32 s84,s46,0x5000f
 s_lshl_b32 s84,s84,12
 buffer_load_dwordx4 v[164:167],v33,s[32:35],s84 offen sc1
 s_bfe_u32 s84,s46,0x50014
 s_lshl_b32 s84,s84,12
 buffer_load_dwordx4 v[168:171],v32,s[32:35],s84 offen sc1
 s_bfe_u32 s84,s46,0x50014
 s_lshl_b32 s84,s84,12
 buffer_load_dwordx4 v[172:175],v33,s[32:35],s84 offen sc1
 s_bfe_u32 s84,s46,0x50019
 s_lshl_b32 s84,s84,12
 buffer_load_dwordx4 v[176:179],v32,s[32:35],s84 offen sc1
 s_bfe_u32 s84,s46,0x50019
 s_lshl_b32 s84,s84,12
 buffer_load_dwordx4 v[180:183],v33,s[32:35],s84 offen sc1
 s_bfe_u32 s84,s47,0x50000
 s_lshl_b32 s84,s84,12
 buffer_load_dwordx4 v[184:187],v32,s[32:35],s84 offen sc1
 s_bfe_u32 s84,s47,0x50000
 s_lshl_b32 s84,s84,12
 buffer_load_dwordx4 v[188:191],v33,s[32:35],s84 offen sc1
 s_waitcnt vmcnt(8)
 v_xor_b32 v152,0x80000000,v152
 v_xor_b32 v156,0x80000000,v156
 v_or_b32 v38,v152,v156
 v_cmp_gt_i32 vcc,0,v38
 s_cbranch_vccz Lok_474
 s_sub_u32 s55,s55,1
 s_cbranch_scc0 Lfix_472
 s_mov_b32 s55,0
Lok_474:
 s_branch Lret_473
Lfix_475:
 s_bfe_u32 s84,s46,0x5000f
 s_lshl_b32 s84,s84,12
 buffer_load_dwordx4 v[160:163],v32,s[32:35],s84 offen sc1
 s_bfe_u32 s84,s46,0x5000f
 s_lshl_b32 s84,s84,12
 buffer_load_dwordx4 v[164:167],v33,s[32:35],s84 offen sc1
 s_bfe_u32 s84,s46,0x50014
 s_lshl_b32 s84,s84,12
 buffer_load_dwordx4 v[168:171],v32,s[32:35],s84 offen sc1
 s_bfe_u32 s84,s46,0x50014
 s_lshl_b32 s84,s84,12
 buffer_load_dwordx4 v[172:175],v33,s[32:35],s84 offen sc1
 s_bfe_u32 s84,s46,0x50019
 s_lshl_b32 s84,s84,12
 buffer_load_dwordx4 v[176:179],v32,s[32:35],s84 offen sc1
 s_bfe_u32 s84,s46,0x50019
 s_lshl_b32 s84,s84,12
 buffer_load_dwordx4 v[180:183],v33,s[32:35],s84 offen sc1
 s_bfe_u32 s84,s47,0x50000
 s_lshl_b32 s84,s84,12
 buffer_load_dwordx4 v[184:187],v32,s[32:35],s84 offen sc1
 s_bfe_u32 s84,s47,0x50000
 s_lshl_b32 s84,s84,12
 buffer_load_dwordx4 v[188:191],v33,s[32:35],s84 offen sc1
 s_bfe_u32 s84,s47,0x50005
 s_lshl_b32 s84,s84,12
 buffer_load_dwordx4 v[192:195],v32,s[32:35],s84 offen sc1
 s_bfe_u32 s84,s47,0x50005
 s_lshl_b32 s84,s84,12
 buffer_load_dwordx4 v[196:199],v33,s[32:35],s84 offen sc1
 s_waitcnt vmcnt(8)
 v_xor_b32 v160,0x80000000,v160
 v_xor_b32 v164,0x80000000,v164
 v_or_b32 v38,v160,v164
 v_cmp_gt_i32 vcc,0,v38
 s_cbranch_vccz Lok_477
 s_sub_u32 s55,s55,1
 s_cbranch_scc0 Lfix_475
 s_mov_b32 s55,0
Lok_477:
 s_branch Lret_476
Lfix_478:
 s_bfe_u32 s84,s46,0x50014
 s_lshl_b32 s84,s84,12
 buffer_load_dwordx4 v[168:171],v32,s[32:35],s84 offen sc1
 s_bfe_u32 s84,s46,0x50014
 s_lshl_b32 s84,s84,12
 buffer_load_dwordx4 v[172:175],v33,s[32:35],s84 offen sc1
 s_bfe_u32 s84,s46,0x50019
 s_lshl_b32 s84,s84,12
 buffer_load_dwordx4 v[176:179],v32,s[32:35],s84 offen sc1
 s_bfe_u32 s84,s46,0x50019
 s_lshl_b32 s84,s84,12
 buffer_load_dwordx4 v[180:183],v33,s[32:35],s84 offen sc1
 s_bfe_u32 s84,s47,0x50000
 s_lshl_b32 s84,s84,12
 buffer_load_dwordx4 v[184:187],v32,s[32:35],s84 offen sc1
 s_bfe_u32 s84,s47,0x50000
 s_lshl_b32 s84,s84,12
 buffer_load_dwordx4 v[188:191],v33,s[32:35],s84 offen sc1
 s_bfe_u32 s84,s47,0x50005
 s_lshl_b32 s84,s84,12
 buffer_load_dwordx4 v[192:195],v32,s[32:35],s84 offen sc1
 s_bfe_u32 s84,s47,0x50005
 s_lshl_b32 s84,s84,12
 buffer_load_dwordx4 v[196:199],v33,s[32:35],s84 offen sc1
 s_bfe_u32 s84,s47,0x5000a
 s_lshl_b32 s84,s84,12
 buffer_load_dwordx4 v[200:203],v32,s[32:35],s84 offen sc1
 s_bfe_u32 s84,s47,0x5000a
 s_lshl_b32 s84,s84,12
 buffer_load_dwordx4 v[204:207],v33,s[32:35],s84 offen sc1
 s_waitcnt vmcnt(8)
 v_xor_b32 v168,0x80000000,v168
 v_xor_b32 v172,0x80000000,v172
 v_or_b32 v38,v168,v172
 v_cmp_gt_i32 vcc,0,v38
 s_cbranch_vccz Lok_480
 s_sub_u32 s55,s55,1
 s_cbranch_scc0 Lfix_478
 s_mov_b32 s55,0
Lok_480:
 s_branch Lret_479
Lfix_481:
 s_bfe_u32 s84,s46,0x50019
 s_lshl_b32 s84,s84,12
 buffer_load_dwordx4 v[176:179],v32,s[32:35],s84 offen sc1
 s_bfe_u32 s84,s46,0x50019
 s_lshl_b32 s84,s84,12
 buffer_load_dwordx4 v[180:183],v33,s[32:35],s84 offen sc1
 s_bfe_u32 s84,s47,0x50000
 s_lshl_b32 s84,s84,12
 buffer_load_dwordx4 v[184:187],v32,s[32:35],s84 offen sc1
 s_bfe_u32 s84,s47,0x50000
 s_lshl_b32 s84,s84,12
 buffer_load_dwordx4 v[188:191],v33,s[32:35],s84 offen sc1
 s_bfe_u32 s84,s47,0x50005
 s_lshl_b32 s84,s84,12
 buffer_load_dwordx4 v[192:195],v32,s[32:35],s84 offen sc1
 s_bfe_u32 s84,s47,0x50005
 s_lshl_b32 s84,s84,12
 buffer_load_dwordx4 v[196:199],v33,s[32:35],s84 offen sc1
 s_bfe_u32 s84,s47,0x5000a
 s_lshl_b32 s84,s84,12
 buffer_load_dwordx4 v[200:203],v32,s[32:35],s84 offen sc1
 s_bfe_u32 s84,s47,0x5000a
 s_lshl_b32 s84,s84,12
 buffer_load_dwordx4 v[204:207],v33,s[32:35],s84 offen sc1
 buffer_load_dwordx4 v[208:211],v32,s[32:35],s70 offen sc1
 buffer_load_dwordx4 v[212:215],v33,s[32:35],s70 offen sc1
 s_waitcnt vmcnt(8)
 v_xor_b32 v176,0x80000000,v176
 v_xor_b32 v180,0x80000000,v180
 v_or_b32 v38,v176,v180
 v_cmp_gt_i32 vcc,0,v38
 s_cbranch_vccz Lok_483
 s_sub_u32 s55,s55,1
 s_cbranch_scc0 Lfix_481
 s_mov_b32 s55,0
Lok_483:
 s_branch Lret_482
Lfix_484:
 s_bfe_u32 s84,s47,0x50000
 s_lshl_b32 s84,s84,12
 buffer_load_dwordx4 v[184:187],v32,s[32:35],s84 offen sc1
 s_bfe_u32 s84,s47,0x50000
 s_lshl_b32 s84,s84,12
 buffer_load_dwordx4 v[188:191],v33,s[32:35],s84 offen sc1
 s_bfe_u32 s84,s47,0x50005
 s_lshl_b32 s84,s84,12
 buffer_load_dwordx4 v[192:195],v32,s[32:35],s84 offen sc1
 s_bfe_u32 s84,s47,0x50005
 s_lshl_b32 s84,s84,12
 buffer_load_dwordx4 v[196:199],v33,s[32:35],s84 offen sc1
 s_bfe_u32 s84,s47,0x5000a
 s_lshl_b32 s84,s84,12
 buffer_load_dwordx4 v[200:203],v32,s[32:35],s84 offen sc1
 s_bfe_u32 s84,s47,0x5000a
 s_lshl_b32 s84,s84,12
 buffer_load_dwordx4 v[204:207],v33,s[32:35],s84 offen sc1
 buffer_load_dwordx4 v[208:211],v32,s[32:35],s70 offen sc1
 buffer_load_dwordx4 v[212:215],v33,s[32:35],s70 offen sc1
 s_waitcnt vmcnt(6)
 v_xor_b32 v184,0x80000000,v184
 v_xor_b32 v188,0x80000000,v188
 v_or_b32 v38,v184,v188
 v_cmp_gt_i32 vcc,0,v38
 s_cbranch_vccz Lok_486
 s_sub_u32 s55,s55,1
 s_cbranch_scc0 Lfix_484
 s_mov_b32 s55,0
Lok_486:
 s_branch Lret_485
Lfix_487:
 s_bfe_u32 s84,s47,0x50005
 s_lshl_b32 s84,s84,12
 buffer_load_dwordx4 v[192:195],v32,s[32:35],s84 offen sc1
 s_bfe_u32 s84,s47,0x50005
 s_lshl_b32 s84,s84,12
 buffer_load_dwordx4 v[196:199],v33,s[32:35],s84 offen sc1
 s_bfe_u32 s84,s47,0x5000a
 s_lshl_b32 s84,s84,12
 buffer_load_dwordx4 v[200:203],v32,s[32:35],s84 offen sc1
 s_bfe_u32 s84,s47,0x5000a
 s_lshl_b32 s84,s84,12
 buffer_load_dwordx4 v[204:207],v33,s[32:35],s84 offen sc1
 buffer_load_dwordx4 v[208:211],v32,s[32:35],s70 offen sc1
 buffer_load_dwordx4 v[212:215],v33,s[32:35],s70 offen sc1
 s_waitcnt vmcnt(4)
 v_xor_b32 v192,0x80000000,v192
 v_xor_b32 v196,0x80000000,v196
 v_or_b32 v38,v192,v196
 v_cmp_gt_i32 vcc,0,v38
 s_cbranch_vccz Lok_489
 s_sub_u32 s55,s55,1
 s_cbranch_scc0 Lfix_487
 s_mov_b32 s55,0
Lok_489:
 s_branch Lret_488
Lfix_490:
 s_bfe_u32 s84,s47,0x5000a
 s_lshl_b32 s84,s84,12
 buffer_load_dwordx4 v[200:203],v32,s[32:35],s84 offen sc1
 s_bfe_u32 s84,s47,0x5000a
 s_lshl_b32 s84,s84,12
 buffer_load_dwordx4 v[204:207],v33,s[32:35],s84 offen sc1
 buffer_load_dwordx4 v[208:211],v32,s[32:35],s70 offen sc1
 buffer_load_dwordx4 v[212:215],v33,s[32:35],s70 offen sc1
 s_waitcnt vmcnt(2)
 v_xor_b32 v200,0x80000000,v200
 v_xor_b32 v204,0x80000000,v204
 v_or_b32 v38,v200,v204
 v_cmp_gt_i32 vcc,0,v38
 s_cbranch_vccz Lok_492
 s_sub_u32 s55,s55,1
 s_cbranch_scc0 Lfix_490
 s_mov_b32 s55,0
Lok_492:
 s_branch Lret_491
Lfix_493:
 buffer_load_dwordx4 v[208:211],v32,s[32:35],s70 offen sc1
 buffer_load_dwordx4 v[212:215],v33,s[32:35],s70 offen sc1
 s_waitcnt vmcnt(0)
 v_xor_b32 v208,0x80000000,v208
 v_xor_b32 v212,0x80000000,v212
 v_or_b32 v38,v208,v212
 v_cmp_gt_i32 vcc,0,v38
 s_cbranch_vccz Lok_495
 s_sub_u32 s55,s55,1
 s_cbranch_scc0 Lfix_493
 s_mov_b32 s55,0
Lok_495:
 s_branch Lret_494
Lfix_496:
 buffer_load_dwordx4 v[136:139],v2,s[32:35],s36 offen sc1
 buffer_load_dwordx4 v[140:143],v2,s[32:35],s36 offen offset:1024 sc1
 buffer_load_dwordx4 v[152:155],v2,s[32:35],s37 offen sc1
 buffer_load_dwordx4 v[156:159],v2,s[32:35],s37 offen offset:1024 sc1
 buffer_load_dwordx4 v[168:171],v2,s[32:35],s38 offen sc1
 buffer_load_dwordx4 v[172:175],v2,s[32:35],s38 offen offset:1024 sc1
 buffer_load_dwordx4 v[184:187],v2,s[32:35],s39 offen sc1
 s_add_u32 s84,s97,32768
 buffer_store_dword v38,off,s[32:35],s84
 buffer_load_dwordx4 v[188:191],v2,s[32:35],s39 offen offset:1024 sc1
 buffer_load_dwordx4 v[200:203],v2,s[32:35],s40 offen sc1
 buffer_load_dwordx4 v[204:207],v2,s[32:35],s40 offen offset:1024 sc1
 buffer_load_dwordx4 v[216:219],v2,s[32:35],s41 offen sc1
 s_waitcnt vmcnt(10)
 v_bitop3_b32 v38,v136,v140,1 bitop3:0xa8
 v_cmp_ne_u32 vcc,0,v38
 s_cbranch_vccz Lok_498
 s_sub_u32 s55,s55,1
 s_cbranch_scc0 Lfix_496
 s_mov_b32 s55,0
Lok_498:
 s_branch Lret_497
Lfix_499:
 buffer_load_dwordx4 v[152:155],v2,s[32:35],s37 offen sc1
 buffer_load_dwordx4 v[156:159],v2,s[32:35],s37 offen offset:1024 sc1
 buffer_load_dwordx4 v[168:171],v2,s[32:35],s38 offen sc1
 buffer_load_dwordx4 v[172:175],v2,s[32:35],s38 offen offset:1024 sc1
 buffer_load_dwordx4 v[184:187],v2,s[32:35],s39 offen sc1
 s_add_u32 s84,s97,32768
 buffer_store_dword v38,off,s[32:35],s84
 buffer_load_dwordx4 v[188:191],v2,s[32:35],s39 offen offset:1024 sc1
 buffer_load_dwordx4 v[200:203],v2,s[32:35],s40 offen sc1
 buffer_load_dwordx4 v[204:207],v2,s[32:35],s40 offen offset:1024 sc1
 buffer_load_dwordx4 v[216:219],v2,s[32:35],s41 offen sc1
 buffer_load_dwordx4 v[220:223],v2,s[32:35],s41 offen offset:1024 sc1
 buffer_load_dwordx4 v[232:235],v2,s[32:35],s42 offen sc1
 s_waitcnt vmcnt(10)
 v_bitop3_b32 v38,v152,v156,1 bitop3:0xa8
 v_cmp_ne_u32 vcc,0,v38
 s_cbranch_vccz Lok_501
 s_sub_u32 s55,s55,1
 s_cbranch_scc0 Lfix_499
 s_mov_b32 s55,0
Lok_501:
 s_branch Lret_500
Lfix_502:
 buffer_load_dwordx4 v[168:171],v2,s[32:35],s38 offen sc1
 buffer_load_dwordx4 v[172:175],v2,s[32:35],s38 offen offset:1024 sc1
 buffer_load_dwordx4 v[184:187],v2,s[32:35],s39 offen sc1
 s_add_u32 s84,s97,32768
 buffer_store_dword v38,off,s[32:35],s84
 buffer_load_dwordx4 v[188:191],v2,s[32:35],s39 offen offset:1024 sc1
 buffer_load_dwordx4 v[200:203],v2,s[32:35],s40 offen sc1
 buffer_load_dwordx4 v[204:207],v2,s[32:35],s40 offen offset:1024 sc1
 buffer_load_dwordx4 v[216:219],v2,s[32:35],s41 offen sc1
 buffer_load_dwordx4 v[220:223],v2,s[32:35],s41 offen offset:1024 sc1
 buffer_load_dwordx4 v[232:235],v2,s[32:35],s42 offen sc1
 buffer_load_dwordx4 v[236:239],v2,s[32:35],s42 offen offset:1024 sc1
 buffer_load_dwordx4 v[248:251],v2,s[32:35],s43 offen sc1
 s_waitcnt vmcnt(10)
 v_bitop3_b32 v38,v168,v172,1 bitop3:0xa8
 v_cmp_ne_u32 vcc,0,v38
 s_cbranch_vccz Lok_504
 s_sub_u32 s55,s55,1
 s_cbranch_scc0 Lfix_502
 s_mov_b32 s55,0
Lok_504:
 s_branch Lret_503
Lfix_505:
 buffer_load_dwordx4 v[184:187],v2,s[32:35],s39 offen sc1
 buffer_load_dwordx4 v[188:191],v2,s[32:35],s39 offen offset:1024 sc1
 buffer_load_dwordx4 v[200:203],v2,s[32:35],s40 offen sc1
 buffer_load_dwordx4 v[204:207],v2,s[32:35],s40 offen offset:1024 sc1
 buffer_load_dwordx4 v[216:219],v2,s[32:35],s41 offen sc1
 buffer_load_dwordx4 v[220:223],v2,s[32:35],s41 offen offset:1024 sc1
 buffer_load_dwordx4 v[232:235],v2,s[32:35],s42 offen sc1
 buffer_load_dwordx4 v[236:239],v2,s[32:35],s42 offen offset:1024 sc1
 buffer_load_dwordx4 v[248:251],v2,s[32:35],s43 offen sc1
 buffer_load_dwordx4 v[252:255],v2,s[32:35],s43 offen offset:1024 sc1
 buffer_load_dwordx4 v[144:147],v2,s[32:35],s8 offen sc1
 s_waitcnt vmcnt(9)
 v_bitop3_b32 v38,v184,v188,1 bitop3:0xa8
 v_cmp_ne_u32 vcc,0,v38
 s_cbranch_vccz Lok_507
 s_sub_u32 s55,s55,1
 s_cbranch_scc0 Lfix_505
 s_mov_b32 s55,0
Lok_507:
 s_branch Lret_506
Lfix_508:
 buffer_load_dwordx4 v[200:203],v2,s[32:35],s40 offen sc1
 buffer_load_dwordx4 v[204:207],v2,s[32:35],s40 offen offset:1024 sc1
 buffer_load_dwordx4 v[216:219],v2,s[32:35],s41 offen sc1
 buffer_load_dwordx4 v[220:223],v2,s[32:35],s41 offen offset:1024 sc1
 buffer_load_dwordx4 v[232:235],v2,s[32:35],s42 offen sc1
 buffer_load_dwordx4 v[236:239],v2,s[32:35],s42 offen offset:1024 sc1
 buffer_load_dwordx4 v[248:251],v2,s[32:35],s43 offen sc1
 buffer_load_dwordx4 v[252:255],v2,s[32:35],s43 offen offset:1024 sc1
 buffer_load_dwordx4 v[144:147],v2,s[32:35],s8 offen sc1
 buffer_load_dwordx4 v[148:151],v2,s[32:35],s8 offen offset:1024 sc1
 buffer_load_dwordx4 v[160:163],v2,s[32:35],s9 offen sc1
 s_waitcnt vmcnt(9)
 v_bitop3_b32 v38,v200,v204,1 bitop3:0xa8
 v_cmp_ne_u32 vcc,0,v38
 s_cbranch_vccz Lok_510
 s_sub_u32 s55,s55,1
 s_cbranch_scc0 Lfix_508
 s_mov_b32 s55,0
Lok_510:
 s_branch Lret_509
Lfix_511:
 buffer_load_dwordx4 v[216:219],v2,s[32:35],s41 offen sc1
 buffer_load_dwordx4 v[220:223],v2,s[32:35],s41 offen offset:1024 sc1
 buffer_load_dwordx4 v[232:235],v2,s[32:35],s42 offen sc1
 buffer_load_dwordx4 v[236:239],v2,s[32:35],s42 offen offset:1024 sc1
 buffer_load_dwordx4 v[248:251],v2,s[32:35],s43 offen sc1
 buffer_load_dwordx4 v[252:255],v2,s[32:35],s43 offen offset:1024 sc1
 buffer_load_dwordx4 v[144:147],v2,s[32:35],s8 offen sc1
 buffer_load_dwordx4 v[148:151],v2,s[32:35],s8 offen offset:1024 sc1
 buffer_load_dwordx4 v[160:163],v2,s[32:35],s9 offen sc1
 buffer_load_dwordx4 v[164:167],v2,s[32:35],s9 offen offset:1024 sc1
 s_add_u32 s84,s97,32768
 buffer_store_dword v38,off,s[32:35],s84
 s_add_u32 s84,s97,32768
 buffer_store_dword v38,off,s[32:35],s84
 buffer_load_dwordx4 v[176:179],v2,s[32:35],s10 offen sc1
 s_waitcnt vmcnt(11)
 v_bitop3_b32 v38,v216,v220,1 bitop3:0xa8
 v_cmp_ne_u32 vcc,0,v38
 s_cbranch_vccz Lok_513
 s_sub_u32 s55,s55,1
 s_cbranch_scc0 Lfix_511
 s_mov_b32 s55,0
Lok_513:
 s_branch Lret_512
Lfix_514:
 buffer_load_dwordx4 v[232:235],v2,s[32:35],s42 offen sc1
 buffer_load_dwordx4 v[236:239],v2,s[32:35],s42 offen offset:1024 sc1
 buffer_load_dwordx4 v[248:251],v2,s[32:35],s43 offen sc1
 buffer_load_dwordx4 v[252:255],v2,s[32:35],s43 offen offset:1024 sc1
 buffer_load_dwordx4 v[144:147],v2,s[32:35],s8 offen sc1
 buffer_load_dwordx4 v[148:151],v2,s[32:35],s8 offen offset:1024 sc1
 buffer_load_dwordx4 v[160:163],v2,s[32:35],s9 offen sc1
 buffer_load_dwordx4 v[164:167],v2,s[32:35],s9 offen offset:1024 sc1
 s_add_u32 s84,s97,32768
 buffer_store_dword v38,off,s[32:35],s84
 s_add_u32 s84,s97,32768
 buffer_store_dword v38,off,s[32:35],s84
 buffer_load_dwordx4 v[176:179],v2,s[32:35],s10 offen sc1
 buffer_load_dwordx4 v[180:183],v2,s[32:35],s10 offen offset:1024 sc1
 buffer_load_dwordx4 v[192:195],v2,s[32:35],s11 offen sc1
 s_waitcnt vmcnt(11)
 v_bitop3_b32 v38,v232,v236,1 bitop3:0xa8
 v_cmp_ne_u32 vcc,0,v38
 s_cbranch_vccz Lok_516
 s_sub_u32 s55,s55,1
 s_cbranch_scc0 Lfix_514
 s_mov_b32 s55,0
Lok_516:
 s_branch Lret_515
Lfix_517:
 buffer_load_dwordx4 v[248:251],v2,s[32:35],s43 offen sc1
 buffer_load_dwordx4 v[252:255],v2,s[32:35],s43 offen offset:1024 sc1
 buffer_load_dwordx4 v[144:147],v2,s[32:35],s8 offen sc1
 buffer_load_dwordx4 v[148:151],v2,s[32:35],s8 offen offset:1024 sc1
 buffer_load_dwordx4 v[160:163],v2,s[32:35],s9 offen sc1
 buffer_load_dwordx4 v[164:167],v2,s[32:35],s9 offen offset:1024 sc1
 s_add_u32 s84,s97,32768
 buffer_store_dword v38,off,s[32:35],s84
 s_add_u32 s84,s97,32768
 buffer_store_dword v38,off,s[32:35],s84
 buffer_load_dwordx4 v[176:179],v2,s[32:35],s10 offen sc1
 buffer_load_dwordx4 v[180:183],v2,s[32:35],s10 offen offset:1024 sc1
 buffer_load_dwordx4 v[192:195],v2,s[32:35],s11 offen sc1
 buffer_load_dwordx4 v[196:199],v2,s[32:35],s11 offen offset:1024 sc1
 buffer_load_dwordx4 v[208:211],v2,s[32:35],s57 offen sc1
 s_waitcnt vmcnt(11)
 v_bitop3_b32 v38,v248,v252,1 bitop3:0xa8
 v_cmp_ne_u32 vcc,0,v38
 s_cbranch_vccz Lok_519
 s_sub_u32 s55,s55,1
 s_cbranch_scc0 Lfix_517
 s_mov_b32 s55,0
Lok_519:
 s_branch Lret_518
Lfix_520:
 buffer_load_dwordx4 v[144:147],v2,s[32:35],s8 offen sc1
 buffer_load_dwordx4 v[148:151],v2,s[32:35],s8 offen offset:1024 sc1
 buffer_load_dwordx4 v[160:163],v2,s[32:35],s9 offen sc1
 buffer_load_dwordx4 v[164:167],v2,s[32:35],s9 offen offset:1024 sc1
 s_add_u32 s84,s97,32768
 buffer_store_dword v38,off,s[32:35],s84
 s_add_u32 s84,s97,32768
 buffer_store_dword v38,off,s[32:35],s84
 buffer_load_dwordx4 v[176:179],v2,s[32:35],s10 offen sc1
 buffer_load_dwordx4 v[180:183],v2,s[32:35],s10 offen offset:1024 sc1
 buffer_load_dwordx4 v[192:195],v2,s[32:35],s11 offen sc1
 buffer_load_dwordx4 v[196:199],v2,s[32:35],s11 offen offset:1024 sc1
 buffer_load_dwordx4 v[208:211],v2,s[32:35],s57 offen sc1
 buffer_load_dwordx4 v[212:215],v2,s[32:35],s57 offen offset:1024 sc1
 buffer_load_dwordx4 v[224:227],v2,s[32:35],s77 offen sc1
 s_waitcnt vmcnt(11)
 v_bitop3_b32 v38,v144,v148,1 bitop3:0xa8
 v_cmp_ne_u32 vcc,0,v38
 s_cbranch_vccz Lok_522
 s_sub_u32 s55,s55,1
 s_cbranch_scc0 Lfix_520
 s_mov_b32 s55,0
Lok_522:
 s_branch Lret_521
Lfix_523:
 buffer_load_dwordx4 v[160:163],v2,s[32:35],s9 offen sc1
 buffer_load_dwordx4 v[164:167],v2,s[32:35],s9 offen offset:1024 sc1
 s_add_u32 s84,s97,32768
 buffer_store_dword v38,off,s[32:35],s84
 s_add_u32 s84,s97,32768
 buffer_store_dword v38,off,s[32:35],s84
 buffer_load_dwordx4 v[176:179],v2,s[32:35],s10 offen sc1
 buffer_load_dwordx4 v[180:183],v2,s[32:35],s10 offen offset:1024 sc1
 buffer_load_dwordx4 v[192:195],v2,s[32:35],s11 offen sc1
 buffer_load_dwordx4 v[196:199],v2,s[32:35],s11 offen offset:1024 sc1
 buffer_load_dwordx4 v[208:211],v2,s[32:35],s57 offen sc1
 buffer_load_dwordx4 v[212:215],v2,s[32:35],s57 offen offset:1024 sc1
 buffer_load_dwordx4 v[224:227],v2,s[32:35],s77 offen sc1
 buffer_load_dwordx4 v[228:231],v2,s[32:35],s77 offen offset:1024 sc1
 buffer_load_dwordx4 v[240:243],v2,s[32:35],s81 offen sc1
 s_waitcnt vmcnt(11)
 v_bitop3_b32 v38,v160,v164,1 bitop3:0xa8
 v_cmp_ne_u32 vcc,0,v38
 s_cbranch_vccz Lok_525
 s_sub_u32 s55,s55,1
 s_cbranch_scc0 Lfix_523
 s_mov_b32 s55,0
Lok_525:
 s_branch Lret_524
Lfix_529:
 s_add_u32 s84,s58,131072
 buffer_load_dwordx4 v[72:75],v13,s[32:35],s84 offen sc1
 buffer_load_dwordx4 v[76:79],v13,s[32:35],s84 offen offset:512 sc1
 s_waitcnt vmcnt(0)
 v_and_b32 v38,v72,v73
 v_bitop3_b32 v38,v74,v75,v38 bitop3:0x80
 v_bitop3_b32 v38,v76,v77,v38 bitop3:0x80
 v_bitop3_b32 v38,v78,v79,v38 bitop3:0x80
 v_and_b32 v38,1,v38
 v_cmp_eq_u32 s[82:83],0,v38
 s_nop 0
 s_cmp_eq_u64 s[82:83],0
 s_cbranch_scc1 Lok_531
 s_sub_u32 s55,s55,1
 s_cbranch_scc0 Lfix_529
 s_mov_b32 s55,0
Lok_531:
 s_branch Lret_530
Lfix_526:
 buffer_load_dwordx4 v[176:179],v2,s[32:35],s10 offen sc1
 buffer_load_dwordx4 v[180:183],v2,s[32:35],s10 offen offset:1024 sc1
 buffer_load_dwordx4 v[192:195],v2,s[32:35],s11 offen sc1
 buffer_load_dwordx4 v[196:199],v2,s[32:35],s11 offen offset:1024 sc1
 buffer_load_dwordx4 v[208:211],v2,s[32:35],s57 offen sc1
 buffer_load_dwordx4 v[212:215],v2,s[32:35],s57 offen offset:1024 sc1
 buffer_load_dwordx4 v[224:227],v2,s[32:35],s77 offen sc1
 buffer_load_dwordx4 v[228:231],v2,s[32:35],s77 offen offset:1024 sc1
 buffer_load_dwordx4 v[240:243],v2,s[32:35],s81 offen sc1
 buffer_load_dwordx4 v[244:247],v2,s[32:35],s81 offen offset:1024 sc1
 buffer_load_dwordx4 a[248:251],v2,s[32:35],s99 offen sc1
 s_waitcnt vmcnt(9)
 v_bitop3_b32 v38,v176,v180,1 bitop3:0xa8
 v_cmp_ne_u32 vcc,0,v38
 s_cbranch_vccz Lok_528
 s_sub_u32 s55,s55,1
 s_cbranch_scc0 Lfix_526
 s_mov_b32 s55,0
Lok_528:
 s_branch Lret_527
Lfix_532:
 buffer_load_dwordx4 v[192:195],v2,s[32:35],s11 offen sc1
 buffer_load_dwordx4 v[196:199],v2,s[32:35],s11 offen offset:1024 sc1
 buffer_load_dwordx4 v[208:211],v2,s[32:35],s57 offen sc1
 buffer_load_dwordx4 v[212:215],v2,s[32:35],s57 offen offset:1024 sc1
 buffer_load_dwordx4 v[224:227],v2,s[32:35],s77 offen sc1
 buffer_load_dwordx4 v[228:231],v2,s[32:35],s77 offen offset:1024 sc1
 buffer_load_dwordx4 v[240:243],v2,s[32:35],s81 offen sc1
 buffer_load_dwordx4 v[244:247],v2,s[32:35],s81 offen offset:1024 sc1
 buffer_load_dwordx4 a[248:251],v2,s[32:35],s99 offen sc1
 buffer_load_dwordx4 a[252:255],v2,s[32:35],s99 offen offset:1024 sc1
 s_add_u32 s84,s97,32768
 buffer_store_dword v38,off,s[32:35],s84
 s_waitcnt vmcnt(9)
 v_bitop3_b32 v38,v192,v196,1 bitop3:0xa8
 v_cmp_ne_u32 vcc,0,v38
 s_cbranch_vccz Lok_534
 s_sub_u32 s55,s55,1
 s_cbranch_scc0 Lfix_532
 s_mov_b32 s55,0
Lok_534:
 s_branch Lret_533
Lfix_535:
 buffer_load_dwordx4 v[208:211],v2,s[32:35],s57 offen sc1
 buffer_load_dwordx4 v[212:215],v2,s[32:35],s57 offen offset:1024 sc1
 buffer_load_dwordx4 v[224:227],v2,s[32:35],s77 offen sc1
 buffer_load_dwordx4 v[228:231],v2,s[32:35],s77 offen offset:1024 sc1
 buffer_load_dwordx4 v[240:243],v2,s[32:35],s81 offen sc1
 buffer_load_dwordx4 v[244:247],v2,s[32:35],s81 offen offset:1024 sc1
 buffer_load_dwordx4 a[248:251],v2,s[32:35],s99 offen sc1
 buffer_load_dwordx4 a[252:255],v2,s[32:35],s99 offen offset:1024 sc1
 s_add_u32 s84,s97,32768
 buffer_store_dword v38,off,s[32:35],s84
 s_add_u32 s84,s97,32768
 buffer_store_dword v38,off,s[32:35],s84
 s_add_u32 s84,s97,32768
 buffer_store_dword v38,off,s[32:35],s84
 s_waitcnt vmcnt(9)
 v_bitop3_b32 v38,v208,v212,1 bitop3:0xa8
 v_cmp_ne_u32 vcc,0,v38
 s_cbranch_vccz Lok_537
 s_sub_u32 s55,s55,1
 s_cbranch_scc0 Lfix_535
 s_mov_b32 s55,0
Lok_537:
 s_branch Lret_536
Lfix_538:
 buffer_load_dwordx4 v[224:227],v2,s[32:35],s77 offen sc1
 buffer_load_dwordx4 v[228:231],v2,s[32:35],s77 offen offset:1024 sc1
 buffer_load_dwordx4 v[240:243],v2,s[32:35],s81 offen sc1
 buffer_load_dwordx4 v[244:247],v2,s[32:35],s81 offen offset:1024 sc1
 buffer_load_dwordx4 a[248:251],v2,s[32:35],s99 offen sc1
 buffer_load_dwordx4 a[252:255],v2,s[32:35],s99 offen offset:1024 sc1
 s_add_u32 s84,s97,32768
 buffer_store_dword v38,off,s[32:35],s84
 s_add_u32 s84,s97,32768
 buffer_store_dword v38,off,s[32:35],s84
 s_add_u32 s84,s97,32768
 buffer_store_dword v38,off,s[32:35],s84
 s_add_u32 s84,s97,32768
 buffer_store_dword v38,off,s[32:35],s84
 s_add_u32 s84,s97,32768
 buffer_store_dword v38,off,s[32:35],s84
 s_waitcnt vmcnt(9)
 v_bitop3_b32 v38,v224,v228,1 bitop3:0xa8
 v_cmp_ne_u32 vcc,0,v38
 s_cbranch_vccz Lok_540
 s_sub_u32 s55,s55,1
 s_cbranch_scc0 Lfix_538
 s_mov_b32 s55,0
Lok_540:
 s_branch Lret_539
Lfix_541:
 buffer_load_dwordx4 v[240:243],v2,s[32:35],s81 offen sc1
 buffer_load_dwordx4 v[244:247],v2,s[32:35],s81 offen offset:1024 sc1
 buffer_load_dwordx4 a[248:251],v2,s[32:35],s99 offen sc1
 buffer_load_dwordx4 a[252:255],v2,s[32:35],s99 offen offset:1024 sc1
 s_add_u32 s84,s97,32768
 buffer_store_dword v38,off,s[32:35],s84
 s_add_u32 s84,s97,32768
 buffer_store_dword v38,off,s[32:35],s84
 s_add_u32 s84,s97,32768
 buffer_store_dword v38,off,s[32:35],s84
 s_add_u32 s84,s97,32768
 buffer_store_dword v38,off,s[32:35],s84
 s_add_u32 s84,s97,32768
 buffer_store_dword v38,off,s[32:35],s84
 s_add_u32 s84,s97,32768
 buffer_store_dword v38,off,s[32:35],s84
 s_add_u32 s84,s97,32768
 buffer_store_dword v38,off,s[32:35],s84
 s_waitcnt vmcnt(9)
 v_bitop3_b32 v38,v240,v244,1 bitop3:0xa8
 v_cmp_ne_u32 vcc,0,v38
 s_cbranch_vccz Lok_543
 s_sub_u32 s55,s55,1
 s_cbranch_scc0 Lfix_541
 s_mov_b32 s55,0
Lok_543:
 s_branch Lret_542
Lfix_544:
 buffer_load_dwordx4 a[248:251],v2,s[32:35],s99 offen sc1
 buffer_load_dwordx4 a[252:255],v2,s[32:35],s99 offen offset:1024 sc1
 s_add_u32 s84,s97,32768
 buffer_store_dword v38,off,s[32:35],s84
 s_add_u32 s84,s97,32768
 buffer_store_dword v38,off,s[32:35],s84
 s_add_u32 s84,s97,32768
 buffer_store_dword v38,off,s[32:35],s84
 s_add_u32 s84,s97,32768
 buffer_store_dword v38,off,s[32:35],s84
 s_add_u32 s84,s97,32768
 buffer_store_dword v38,off,s[32:35],s84
 s_add_u32 s84,s97,32768
 buffer_store_dword v38,off,s[32:35],s84
 s_add_u32 s84,s97,32768
 buffer_store_dword v38,off,s[32:35],s84
 s_add_u32 s84,s97,32768
 buffer_store_dword v38,off,s[32:35],s84
 s_waitcnt vmcnt(8)
 v_accvgpr_read_b32 v38,a248
 v_lshlrev_b32 v38,31,v38
 v_cmp_ne_u32 s[82:83],0,v38
 v_accvgpr_read_b32 v38,a252
 v_lshlrev_b32 v38,31,v38
 v_cmp_ne_u32 vcc,0,v38
 s_nop 1
 s_or_b64 vcc,vcc,s[82:83]
 s_cbranch_vccz Lok_546
 s_sub_u32 s55,s55,1
 s_cbranch_scc0 Lfix_544
 s_mov_b32 s55,0
Lok_546:
 s_branch Lret_545
Lfix_564:
 buffer_load_dwordx4 v[136:139],v2,s[32:35],s36 offen sc1
 buffer_load_dwordx4 v[140:143],v2,s[32:35],s36 offen offset:1024 sc1
 buffer_load_dwordx4 v[152:155],v2,s[32:35],s37 offen sc1
 buffer_load_dwordx4 v[156:159],v2,s[32:35],s37 offen offset:1024 sc1
 buffer_load_dwordx4 v[168:171],v2,s[32:35],s38 offen sc1
 buffer_load_dwordx4 v[172:175],v2,s[32:35],s38 offen offset:1024 sc1
 buffer_load_dwordx4 v[184:187],v2,s[32:35],s39 offen sc1
 s_add_u32 s84,s97,32768
 buffer_store_dword v38,off,s[32:35],s84
 buffer_load_dwordx4 v[188:191],v2,s[32:35],s39 offen offset:1024 sc1
 buffer_load_dwordx4 v[200:203],v2,s[32:35],s40 offen sc1
 buffer_load_dwordx4 v[204:207],v2,s[32:35],s40 offen offset:1024 sc1
 buffer_load_dwordx4 v[216:219],v2,s[32:35],s41 offen sc1
 s_waitcnt vmcnt(10)
 v_bitop3_b32 v38,v136,v140,1 bitop3:0x80
 v_cmp_eq_u32 vcc,0,v38
 s_cbranch_vccz Lok_566
 s_sub_u32 s55,s55,1
 s_cbranch_scc0 Lfix_564
 s_mov_b32 s55,0
Lok_566:
 s_branch Lret_565
Lfix_567:
 buffer_load_dwordx4 v[152:155],v2,s[32:35],s37 offen sc1
 buffer_load_dwordx4 v[156:159],v2,s[32:35],s37 offen offset:1024 sc1
 buffer_load_dwordx4 v[168:171],v2,s[32:35],s38 offen sc1
 buffer_load_dwordx4 v[172:175],v2,s[32:35],s38 offen offset:1024 sc1
 buffer_load_dwordx4 v[184:187],v2,s[32:35],s39 offen sc1
 s_add_u32 s84,s97,32768
 buffer_store_dword v38,off,s[32:35],s84
 buffer_load_dwordx4 v[188:191],v2,s[32:35],s39 offen offset:1024 sc1
 buffer_load_dwordx4 v[200:203],v2,s[32:35],s40 offen sc1
 buffer_load_dwordx4 v[204:207],v2,s[32:35],s40 offen offset:1024 sc1
 buffer_load_dwordx4 v[216:219],v2,s[32:35],s41 offen sc1
 buffer_load_dwordx4 v[220:223],v2,s[32:35],s41 offen offset:1024 sc1
 buffer_load_dwordx4 v[232:235],v2,s[32:35],s42 offen sc1
 s_waitcnt vmcnt(10)
 v_bitop3_b32 v38,v152,v156,1 bitop3:0x80
 v_cmp_eq_u32 vcc,0,v38
 s_cbranch_vccz Lok_569
 s_sub_u32 s55,s55,1
 s_cbranch_scc0 Lfix_567
 s_mov_b32 s55,0
Lok_569:
 s_branch Lret_568
Lfix_570:
 buffer_load_dwordx4 v[168:171],v2,s[32:35],s38 offen sc1
 buffer_load_dwordx4 v[172:175],v2,s[32:35],s38 offen offset:1024 sc1
 buffer_load_dwordx4 v[184:187],v2,s[32:35],s39 offen sc1
 s_add_u32 s84,s97,32768
 buffer_store_dword v38,off,s[32:35],s84
 buffer_load_dwordx4 v[188:191],v2,s[32:35],s39 offen offset:1024 sc1
 buffer_load_dwordx4 v[200:203],v2,s[32:35],s40 offen sc1
 buffer_load_dwordx4 v[204:207],v2,s[32:35],s40 offen offset:1024 sc1
 buffer_load_dwordx4 v[216:219],v2,s[32:35],s41 offen sc1
 buffer_load_dwordx4 v[220:223],v2,s[32:35],s41 offen offset:1024 sc1
 buffer_load_dwordx4 v[232:235],v2,s[32:35],s42 offen sc1
 buffer_load_dwordx4 v[236:239],v2,s[32:35],s42 offen offset:1024 sc1
 buffer_load_dwordx4 v[248:251],v2,s[32:35],s43 offen sc1
 s_waitcnt vmcnt(10)
 v_bitop3_b32 v38,v168,v172,1 bitop3:0x80
 v_cmp_eq_u32 vcc,0,v38
 s_cbranch_vccz Lok_572
 s_sub_u32 s55,s55,1
 s_cbranch_scc0 Lfix_570
 s_mov_b32 s55,0
Lok_572:
 s_branch Lret_571
Lfix_573:
 buffer_load_dwordx4 v[184:187],v2,s[32:35],s39 offen sc1
 buffer_load_dwordx4 v[188:191],v2,s[32:35],s39 offen offset:1024 sc1
 buffer_load_dwordx4 v[200:203],v2,s[32:35],s40 offen sc1
 buffer_load_dwordx4 v[204:207],v2,s[32:35],s40 offen offset:1024 sc1
 buffer_load_dwordx4 v[216:219],v2,s[32:35],s41 offen sc1
 buffer_load_dwordx4 v[220:223],v2,s[32:35],s41 offen offset:1024 sc1
 buffer_load_dwordx4 v[232:235],v2,s[32:35],s42 offen sc1
 buffer_load_dwordx4 v[236:239],v2,s[32:35],s42 offen offset:1024 sc1
 buffer_load_dwordx4 v[248:251],v2,s[32:35],s43 offen sc1
 buffer_load_dwordx4 v[252:255],v2,s[32:35],s43 offen offset:1024 sc1
 buffer_load_dwordx4 v[144:147],v2,s[32:35],s8 offen sc1
 s_waitcnt vmcnt(9)
 v_bitop3_b32 v38,v184,v188,1 bitop3:0x80
 v_cmp_eq_u32 vcc,0,v38
 s_cbranch_vccz Lok_575
 s_sub_u32 s55,s55,1
 s_cbranch_scc0 Lfix_573
 s_mov_b32 s55,0
Lok_575:
 s_branch Lret_574
Lfix_576:
 buffer_load_dwordx4 v[200:203],v2,s[32:35],s40 offen sc1
 buffer_load_dwordx4 v[204:207],v2,s[32:35],s40 offen offset:1024 sc1
 buffer_load_dwordx4 v[216:219],v2,s[32:35],s41 offen sc1
 buffer_load_dwordx4 v[220:223],v2,s[32:35],s41 offen offset:1024 sc1
 buffer_load_dwordx4 v[232:235],v2,s[32:35],s42 offen sc1
 buffer_load_dwordx4 v[236:239],v2,s[32:35],s42 offen offset:1024 sc1
 buffer_load_dwordx4 v[248:251],v2,s[32:35],s43 offen sc1
 buffer_load_dwordx4 v[252:255],v2,s[32:35],s43 offen offset:1024 sc1
 buffer_load_dwordx4 v[144:147],v2,s[32:35],s8 offen sc1
 buffer_load_dwordx4 v[148:151],v2,s[32:35],s8 offen offset:1024 sc1
 buffer_load_dwordx4 v[160:163],v2,s[32:35],s9 offen sc1
 s_waitcnt vmcnt(9)
 v_bitop3_b32 v38,v200,v204,1 bitop3:0x80
 v_cmp_eq_u32 vcc,0,v38
 s_cbranch_vccz Lok_578
 s_sub_u32 s55,s55,1
 s_cbranch_scc0 Lfix_576
 s_mov_b32 s55,0
Lok_578:
 s_branch Lret_577
Lfix_579:
 buffer_load_dwordx4 v[216:219],v2,s[32:35],s41 offen sc1
 buffer_load_dwordx4 v[220:223],v2,s[32:35],s41 offen offset:1024 sc1
 buffer_load_dwordx4 v[232:235],v2,s[32:35],s42 offen sc1
 buffer_load_dwordx4 v[236:239],v2,s[32:35],s42 offen offset:1024 sc1
 buffer_load_dwordx4 v[248:251],v2,s[32:35],s43 offen sc1
 buffer_load_dwordx4 v[252:255],v2,s[32:35],s43 offen offset:1024 sc1
 buffer_load_dwordx4 v[144:147],v2,s[32:35],s8 offen sc1
 buffer_load_dwordx4 v[148:151],v2,s[32:35],s8 offen offset:1024 sc1
 buffer_load_dwordx4 v[160:163],v2,s[32:35],s9 offen sc1
 buffer_load_dwordx4 v[164:167],v2,s[32:35],s9 offen offset:1024 sc1
 s_add_u32 s84,s97,32768
 buffer_store_dword v38,off,s[32:35],s84
 s_add_u32 s84,s97,32768
 buffer_store_dword v38,off,s[32:35],s84
 buffer_load_dwordx4 v[176:179],v2,s[32:35],s10 offen sc1
 s_waitcnt vmcnt(11)
 v_bitop3_b32 v38,v216,v220,1 bitop3:0x80
 v_cmp_eq_u32 vcc,0,v38
 s_cbranch_vccz Lok_581
 s_sub_u32 s55,s55,1
 s_cbranch_scc0 Lfix_579
 s_mov_b32 s55,0
Lok_581:
 s_branch Lret_580
Lfix_582:
 buffer_load_dwordx4 v[232:235],v2,s[32:35],s42 offen sc1
 buffer_load_dwordx4 v[236:239],v2,s[32:35],s42 offen offset:1024 sc1
 buffer_load_dwordx4 v[248:251],v2,s[32:35],s43 offen sc1
 buffer_load_dwordx4 v[252:255],v2,s[32:35],s43 offen offset:1024 sc1
 buffer_load_dwordx4 v[144:147],v2,s[32:35],s8 offen sc1
 buffer_load_dwordx4 v[148:151],v2,s[32:35],s8 offen offset:1024 sc1
 buffer_load_dwordx4 v[160:163],v2,s[32:35],s9 offen sc1
 buffer_load_dwordx4 v[164:167],v2,s[32:35],s9 offen offset:1024 sc1
 s_add_u32 s84,s97,32768
 buffer_store_dword v38,off,s[32:35],s84
 s_add_u32 s84,s97,32768
 buffer_store_dword v38,off,s[32:35],s84
 buffer_load_dwordx4 v[176:179],v2,s[32:35],s10 offen sc1
 buffer_load_dwordx4 v[180:183],v2,s[32:35],s10 offen offset:1024 sc1
 buffer_load_dwordx4 v[192:195],v2,s[32:35],s11 offen sc1
 s_waitcnt vmcnt(11)
 v_bitop3_b32 v38,v232,v236,1 bitop3:0x80
 v_cmp_eq_u32 vcc,0,v38
 s_cbranch_vccz Lok_584
 s_sub_u32 s55,s55,1
 s_cbranch_scc0 Lfix_582
 s_mov_b32 s55,0
Lok_584:
 s_branch Lret_583
Lfix_585:
 buffer_load_dwordx4 v[248:251],v2,s[32:35],s43 offen sc1
 buffer_load_dwordx4 v[252:255],v2,s[32:35],s43 offen offset:1024 sc1
 buffer_load_dwordx4 v[144:147],v2,s[32:35],s8 offen sc1
 buffer_load_dwordx4 v[148:151],v2,s[32:35],s8 offen offset:1024 sc1
 buffer_load_dwordx4 v[160:163],v2,s[32:35],s9 offen sc1
 buffer_load_dwordx4 v[164:167],v2,s[32:35],s9 offen offset:1024 sc1
 s_add_u32 s84,s97,32768
 buffer_store_dword v38,off,s[32:35],s84
 s_add_u32 s84,s97,32768
 buffer_store_dword v38,off,s[32:35],s84
 buffer_load_dwordx4 v[176:179],v2,s[32:35],s10 offen sc1
 buffer_load_dwordx4 v[180:183],v2,s[32:35],s10 offen offset:1024 sc1
 buffer_load_dwordx4 v[192:195],v2,s[32:35],s11 offen sc1
 buffer_load_dwordx4 v[196:199],v2,s[32:35],s11 offen offset:1024 sc1
 buffer_load_dwordx4 v[208:211],v2,s[32:35],s57 offen sc1
 s_waitcnt vmcnt(11)
 v_bitop3_b32 v38,v248,v252,1 bitop3:0x80
 v_cmp_eq_u32 vcc,0,v38
 s_cbranch_vccz Lok_587
 s_sub_u32 s55,s55,1
 s_cbranch_scc0 Lfix_585
 s_mov_b32 s55,0
Lok_587:
 s_branch Lret_586
Lfix_588:
 buffer_load_dwordx4 v[144:147],v2,s[32:35],s8 offen sc1
 buffer_load_dwordx4 v[148:151],v2,s[32:35],s8 offen offset:1024 sc1
 buffer_load_dwordx4 v[160:163],v2,s[32:35],s9 offen sc1
 buffer_load_dwordx4 v[164:167],v2,s[32:35],s9 offen offset:1024 sc1
 s_add_u32 s84,s97,32768
 buffer_store_dword v38,off,s[32:35],s84
 s_add_u32 s84,s97,32768
 buffer_store_dword v38,off,s[32:35],s84
 buffer_load_dwordx4 v[176:179],v2,s[32:35],s10 offen sc1
 buffer_load_dwordx4 v[180:183],v2,s[32:35],s10 offen offset:1024 sc1
 buffer_load_dwordx4 v[192:195],v2,s[32:35],s11 offen sc1
 buffer_load_dwordx4 v[196:199],v2,s[32:35],s11 offen offset:1024 sc1
 buffer_load_dwordx4 v[208:211],v2,s[32:35],s57 offen sc1
 buffer_load_dwordx4 v[212:215],v2,s[32:35],s57 offen offset:1024 sc1
 buffer_load_dwordx4 v[224:227],v2,s[32:35],s77 offen sc1
 s_waitcnt vmcnt(11)
 v_bitop3_b32 v38,v144,v148,1 bitop3:0x80
 v_cmp_eq_u32 vcc,0,v38
 s_cbranch_vccz Lok_590
 s_sub_u32 s55,s55,1
 s_cbranch_scc0 Lfix_588
 s_mov_b32 s55,0
Lok_590:
 s_branch Lret_589
Lfix_591:
 buffer_load_dwordx4 v[160:163],v2,s[32:35],s9 offen sc1
 buffer_load_dwordx4 v[164:167],v2,s[32:35],s9 offen offset:1024 sc1
 s_add_u32 s84,s97,32768
 buffer_store_dword v38,off,s[32:35],s84
 s_add_u32 s84,s97,32768
 buffer_store_dword v38,off,s[32:35],s84
 buffer_load_dwordx4 v[176:179],v2,s[32:35],s10 offen sc1
 buffer_load_dwordx4 v[180:183],v2,s[32:35],s10 offen offset:1024 sc1
 buffer_load_dwordx4 v[192:195],v2,s[32:35],s11 offen sc1
 buffer_load_dwordx4 v[196:199],v2,s[32:35],s11 offen offset:1024 sc1
 buffer_load_dwordx4 v[208:211],v2,s[32:35],s57 offen sc1
 buffer_load_dwordx4 v[212:215],v2,s[32:35],s57 offen offset:1024 sc1
 buffer_load_dwordx4 v[224:227],v2,s[32:35],s77 offen sc1
 buffer_load_dwordx4 v[228:231],v2,s[32:35],s77 offen offset:1024 sc1
 buffer_load_dwordx4 v[240:243],v2,s[32:35],s81 offen sc1
 s_waitcnt vmcnt(11)
 v_bitop3_b32 v38,v160,v164,1 bitop3:0x80
 v_cmp_eq_u32 vcc,0,v38
 s_cbranch_vccz Lok_593
 s_sub_u32 s55,s55,1
 s_cbranch_scc0 Lfix_591
 s_mov_b32 s55,0
Lok_593:
 s_branch Lret_592
Lfix_597:
 s_add_u32 s84,s58,262144
 buffer_load_dwordx4 v[72:75],v13,s[32:35],s84 offen sc1
 buffer_load_dwordx4 v[76:79],v13,s[32:35],s84 offen offset:512 sc1
 s_waitcnt vmcnt(0)
 v_and_b32 v38,v72,v73
 v_bitop3_b32 v38,v74,v75,v38 bitop3:0x80
 v_bitop3_b32 v38,v76,v77,v38 bitop3:0x80
 v_bitop3_b32 v38,v78,v79,v38 bitop3:0x80
 v_and_b32 v38,1,v38
 v_cmp_eq_u32 s[82:83],0,v38
 s_nop 0
 s_cmp_eq_u64 s[82:83],0
 s_cbranch_scc1 Lok_599
 s_sub_u32 s55,s55,1
 s_cbranch_scc0 Lfix_597
 s_mov_b32 s55,0
Lok_599:
 s_branch Lret_598
Lfix_594:
 buffer_load_dwordx4 v[176:179],v2,s[32:35],s10 offen sc1
 buffer_load_dwordx4 v[180:183],v2,s[32:35],s10 offen offset:1024 sc1
 buffer_load_dwordx4 v[192:195],v2,s[32:35],s11 offen sc1
 buffer_load_dwordx4 v[196:199],v2,s[32:35],s11 offen offset:1024 sc1
 buffer_load_dwordx4 v[208:211],v2,s[32:35],s57 offen sc1
 buffer_load_dwordx4 v[212:215],v2,s[32:35],s57 offen offset:1024 sc1
 buffer_load_dwordx4 v[224:227],v2,s[32:35],s77 offen sc1
 buffer_load_dwordx4 v[228:231],v2,s[32:35],s77 offen offset:1024 sc1
 buffer_load_dwordx4 v[240:243],v2,s[32:35],s81 offen sc1
 buffer_load_dwordx4 v[244:247],v2,s[32:35],s81 offen offset:1024 sc1
 buffer_load_dwordx4 a[248:251],v2,s[32:35],s99 offen sc1
 s_waitcnt vmcnt(9)
 v_bitop3_b32 v38,v176,v180,1 bitop3:0x80
 v_cmp_eq_u32 vcc,0,v38
 s_cbranch_vccz Lok_596
 s_sub_u32 s55,s55,1
 s_cbranch_scc0 Lfix_594
 s_mov_b32 s55,0
Lok_596:
 s_branch Lret_595
Lfix_600:
 buffer_load_dwordx4 v[192:195],v2,s[32:35],s11 offen sc1
 buffer_load_dwordx4 v[196:199],v2,s[32:35],s11 offen offset:1024 sc1
 buffer_load_dwordx4 v[208:211],v2,s[32:35],s57 offen sc1
 buffer_load_dwordx4 v[212:215],v2,s[32:35],s57 offen offset:1024 sc1
 buffer_load_dwordx4 v[224:227],v2,s[32:35],s77 offen sc1
 buffer_load_dwordx4 v[228:231],v2,s[32:35],s77 offen offset:1024 sc1
 buffer_load_dwordx4 v[240:243],v2,s[32:35],s81 offen sc1
 buffer_load_dwordx4 v[244:247],v2,s[32:35],s81 offen offset:1024 sc1
 buffer_load_dwordx4 a[248:251],v2,s[32:35],s99 offen sc1
 buffer_load_dwordx4 a[252:255],v2,s[32:35],s99 offen offset:1024 sc1
 s_waitcnt vmcnt(8)
 v_bitop3_b32 v38,v192,v196,1 bitop3:0x80
 v_cmp_eq_u32 vcc,0,v38
 s_cbranch_vccz Lok_602
 s_sub_u32 s55,s55,1
 s_cbranch_scc0 Lfix_600
 s_mov_b32 s55,0
Lok_602:
 s_branch Lret_601
Lfix_603:
 buffer_load_dwordx4 v[208:211],v2,s[32:35],s57 offen sc1
 buffer_load_dwordx4 v[212:215],v2,s[32:35],s57 offen offset:1024 sc1
 buffer_load_dwordx4 v[224:227],v2,s[32:35],s77 offen sc1
 buffer_load_dwordx4 v[228:231],v2,s[32:35],s77 offen offset:1024 sc1
 buffer_load_dwordx4 v[240:243],v2,s[32:35],s81 offen sc1
 buffer_load_dwordx4 v[244:247],v2,s[32:35],s81 offen offset:1024 sc1
 buffer_load_dwordx4 a[248:251],v2,s[32:35],s99 offen sc1
 buffer_load_dwordx4 a[252:255],v2,s[32:35],s99 offen offset:1024 sc1
 s_waitcnt vmcnt(6)
 v_bitop3_b32 v38,v208,v212,1 bitop3:0x80
 v_cmp_eq_u32 vcc,0,v38
 s_cbranch_vccz Lok_605
 s_sub_u32 s55,s55,1
 s_cbranch_scc0 Lfix_603
 s_mov_b32 s55,0
Lok_605:
 s_branch Lret_604
Lfix_606:
 buffer_load_dwordx4 v[224:227],v2,s[32:35],s77 offen sc1
 buffer_load_dwordx4 v[228:231],v2,s[32:35],s77 offen offset:1024 sc1
 buffer_load_dwordx4 v[240:243],v2,s[32:35],s81 offen sc1
 buffer_load_dwordx4 v[244:247],v2,s[32:35],s81 offen offset:1024 sc1
 buffer_load_dwordx4 a[248:251],v2,s[32:35],s99 offen sc1
 buffer_load_dwordx4 a[252:255],v2,s[32:35],s99 offen offset:1024 sc1
 s_waitcnt vmcnt(4)
 v_bitop3_b32 v38,v224,v228,1 bitop3:0x80
 v_cmp_eq_u32 vcc,0,v38
 s_cbranch_vccz Lok_608
 s_sub_u32 s55,s55,1
 s_cbranch_scc0 Lfix_606
 s_mov_b32 s55,0
Lok_608:
 s_branch Lret_607
Lfix_609:
 buffer_load_dwordx4 v[240:243],v2,s[32:35],s81 offen sc1
 buffer_load_dwordx4 v[244:247],v2,s[32:35],s81 offen offset:1024 sc1
 buffer_load_dwordx4 a[248:251],v2,s[32:35],s99 offen sc1
 buffer_load_dwordx4 a[252:255],v2,s[32:35],s99 offen offset:1024 sc1
 s_waitcnt vmcnt(2)
 v_bitop3_b32 v38,v240,v244,1 bitop3:0x80
 v_cmp_eq_u32 vcc,0,v38
 s_cbranch_vccz Lok_611
 s_sub_u32 s55,s55,1
 s_cbranch_scc0 Lfix_609
 s_mov_b32 s55,0
Lok_611:
 s_branch Lret_610
Lfix_612:
 buffer_load_dwordx4 a[248:251],v2,s[32:35],s99 offen sc1
 buffer_load_dwordx4 a[252:255],v2,s[32:35],s99 offen offset:1024 sc1
 s_waitcnt vmcnt(0)
 v_accvgpr_read_b32 v38,a248
 v_lshlrev_b32 v38,31,v38
 v_cmp_eq_u32 s[82:83],0,v38
 v_accvgpr_read_b32 v38,a252
 v_lshlrev_b32 v38,31,v38
 v_cmp_eq_u32 vcc,0,v38
 s_nop 1
 s_or_b64 vcc,vcc,s[82:83]
 s_cbranch_vccz Lok_614
 s_sub_u32 s55,s55,1
 s_cbranch_scc0 Lfix_612
 s_mov_b32 s55,0
Lok_614:
 s_branch Lret_613
Lfix_616:
 s_bfe_u32 s84,s44,0x50000
 s_lshl_b32 s84,s84,12
 buffer_load_dwordx4 v[136:139],v32,s[32:35],s84 offen sc1
 s_bfe_u32 s84,s44,0x50005
 s_lshl_b32 s84,s84,12
 buffer_load_dwordx4 v[140:143],v32,s[32:35],s84 offen sc1
 s_bfe_u32 s84,s44,0x5000a
 s_lshl_b32 s84,s84,12
 buffer_load_dwordx4 v[144:147],v32,s[32:35],s84 offen sc1
 s_bfe_u32 s84,s44,0x5000f
 s_lshl_b32 s84,s84,12
 buffer_load_dwordx4 v[148:151],v32,s[32:35],s84 offen sc1
 s_bfe_u32 s84,s44,0x50014
 s_lshl_b32 s84,s84,12
 buffer_load_dwordx4 v[152:155],v32,s[32:35],s84 offen sc1
 s_bfe_u32 s84,s44,0x50019
 s_lshl_b32 s84,s84,12
 buffer_load_dwordx4 v[156:159],v32,s[32:35],s84 offen sc1
 s_bfe_u32 s84,s45,0x50000
 s_lshl_b32 s84,s84,12
 buffer_load_dwordx4 v[160:163],v32,s[32:35],s84 offen sc1
 s_bfe_u32 s84,s45,0x50005
 s_lshl_b32 s84,s84,12
 buffer_load_dwordx4 v[164:167],v32,s[32:35],s84 offen sc1
 s_bfe_u32 s84,s45,0x5000a
 s_lshl_b32 s84,s84,12
 buffer_load_dwordx4 v[168:171],v32,s[32:35],s84 offen sc1
 s_bfe_u32 s84,s45,0x5000f
 s_lshl_b32 s84,s84,12
 buffer_load_dwordx4 v[172:175],v32,s[32:35],s84 offen sc1
 s_add_u32 s84,s97,32768
 buffer_store_dword v38,off,s[32:35],s84
 s_waitcnt vmcnt(9)
 v_or_b32 v38,v136,v140
 v_cmp_gt_i32 vcc,0,v38
 s_cbranch_vccz Lok_618
 s_sub_u32 s55,s55,1
 s_cbranch_scc0 Lfix_616
 s_mov_b32 s55,0
Lok_618:
 s_branch Lret_617
Lfix_619:
 s_bfe_u32 s84,s44,0x5000a
 s_lshl_b32 s84,s84,12
 buffer_load_dwordx4 v[144:147],v32,s[32:35],s84 offen sc1
 s_bfe_u32 s84,s44,0x5000f
 s_lshl_b32 s84,s84,12
 buffer_load_dwordx4 v[148:151],v32,s[32:35],s84 offen sc1
 s_bfe_u32 s84,s44,0x50014
 s_lshl_b32 s84,s84,12
 buffer_load_dwordx4 v[152:155],v32,s[32:35],s84 offen sc1
 s_bfe_u32 s84,s44,0x50019
 s_lshl_b32 s84,s84,12
 buffer_load_dwordx4 v[156:159],v32,s[32:35],s84 offen sc1
 s_bfe_u32 s84,s45,0x50000
 s_lshl_b32 s84,s84,12
 buffer_load_dwordx4 v[160:163],v32,s[32:35],s84 offen sc1
 s_bfe_u32 s84,s45,0x50005
 s_lshl_b32 s84,s84,12
 buffer_load_dwordx4 v[164:167],v32,s[32:35],s84 offen sc1
 s_bfe_u32 s84,s45,0x5000a
 s_lshl_b32 s84,s84,12
 buffer_load_dwordx4 v[168:171],v32,s[32:35],s84 offen sc1
 s_bfe_u32 s84,s45,0x5000f
 s_lshl_b32 s84,s84,12
 buffer_load_dwordx4 v[172:175],v32,s[32:35],s84 offen sc1
 s_add_u32 s84,s97,32768
 buffer_store_dword v38,off,s[32:35],s84
 s_bfe_u32 s84,s45,0x50014
 s_lshl_b32 s84,s84,12
 buffer_load_dwordx4 v[176:179],v32,s[32:35],s84 offen sc1
 s_bfe_u32 s84,s45,0x50019
 s_lshl_b32 s84,s84,12
 buffer_load_dwordx4 v[180:183],v32,s[32:35],s84 offen sc1
 s_waitcnt vmcnt(9)
 v_or_b32 v38,v144,v148
 v_cmp_gt_i32 vcc,0,v38
 s_cbranch_vccz Lok_621
 s_sub_u32 s55,s55,1
 s_cbranch_scc0 Lfix_619
 s_mov_b32 s55,0
Lok_621:
 s_branch Lret_620
Lfix_622:
 s_bfe_u32 s84,s44,0x50014
 s_lshl_b32 s84,s84,12
 buffer_load_dwordx4 v[152:155],v32,s[32:35],s84 offen sc1
 s_bfe_u32 s84,s44,0x50019
 s_lshl_b32 s84,s84,12
 buffer_load_dwordx4 v[156:159],v32,s[32:35],s84 offen sc1
 s_bfe_u32 s84,s45,0x50000
 s_lshl_b32 s84,s84,12
 buffer_load_dwordx4 v[160:163],v32,s[32:35],s84 offen sc1
 s_bfe_u32 s84,s45,0x50005
 s_lshl_b32 s84,s84,12
 buffer_load_dwordx4 v[164:167],v32,s[32:35],s84 offen sc1
 s_bfe_u32 s84,s45,0x5000a
 s_lshl_b32 s84,s84,12
 buffer_load_dwordx4 v[168:171],v32,s[32:35],s84 offen sc1
 s_bfe_u32 s84,s45,0x5000f
 s_lshl_b32 s84,s84,12
 buffer_load_dwordx4 v[172:175],v32,s[32:35],s84 offen sc1
 s_add_u32 s84,s97,32768
 buffer_store_dword v38,off,s[32:35],s84
 s_bfe_u32 s84,s45,0x50014
 s_lshl_b32 s84,s84,12
 buffer_load_dwordx4 v[176:179],v32,s[32:35],s84 offen sc1
 s_bfe_u32 s84,s45,0x50019
 s_lshl_b32 s84,s84,12
 buffer_load_dwordx4 v[180:183],v32,s[32:35],s84 offen sc1
 s_bfe_u32 s84,s46,0x50000
 s_lshl_b32 s84,s84,12
 buffer_load_dwordx4 v[184:187],v32,s[32:35],s84 offen sc1
 s_bfe_u32 s84,s46,0x50005
 s_lshl_b32 s84,s84,12
 buffer_load_dwordx4 v[188:191],v32,s[32:35],s84 offen sc1
 s_waitcnt vmcnt(9)
 v_or_b32 v38,v152,v156
 v_cmp_gt_i32 vcc,0,v38
 s_cbranch_vccz Lok_624
 s_sub_u32 s55,s55,1
 s_cbranch_scc0 Lfix_622
 s_mov_b32 s55,0
Lok_624:
 s_branch Lret_623
Lfix_625:
 s_bfe_u32 s84,s45,0x50000
 s_lshl_b32 s84,s84,12
 buffer_load_dwordx4 v[160:163],v32,s[32:35],s84 offen sc1
 s_bfe_u32 s84,s45,0x50005
 s_lshl_b32 s84,s84,12
 buffer_load_dwordx4 v[164:167],v32,s[32:35],s84 offen sc1
 s_bfe_u32 s84,s45,0x5000a
 s_lshl_b32 s84,s84,12
 buffer_load_dwordx4 v[168:171],v32,s[32:35],s84 offen sc1
 s_bfe_u32 s84,s45,0x5000f
 s_lshl_b32 s84,s84,12
 buffer_load_dwordx4 v[172:175],v32,s[32:35],s84 offen sc1
 s_add_u32 s84,s97,32768
 buffer_store_dword v38,off,s[32:35],s84
 s_bfe_u32 s84,s45,0x50014
 s_lshl_b32 s84,s84,12
 buffer_load_dwordx4 v[176:179],v32,s[32:35],s84 offen sc1
 s_bfe_u32 s84,s45,0x50019
 s_lshl_b32 s84,s84,12
 buffer_load_dwordx4 v[180:183],v32,s[32:35],s84 offen sc1
 s_bfe_u32 s84,s46,0x50000
 s_lshl_b32 s84,s84,12
 buffer_load_dwordx4 v[184:187],v32,s[32:35],s84 offen sc1
 s_bfe_u32 s84,s46,0x50005
 s_lshl_b32 s84,s84,12
 buffer_load_dwordx4 v[188:191],v32,s[32:35],s84 offen sc1
 s_bfe_u32 s84,s46,0x5000a
 s_lshl_b32 s84,s84,12
 buffer_load_dwordx4 v[192:195],v32,s[32:35],s84 offen sc1
 s_bfe_u32 s84,s46,0x5000f
 s_lshl_b32 s84,s84,12
 buffer_load_dwordx4 v[196:199],v32,s[32:35],s84 offen sc1
 s_waitcnt vmcnt(9)
 v_or_b32 v38,v160,v164
 v_cmp_gt_i32 vcc,0,v38
 s_cbranch_vccz Lok_627
 s_sub_u32 s55,s55,1
 s_cbranch_scc0 Lfix_625
 s_mov_b32 s55,0
Lok_627:
 s_branch Lret_626
Lfix_628:
 s_bfe_u32 s84,s45,0x5000a
 s_lshl_b32 s84,s84,12
 buffer_load_dwordx4 v[168:171],v32,s[32:35],s84 offen sc1
 s_bfe_u32 s84,s45,0x5000f
 s_lshl_b32 s84,s84,12
 buffer_load_dwordx4 v[172:175],v32,s[32:35],s84 offen sc1
 s_add_u32 s84,s97,32768
 buffer_store_dword v38,off,s[32:35],s84
 s_bfe_u32 s84,s45,0x50014
 s_lshl_b32 s84,s84,12
 buffer_load_dwordx4 v[176:179],v32,s[32:35],s84 offen sc1
 s_bfe_u32 s84,s45,0x50019
 s_lshl_b32 s84,s84,12
 buffer_load_dwordx4 v[180:183],v32,s[32:35],s84 offen sc1
 s_bfe_u32 s84,s46,0x50000
 s_lshl_b32 s84,s84,12
 buffer_load_dwordx4 v[184:187],v32,s[32:35],s84 offen sc1
 s_bfe_u32 s84,s46,0x50005
 s_lshl_b32 s84,s84,12
 buffer_load_dwordx4 v[188:191],v32,s[32:35],s84 offen sc1
 s_bfe_u32 s84,s46,0x5000a
 s_lshl_b32 s84,s84,12
 buffer_load_dwordx4 v[192:195],v32,s[32:35],s84 offen sc1
 s_bfe_u32 s84,s46,0x5000f
 s_lshl_b32 s84,s84,12
 buffer_load_dwordx4 v[196:199],v32,s[32:35],s84 offen sc1
 s_bfe_u32 s84,s46,0x50014
 s_lshl_b32 s84,s84,12
 buffer_load_dwordx4 v[200:203],v32,s[32:35],s84 offen sc1
 s_bfe_u32 s84,s46,0x50019
 s_lshl_b32 s84,s84,12
 buffer_load_dwordx4 v[204:207],v32,s[32:35],s84 offen sc1
 s_waitcnt vmcnt(9)
 v_or_b32 v38,v168,v172
 v_cmp_gt_i32 vcc,0,v38
 s_cbranch_vccz Lok_630
 s_sub_u32 s55,s55,1
 s_cbranch_scc0 Lfix_628
 s_mov_b32 s55,0
Lok_630:
 s_branch Lret_629
Lfix_631:
 s_add_u32 s84,s69,262144
 buffer_load_dwordx4 v[24:27],v14,s[32:35],s84 offen sc1
 s_waitcnt vmcnt(0)
 v_and_b32 v30,v24,v25
 v_bitop3_b32 v30,v26,v27,v30 bitop3:0x80
 v_and_b32 v30,1,v30
 v_cmp_eq_u32 s[82:83],0,v30
 s_nop 0
 s_cmp_eq_u64 s[82:83],0
 s_cbranch_scc1 Lok_633
 s_sub_u32 s55,s55,1
 s_cbranch_scc0 Lfix_631
 s_mov_b32 s55,0
Lok_633:
 s_branch Lret_632
Lfix_634:
 s_bfe_u32 s84,s45,0x50014
 s_lshl_b32 s84,s84,12
 buffer_load_dwordx4 v[176:179],v32,s[32:35],s84 offen sc1
 s_bfe_u32 s84,s45,0x50019
 s_lshl_b32 s84,s84,12
 buffer_load_dwordx4 v[180:183],v32,s[32:35],s84 offen sc1
 s_bfe_u32 s84,s46,0x50000
 s_lshl_b32 s84,s84,12
 buffer_load_dwordx4 v[184:187],v32,s[32:35],s84 offen sc1
 s_bfe_u32 s84,s46,0x50005
 s_lshl_b32 s84,s84,12
 buffer_load_dwordx4 v[188:191],v32,s[32:35],s84 offen sc1
 s_bfe_u32 s84,s46,0x5000a
 s_lshl_b32 s84,s84,12
 buffer_load_dwordx4 v[192:195],v32,s[32:35],s84 offen sc1
 s_bfe_u32 s84,s46,0x5000f
 s_lshl_b32 s84,s84,12
 buffer_load_dwordx4 v[196:199],v32,s[32:35],s84 offen sc1
 s_bfe_u32 s84,s46,0x50014
 s_lshl_b32 s84,s84,12
 buffer_load_dwordx4 v[200:203],v32,s[32:35],s84 offen sc1
 s_bfe_u32 s84,s46,0x50019
 s_lshl_b32 s84,s84,12
 buffer_load_dwordx4 v[204:207],v32,s[32:35],s84 offen sc1
 s_bfe_u32 s84,s47,0x50000
 s_lshl_b32 s84,s84,12
 buffer_load_dwordx4 v[208:211],v32,s[32:35],s84 offen sc1
 s_bfe_u32 s84,s47,0x50005
 s_lshl_b32 s84,s84,12
 buffer_load_dwordx4 v[212:215],v32,s[32:35],s84 offen sc1
 s_waitcnt vmcnt(8)
 v_or_b32 v38,v176,v180
 v_cmp_gt_i32 vcc,0,v38
 s_cbranch_vccz Lok_636
 s_sub_u32 s55,s55,1
 s_cbranch_scc0 Lfix_634
 s_mov_b32 s55,0
Lok_636:
 s_branch Lret_635
Lfix_637:
 s_bfe_u32 s84,s46,0x50000
 s_lshl_b32 s84,s84,12
 buffer_load_dwordx4 v[184:187],v32,s[32:35],s84 offen sc1
 s_bfe_u32 s84,s46,0x50005
 s_lshl_b32 s84,s84,12
 buffer_load_dwordx4 v[188:191],v32,s[32:35],s84 offen sc1
 s_bfe_u32 s84,s46,0x5000a
 s_lshl_b32 s84,s84,12
 buffer_load_dwordx4 v[192:195],v32,s[32:35],s84 offen sc1
 s_bfe_u32 s84,s46,0x5000f
 s_lshl_b32 s84,s84,12
 buffer_load_dwordx4 v[196:199],v32,s[32:35],s84 offen sc1
 s_bfe_u32 s84,s46,0x50014
 s_lshl_b32 s84,s84,12
 buffer_load_dwordx4 v[200:203],v32,s[32:35],s84 offen sc1
 s_bfe_u32 s84,s46,0x50019
 s_lshl_b32 s84,s84,12
 buffer_load_dwordx4 v[204:207],v32,s[32:35],s84 offen sc1
 s_bfe_u32 s84,s47,0x50000
 s_lshl_b32 s84,s84,12
 buffer_load_dwordx4 v[208:211],v32,s[32:35],s84 offen sc1
 s_bfe_u32 s84,s47,0x50005
 s_lshl_b32 s84,s84,12
 buffer_load_dwordx4 v[212:215],v32,s[32:35],s84 offen sc1
 s_bfe_u32 s84,s47,0x5000a
 s_lshl_b32 s84,s84,12
 buffer_load_dwordx4 v[216:219],v32,s[32:35],s84 offen sc1
 buffer_load_dwordx4 v[220:223],v32,s[32:35],s70 offen sc1
 s_waitcnt vmcnt(8)
 v_or_b32 v38,v184,v188
 v_cmp_gt_i32 vcc,0,v38
 s_cbranch_vccz Lok_639
 s_sub_u32 s55,s55,1
 s_cbranch_scc0 Lfix_637
 s_mov_b32 s55,0
Lok_639:
 s_branch Lret_638
Lfix_640:
 s_bfe_u32 s84,s46,0x5000a
 s_lshl_b32 s84,s84,12
 buffer_load_dwordx4 v[192:195],v32,s[32:35],s84 offen sc1
 s_bfe_u32 s84,s46,0x5000f
 s_lshl_b32 s84,s84,12
 buffer_load_dwordx4 v[196:199],v32,s[32:35],s84 offen sc1
 s_bfe_u32 s84,s46,0x50014
 s_lshl_b32 s84,s84,12
 buffer_load_dwordx4 v[200:203],v32,s[32:35],s84 offen sc1
 s_bfe_u32 s84,s46,0x50019
 s_lshl_b32 s84,s84,12
 buffer_load_dwordx4 v[204:207],v32,s[32:35],s84 offen sc1
 s_bfe_u32 s84,s47,0x50000
 s_lshl_b32 s84,s84,12
 buffer_load_dwordx4 v[208:211],v32,s[32:35],s84 offen sc1
 s_bfe_u32 s84,s47,0x50005
 s_lshl_b32 s84,s84,12
 buffer_load_dwordx4 v[212:215],v32,s[32:35],s84 offen sc1
 s_bfe_u32 s84,s47,0x5000a
 s_lshl_b32 s84,s84,12
 buffer_load_dwordx4 v[216:219],v32,s[32:35],s84 offen sc1
 buffer_load_dwordx4 v[220:223],v32,s[32:35],s70 offen sc1
 s_bfe_u32 s84,s44,0x50000
 s_lshl_b32 s84,s84,12
 buffer_load_dwordx4 v[224:227],v33,s[32:35],s84 offen sc1
 s_bfe_u32 s84,s44,0x50005
 s_lshl_b32 s84,s84,12
 buffer_load_dwordx4 v[228:231],v33,s[32:35],s84 offen sc1
 s_waitcnt vmcnt(8)
 v_or_b32 v38,v192,v196
 v_cmp_gt_i32 vcc,0,v38
 s_cbranch_vccz Lok_642
 s_sub_u32 s55,s55,1
 s_cbranch_scc0 Lfix_640
 s_mov_b32 s55,0
Lok_642:
 s_branch Lret_641
Lfix_643:
 s_bfe_u32 s84,s46,0x50014
 s_lshl_b32 s84,s84,12
 buffer_load_dwordx4 v[200:203],v32,s[32:35],s84 offen sc1
 s_bfe_u32 s84,s46,0x50019
 s_lshl_b32 s84,s84,12
 buffer_load_dwordx4 v[204:207],v32,s[32:35],s84 offen sc1
 s_bfe_u32 s84,s47,0x50000
 s_lshl_b32 s84,s84,12
 buffer_load_dwordx4 v[208:211],v32,s[32:35],s84 offen sc1
 s_bfe_u32 s84,s47,0x50005
 s_lshl_b32 s84,s84,12
 buffer_load_dwordx4 v[212:215],v32,s[32:35],s84 offen sc1
 s_bfe_u32 s84,s47,0x5000a
 s_lshl_b32 s84,s84,12
 buffer_load_dwordx4 v[216:219],v32,s[32:35],s84 offen sc1
 buffer_load_dwordx4 v[220:223],v32,s[32:35],s70 offen sc1
 s_bfe_u32 s84,s44,0x50000
 s_lshl_b32 s84,s84,12
 buffer_load_dwordx4 v[224:227],v33,s[32:35],s84 offen sc1
 s_bfe_u32 s84,s44,0x50005
 s_lshl_b32 s84,s84,12
 buffer_load_dwordx4 v[228:231],v33,s[32:35],s84 offen sc1
 s_bfe_u32 s84,s44,0x5000a
 s_lshl_b32 s84,s84,12
 buffer_load_dwordx4 v[136:139],v33,s[32:35],s84 offen sc1
 s_bfe_u32 s84,s44,0x5000f
 s_lshl_b32 s84,s84,12
 buffer_load_dwordx4 v[140:143],v33,s[32:35],s84 offen sc1
 s_waitcnt vmcnt(8)
 v_or_b32 v38,v200,v204
 v_cmp_gt_i32 vcc,0,v38
 s_cbranch_vccz Lok_645
 s_sub_u32 s55,s55,1
 s_cbranch_scc0 Lfix_643
 s_mov_b32 s55,0
Lok_645:
 s_branch Lret_644
Lfix_646:
 s_bfe_u32 s84,s47,0x50000
 s_lshl_b32 s84,s84,12
 buffer_load_dwordx4 v[208:211],v32,s[32:35],s84 offen sc1
 s_bfe_u32 s84,s47,0x50005
 s_lshl_b32 s84,s84,12
 buffer_load_dwordx4 v[212:215],v32,s[32:35],s84 offen sc1
 s_bfe_u32 s84,s47,0x5000a
 s_lshl_b32 s84,s84,12
 buffer_load_dwordx4 v[216:219],v32,s[32:35],s84 offen sc1
 buffer_load_dwordx4 v[220:223],v32,s[32:35],s70 offen sc1
 s_bfe_u32 s84,s44,0x50000
 s_lshl_b32 s84,s84,12
 buffer_load_dwordx4 v[224:227],v33,s[32:35],s84 offen sc1
 s_bfe_u32 s84,s44,0x50005
 s_lshl_b32 s84,s84,12
 buffer_load_dwordx4 v[228:231],v33,s[32:35],s84 offen sc1
 s_bfe_u32 s84,s44,0x5000a
 s_lshl_b32 s84,s84,12
 buffer_load_dwordx4 v[136:139],v33,s[32:35],s84 offen sc1
 s_bfe_u32 s84,s44,0x5000f
 s_lshl_b32 s84,s84,12
 buffer_load_dwordx4 v[140:143],v33,s[32:35],s84 offen sc1
 s_bfe_u32 s84,s44,0x50014
 s_lshl_b32 s84,s84,12
 buffer_load_dwordx4 v[144:147],v33,s[32:35],s84 offen sc1
 s_bfe_u32 s84,s44,0x50019
 s_lshl_b32 s84,s84,12
 buffer_load_dwordx4 v[148:151],v33,s[32:35],s84 offen sc1
 s_waitcnt vmcnt(8)
 v_or_b32 v38,v208,v212
 v_cmp_gt_i32 vcc,0,v38
 s_cbranch_vccz Lok_648
 s_sub_u32 s55,s55,1
 s_cbranch_scc0 Lfix_646
 s_mov_b32 s55,0
Lok_648:
 s_branch Lret_647
Lfix_649:
 s_bfe_u32 s84,s47,0x5000a
 s_lshl_b32 s84,s84,12
 buffer_load_dwordx4 v[216:219],v32,s[32:35],s84 offen sc1
 buffer_load_dwordx4 v[220:223],v32,s[32:35],s70 offen sc1
 s_bfe_u32 s84,s44,0x50000
 s_lshl_b32 s84,s84,12
 buffer_load_dwordx4 v[224:227],v33,s[32:35],s84 offen sc1
 s_bfe_u32 s84,s44,0x50005
 s_lshl_b32 s84,s84,12
 buffer_load_dwordx4 v[228:231],v33,s[32:35],s84 offen sc1
 s_bfe_u32 s84,s44,0x5000a
 s_lshl_b32 s84,s84,12
 buffer_load_dwordx4 v[136:139],v33,s[32:35],s84 offen sc1
 s_bfe_u32 s84,s44,0x5000f
 s_lshl_b32 s84,s84,12
 buffer_load_dwordx4 v[140:143],v33,s[32:35],s84 offen sc1
 s_bfe_u32 s84,s44,0x50014
 s_lshl_b32 s84,s84,12
 buffer_load_dwordx4 v[144:147],v33,s[32:35],s84 offen sc1
 s_bfe_u32 s84,s44,0x50019
 s_lshl_b32 s84,s84,12
 buffer_load_dwordx4 v[148:151],v33,s[32:35],s84 offen sc1
 s_bfe_u32 s84,s45,0x50000
 s_lshl_b32 s84,s84,12
 buffer_load_dwordx4 v[152:155],v33,s[32:35],s84 offen sc1
 s_bfe_u32 s84,s45,0x50005
 s_lshl_b32 s84,s84,12
 buffer_load_dwordx4 v[156:159],v33,s[32:35],s84 offen sc1
 s_waitcnt vmcnt(8)
 v_or_b32 v38,v216,v220
 v_cmp_gt_i32 vcc,0,v38
 s_cbranch_vccz Lok_651
 s_sub_u32 s55,s55,1
 s_cbranch_scc0 Lfix_649
 s_mov_b32 s55,0
Lok_651:
 s_branch Lret_650
Lfix_652:
 s_bfe_u32 s84,s44,0x50000
 s_lshl_b32 s84,s84,12
 buffer_load_dwordx4 v[224:227],v33,s[32:35],s84 offen sc1
 s_bfe_u32 s84,s44,0x50005
 s_lshl_b32 s84,s84,12
 buffer_load_dwordx4 v[228:231],v33,s[32:35],s84 offen sc1
 s_bfe_u32 s84,s44,0x5000a
 s_lshl_b32 s84,s84,12
 buffer_load_dwordx4 v[136:139],v33,s[32:35],s84 offen sc1
 s_bfe_u32 s84,s44,0x5000f
 s_lshl_b32 s84,s84,12
 buffer_load_dwordx4 v[140:143],v33,s[32:35],s84 offen sc1
 s_bfe_u32 s84,s44,0x50014
 s_lshl_b32 s84,s84,12
 buffer_load_dwordx4 v[144:147],v33,s[32:35],s84 offen sc1
 s_bfe_u32 s84,s44,0x50019
 s_lshl_b32 s84,s84,12
 buffer_load_dwordx4 v[148:151],v33,s[32:35],s84 offen sc1
 s_bfe_u32 s84,s45,0x50000
 s_lshl_b32 s84,s84,12
 buffer_load_dwordx4 v[152:155],v33,s[32:35],s84 offen sc1
 s_bfe_u32 s84,s45,0x50005
 s_lshl_b32 s84,s84,12
 buffer_load_dwordx4 v[156:159],v33,s[32:35],s84 offen sc1
 s_bfe_u32 s84,s45,0x5000a
 s_lshl_b32 s84,s84,12
 buffer_load_dwordx4 v[160:163],v33,s[32:35],s84 offen sc1
 s_bfe_u32 s84,s45,0x5000f
 s_lshl_b32 s84,s84,12
 buffer_load_dwordx4 v[164:167],v33,s[32:35],s84 offen sc1
 s_waitcnt vmcnt(8)
 v_or_b32 v38,v224,v228
 v_cmp_gt_i32 vcc,0,v38
 s_cbranch_vccz Lok_654
 s_sub_u32 s55,s55,1
 s_cbranch_scc0 Lfix_652
 s_mov_b32 s55,0
Lok_654:
 s_branch Lret_653
Lfix_655:
 s_bfe_u32 s84,s44,0x5000a
 s_lshl_b32 s84,s84,12
 buffer_load_dwordx4 v[136:139],v33,s[32:35],s84 offen sc1
 s_bfe_u32 s84,s44,0x5000f
 s_lshl_b32 s84,s84,12
 buffer_load_dwordx4 v[140:143],v33,s[32:35],s84 offen sc1
 s_bfe_u32 s84,s44,0x50014
 s_lshl_b32 s84,s84,12
 buffer_load_dwordx4 v[144:147],v33,s[32:35],s84 offen sc1
 s_bfe_u32 s84,s44,0x50019
 s_lshl_b32 s84,s84,12
 buffer_load_dwordx4 v[148:151],v33,s[32:35],s84 offen sc1
 s_bfe_u32 s84,s45,0x50000
 s_lshl_b32 s84,s84,12
 buffer_load_dwordx4 v[152:155],v33,s[32:35],s84 offen sc1
 s_bfe_u32 s84,s45,0x50005
 s_lshl_b32 s84,s84,12
 buffer_load_dwordx4 v[156:159],v33,s[32:35],s84 offen sc1
 s_bfe_u32 s84,s45,0x5000a
 s_lshl_b32 s84,s84,12
 buffer_load_dwordx4 v[160:163],v33,s[32:35],s84 offen sc1
 s_bfe_u32 s84,s45,0x5000f
 s_lshl_b32 s84,s84,12
 buffer_load_dwordx4 v[164:167],v33,s[32:35],s84 offen sc1
 s_bfe_u32 s84,s45,0x50014
 s_lshl_b32 s84,s84,12
 buffer_load_dwordx4 v[168:171],v33,s[32:35],s84 offen sc1
 s_bfe_u32 s84,s45,0x50019
 s_lshl_b32 s84,s84,12
 buffer_load_dwordx4 v[172:175],v33,s[32:35],s84 offen sc1
 s_waitcnt vmcnt(8)
 v_or_b32 v38,v136,v140
 v_cmp_gt_i32 vcc,0,v38
 s_cbranch_vccz Lok_657
 s_sub_u32 s55,s55,1
 s_cbranch_scc0 Lfix_655
 s_mov_b32 s55,0
Lok_657:
 s_branch Lret_656
Lfix_658:
 s_bfe_u32 s84,s44,0x50014
 s_lshl_b32 s84,s84,12
 buffer_load_dwordx4 v[144:147],v33,s[32:35],s84 offen sc1
 s_bfe_u32 s84,s44,0x50019
 s_lshl_b32 s84,s84,12
 buffer_load_dwordx4 v[148:151],v33,s[32:35],s84 offen sc1
 s_bfe_u32 s84,s45,0x50000
 s_lshl_b32 s84,s84,12
 buffer_load_dwordx4 v[152:155],v33,s[32:35],s84 offen sc1
 s_bfe_u32 s84,s45,0x50005
 s_lshl_b32 s84,s84,12
 buffer_load_dwordx4 v[156:159],v33,s[32:35],s84 offen sc1
 s_bfe_u32 s84,s45,0x5000a
 s_lshl_b32 s84,s84,12
 buffer_load_dwordx4 v[160:163],v33,s[32:35],s84 offen sc1
 s_bfe_u32 s84,s45,0x5000f
 s_lshl_b32 s84,s84,12
 buffer_load_dwordx4 v[164:167],v33,s[32:35],s84 offen sc1
 s_bfe_u32 s84,s45,0x50014
 s_lshl_b32 s84,s84,12
 buffer_load_dwordx4 v[168:171],v33,s[32:35],s84 offen sc1
 s_bfe_u32 s84,s45,0x50019
 s_lshl_b32 s84,s84,12
 buffer_load_dwordx4 v[172:175],v33,s[32:35],s84 offen sc1
 s_bfe_u32 s84,s46,0x50000
 s_lshl_b32 s84,s84,12
 buffer_load_dwordx4 v[176:179],v33,s[32:35],s84 offen sc1
 s_bfe_u32 s84,s46,0x50005
 s_lshl_b32 s84,s84,12
 buffer_load_dwordx4 v[180:183],v33,s[32:35],s84 offen sc1
 s_waitcnt vmcnt(8)
 v_or_b32 v38,v144,v148
 v_cmp_gt_i32 vcc,0,v38
 s_cbranch_vccz Lok_660
 s_sub_u32 s55,s55,1
 s_cbranch_scc0 Lfix_658
 s_mov_b32 s55,0
Lok_660:
 s_branch Lret_659
Lfix_661:
 s_bfe_u32 s84,s45,0x50000
 s_lshl_b32 s84,s84,12
 buffer_load_dwordx4 v[152:155],v33,s[32:35],s84 offen sc1
 s_bfe_u32 s84,s45,0x50005
 s_lshl_b32 s84,s84,12
 buffer_load_dwordx4 v[156:159],v33,s[32:35],s84 offen sc1
 s_bfe_u32 s84,s45,0x5000a
 s_lshl_b32 s84,s84,12
 buffer_load_dwordx4 v[160:163],v33,s[32:35],s84 offen sc1
 s_bfe_u32 s84,s45,0x5000f
 s_lshl_b32 s84,s84,12
 buffer_load_dwordx4 v[164:167],v33,s[32:35],s84 offen sc1
 s_bfe_u32 s84,s45,0x50014
 s_lshl_b32 s84,s84,12
 buffer_load_dwordx4 v[168:171],v33,s[32:35],s84 offen sc1
 s_bfe_u32 s84,s45,0x50019
 s_lshl_b32 s84,s84,12
 buffer_load_dwordx4 v[172:175],v33,s[32:35],s84 offen sc1
 s_bfe_u32 s84,s46,0x50000
 s_lshl_b32 s84,s84,12
 buffer_load_dwordx4 v[176:179],v33,s[32:35],s84 offen sc1
 s_bfe_u32 s84,s46,0x50005
 s_lshl_b32 s84,s84,12
 buffer_load_dwordx4 v[180:183],v33,s[32:35],s84 offen sc1
 s_bfe_u32 s84,s46,0x5000a
 s_lshl_b32 s84,s84,12
 buffer_load_dwordx4 v[184:187],v33,s[32:35],s84 offen sc1
 s_bfe_u32 s84,s46,0x5000f
 s_lshl_b32 s84,s84,12
 buffer_load_dwordx4 v[188:191],v33,s[32:35],s84 offen sc1
 s_waitcnt vmcnt(8)
 v_or_b32 v38,v152,v156
 v_cmp_gt_i32 vcc,0,v38
 s_cbranch_vccz Lok_663
 s_sub_u32 s55,s55,1
 s_cbranch_scc0 Lfix_661
 s_mov_b32 s55,0
Lok_663:
 s_branch Lret_662
Lfix_664:
 s_bfe_u32 s84,s45,0x5000a
 s_lshl_b32 s84,s84,12
 buffer_load_dwordx4 v[160:163],v33,s[32:35],s84 offen sc1
 s_bfe_u32 s84,s45,0x5000f
 s_lshl_b32 s84,s84,12
 buffer_load_dwordx4 v[164:167],v33,s[32:35],s84 offen sc1
 s_bfe_u32 s84,s45,0x50014
 s_lshl_b32 s84,s84,12
 buffer_load_dwordx4 v[168:171],v33,s[32:35],s84 offen sc1
 s_bfe_u32 s84,s45,0x50019
 s_lshl_b32 s84,s84,12
 buffer_load_dwordx4 v[172:175],v33,s[32:35],s84 offen sc1
 s_bfe_u32 s84,s46,0x50000
 s_lshl_b32 s84,s84,12
 buffer_load_dwordx4 v[176:179],v33,s[32:35],s84 offen sc1
 s_bfe_u32 s84,s46,0x50005
 s_lshl_b32 s84,s84,12
 buffer_load_dwordx4 v[180:183],v33,s[32:35],s84 offen sc1
 s_bfe_u32 s84,s46,0x5000a
 s_lshl_b32 s84,s84,12
 buffer_load_dwordx4 v[184:187],v33,s[32:35],s84 offen sc1
 s_bfe_u32 s84,s46,0x5000f
 s_lshl_b32 s84,s84,12
 buffer_load_dwordx4 v[188:191],v33,s[32:35],s84 offen sc1
 s_bfe_u32 s84,s46,0x50014
 s_lshl_b32 s84,s84,12
 buffer_load_dwordx4 v[192:195],v33,s[32:35],s84 offen sc1
 s_bfe_u32 s84,s46,0x50019
 s_lshl_b32 s84,s84,12
 buffer_load_dwordx4 v[196:199],v33,s[32:35],s84 offen sc1
 s_waitcnt vmcnt(8)
 v_or_b32 v38,v160,v164
 v_cmp_gt_i32 vcc,0,v38
 s_cbranch_vccz Lok_666
 s_sub_u32 s55,s55,1
 s_cbranch_scc0 Lfix_664
 s_mov_b32 s55,0
Lok_666:
 s_branch Lret_665
Lfix_667:
 s_bfe_u32 s84,s45,0x50014
 s_lshl_b32 s84,s84,12
 buffer_load_dwordx4 v[168:171],v33,s[32:35],s84 offen sc1
 s_bfe_u32 s84,s45,0x50019
 s_lshl_b32 s84,s84,12
 buffer_load_dwordx4 v[172:175],v33,s[32:35],s84 offen sc1
 s_bfe_u32 s84,s46,0x50000
 s_lshl_b32 s84,s84,12
 buffer_load_dwordx4 v[176:179],v33,s[32:35],s84 offen sc1
 s_bfe_u32 s84,s46,0x50005
 s_lshl_b32 s84,s84,12
 buffer_load_dwordx4 v[180:183],v33,s[32:35],s84 offen sc1
 s_bfe_u32 s84,s46,0x5000a
 s_lshl_b32 s84,s84,12
 buffer_load_dwordx4 v[184:187],v33,s[32:35],s84 offen sc1
 s_bfe_u32 s84,s46,0x5000f
 s_lshl_b32 s84,s84,12
 buffer_load_dwordx4 v[188:191],v33,s[32:35],s84 offen sc1
 s_bfe_u32 s84,s46,0x50014
 s_lshl_b32 s84,s84,12
 buffer_load_dwordx4 v[192:195],v33,s[32:35],s84 offen sc1
 s_bfe_u32 s84,s46,0x50019
 s_lshl_b32 s84,s84,12
 buffer_load_dwordx4 v[196:199],v33,s[32:35],s84 offen sc1
 s_bfe_u32 s84,s47,0x50000
 s_lshl_b32 s84,s84,12
 buffer_load_dwordx4 v[200:203],v33,s[32:35],s84 offen sc1
 s_bfe_u32 s84,s47,0x50005
 s_lshl_b32 s84,s84,12
 buffer_load_dwordx4 v[204:207],v33,s[32:35],s84 offen sc1
 s_waitcnt vmcnt(8)
 v_or_b32 v38,v168,v172
 v_cmp_gt_i32 vcc,0,v38
 s_cbranch_vccz Lok_669
 s_sub_u32 s55,s55,1
 s_cbranch_scc0 Lfix_667
 s_mov_b32 s55,0
Lok_669:
 s_branch Lret_668
Lfix_670:
 s_bfe_u32 s84,s46,0x50000
 s_lshl_b32 s84,s84,12
 buffer_load_dwordx4 v[176:179],v33,s[32:35],s84 offen sc1
 s_bfe_u32 s84,s46,0x50005
 s_lshl_b32 s84,s84,12
 buffer_load_dwordx4 v[180:183],v33,s[32:35],s84 offen sc1
 s_bfe_u32 s84,s46,0x5000a
 s_lshl_b32 s84,s84,12
 buffer_load_dwordx4 v[184:187],v33,s[32:35],s84 offen sc1
 s_bfe_u32 s84,s46,0x5000f
 s_lshl_b32 s84,s84,12
 buffer_load_dwordx4 v[188:191],v33,s[32:35],s84 offen sc1
 s_bfe_u32 s84,s46,0x50014
 s_lshl_b32 s84,s84,12
 buffer_load_dwordx4 v[192:195],v33,s[32:35],s84 offen sc1
 s_bfe_u32 s84,s46,0x50019
 s_lshl_b32 s84,s84,12
 buffer_load_dwordx4 v[196:199],v33,s[32:35],s84 offen sc1
 s_bfe_u32 s84,s47,0x50000
 s_lshl_b32 s84,s84,12
 buffer_load_dwordx4 v[200:203],v33,s[32:35],s84 offen sc1
 s_bfe_u32 s84,s47,0x50005
 s_lshl_b32 s84,s84,12
 buffer_load_dwordx4 v[204:207],v33,s[32:35],s84 offen sc1
 s_bfe_u32 s84,s47,0x5000a
 s_lshl_b32 s84,s84,12
 buffer_load_dwordx4 v[208:211],v33,s[32:35],s84 offen sc1
 buffer_load_dwordx4 v[212:215],v33,s[32:35],s70 offen sc1
 s_waitcnt vmcnt(8)
 v_or_b32 v38,v176,v180
 v_cmp_gt_i32 vcc,0,v38
 s_cbranch_vccz Lok_672
 s_sub_u32 s55,s55,1
 s_cbranch_scc0 Lfix_670
 s_mov_b32 s55,0
Lok_672:
 s_branch Lret_671
Lfix_673:
 s_bfe_u32 s84,s46,0x5000a
 s_lshl_b32 s84,s84,12
 buffer_load_dwordx4 v[184:187],v33,s[32:35],s84 offen sc1
 s_bfe_u32 s84,s46,0x5000f
 s_lshl_b32 s84,s84,12
 buffer_load_dwordx4 v[188:191],v33,s[32:35],s84 offen sc1
 s_bfe_u32 s84,s46,0x50014
 s_lshl_b32 s84,s84,12
 buffer_load_dwordx4 v[192:195],v33,s[32:35],s84 offen sc1
 s_bfe_u32 s84,s46,0x50019
 s_lshl_b32 s84,s84,12
 buffer_load_dwordx4 v[196:199],v33,s[32:35],s84 offen sc1
 s_bfe_u32 s84,s47,0x50000
 s_lshl_b32 s84,s84,12
 buffer_load_dwordx4 v[200:203],v33,s[32:35],s84 offen sc1
 s_bfe_u32 s84,s47,0x50005
 s_lshl_b32 s84,s84,12
 buffer_load_dwordx4 v[204:207],v33,s[32:35],s84 offen sc1
 s_bfe_u32 s84,s47,0x5000a
 s_lshl_b32 s84,s84,12
 buffer_load_dwordx4 v[208:211],v33,s[32:35],s84 offen sc1
 buffer_load_dwordx4 v[212:215],v33,s[32:35],s70 offen sc1
 s_waitcnt vmcnt(6)
 v_or_b32 v38,v184,v188
 v_cmp_gt_i32 vcc,0,v38
 s_cbranch_vccz Lok_675
 s_sub_u32 s55,s55,1
 s_cbranch_scc0 Lfix_673
 s_mov_b32 s55,0
Lok_675:
 s_branch Lret_674
Lfix_677:
 s_bfe_u32 s84,s46,0x50014
 s_lshl_b32 s84,s84,12
 buffer_load_dwordx4 v[192:195],v33,s[32:35],s84 offen sc1
 s_bfe_u32 s84,s46,0x50019
 s_lshl_b32 s84,s84,12
 buffer_load_dwordx4 v[196:199],v33,s[32:35],s84 offen sc1
 s_bfe_u32 s84,s47,0x50000
 s_lshl_b32 s84,s84,12
 buffer_load_dwordx4 v[200:203],v33,s[32:35],s84 offen sc1
 s_bfe_u32 s84,s47,0x50005
 s_lshl_b32 s84,s84,12
 buffer_load_dwordx4 v[204:207],v33,s[32:35],s84 offen sc1
 s_bfe_u32 s84,s47,0x5000a
 s_lshl_b32 s84,s84,12
 buffer_load_dwordx4 v[208:211],v33,s[32:35],s84 offen sc1
 buffer_load_dwordx4 v[212:215],v33,s[32:35],s70 offen sc1
 s_waitcnt vmcnt(4)
 v_or_b32 v38,v192,v196
 v_cmp_gt_i32 vcc,0,v38
 s_cbranch_vccz Lok_679
 s_sub_u32 s55,s55,1
 s_cbranch_scc0 Lfix_677
 s_mov_b32 s55,0
Lok_679:
 s_branch Lret_678
Lfix_680:
 s_bfe_u32 s84,s47,0x50000
 s_lshl_b32 s84,s84,12
 buffer_load_dwordx4 v[200:203],v33,s[32:35],s84 offen sc1
 s_bfe_u32 s84,s47,0x50005
 s_lshl_b32 s84,s84,12
 buffer_load_dwordx4 v[204:207],v33,s[32:35],s84 offen sc1
 s_bfe_u32 s84,s47,0x5000a
 s_lshl_b32 s84,s84,12
 buffer_load_dwordx4 v[208:211],v33,s[32:35],s84 offen sc1
 buffer_load_dwordx4 v[212:215],v33,s[32:35],s70 offen sc1
 s_waitcnt vmcnt(2)
 v_or_b32 v38,v200,v204
 v_cmp_gt_i32 vcc,0,v38
 s_cbranch_vccz Lok_682
 s_sub_u32 s55,s55,1
 s_cbranch_scc0 Lfix_680
 s_mov_b32 s55,0
Lok_682:
 s_branch Lret_681
Lfix_683:
 s_bfe_u32 s84,s47,0x5000a
 s_lshl_b32 s84,s84,12
 buffer_load_dwordx4 v[208:211],v33,s[32:35],s84 offen sc1
 buffer_load_dwordx4 v[212:215],v33,s[32:35],s70 offen sc1
 s_waitcnt vmcnt(0)
 v_or_b32 v38,v208,v212
 v_cmp_gt_i32 vcc,0,v38
 s_cbranch_vccz Lok_685
 s_sub_u32 s55,s55,1
 s_cbranch_scc0 Lfix_683
 s_mov_b32 s55,0
Lok_685:
 s_branch Lret_684
L_codeend:
.section .rodata,"a"
.p2align 6
.amdhsa_kernel interleave_layers__linear_attn_block__dense_activation_relu__prompt_kernel
  .amdhsa_next_free_vgpr 512
  .amdhsa_next_free_sgpr 102
  .amdhsa_accum_offset 256
  .amdhsa_group_segment_fixed_size 0
  .amdhsa_kernarg_size 72
  .amdhsa_user_sgpr_count 2
  .amdhsa_user_sgpr_kernarg_segment_ptr 1
  .amdhsa_system_sgpr_workgroup_id_x 1
  .amdhsa_float_denorm_mode_32 3
.end_amdhsa_kernel
```
